```python
import torch

def _softmax(x, axis=-1):
    return torch.softmax(x, dim=axis)
def _gelu(x):
    return torch.nn.functional.gelu(x, approximate="tanh")
def _silu(x):
    return torch.nn.functional.silu(x)
def _sigmoid(x):
    return torch.sigmoid(x)
def _layernorm(x, axis=-1, eps=1e-5):
    m = x.mean(dim=axis, keepdim=True)
    v = x.var(dim=axis, keepdim=True, unbiased=False)
    return (x - m) / torch.sqrt(v + eps)
def _scatter_add(tgt, idx, src, axis=0):
    return tgt.clone().index_add_(axis, idx, src)
def _segment_sum(src, seg, n):
    out = torch.zeros((n,) + src.shape[1:], dtype=src.dtype)
    return out.index_add_(0, seg, src)
def _pad(x, pw):
    flat = tuple(v for pair in reversed(pw) for v in pair)
    return torch.nn.functional.pad(x, flat)

kernel_name = 'parallel_sum__compressed_kv_cla__moe_arch_mod__prompt'

def setup_inputs():

    _w = (lambda a: (lambda t: t.to(torch.bfloat16) if t.is_floating_point() else t)(torch.as_tensor(a)))
    def _A_setup():
        B, H, Sq, Sk, D, M = 1, 32, 2048, 2048, 128, 512
        Dc = 4 * D
        return {
            "x": _w((lambda *s: torch.randn(*s, dtype=torch.bfloat16) * 0.05)(B, Sq, M)),
            "c_kv": _w((lambda *s: torch.randn(*s, dtype=torch.bfloat16) * 1.6)(B, Sk, Dc)),
            "w_q": _w((lambda *s: torch.randn(*s, dtype=torch.bfloat16) * 0.8)(M, H, D) * (M ** -0.5)),
            "w_uk": _w((lambda *s: torch.randn(*s, dtype=torch.bfloat16) * 0.8)(Dc, H, D) * (Dc ** -0.5)),
            "w_uv": _w((lambda *s: torch.randn(*s, dtype=torch.bfloat16) * 1.6)(Dc, H, D) * (Dc ** -0.5)),
            "w_o": _w((lambda *s: torch.randn(*s, dtype=torch.bfloat16) * 1.6)(H, D, M) * ((H * D) ** -0.5)),
        }
    _A_in = _A_setup()

    def _B_setup():
        B, S, D, F, C = 1, 2048, 512, 1376, 8
        return {
            "x": _w((lambda *s: torch.randn(*s, dtype=torch.bfloat16) * 0.05)(B, S, D)),
            "w_r": _w((lambda *s: torch.randn(*s, dtype=torch.bfloat16) * 0.05)(D)),
            "w_gate": _w((lambda *s: torch.randn(*s, dtype=torch.bfloat16) * 0.05)(D, F)),
            "w_up": _w((lambda *s: torch.randn(*s, dtype=torch.bfloat16) * 0.05)(D, F)),
            "w_down": _w((lambda *s: torch.randn(*s, dtype=torch.bfloat16) * 0.05)(F, D)),
        }
    _B_in = _B_setup()

    return {
        "A_x": _A_in["x"],
        "A_c_kv": _A_in["c_kv"],
        "A_w_q": _A_in["w_q"],
        "A_w_uk": _A_in["w_uk"],
        "A_w_uv": _A_in["w_uv"],
        "A_w_o": _A_in["w_o"],
        "B_x": _B_in["x"],
        "B_w_r": _B_in["w_r"],
        "B_w_gate": _B_in["w_gate"],
        "B_w_up": _B_in["w_up"],
        "B_w_down": _B_in["w_down"],
    }

def reference(A_x, A_c_kv, A_w_q, A_w_uk, A_w_uv, A_w_o, B_x, B_w_r, B_w_gate, B_w_up, B_w_down):
    def _A_ref(x, c_kv, w_q, w_uk, w_uv, w_o):
        B, Sq, M = x.shape[0], x.shape[1], x.shape[2]
        Sk = c_kv.shape[1]
        H, D = w_q.shape[1], w_q.shape[2]
        q = torch.einsum("bqm,mhd->bhqd", x, w_q)
        k = torch.einsum("bkc,chd->bhkd", c_kv, w_uk)
        v = torch.einsum("bkc,chd->bhkd", c_kv, w_uv)
        scores = torch.einsum("bhqd,bhkd->bhqk", q, k) * (D ** -0.5)
        off = Sk - Sq
        qi = torch.arange(Sq)[:, None]
        kj = torch.arange(Sk)[None, :]
        cmask = kj <= (qi + off)
        scores = torch.where(cmask[None, None], scores, -1e9)
        p = _softmax(scores, axis=-1)
        ctx = torch.einsum("bhqk,bhkd->bhqd", p, v)
        return torch.einsum("bhqd,hdm->bqm", ctx, w_o)

    def _B_ref(x, w_r, w_gate, w_up, w_down):
        B, S, D = x.shape
        C = 8
        r = x @ w_r
        idx = torch.argsort(-r, axis=-1)[:, :C]
        idx_e = (lambda x, n, axis: torch.repeat_interleave(x, n, dim=axis))(idx.reshape(B, C, 1), D, axis=2)
        x_sel = (lambda x, i, axis: torch.take_along_dim(x, i, dim=axis))(x, idx_e, axis=1)
        g = _silu(x_sel @ w_gate)
        u = x_sel @ w_up
        y = (g * u) @ w_down
        r_sel = _sigmoid((lambda x, i, axis: torch.take_along_dim(x, i, dim=axis))(r, idx, axis=1))
        y = y * r_sel.reshape(B, C, 1)
        b_off = (torch.arange(B) * S).reshape(B, 1)
        flat_idx = (idx + b_off).reshape(B * C)
        zero = (x * 0.0).reshape(B * S, D)
        upd = _scatter_add(zero, flat_idx, y.reshape(B * C, D), axis=0)
        return x + upd.reshape(B, S, D)

    x = A_x
    xn = _layernorm(x, axis=-1)
    return x + _A_ref(xn, A_c_kv, A_w_q, A_w_uk, A_w_uv, A_w_o) + _B_ref(xn, B_w_r, B_w_gate, B_w_up, B_w_down)
```

```asm
; @launch grid=(256,1,1) block=(256,1,1) lds=163840
.amdgcn_target "amdgcn-amd-amdhsa--gfx950"
.text
.globl parallel_sum__compressed_kv_cla__moe_arch_mod__prompt_kernel
.p2align 8
.type parallel_sum__compressed_kv_cla__moe_arch_mod__prompt_kernel,@function
parallel_sum__compressed_kv_cla__moe_arch_mod__prompt_kernel:
  s_cmp_ge_u32 s2, 256
  s_cbranch_scc1 Lend
  s_load_dwordx4 s[84:87], s[0:1], 0
  s_load_dwordx4 s[88:91], s[0:1], 16
  s_load_dwordx2 s[92:93], s[0:1], 32
  s_load_dwordx2 s[82:83], s[0:1], 56
  s_load_dwordx2 s[62:63], s[0:1], 96
  s_load_dwordx2 s[38:39], s[0:1], 104
  v_lshrrev_b32 v96, 6, v0
  v_and_b32 v0, 63, v0
  v_readfirstlane_b32 s40, v96
  v_lshlrev_b32 v1, 4, v0
  v_lshrrev_b32 v96, 4, v0
  v_and_b32 v98, 3, v0
  v_and_b32 v99, 7, v0
  v_xor_b32 v99, v99, v96
  v_lshlrev_b32 v99, 4, v99
  v_lshrrev_b32_e64 v100, 3, v0
  v_lshl_add_u32 v10, v100, 10, v99
  v_xor_b32_e64 v11, 64, v10
  v_add_u32 v11, 7168, v11
  v_add_u32 v12, 14336, v10
  v_add_u32 v13, 14336, v11
  v_lshlrev_b32_e64 v99, 13, v100
  v_bfe_u32 v100, v0, 1, 2
  v_and_b32 v97, 1, v96
  v_xor_b32 v100, v100, v97
  v_lshl_add_u32 v99, v100, 5, v99
  v_and_b32_e64 v100, 1, v0
  v_lshl_add_u32 v6, v100, 4, v99
  v_xor_b32_e64 v7, 64, v6
  v_add_u32 v7, 64512, v7
  v_add_u32 v8, 129024, v6
  v_add_u32 v9, 129024, v7
  s_bfe_u32 s64, s2, 0x20001
  s_lshl_b32 s64, s64, 3
  s_bfe_u32 s42, s2, 0x30003
  s_add_u32 s64, s64, s42
  s_and_b32 s65, s2, 1
  s_lshl_b32 s65, s65, 2
  s_lshr_b32 s42, s2, 6
  s_add_u32 s65, s65, s42
  s_mul_i32 s71, s65, 2
  s_add_u32 s71, s71, s64
  s_lshr_b32 s81, s40, 1
  s_add_u32 s81, s81, s71
  s_lshl_b32 s66, s40, 14
  s_add_u32 s66, s66, 98304
  s_lshl_b32 s68, s65, 18
  s_lshl_b32 s43, s40, 16
  s_add_u32 s68, s68, s43
  s_lshl_b32 s44, s40, 12
  s_and_b32 s67, s40, 1
  s_lshl_b32 s67, s67, 18
  s_lshl_b32 s43, s64, 8
  s_add_u32 s67, s67, s43
  s_waitcnt lgkmcnt(0)
  s_mov_b32 s8, s86
  s_and_b32 s9, s87, 0xffff
  s_mov_b32 s10, 0x200000
  s_mov_b32 s11, 0x20000
  s_mov_b32 s16, s90
  s_and_b32 s17, s91, 0xffff
  s_mov_b32 s18, 0x400000
  s_mov_b32 s19, 0x20000
  s_mov_b32 s28, s84
  s_and_b32 s29, s85, 0xffff
  s_mov_b32 s30, 0x200000
  s_mov_b32 s31, 0x20000
  s_mov_b32 s32, s82
  s_and_b32 s33, s83, 0xffff
  s_mov_b32 s34, 0x400
  s_mov_b32 s35, 0x20000
  s_lshl_b32 s74, s2, 3
  s_lshl_b32 s72, s40, 1
  s_add_u32 s74, s74, s72
  s_lshl_b32 s72, s74, 10
  buffer_load_dwordx4 v[160:163], v1, s[28:31], s72 offen
  buffer_load_dwordx4 v[164:167], v1, s[28:31], s72 offen offset:1024
  buffer_load_dwordx4 v[168:171], v1, s[32:35], 0 offen
  s_add_u32 m0, s66, 0
  s_add_u32 s42, s71, 0
  s_and_b32 s42, s42, 7
  s_lshl_b32 s42, s42, 7
  s_add_u32 s42, s42, s68
  buffer_load_dwordx4 v10, s[8:11], s42 offen offset:0 lds
  buffer_load_dwordx4 v11, s[8:11], s42 offen offset:1024 lds
  buffer_load_dwordx4 v12, s[8:11], s42 offen offset:2048 lds
  buffer_load_dwordx4 v13, s[8:11], s42 offen offset:3072 lds
  s_add_u32 m0, s66, 4096
  s_add_u32 s42, s42, 32768
  buffer_load_dwordx4 v10, s[8:11], s42 offen offset:0 lds
  buffer_load_dwordx4 v11, s[8:11], s42 offen offset:1024 lds
  buffer_load_dwordx4 v12, s[8:11], s42 offen offset:2048 lds
  buffer_load_dwordx4 v13, s[8:11], s42 offen offset:3072 lds
  s_add_u32 m0, s44, 0
  s_add_u32 s42, s81, 0
  s_and_b32 s42, s42, 7
  s_lshl_b32 s42, s42, 19
  s_add_u32 s42, s42, s67
  buffer_load_dwordx4 v6, s[16:19], s42 offen offset:0 lds
  buffer_load_dwordx4 v7, s[16:19], s42 offen offset:1024 lds
  buffer_load_dwordx4 v8, s[16:19], s42 offen offset:2048 lds
  buffer_load_dwordx4 v9, s[16:19], s42 offen offset:3072 lds
  s_add_u32 m0, s44, 16384
  s_add_u32 s42, s42, 128
  buffer_load_dwordx4 v6, s[16:19], s42 offen offset:0 lds
  buffer_load_dwordx4 v7, s[16:19], s42 offen offset:1024 lds
  buffer_load_dwordx4 v8, s[16:19], s42 offen offset:2048 lds
  buffer_load_dwordx4 v9, s[16:19], s42 offen offset:3072 lds
  s_mov_b32 s12, s38
  s_and_b32 s13, s39, 0xffff
  s_mov_b32 s14, 0x1000000
  s_mov_b32 s15, 0x20000
  s_waitcnt vmcnt(16)
  v_lshlrev_b32_e64 v172, 16, v160
  v_and_b32 v173, 0xffff0000, v160
  v_lshlrev_b32_e64 v174, 16, v161
  v_and_b32 v175, 0xffff0000, v161
  v_lshlrev_b32_e64 v176, 16, v162
  v_and_b32 v177, 0xffff0000, v162
  v_lshlrev_b32_e64 v178, 16, v163
  v_and_b32 v179, 0xffff0000, v163
  v_lshlrev_b32_e64 v180, 16, v164
  v_and_b32 v181, 0xffff0000, v164
  v_lshlrev_b32_e64 v182, 16, v165
  v_and_b32 v183, 0xffff0000, v165
  v_lshlrev_b32_e64 v184, 16, v166
  v_and_b32 v185, 0xffff0000, v166
  v_lshlrev_b32_e64 v186, 16, v167
  v_and_b32 v187, 0xffff0000, v167
  v_add_f32 v196, v172, v173
  v_add_f32 v197, v180, v181
  v_add_f32 v196, v196, v174
  v_add_f32 v197, v197, v182
  v_add_f32 v196, v196, v175
  v_add_f32 v197, v197, v183
  v_add_f32 v196, v196, v176
  v_add_f32 v197, v197, v184
  v_add_f32 v196, v196, v177
  v_add_f32 v197, v197, v185
  v_add_f32 v196, v196, v178
  v_add_f32 v197, v197, v186
  v_add_f32 v196, v196, v179
  v_add_f32_e64 v197, v197, v187
  s_nop 0
  v_add_f32_dpp v196, v196, v196 row_shr:1 row_mask:0xf bank_mask:0xf bound_ctrl:0
  v_add_f32_dpp v197, v197, v197 row_shr:1 row_mask:0xf bank_mask:0xf bound_ctrl:0
  s_nop 0
  v_add_f32_dpp v196, v196, v196 row_shr:2 row_mask:0xf bank_mask:0xf bound_ctrl:0
  v_add_f32_dpp v197, v197, v197 row_shr:2 row_mask:0xf bank_mask:0xf bound_ctrl:0
  s_nop 0
  v_add_f32_dpp v196, v196, v196 row_shr:4 row_mask:0xf bank_mask:0xf bound_ctrl:0
  v_add_f32_dpp v197, v197, v197 row_shr:4 row_mask:0xf bank_mask:0xf bound_ctrl:0
  s_nop 0
  v_add_f32_dpp v196, v196, v196 row_shr:8 row_mask:0xf bank_mask:0xf bound_ctrl:0
  v_add_f32_dpp v197, v197, v197 row_shr:8 row_mask:0xf bank_mask:0xf bound_ctrl:0
  s_nop 0
  v_add_f32_dpp v196, v196, v196 row_bcast:15 row_mask:0xa bank_mask:0xf
  v_add_f32_dpp v197, v197, v197 row_bcast:15 row_mask:0xa bank_mask:0xf
  s_nop 0
  v_add_f32_dpp v196, v196, v196 row_bcast:31 row_mask:0xc bank_mask:0xf
  v_add_f32_dpp v197, v197, v197 row_bcast:31 row_mask:0xc bank_mask:0xf
  s_nop 0
  v_readlane_b32 s75, v196, 63
  v_readlane_b32 s76, v197, 63
  v_lshlrev_b32_e64 v188, 16, v168
  v_and_b32 v189, 0xffff0000, v168
  v_lshlrev_b32_e64 v190, 16, v169
  v_and_b32 v191, 0xffff0000, v169
  v_lshlrev_b32_e64 v192, 16, v170
  v_and_b32 v193, 0xffff0000, v170
  v_lshlrev_b32_e64 v194, 16, v171
  v_and_b32 v195, 0xffff0000, v171
  v_mov_b32 v198, s75
  v_mov_b32 v199, s76
  v_mul_f32 v198, 0x3b000000, v198
  v_mul_f32 v199, 0x3b000000, v199
  v_sub_f32 v200, v172, v198
  v_sub_f32 v208, v180, v199
  v_sub_f32 v201, v173, v198
  v_sub_f32 v209, v181, v199
  v_sub_f32 v202, v174, v198
  v_sub_f32 v210, v182, v199
  v_sub_f32 v203, v175, v198
  v_sub_f32 v211, v183, v199
  v_sub_f32 v204, v176, v198
  v_sub_f32 v212, v184, v199
  v_sub_f32 v205, v177, v198
  v_sub_f32 v213, v185, v199
  v_sub_f32 v206, v178, v198
  v_sub_f32 v214, v186, v199
  v_sub_f32 v207, v179, v198
  v_sub_f32 v215, v187, v199
  v_mul_f32 v196, v200, v200
  v_mul_f32 v197, v208, v208
  v_fmac_f32 v196, v201, v201
  v_fmac_f32 v197, v209, v209
  v_fmac_f32 v196, v202, v202
  v_fmac_f32 v197, v210, v210
  v_fmac_f32 v196, v203, v203
  v_fmac_f32 v197, v211, v211
  v_fmac_f32 v196, v204, v204
  v_fmac_f32 v197, v212, v212
  v_fmac_f32 v196, v205, v205
  v_fmac_f32 v197, v213, v213
  v_fmac_f32 v196, v206, v206
  v_fmac_f32 v197, v214, v214
  v_fmac_f32 v196, v207, v207
  v_fmac_f32_e64 v197, v215, v215
  s_nop 0
  v_add_f32_dpp v196, v196, v196 row_shr:1 row_mask:0xf bank_mask:0xf bound_ctrl:0
  v_add_f32_dpp v197, v197, v197 row_shr:1 row_mask:0xf bank_mask:0xf bound_ctrl:0
  s_nop 0
  v_add_f32_dpp v196, v196, v196 row_shr:2 row_mask:0xf bank_mask:0xf bound_ctrl:0
  v_add_f32_dpp v197, v197, v197 row_shr:2 row_mask:0xf bank_mask:0xf bound_ctrl:0
  s_nop 0
  v_add_f32_dpp v196, v196, v196 row_shr:4 row_mask:0xf bank_mask:0xf bound_ctrl:0
  v_add_f32_dpp v197, v197, v197 row_shr:4 row_mask:0xf bank_mask:0xf bound_ctrl:0
  s_nop 0
  v_add_f32_dpp v196, v196, v196 row_shr:8 row_mask:0xf bank_mask:0xf bound_ctrl:0
  v_add_f32_dpp v197, v197, v197 row_shr:8 row_mask:0xf bank_mask:0xf bound_ctrl:0
  s_nop 0
  v_add_f32_dpp v196, v196, v196 row_bcast:15 row_mask:0xa bank_mask:0xf
  v_add_f32_dpp v197, v197, v197 row_bcast:15 row_mask:0xa bank_mask:0xf
  s_nop 0
  v_add_f32_dpp v196, v196, v196 row_bcast:31 row_mask:0xc bank_mask:0xf
  v_add_f32_dpp v197, v197, v197 row_bcast:31 row_mask:0xc bank_mask:0xf
  s_nop 0
  v_readlane_b32 s75, v196, 63
  v_readlane_b32 s76, v197, 63
  v_cvt_pk_bf16_f32 v198, v198, v198
  v_cvt_pk_bf16_f32 v199, v199, v199
  v_lshlrev_b32 v198, 16, v198
  v_lshlrev_b32 v199, 16, v199
  v_sub_f32 v200, v172, v198
  v_sub_f32 v208, v180, v199
  v_sub_f32 v201, v173, v198
  v_sub_f32 v209, v181, v199
  v_sub_f32 v202, v174, v198
  v_sub_f32 v210, v182, v199
  v_sub_f32 v203, v175, v198
  v_sub_f32 v211, v183, v199
  v_sub_f32 v204, v176, v198
  v_sub_f32 v212, v184, v199
  v_sub_f32 v205, v177, v198
  v_sub_f32 v213, v185, v199
  v_sub_f32 v206, v178, v198
  v_sub_f32 v214, v186, v199
  v_sub_f32 v207, v179, v198
  v_sub_f32 v215, v187, v199
  v_mov_b32 v198, s75
  v_mov_b32 v199, s76
  v_mul_f32 v198, 0x3b000000, v198
  v_mul_f32 v199, 0x3b000000, v199
  v_cvt_pk_bf16_f32 v198, v198, v198
  v_cvt_pk_bf16_f32 v199, v199, v199
  v_lshlrev_b32 v198, 16, v198
  v_lshlrev_b32 v199, 16, v199
  v_add_f32 v198, 0x3727c5ac, v198
  v_add_f32 v199, 0x3727c5ac, v199
  v_cvt_pk_bf16_f32 v198, v198, v198
  v_cvt_pk_bf16_f32 v199, v199, v199
  v_lshlrev_b32 v198, 16, v198
  v_lshlrev_b32 v199, 16, v199
  v_sqrt_f32 v198, v198
  v_sqrt_f32 v199, v199
  v_cvt_pk_bf16_f32 v216, v200, v201
  v_cvt_pk_bf16_f32 v220, v208, v209
  v_cvt_pk_bf16_f32 v217, v202, v203
  v_cvt_pk_bf16_f32 v221, v210, v211
  v_cvt_pk_bf16_f32 v218, v204, v205
  v_cvt_pk_bf16_f32 v222, v212, v213
  v_cvt_pk_bf16_f32 v219, v206, v207
  v_cvt_pk_bf16_f32 v223, v214, v215
  v_cvt_pk_bf16_f32 v198, v198, v198
  v_cvt_pk_bf16_f32 v199, v199, v199
  v_lshlrev_b32 v198, 16, v198
  v_lshlrev_b32 v199, 16, v199
  v_rcp_f32 v198, v198
  v_rcp_f32 v199, v199
  v_lshlrev_b32_e64 v200, 16, v216
  v_and_b32 v201, 0xffff0000, v216
  v_lshlrev_b32_e64 v208, 16, v220
  v_and_b32 v209, 0xffff0000, v220
  v_lshlrev_b32_e64 v202, 16, v217
  v_and_b32 v203, 0xffff0000, v217
  v_lshlrev_b32_e64 v210, 16, v221
  v_and_b32 v211, 0xffff0000, v221
  v_lshlrev_b32_e64 v204, 16, v218
  v_and_b32 v205, 0xffff0000, v218
  v_lshlrev_b32_e64 v212, 16, v222
  v_and_b32 v213, 0xffff0000, v222
  v_lshlrev_b32_e64 v206, 16, v219
  v_and_b32 v207, 0xffff0000, v219
  v_lshlrev_b32_e64 v214, 16, v223
  v_and_b32 v215, 0xffff0000, v223
  v_mul_f32 v200, v200, v198
  v_mul_f32 v208, v208, v199
  v_mul_f32 v201, v201, v198
  v_mul_f32 v209, v209, v199
  v_mul_f32 v202, v202, v198
  v_mul_f32 v210, v210, v199
  v_mul_f32 v203, v203, v198
  v_mul_f32 v211, v211, v199
  v_mul_f32 v204, v204, v198
  v_mul_f32 v212, v212, v199
  v_mul_f32 v205, v205, v198
  v_mul_f32 v213, v213, v199
  v_mul_f32 v206, v206, v198
  v_mul_f32 v214, v214, v199
  v_mul_f32 v207, v207, v198
  v_mul_f32 v215, v215, v199
  v_cvt_pk_bf16_f32 v216, v200, v201
  v_cvt_pk_bf16_f32 v220, v208, v209
  v_cvt_pk_bf16_f32 v217, v202, v203
  v_cvt_pk_bf16_f32 v221, v210, v211
  v_cvt_pk_bf16_f32 v218, v204, v205
  v_cvt_pk_bf16_f32 v222, v212, v213
  v_cvt_pk_bf16_f32 v219, v206, v207
  v_cvt_pk_bf16_f32 v223, v214, v215
  s_lshl_b32 s72, s74, 10
  s_add_u32 s72, s72, 0x200000
  s_lshl_b32 s73, s40, 5
  s_add_u32 s73, s73, 81920
  v_lshlrev_b32 v24, 7, v0
  v_add_u32 v24, s73, v24
  ds_write_b128 v24, v[216:219] offset:0
  ds_write_b128 v24, v[220:223] offset:16
  v_lshlrev_b32_e64 v200, 16, v216
  v_and_b32 v201, 0xffff0000, v216
  v_lshlrev_b32_e64 v208, 16, v220
  v_and_b32 v209, 0xffff0000, v220
  v_lshlrev_b32_e64 v202, 16, v217
  v_and_b32 v203, 0xffff0000, v217
  v_lshlrev_b32_e64 v210, 16, v221
  v_and_b32 v211, 0xffff0000, v221
  v_lshlrev_b32_e64 v204, 16, v218
  v_and_b32 v205, 0xffff0000, v218
  v_lshlrev_b32_e64 v212, 16, v222
  v_and_b32 v213, 0xffff0000, v222
  v_lshlrev_b32_e64 v206, 16, v219
  v_and_b32 v207, 0xffff0000, v219
  v_lshlrev_b32_e64 v214, 16, v223
  v_and_b32 v215, 0xffff0000, v223
  v_mul_f32 v196, v200, v188
  v_mul_f32 v197, v208, v188
  v_fmac_f32 v196, v201, v189
  v_fmac_f32 v197, v209, v189
  v_fmac_f32 v196, v202, v190
  v_fmac_f32 v197, v210, v190
  v_fmac_f32 v196, v203, v191
  v_fmac_f32 v197, v211, v191
  v_fmac_f32 v196, v204, v192
  v_fmac_f32 v197, v212, v192
  v_fmac_f32 v196, v205, v193
  v_fmac_f32 v197, v213, v193
  v_fmac_f32 v196, v206, v194
  v_fmac_f32 v197, v214, v194
  v_fmac_f32 v196, v207, v195
  v_fmac_f32_e64 v197, v215, v195
  s_nop 0
  v_add_f32_dpp v196, v196, v196 row_shr:1 row_mask:0xf bank_mask:0xf bound_ctrl:0
  v_add_f32_dpp v197, v197, v197 row_shr:1 row_mask:0xf bank_mask:0xf bound_ctrl:0
  s_nop 0
  v_add_f32_dpp v196, v196, v196 row_shr:2 row_mask:0xf bank_mask:0xf bound_ctrl:0
  v_add_f32_dpp v197, v197, v197 row_shr:2 row_mask:0xf bank_mask:0xf bound_ctrl:0
  s_nop 0
  v_add_f32_dpp v196, v196, v196 row_shr:4 row_mask:0xf bank_mask:0xf bound_ctrl:0
  v_add_f32_dpp v197, v197, v197 row_shr:4 row_mask:0xf bank_mask:0xf bound_ctrl:0
  s_nop 0
  v_add_f32_dpp v196, v196, v196 row_shr:8 row_mask:0xf bank_mask:0xf bound_ctrl:0
  v_add_f32_dpp v197, v197, v197 row_shr:8 row_mask:0xf bank_mask:0xf bound_ctrl:0
  s_nop 0
  v_add_f32_dpp v196, v196, v196 row_bcast:15 row_mask:0xa bank_mask:0xf
  v_add_f32_dpp v197, v197, v197 row_bcast:15 row_mask:0xa bank_mask:0xf
  s_nop 0
  v_add_f32_dpp v196, v196, v196 row_bcast:31 row_mask:0xc bank_mask:0xf
  v_add_f32_dpp v197, v197, v197 row_bcast:31 row_mask:0xc bank_mask:0xf
  s_nop 0
  v_cvt_pk_bf16_f32 v196, v196, v196
  v_cvt_pk_bf16_f32 v197, v197, v197
  v_lshlrev_b32 v196, 16, v196
  v_lshlrev_b32 v197, 16, v197
  v_ashrrev_i32_e64 v198, 31, v196
  v_and_b32 v198, 0x7fff0000, v198
  v_or_b32 v198, 0x80000000, v198
  v_xor_b32_e64 v196, v196, v198
  s_sub_u32 s73, 2047, s74
  v_or_b32 v196, s73, v196
  v_ashrrev_i32 v199, 31, v197
  v_and_b32 v199, 0x7fff0000, v199
  v_or_b32 v199, 0x80000000, v199
  v_xor_b32_e64 v197, v197, v199
  s_sub_u32 s73, 2046, s74
  v_or_b32 v197, s73, v197
  s_lshl_b32 s72, s74, 2
  s_add_u32 s72, s72, 0x400000
  v_cmp_ne_u32_e64 vcc, 63, v0
  v_mov_b32 v25, 0x7fff0000
  s_nop 0
  v_cndmask_b32 v24, 0, v25, vcc
  s_add_u32 m0, s66, 8192
  s_add_u32 s42, s71, 1
  s_and_b32 s42, s42, 7
  s_lshl_b32 s42, s42, 7
  s_add_u32 s42, s42, s68
  buffer_load_dwordx4 v10, s[8:11], s42 offen offset:0 lds
  buffer_load_dwordx4 v11, s[8:11], s42 offen offset:1024 lds
  buffer_load_dwordx4 v12, s[8:11], s42 offen offset:2048 lds
  buffer_load_dwordx4 v13, s[8:11], s42 offen offset:3072 lds
  s_add_u32 m0, s66, 12288
  s_add_u32 s42, s42, 32768
  buffer_load_dwordx4 v10, s[8:11], s42 offen offset:0 lds
  buffer_load_dwordx4 v11, s[8:11], s42 offen offset:1024 lds
  buffer_load_dwordx4 v12, s[8:11], s42 offen offset:2048 lds
  buffer_load_dwordx4 v13, s[8:11], s42 offen offset:3072 lds
  s_getpc_b64 s[36:37]
  s_lshr_b32 s43, s2, 3
  s_lshl_b32 s43, s43, 2
  s_add_u32 s43, s43, s40
  s_mul_i32 s43, s43, 384
  v_min_u32 v26, 2, v0
  v_lshlrev_b32 v26, 7, v26
  v_add_u32_e64 v26, s43, v26
  global_load_dword v27, v26, s[36:37]
  buffer_store_dwordx2 v[196:197], v24, s[12:15], s72 offen sc1
  v_bfe_u32 v97, v0, 2, 2
  v_lshl_add_u32 v99, v96, 3, v97
  v_lshlrev_b32_e64 v99, 7, v99
  v_bfe_u32 v100, v0, 3, 2
  v_lshl_add_u32 v99, v100, 5, v99
  v_lshl_add_u32 v14, v98, 3, v99
  v_xor_b32 v15, 32, v14
  v_xor_b32 v16, 64, v14
  v_xor_b32 v17, 96, v14
  v_add_u32 v20, 0x10000, v14
  v_add_u32 v21, 0x10000, v15
  v_add_u32 v22, 0x10000, v16
  v_add_u32 v23, 0x10000, v17
  v_and_b32 v99, 15, v0
  v_lshlrev_b32 v99, 7, v99
  v_bfe_u32 v98, v0, 1, 3
  v_xor_b32_e64 v100, v96, v98
  v_lshl_add_u32 v99, v100, 4, v99
  v_add_u32 v18, s66, v99
  v_xor_b32_e64 v19, 64, v18
  s_lshl_b32 s96, s64, 20
  s_lshl_b32 s43, s65, 17
  s_add_u32 s96, s96, s43
  s_lshl_b32 s43, s40, 15
  s_add_u32 s96, s96, s43
  s_mov_b32 s70, 0x3e0293ee
  s_mov_b32 s20, s92
  s_and_b32 s21, s93, 0xffff
  s_mov_b32 s22, 0x400000
  s_mov_b32 s23, 0x20000
  s_add_u32 s24, s38, 0x1000000
  s_addc_u32 s25, s39, 0
  s_and_b32 s25, s25, 0xffff
  s_mov_b32 s26, 0x2000000
  s_mov_b32 s27, 0x20000
  s_and_b32 s59, s2, 7
  s_lshl_b32 s59, s59, 2
  s_bfe_u32 s43, s2, 0x20003
  s_add_u32 s59, s59, s43
  s_xor_b32 s59, s59, 2
  s_lshr_b32 s41, s2, 5
  s_mov_b32 s61, s41
  s_lshl_b32 s45, s40, 18
  s_lshl_b32 s43, s59, 8
  s_add_u32 s45, s45, s43
  s_lshl_b32 s43, s41, 2
  s_add_u32 s51, s43, s40
  s_sub_u32 s52, 60, s43
  s_add_u32 s52, s52, s40
  s_add_u32 s54, s43, 4
  s_lshl_b32 s46, s51, 15
  s_lshl_b32 s47, s52, 15
  s_lshl_b32 s48, s40, 12
  s_add_u32 s48, s48, 65536
  s_add_u32 s49, s48, 16384
  s_mov_b32 s55, 0x49800000
  s_and_b32 s56, s40, 1
  s_lshl_b32 s56, s56, 13
  s_lshl_b32 s43, s59, 13
  s_lshl_b32 s57, s51, 18
  s_add_u32 s57, s57, s43
  s_lshl_b32 s58, s52, 18
  s_add_u32 s58, s58, s43
  s_mov_b32 s53, s51
  s_mov_b32 s50, 0
  s_lshl_b32 s97, s64, 3
  s_add_u32 s97, s97, s65
  s_lshl_b32 s97, s97, 2
  s_add_u32 s97, s97, 0x430000
  v_mov_b32 v96, 0x7fff0000
  s_lshl_b32 s43, s40, 6
  v_add_u32 v97, s43, v0
  v_cmp_ne_u32 vcc, 0, v97
  v_mov_b32 v28, 0
  v_mov_b32 v29, 0
  v_mov_b32 v30, 0
  v_mov_b32 v31, 0
  v_cndmask_b32_e64 v3, 0, v96, vcc
  s_mul_i32 s43, s2, 192
  s_add_u32 s43, s43, 0x430000
  s_mov_b32 s77, s43
  v_cmp_gt_u32 vcc, 12, v97
  s_nop 1
  v_cndmask_b32 v26, v96, v1, vcc
  s_lshl_b32 s60, s2, 2
  s_add_u32 s60, s60, s40
  s_lshl_b32 s60, s60, 9
  v_lshrrev_b32 v101, 1, v0
  v_lshlrev_b32 v101, 13, v101
  v_and_b32 v96, 1, v0
  v_lshl_add_u32 v101, v96, 7, v101
  v_and_b32 v2, 0x1e080, v101
  s_lshl_b32 s43, s41, 2
  s_add_u32 s43, s43, s40
  s_lshl_b32 s43, s43, 17
  s_lshl_b32 s69, s59, 8
  s_add_u32 s43, s43, s69
  v_add_u32 v2, s43, v2
  s_waitcnt vmcnt(10) lgkmcnt(0)
  s_barrier
Lgemm:
  ds_read_b64_tr_b16 v[224:225], v14 offset:0
  ds_read_b64_tr_b16 v[226:227], v14 offset:512
  ds_read_b64_tr_b16 v[228:229], v15 offset:0
  ds_read_b64_tr_b16 v[230:231], v15 offset:512
  ds_read_b64_tr_b16 v[232:233], v14 offset:4096
  ds_read_b64_tr_b16 v[234:235], v14 offset:4608
  ds_read_b64_tr_b16 v[236:237], v15 offset:4096
  ds_read_b64_tr_b16 v[238:239], v15 offset:4608
  ds_read_b128 a[0:3], v18 offset:0
  ds_read_b128 a[4:7], v18 offset:2048
  ds_read_b128 a[8:11], v18 offset:4096
  ds_read_b128 a[12:15], v18 offset:6144
  ds_read_b128 a[16:19], v19 offset:0
  ds_read_b128 a[20:23], v19 offset:2048
  ds_read_b128 a[24:27], v19 offset:4096
  ds_read_b128 a[28:31], v19 offset:6144
  s_waitcnt lgkmcnt(0)
  v_mfma_f32_16x16x32_bf16 v[32:35], v[224:227], a[0:3], 0
  ds_read_b64_tr_b16 v[240:241], v16 offset:0
  ds_read_b64_tr_b16 v[242:243], v16 offset:512
  v_mfma_f32_16x16x32_bf16 v[32:35], v[232:235], a[16:19], v[32:35]
  ds_read_b64_tr_b16 v[244:245], v17 offset:0
  ds_read_b64_tr_b16 v[246:247], v17 offset:512
  v_mfma_f32_16x16x32_bf16 v[40:43], v[224:227], a[4:7], 0
  ds_read_b64_tr_b16 v[248:249], v16 offset:4096
  ds_read_b64_tr_b16 v[250:251], v16 offset:4608
  v_mfma_f32_16x16x32_bf16 v[40:43], v[232:235], a[20:23], v[40:43]
  s_add_u32 m0, s66, 0
  s_add_u32 s42, s71, 2
  v_mfma_f32_16x16x32_bf16 v[48:51], v[224:227], a[8:11], 0
  ds_read_b64_tr_b16 v[252:253], v17 offset:4096
  ds_read_b64_tr_b16 v[254:255], v17 offset:4608
  v_mfma_f32_16x16x32_bf16 v[48:51], v[232:235], a[24:27], v[48:51]
  s_and_b32 s42, s42, 7
  s_lshl_b32 s42, s42, 7
  v_mfma_f32_16x16x32_bf16 v[56:59], v[224:227], a[12:15], 0
  s_add_u32 s42, s42, s68
  s_lshl_b32 s73, s40, 11
  v_mfma_f32_16x16x32_bf16 v[56:59], v[232:235], a[28:31], v[56:59]
  buffer_load_dwordx4 v10, s[8:11], s42 offen offset:0 lds
  v_mfma_f32_16x16x32_bf16 v[36:39], v[228:231], a[0:3], 0
  s_add_u32 s73, s73, 81920
  v_add_u32 v24, s73, v1
  v_mfma_f32_16x16x32_bf16 v[36:39], v[236:239], a[16:19], v[36:39]
  buffer_load_dwordx4 v11, s[8:11], s42 offen offset:1024 lds
  v_mfma_f32_16x16x32_bf16 v[44:47], v[228:231], a[4:7], 0
  ds_read_b128 v[160:163], v24 offset:0
  ds_read_b128 v[164:167], v24 offset:1024
  v_mfma_f32_16x16x32_bf16 v[44:47], v[236:239], a[20:23], v[44:47]
  v_lshrrev_b32 v25, 5, v0
  v_lshlrev_b32 v25, 11, v25
  v_mfma_f32_16x16x32_bf16 v[52:55], v[228:231], a[8:11], 0
  v_bfe_u32 v198, v0, 3, 2
  v_lshl_add_u32 v25, v198, 8, v25
  v_mfma_f32_16x16x32_bf16 v[52:55], v[236:239], a[24:27], v[52:55]
  buffer_load_dwordx4 v12, s[8:11], s42 offen offset:2048 lds
  v_mfma_f32_16x16x32_bf16 v[60:63], v[228:231], a[12:15], 0
  v_and_b32_e64 v198, 7, v0
  v_lshl_add_u32 v25, v198, 4, v25
  v_mfma_f32_16x16x32_bf16 v[60:63], v[236:239], a[28:31], v[60:63]
  s_lshr_b32 s72, s2, 2
  s_lshl_b32 s72, s72, 15
  s_waitcnt lgkmcnt(0)
  v_mfma_f32_16x16x32_bf16 v[64:67], v[240:243], a[0:3], 0
  ds_read_b64_tr_b16 v[224:225], v14 offset:16384
  ds_read_b64_tr_b16 v[226:227], v14 offset:16896
  v_mfma_f32_16x16x32_bf16 v[64:67], v[248:251], a[16:19], v[64:67]
  ds_read_b64_tr_b16 v[228:229], v15 offset:16384
  ds_read_b64_tr_b16 v[230:231], v15 offset:16896
  v_mfma_f32_16x16x32_bf16 v[72:75], v[240:243], a[4:7], 0
  ds_read_b64_tr_b16 v[232:233], v14 offset:20480
  ds_read_b64_tr_b16 v[234:235], v14 offset:20992
  v_mfma_f32_16x16x32_bf16 v[72:75], v[248:251], a[20:23], v[72:75]
  buffer_load_dwordx4 v13, s[8:11], s42 offen offset:3072 lds
  v_mfma_f32_16x16x32_bf16 v[80:83], v[240:243], a[8:11], 0
  ds_read_b64_tr_b16 v[236:237], v15 offset:20480
  ds_read_b64_tr_b16 v[238:239], v15 offset:20992
  v_mfma_f32_16x16x32_bf16 v[80:83], v[248:251], a[24:27], v[80:83]
  s_add_u32 m0, s66, 4096
  s_add_u32 s42, s42, 32768
  v_mfma_f32_16x16x32_bf16 v[88:91], v[240:243], a[12:15], 0
  buffer_load_dwordx4 v10, s[8:11], s42 offen offset:0 lds
  v_mfma_f32_16x16x32_bf16 v[88:91], v[248:251], a[28:31], v[88:91]
  s_and_b32 s73, s2, 1
  s_lshl_b32 s73, s73, 7
  v_mfma_f32_16x16x32_bf16 v[68:71], v[244:247], a[0:3], 0
  s_add_u32 s72, s72, s73
  s_and_b32 s73, s2, 2
  v_mfma_f32_16x16x32_bf16 v[68:71], v[252:255], a[16:19], v[68:71]
  buffer_load_dwordx4 v11, s[8:11], s42 offen offset:1024 lds
  v_mfma_f32_16x16x32_bf16 v[76:79], v[244:247], a[4:7], 0
  s_lshl_b32 s73, s73, 9
  s_add_u32 s72, s72, s73
  v_mfma_f32_16x16x32_bf16 v[76:79], v[252:255], a[20:23], v[76:79]
  s_lshl_b32 s73, s40, 13
  s_add_u32 s72, s72, s73
  v_mfma_f32_16x16x32_bf16 v[84:87], v[244:247], a[8:11], 0
  s_add_u32 s73, s72, 4096
  v_mfma_f32_16x16x32_bf16 v[84:87], v[252:255], a[24:27], v[84:87]
  buffer_load_dwordx4 v12, s[8:11], s42 offen offset:2048 lds
  v_mfma_f32_16x16x32_bf16 v[92:95], v[244:247], a[12:15], 0
  v_mfma_f32_16x16x32_bf16 v[92:95], v[252:255], a[28:31], v[92:95]
  s_waitcnt lgkmcnt(0)
  v_mfma_f32_16x16x32_bf16 v[96:99], v[224:227], a[0:3], 0
  ds_read_b64_tr_b16 v[240:241], v16 offset:16384
  ds_read_b64_tr_b16 v[242:243], v16 offset:16896
  v_mfma_f32_16x16x32_bf16 v[96:99], v[232:235], a[16:19], v[96:99]
  ds_read_b64_tr_b16 v[244:245], v17 offset:16384
  ds_read_b64_tr_b16 v[246:247], v17 offset:16896
  v_mfma_f32_16x16x32_bf16 v[104:107], v[224:227], a[4:7], 0
  ds_read_b64_tr_b16 v[248:249], v16 offset:20480
  ds_read_b64_tr_b16 v[250:251], v16 offset:20992
  v_mfma_f32_16x16x32_bf16 v[104:107], v[232:235], a[20:23], v[104:107]
  buffer_load_dwordx4 v13, s[8:11], s42 offen offset:3072 lds
  v_mfma_f32_16x16x32_bf16 v[112:115], v[224:227], a[8:11], 0
  ds_read_b64_tr_b16 v[252:253], v17 offset:20480
  ds_read_b64_tr_b16 v[254:255], v17 offset:20992
  v_mfma_f32_16x16x32_bf16 v[112:115], v[232:235], a[24:27], v[112:115]
  s_add_u32 m0, s44, 32768
  s_add_u32 s42, s81, 2
  v_mfma_f32_16x16x32_bf16 v[120:123], v[224:227], a[12:15], 0
  s_and_b32 s42, s42, 7
  s_lshl_b32 s42, s42, 19
  v_mfma_f32_16x16x32_bf16 v[120:123], v[232:235], a[28:31], v[120:123]
  s_add_u32 s42, s42, s67
  v_mfma_f32_16x16x32_bf16 v[100:103], v[228:231], a[0:3], 0
  buffer_load_dwordx4 v6, s[16:19], s42 offen offset:0 lds
  v_mfma_f32_16x16x32_bf16 v[100:103], v[236:239], a[16:19], v[100:103]
  v_mfma_f32_16x16x32_bf16 v[108:111], v[228:231], a[4:7], 0
  buffer_load_dwordx4 v7, s[16:19], s42 offen offset:1024 lds
  v_mfma_f32_16x16x32_bf16 v[108:111], v[236:239], a[20:23], v[108:111]
  v_mfma_f32_16x16x32_bf16 v[116:119], v[228:231], a[8:11], 0
  v_mfma_f32_16x16x32_bf16 v[116:119], v[236:239], a[24:27], v[116:119]
  v_mfma_f32_16x16x32_bf16 v[124:127], v[228:231], a[12:15], 0
  buffer_load_dwordx4 v8, s[16:19], s42 offen offset:2048 lds
  v_mfma_f32_16x16x32_bf16 v[124:127], v[236:239], a[28:31], v[124:127]
  s_waitcnt lgkmcnt(0)
  v_mfma_f32_16x16x32_bf16 v[128:131], v[240:243], a[0:3], 0
  s_waitcnt vmcnt(13)
  v_mfma_f32_16x16x32_bf16 v[128:131], v[248:251], a[16:19], v[128:131]
  ds_read_b64_tr_b16 v[224:225], v14 offset:8192
  ds_read_b64_tr_b16 v[226:227], v14 offset:8704
  v_mfma_f32_16x16x32_bf16 v[136:139], v[240:243], a[4:7], 0
  ds_read_b64_tr_b16 v[228:229], v15 offset:8192
  ds_read_b64_tr_b16 v[230:231], v15 offset:8704
  v_mfma_f32_16x16x32_bf16 v[136:139], v[248:251], a[20:23], v[136:139]
  ds_read_b64_tr_b16 v[232:233], v14 offset:12288
  ds_read_b64_tr_b16 v[234:235], v14 offset:12800
  v_mfma_f32_16x16x32_bf16 v[144:147], v[240:243], a[8:11], 0
  ds_read_b64_tr_b16 v[236:237], v15 offset:12288
  ds_read_b64_tr_b16 v[238:239], v15 offset:12800
  v_mfma_f32_16x16x32_bf16 v[144:147], v[248:251], a[24:27], v[144:147]
  ds_read_b128 a[32:35], v18 offset:8192
  ds_read_b128 a[36:39], v18 offset:10240
  v_mfma_f32_16x16x32_bf16 v[152:155], v[240:243], a[12:15], 0
  ds_read_b128 a[40:43], v18 offset:12288
  ds_read_b128 a[44:47], v18 offset:14336
  v_mfma_f32_16x16x32_bf16 v[152:155], v[248:251], a[28:31], v[152:155]
  ds_read_b128 a[48:51], v19 offset:8192
  ds_read_b128 a[52:55], v19 offset:10240
  v_mfma_f32_16x16x32_bf16 v[132:135], v[244:247], a[0:3], 0
  ds_read_b128 a[56:59], v19 offset:12288
  ds_read_b128 a[60:63], v19 offset:14336
  v_mfma_f32_16x16x32_bf16 v[132:135], v[252:255], a[16:19], v[132:135]
  buffer_load_dwordx4 v9, s[16:19], s42 offen offset:3072 lds
  v_mfma_f32_16x16x32_bf16 v[140:143], v[244:247], a[4:7], 0
  s_add_u32 m0, s44, 49152
  s_add_u32 s42, s42, 128
  v_mfma_f32_16x16x32_bf16 v[140:143], v[252:255], a[20:23], v[140:143]
  buffer_load_dwordx4 v6, s[16:19], s42 offen offset:0 lds
  v_mfma_f32_16x16x32_bf16 v[148:151], v[244:247], a[8:11], 0
  v_mfma_f32_16x16x32_bf16 v[148:151], v[252:255], a[24:27], v[148:151]
  buffer_store_dwordx4 v[160:163], v25, s[12:15], s72 offen sc1
  v_mfma_f32_16x16x32_bf16 v[156:159], v[244:247], a[12:15], 0
  v_mfma_f32_16x16x32_bf16 v[156:159], v[252:255], a[28:31], v[156:159]
  buffer_load_dwordx4 v7, s[16:19], s42 offen offset:1024 lds
  s_waitcnt lgkmcnt(0)
  v_mfma_f32_16x16x32_bf16 v[32:35], v[224:227], a[32:35], v[32:35]
  ds_read_b64_tr_b16 v[240:241], v16 offset:8192
  ds_read_b64_tr_b16 v[242:243], v16 offset:8704
  v_mfma_f32_16x16x32_bf16 v[32:35], v[232:235], a[48:51], v[32:35]
  ds_read_b64_tr_b16 v[244:245], v17 offset:8192
  ds_read_b64_tr_b16 v[246:247], v17 offset:8704
  v_mfma_f32_16x16x32_bf16 v[40:43], v[224:227], a[36:39], v[40:43]
  ds_read_b64_tr_b16 v[248:249], v16 offset:12288
  ds_read_b64_tr_b16 v[250:251], v16 offset:12800
  v_mfma_f32_16x16x32_bf16 v[40:43], v[232:235], a[52:55], v[40:43]
  buffer_load_dwordx4 v8, s[16:19], s42 offen offset:2048 lds
  v_mfma_f32_16x16x32_bf16 v[48:51], v[224:227], a[40:43], v[48:51]
  ds_read_b64_tr_b16 v[252:253], v17 offset:12288
  ds_read_b64_tr_b16 v[254:255], v17 offset:12800
  v_mfma_f32_16x16x32_bf16 v[48:51], v[232:235], a[56:59], v[48:51]
  v_mfma_f32_16x16x32_bf16 v[56:59], v[224:227], a[44:47], v[56:59]
  buffer_store_dwordx4 v[164:167], v25, s[12:15], s73 offen sc1
  v_mfma_f32_16x16x32_bf16 v[56:59], v[232:235], a[60:63], v[56:59]
  buffer_load_dwordx4 v9, s[16:19], s42 offen offset:3072 lds
  v_mfma_f32_16x16x32_bf16 v[36:39], v[228:231], a[32:35], v[36:39]
  s_add_u32 m0, s66, 8192
  s_add_u32 s42, s71, 3
  v_mfma_f32_16x16x32_bf16 v[36:39], v[236:239], a[48:51], v[36:39]
  s_and_b32 s42, s42, 7
  s_lshl_b32 s42, s42, 7
  v_mfma_f32_16x16x32_bf16 v[44:47], v[228:231], a[36:39], v[44:47]
  s_add_u32 s42, s42, s68
  v_mfma_f32_16x16x32_bf16 v[44:47], v[236:239], a[52:55], v[44:47]
  buffer_load_dwordx4 v10, s[8:11], s42 offen offset:0 lds
  v_mfma_f32_16x16x32_bf16 v[52:55], v[228:231], a[40:43], v[52:55]
  v_mfma_f32_16x16x32_bf16 v[52:55], v[236:239], a[56:59], v[52:55]
  v_mfma_f32_16x16x32_bf16 v[60:63], v[228:231], a[44:47], v[60:63]
  v_mfma_f32_16x16x32_bf16 v[60:63], v[236:239], a[60:63], v[60:63]
  buffer_load_dwordx4 v11, s[8:11], s42 offen offset:1024 lds
  s_waitcnt lgkmcnt(0)
  v_mfma_f32_16x16x32_bf16 v[64:67], v[240:243], a[32:35], v[64:67]
  ds_read_b64_tr_b16 v[224:225], v14 offset:24576
  ds_read_b64_tr_b16 v[226:227], v14 offset:25088
  v_mfma_f32_16x16x32_bf16 v[64:67], v[248:251], a[48:51], v[64:67]
  ds_read_b64_tr_b16 v[228:229], v15 offset:24576
  ds_read_b64_tr_b16 v[230:231], v15 offset:25088
  v_mfma_f32_16x16x32_bf16 v[72:75], v[240:243], a[36:39], v[72:75]
  ds_read_b64_tr_b16 v[232:233], v14 offset:28672
  ds_read_b64_tr_b16 v[234:235], v14 offset:29184
  v_mfma_f32_16x16x32_bf16 v[72:75], v[248:251], a[52:55], v[72:75]
  buffer_load_dwordx4 v12, s[8:11], s42 offen offset:2048 lds
  v_mfma_f32_16x16x32_bf16 v[80:83], v[240:243], a[40:43], v[80:83]
  ds_read_b64_tr_b16 v[236:237], v15 offset:28672
  ds_read_b64_tr_b16 v[238:239], v15 offset:29184
  v_mfma_f32_16x16x32_bf16 v[80:83], v[248:251], a[56:59], v[80:83]
  v_mfma_f32_16x16x32_bf16 v[88:91], v[240:243], a[44:47], v[88:91]
  v_mfma_f32_16x16x32_bf16 v[88:91], v[248:251], a[60:63], v[88:91]
  buffer_load_dwordx4 v13, s[8:11], s42 offen offset:3072 lds
  v_mfma_f32_16x16x32_bf16 v[68:71], v[244:247], a[32:35], v[68:71]
  s_add_u32 m0, s66, 12288
  s_add_u32 s42, s42, 32768
  v_mfma_f32_16x16x32_bf16 v[68:71], v[252:255], a[48:51], v[68:71]
  v_mfma_f32_16x16x32_bf16 v[76:79], v[244:247], a[36:39], v[76:79]
  v_mfma_f32_16x16x32_bf16 v[76:79], v[252:255], a[52:55], v[76:79]
  buffer_load_dwordx4 v10, s[8:11], s42 offen offset:0 lds
  v_mfma_f32_16x16x32_bf16 v[84:87], v[244:247], a[40:43], v[84:87]
  v_mfma_f32_16x16x32_bf16 v[84:87], v[252:255], a[56:59], v[84:87]
  v_mfma_f32_16x16x32_bf16 v[92:95], v[244:247], a[44:47], v[92:95]
  v_mfma_f32_16x16x32_bf16 v[92:95], v[252:255], a[60:63], v[92:95]
  buffer_load_dwordx4 v11, s[8:11], s42 offen offset:1024 lds
  s_waitcnt lgkmcnt(0)
  v_mfma_f32_16x16x32_bf16 v[96:99], v[224:227], a[32:35], v[96:99]
  ds_read_b64_tr_b16 v[240:241], v16 offset:24576
  ds_read_b64_tr_b16 v[242:243], v16 offset:25088
  v_mfma_f32_16x16x32_bf16 v[96:99], v[232:235], a[48:51], v[96:99]
  ds_read_b64_tr_b16 v[244:245], v17 offset:24576
  ds_read_b64_tr_b16 v[246:247], v17 offset:25088
  v_mfma_f32_16x16x32_bf16 v[104:107], v[224:227], a[36:39], v[104:107]
  ds_read_b64_tr_b16 v[248:249], v16 offset:28672
  ds_read_b64_tr_b16 v[250:251], v16 offset:29184
  v_mfma_f32_16x16x32_bf16 v[104:107], v[232:235], a[52:55], v[104:107]
  buffer_load_dwordx4 v12, s[8:11], s42 offen offset:2048 lds
  v_mfma_f32_16x16x32_bf16 v[112:115], v[224:227], a[40:43], v[112:115]
  ds_read_b64_tr_b16 v[252:253], v17 offset:28672
  ds_read_b64_tr_b16 v[254:255], v17 offset:29184
  v_mfma_f32_16x16x32_bf16 v[112:115], v[232:235], a[56:59], v[112:115]
  v_mfma_f32_16x16x32_bf16 v[120:123], v[224:227], a[44:47], v[120:123]
  v_mfma_f32_16x16x32_bf16 v[120:123], v[232:235], a[60:63], v[120:123]
  buffer_load_dwordx4 v13, s[8:11], s42 offen offset:3072 lds
  v_mfma_f32_16x16x32_bf16 v[100:103], v[228:231], a[32:35], v[100:103]
  s_add_u32 m0, s44, 65536
  s_add_u32 s42, s81, 0
  v_mfma_f32_16x16x32_bf16 v[100:103], v[236:239], a[48:51], v[100:103]
  s_and_b32 s42, s42, 7
  s_lshl_b32 s42, s42, 19
  v_mfma_f32_16x16x32_bf16 v[108:111], v[228:231], a[36:39], v[108:111]
  s_add_u32 s42, s42, s67
  s_xor_b32 s42, s42, 256
  v_mfma_f32_16x16x32_bf16 v[108:111], v[236:239], a[52:55], v[108:111]
  buffer_load_dwordx4 v6, s[20:23], s42 offen offset:0 lds
  v_mfma_f32_16x16x32_bf16 v[116:119], v[228:231], a[40:43], v[116:119]
  v_mfma_f32_16x16x32_bf16 v[116:119], v[236:239], a[56:59], v[116:119]
  v_mfma_f32_16x16x32_bf16 v[124:127], v[228:231], a[44:47], v[124:127]
  v_mfma_f32_16x16x32_bf16 v[124:127], v[236:239], a[60:63], v[124:127]
  buffer_load_dwordx4 v7, s[20:23], s42 offen offset:1024 lds
  s_waitcnt lgkmcnt(0)
  v_mfma_f32_16x16x32_bf16 v[128:131], v[240:243], a[32:35], v[128:131]
  s_waitcnt vmcnt(10)
  s_barrier
  v_mfma_f32_16x16x32_bf16 v[128:131], v[248:251], a[48:51], v[128:131]
  ds_read_b64_tr_b16 v[224:225], v14 offset:32768
  ds_read_b64_tr_b16 v[226:227], v14 offset:33280
  v_mfma_f32_16x16x32_bf16 v[136:139], v[240:243], a[36:39], v[136:139]
  ds_read_b64_tr_b16 v[228:229], v15 offset:32768
  ds_read_b64_tr_b16 v[230:231], v15 offset:33280
  v_mfma_f32_16x16x32_bf16 v[136:139], v[248:251], a[52:55], v[136:139]
  ds_read_b64_tr_b16 v[232:233], v14 offset:36864
  ds_read_b64_tr_b16 v[234:235], v14 offset:37376
  v_mfma_f32_16x16x32_bf16 v[144:147], v[240:243], a[40:43], v[144:147]
  ds_read_b64_tr_b16 v[236:237], v15 offset:36864
  ds_read_b64_tr_b16 v[238:239], v15 offset:37376
  v_mfma_f32_16x16x32_bf16 v[144:147], v[248:251], a[56:59], v[144:147]
  ds_read_b128 a[64:67], v18 offset:0
  ds_read_b128 a[68:71], v18 offset:2048
  v_mfma_f32_16x16x32_bf16 v[152:155], v[240:243], a[44:47], v[152:155]
  ds_read_b128 a[72:75], v18 offset:4096
  ds_read_b128 a[76:79], v18 offset:6144
  v_mfma_f32_16x16x32_bf16 v[152:155], v[248:251], a[60:63], v[152:155]
  ds_read_b128 a[80:83], v19 offset:0
  ds_read_b128 a[84:87], v19 offset:2048
  v_mfma_f32_16x16x32_bf16 v[132:135], v[244:247], a[32:35], v[132:135]
  ds_read_b128 a[88:91], v19 offset:4096
  ds_read_b128 a[92:95], v19 offset:6144
  v_mfma_f32_16x16x32_bf16 v[132:135], v[252:255], a[48:51], v[132:135]
  buffer_load_dwordx4 v8, s[20:23], s42 offen offset:2048 lds
  v_mfma_f32_16x16x32_bf16 v[140:143], v[244:247], a[36:39], v[140:143]
  v_mfma_f32_16x16x32_bf16 v[140:143], v[252:255], a[52:55], v[140:143]
  buffer_load_dwordx4 v9, s[20:23], s42 offen offset:3072 lds
  v_mfma_f32_16x16x32_bf16 v[148:151], v[244:247], a[40:43], v[148:151]
  v_mfma_f32_16x16x32_bf16 v[148:151], v[252:255], a[56:59], v[148:151]
  v_mfma_f32_16x16x32_bf16 v[156:159], v[244:247], a[44:47], v[156:159]
  v_mfma_f32_16x16x32_bf16 v[156:159], v[252:255], a[60:63], v[156:159]
  buffer_store_dwordx4 v[28:31], v26, s[12:15], s77 offen sc1
  s_waitcnt lgkmcnt(0)
  v_mfma_f32_16x16x32_bf16 v[32:35], v[224:227], a[64:67], v[32:35]
  ds_read_b64_tr_b16 v[240:241], v16 offset:32768
  ds_read_b64_tr_b16 v[242:243], v16 offset:33280
  v_mfma_f32_16x16x32_bf16 v[32:35], v[232:235], a[80:83], v[32:35]
  ds_read_b64_tr_b16 v[244:245], v17 offset:32768
  ds_read_b64_tr_b16 v[246:247], v17 offset:33280
  v_mfma_f32_16x16x32_bf16 v[40:43], v[224:227], a[68:71], v[40:43]
  ds_read_b64_tr_b16 v[248:249], v16 offset:36864
  ds_read_b64_tr_b16 v[250:251], v16 offset:37376
  v_mfma_f32_16x16x32_bf16 v[40:43], v[232:235], a[84:87], v[40:43]
  s_add_u32 m0, s66, 0
  s_add_u32 s42, s71, 4
  v_mfma_f32_16x16x32_bf16 v[48:51], v[224:227], a[72:75], v[48:51]
  ds_read_b64_tr_b16 v[252:253], v17 offset:36864
  ds_read_b64_tr_b16 v[254:255], v17 offset:37376
  v_mfma_f32_16x16x32_bf16 v[48:51], v[232:235], a[88:91], v[48:51]
  s_and_b32 s42, s42, 7
  s_lshl_b32 s42, s42, 7
  v_mfma_f32_16x16x32_bf16 v[56:59], v[224:227], a[76:79], v[56:59]
  s_add_u32 s42, s42, s68
  v_mfma_f32_16x16x32_bf16 v[56:59], v[232:235], a[92:95], v[56:59]
  buffer_load_dwordx4 v10, s[8:11], s42 offen offset:0 lds
  v_mfma_f32_16x16x32_bf16 v[36:39], v[228:231], a[64:67], v[36:39]
  v_mfma_f32_16x16x32_bf16 v[36:39], v[236:239], a[80:83], v[36:39]
  buffer_load_dwordx4 v11, s[8:11], s42 offen offset:1024 lds
  v_mfma_f32_16x16x32_bf16 v[44:47], v[228:231], a[68:71], v[44:47]
  v_mfma_f32_16x16x32_bf16 v[44:47], v[236:239], a[84:87], v[44:47]
  v_mfma_f32_16x16x32_bf16 v[52:55], v[228:231], a[72:75], v[52:55]
  v_mfma_f32_16x16x32_bf16 v[52:55], v[236:239], a[88:91], v[52:55]
  buffer_load_dwordx4 v12, s[8:11], s42 offen offset:2048 lds
  v_mfma_f32_16x16x32_bf16 v[60:63], v[228:231], a[76:79], v[60:63]
  v_mfma_f32_16x16x32_bf16 v[60:63], v[236:239], a[92:95], v[60:63]
  s_waitcnt lgkmcnt(0)
  v_mfma_f32_16x16x32_bf16 v[64:67], v[240:243], a[64:67], v[64:67]
  ds_read_b64_tr_b16 v[224:225], v14 offset:49152
  ds_read_b64_tr_b16 v[226:227], v14 offset:49664
  v_mfma_f32_16x16x32_bf16 v[64:67], v[248:251], a[80:83], v[64:67]
  ds_read_b64_tr_b16 v[228:229], v15 offset:49152
  ds_read_b64_tr_b16 v[230:231], v15 offset:49664
  v_mfma_f32_16x16x32_bf16 v[72:75], v[240:243], a[68:71], v[72:75]
  ds_read_b64_tr_b16 v[232:233], v14 offset:53248
  ds_read_b64_tr_b16 v[234:235], v14 offset:53760
  v_mfma_f32_16x16x32_bf16 v[72:75], v[248:251], a[84:87], v[72:75]
  buffer_load_dwordx4 v13, s[8:11], s42 offen offset:3072 lds
  v_mfma_f32_16x16x32_bf16 v[80:83], v[240:243], a[72:75], v[80:83]
  ds_read_b64_tr_b16 v[236:237], v15 offset:53248
  ds_read_b64_tr_b16 v[238:239], v15 offset:53760
  v_mfma_f32_16x16x32_bf16 v[80:83], v[248:251], a[88:91], v[80:83]
  s_add_u32 m0, s66, 4096
  s_add_u32 s42, s42, 32768
  v_mfma_f32_16x16x32_bf16 v[88:91], v[240:243], a[76:79], v[88:91]
  buffer_load_dwordx4 v10, s[8:11], s42 offen offset:0 lds
  v_mfma_f32_16x16x32_bf16 v[88:91], v[248:251], a[92:95], v[88:91]
  v_mfma_f32_16x16x32_bf16 v[68:71], v[244:247], a[64:67], v[68:71]
  v_mfma_f32_16x16x32_bf16 v[68:71], v[252:255], a[80:83], v[68:71]
  buffer_load_dwordx4 v11, s[8:11], s42 offen offset:1024 lds
  v_mfma_f32_16x16x32_bf16 v[76:79], v[244:247], a[68:71], v[76:79]
  v_mfma_f32_16x16x32_bf16 v[76:79], v[252:255], a[84:87], v[76:79]
  v_mfma_f32_16x16x32_bf16 v[84:87], v[244:247], a[72:75], v[84:87]
  v_mfma_f32_16x16x32_bf16 v[84:87], v[252:255], a[88:91], v[84:87]
  buffer_load_dwordx4 v12, s[8:11], s42 offen offset:2048 lds
  v_mfma_f32_16x16x32_bf16 v[92:95], v[244:247], a[76:79], v[92:95]
  v_mfma_f32_16x16x32_bf16 v[92:95], v[252:255], a[92:95], v[92:95]
  s_waitcnt lgkmcnt(0)
  v_mfma_f32_16x16x32_bf16 v[96:99], v[224:227], a[64:67], v[96:99]
  ds_read_b64_tr_b16 v[240:241], v16 offset:49152
  ds_read_b64_tr_b16 v[242:243], v16 offset:49664
  v_mfma_f32_16x16x32_bf16 v[96:99], v[232:235], a[80:83], v[96:99]
  ds_read_b64_tr_b16 v[244:245], v17 offset:49152
  ds_read_b64_tr_b16 v[246:247], v17 offset:49664
  v_mfma_f32_16x16x32_bf16 v[104:107], v[224:227], a[68:71], v[104:107]
  ds_read_b64_tr_b16 v[248:249], v16 offset:53248
  ds_read_b64_tr_b16 v[250:251], v16 offset:53760
  v_mfma_f32_16x16x32_bf16 v[104:107], v[232:235], a[84:87], v[104:107]
  buffer_load_dwordx4 v13, s[8:11], s42 offen offset:3072 lds
  v_mfma_f32_16x16x32_bf16 v[112:115], v[224:227], a[72:75], v[112:115]
  ds_read_b64_tr_b16 v[252:253], v17 offset:53248
  ds_read_b64_tr_b16 v[254:255], v17 offset:53760
  v_mfma_f32_16x16x32_bf16 v[112:115], v[232:235], a[88:91], v[112:115]
  s_add_u32 m0, s44, 0
  s_add_u32 s42, s81, 4
  v_mfma_f32_16x16x32_bf16 v[120:123], v[224:227], a[76:79], v[120:123]
  s_and_b32 s42, s42, 7
  s_lshl_b32 s42, s42, 19
  v_mfma_f32_16x16x32_bf16 v[120:123], v[232:235], a[92:95], v[120:123]
  s_add_u32 s42, s42, s67
  v_mfma_f32_16x16x32_bf16 v[100:103], v[228:231], a[64:67], v[100:103]
  buffer_load_dwordx4 v6, s[16:19], s42 offen offset:0 lds
  v_mfma_f32_16x16x32_bf16 v[100:103], v[236:239], a[80:83], v[100:103]
  v_mfma_f32_16x16x32_bf16 v[108:111], v[228:231], a[68:71], v[108:111]
  buffer_load_dwordx4 v7, s[16:19], s42 offen offset:1024 lds
  v_mfma_f32_16x16x32_bf16 v[108:111], v[236:239], a[84:87], v[108:111]
  v_mfma_f32_16x16x32_bf16 v[116:119], v[228:231], a[72:75], v[116:119]
  v_mfma_f32_16x16x32_bf16 v[116:119], v[236:239], a[88:91], v[116:119]
  v_mfma_f32_16x16x32_bf16 v[124:127], v[228:231], a[76:79], v[124:127]
  buffer_load_dwordx4 v8, s[16:19], s42 offen offset:2048 lds
  v_mfma_f32_16x16x32_bf16 v[124:127], v[236:239], a[92:95], v[124:127]
  s_waitcnt lgkmcnt(0)
  v_mfma_f32_16x16x32_bf16 v[128:131], v[240:243], a[64:67], v[128:131]
  s_waitcnt vmcnt(16)
  v_mfma_f32_16x16x32_bf16 v[128:131], v[248:251], a[80:83], v[128:131]
  ds_read_b64_tr_b16 v[224:225], v14 offset:40960
  ds_read_b64_tr_b16 v[226:227], v14 offset:41472
  v_mfma_f32_16x16x32_bf16 v[136:139], v[240:243], a[68:71], v[136:139]
  ds_read_b64_tr_b16 v[228:229], v15 offset:40960
  ds_read_b64_tr_b16 v[230:231], v15 offset:41472
  v_mfma_f32_16x16x32_bf16 v[136:139], v[248:251], a[84:87], v[136:139]
  ds_read_b64_tr_b16 v[232:233], v14 offset:45056
  ds_read_b64_tr_b16 v[234:235], v14 offset:45568
  v_mfma_f32_16x16x32_bf16 v[144:147], v[240:243], a[72:75], v[144:147]
  ds_read_b64_tr_b16 v[236:237], v15 offset:45056
  ds_read_b64_tr_b16 v[238:239], v15 offset:45568
  v_mfma_f32_16x16x32_bf16 v[144:147], v[248:251], a[88:91], v[144:147]
  ds_read_b128 a[96:99], v18 offset:8192
  ds_read_b128 a[100:103], v18 offset:10240
  v_mfma_f32_16x16x32_bf16 v[152:155], v[240:243], a[76:79], v[152:155]
  ds_read_b128 a[104:107], v18 offset:12288
  ds_read_b128 a[108:111], v18 offset:14336
  v_mfma_f32_16x16x32_bf16 v[152:155], v[248:251], a[92:95], v[152:155]
  ds_read_b128 a[112:115], v19 offset:8192
  ds_read_b128 a[116:119], v19 offset:10240
  v_mfma_f32_16x16x32_bf16 v[132:135], v[244:247], a[64:67], v[132:135]
  ds_read_b128 a[120:123], v19 offset:12288
  ds_read_b128 a[124:127], v19 offset:14336
  v_mfma_f32_16x16x32_bf16 v[132:135], v[252:255], a[80:83], v[132:135]
  buffer_load_dwordx4 v9, s[16:19], s42 offen offset:3072 lds
  v_mfma_f32_16x16x32_bf16 v[140:143], v[244:247], a[68:71], v[140:143]
  s_add_u32 m0, s44, 16384
  s_add_u32 s42, s42, 128
  v_mfma_f32_16x16x32_bf16 v[140:143], v[252:255], a[84:87], v[140:143]
  buffer_load_dwordx4 v6, s[16:19], s42 offen offset:0 lds
  v_mfma_f32_16x16x32_bf16 v[148:151], v[244:247], a[72:75], v[148:151]
  v_mfma_f32_16x16x32_bf16 v[148:151], v[252:255], a[88:91], v[148:151]
  v_mfma_f32_16x16x32_bf16 v[156:159], v[244:247], a[76:79], v[156:159]
  v_mfma_f32_16x16x32_bf16 v[156:159], v[252:255], a[92:95], v[156:159]
  buffer_load_dwordx4 v7, s[16:19], s42 offen offset:1024 lds
  s_waitcnt lgkmcnt(0)
  v_mfma_f32_16x16x32_bf16 v[32:35], v[224:227], a[96:99], v[32:35]
  ds_read_b64_tr_b16 v[240:241], v16 offset:40960
  ds_read_b64_tr_b16 v[242:243], v16 offset:41472
  v_mfma_f32_16x16x32_bf16 v[32:35], v[232:235], a[112:115], v[32:35]
  ds_read_b64_tr_b16 v[244:245], v17 offset:40960
  ds_read_b64_tr_b16 v[246:247], v17 offset:41472
  v_mfma_f32_16x16x32_bf16 v[40:43], v[224:227], a[100:103], v[40:43]
  ds_read_b64_tr_b16 v[248:249], v16 offset:45056
  ds_read_b64_tr_b16 v[250:251], v16 offset:45568
  v_mfma_f32_16x16x32_bf16 v[40:43], v[232:235], a[116:119], v[40:43]
  buffer_load_dwordx4 v8, s[16:19], s42 offen offset:2048 lds
  v_mfma_f32_16x16x32_bf16 v[48:51], v[224:227], a[104:107], v[48:51]
  ds_read_b64_tr_b16 v[252:253], v17 offset:45056
  ds_read_b64_tr_b16 v[254:255], v17 offset:45568
  v_mfma_f32_16x16x32_bf16 v[48:51], v[232:235], a[120:123], v[48:51]
  v_mfma_f32_16x16x32_bf16 v[56:59], v[224:227], a[108:111], v[56:59]
  v_mfma_f32_16x16x32_bf16 v[56:59], v[232:235], a[124:127], v[56:59]
  buffer_load_dwordx4 v9, s[16:19], s42 offen offset:3072 lds
  v_mfma_f32_16x16x32_bf16 v[36:39], v[228:231], a[96:99], v[36:39]
  s_add_u32 m0, s66, 8192
  s_add_u32 s42, s71, 5
  v_mfma_f32_16x16x32_bf16 v[36:39], v[236:239], a[112:115], v[36:39]
  s_and_b32 s42, s42, 7
  s_lshl_b32 s42, s42, 7
  v_mfma_f32_16x16x32_bf16 v[44:47], v[228:231], a[100:103], v[44:47]
  s_add_u32 s42, s42, s68
  v_mfma_f32_16x16x32_bf16 v[44:47], v[236:239], a[116:119], v[44:47]
  buffer_load_dwordx4 v10, s[8:11], s42 offen offset:0 lds
  v_mfma_f32_16x16x32_bf16 v[52:55], v[228:231], a[104:107], v[52:55]
  v_mfma_f32_16x16x32_bf16 v[52:55], v[236:239], a[120:123], v[52:55]
  v_mfma_f32_16x16x32_bf16 v[60:63], v[228:231], a[108:111], v[60:63]
  v_mfma_f32_16x16x32_bf16 v[60:63], v[236:239], a[124:127], v[60:63]
  buffer_load_dwordx4 v11, s[8:11], s42 offen offset:1024 lds
  s_waitcnt lgkmcnt(0)
  v_mfma_f32_16x16x32_bf16 v[64:67], v[240:243], a[96:99], v[64:67]
  ds_read_b64_tr_b16 v[224:225], v14 offset:57344
  ds_read_b64_tr_b16 v[226:227], v14 offset:57856
  v_mfma_f32_16x16x32_bf16 v[64:67], v[248:251], a[112:115], v[64:67]
  ds_read_b64_tr_b16 v[228:229], v15 offset:57344
  ds_read_b64_tr_b16 v[230:231], v15 offset:57856
  v_mfma_f32_16x16x32_bf16 v[72:75], v[240:243], a[100:103], v[72:75]
  ds_read_b64_tr_b16 v[232:233], v14 offset:61440
  ds_read_b64_tr_b16 v[234:235], v14 offset:61952
  v_mfma_f32_16x16x32_bf16 v[72:75], v[248:251], a[116:119], v[72:75]
  buffer_load_dwordx4 v12, s[8:11], s42 offen offset:2048 lds
  v_mfma_f32_16x16x32_bf16 v[80:83], v[240:243], a[104:107], v[80:83]
  ds_read_b64_tr_b16 v[236:237], v15 offset:61440
  ds_read_b64_tr_b16 v[238:239], v15 offset:61952
  v_mfma_f32_16x16x32_bf16 v[80:83], v[248:251], a[120:123], v[80:83]
  v_mfma_f32_16x16x32_bf16 v[88:91], v[240:243], a[108:111], v[88:91]
  v_mfma_f32_16x16x32_bf16 v[88:91], v[248:251], a[124:127], v[88:91]
  buffer_load_dwordx4 v13, s[8:11], s42 offen offset:3072 lds
  v_mfma_f32_16x16x32_bf16 v[68:71], v[244:247], a[96:99], v[68:71]
  s_add_u32 m0, s66, 12288
  s_add_u32 s42, s42, 32768
  v_mfma_f32_16x16x32_bf16 v[68:71], v[252:255], a[112:115], v[68:71]
  v_mfma_f32_16x16x32_bf16 v[76:79], v[244:247], a[100:103], v[76:79]
  v_mfma_f32_16x16x32_bf16 v[76:79], v[252:255], a[116:119], v[76:79]
  buffer_load_dwordx4 v10, s[8:11], s42 offen offset:0 lds
  v_mfma_f32_16x16x32_bf16 v[84:87], v[244:247], a[104:107], v[84:87]
  v_mfma_f32_16x16x32_bf16 v[84:87], v[252:255], a[120:123], v[84:87]
  v_mfma_f32_16x16x32_bf16 v[92:95], v[244:247], a[108:111], v[92:95]
  v_mfma_f32_16x16x32_bf16 v[92:95], v[252:255], a[124:127], v[92:95]
  buffer_load_dwordx4 v11, s[8:11], s42 offen offset:1024 lds
  s_waitcnt lgkmcnt(0)
  v_mfma_f32_16x16x32_bf16 v[96:99], v[224:227], a[96:99], v[96:99]
  ds_read_b64_tr_b16 v[240:241], v16 offset:57344
  ds_read_b64_tr_b16 v[242:243], v16 offset:57856
  v_mfma_f32_16x16x32_bf16 v[96:99], v[232:235], a[112:115], v[96:99]
  ds_read_b64_tr_b16 v[244:245], v17 offset:57344
  ds_read_b64_tr_b16 v[246:247], v17 offset:57856
  v_mfma_f32_16x16x32_bf16 v[104:107], v[224:227], a[100:103], v[104:107]
  ds_read_b64_tr_b16 v[248:249], v16 offset:61440
  ds_read_b64_tr_b16 v[250:251], v16 offset:61952
  v_mfma_f32_16x16x32_bf16 v[104:107], v[232:235], a[116:119], v[104:107]
  buffer_load_dwordx4 v12, s[8:11], s42 offen offset:2048 lds
  v_mfma_f32_16x16x32_bf16 v[112:115], v[224:227], a[104:107], v[112:115]
  ds_read_b64_tr_b16 v[252:253], v17 offset:61440
  ds_read_b64_tr_b16 v[254:255], v17 offset:61952
  v_mfma_f32_16x16x32_bf16 v[112:115], v[232:235], a[120:123], v[112:115]
  v_mfma_f32_16x16x32_bf16 v[120:123], v[224:227], a[108:111], v[120:123]
  v_mfma_f32_16x16x32_bf16 v[120:123], v[232:235], a[124:127], v[120:123]
  buffer_load_dwordx4 v13, s[8:11], s42 offen offset:3072 lds
  v_mfma_f32_16x16x32_bf16 v[100:103], v[228:231], a[96:99], v[100:103]
  v_mfma_f32_16x16x32_bf16 v[100:103], v[236:239], a[112:115], v[100:103]
  v_mfma_f32_16x16x32_bf16 v[108:111], v[228:231], a[100:103], v[108:111]
  v_mfma_f32_16x16x32_bf16 v[108:111], v[236:239], a[116:119], v[108:111]
  v_mfma_f32_16x16x32_bf16 v[116:119], v[228:231], a[104:107], v[116:119]
  v_mfma_f32_16x16x32_bf16 v[116:119], v[236:239], a[120:123], v[116:119]
  v_mfma_f32_16x16x32_bf16 v[124:127], v[228:231], a[108:111], v[124:127]
  v_mfma_f32_16x16x32_bf16 v[124:127], v[236:239], a[124:127], v[124:127]
  s_waitcnt lgkmcnt(0)
  v_mfma_f32_16x16x32_bf16 v[128:131], v[240:243], a[96:99], v[128:131]
  s_waitcnt vmcnt(8)
  s_barrier
  v_mfma_f32_16x16x32_bf16 v[128:131], v[248:251], a[112:115], v[128:131]
  ds_read_b64_tr_b16 v[224:225], v14 offset:0
  ds_read_b64_tr_b16 v[226:227], v14 offset:512
  v_mfma_f32_16x16x32_bf16 v[136:139], v[240:243], a[100:103], v[136:139]
  ds_read_b64_tr_b16 v[228:229], v15 offset:0
  ds_read_b64_tr_b16 v[230:231], v15 offset:512
  v_mfma_f32_16x16x32_bf16 v[136:139], v[248:251], a[116:119], v[136:139]
  ds_read_b64_tr_b16 v[232:233], v14 offset:4096
  ds_read_b64_tr_b16 v[234:235], v14 offset:4608
  v_mfma_f32_16x16x32_bf16 v[144:147], v[240:243], a[104:107], v[144:147]
  ds_read_b64_tr_b16 v[236:237], v15 offset:4096
  ds_read_b64_tr_b16 v[238:239], v15 offset:4608
  v_mfma_f32_16x16x32_bf16 v[144:147], v[248:251], a[120:123], v[144:147]
  ds_read_b128 a[128:131], v18 offset:0
  ds_read_b128 a[132:135], v18 offset:2048
  v_mfma_f32_16x16x32_bf16 v[152:155], v[240:243], a[108:111], v[152:155]
  ds_read_b128 a[136:139], v18 offset:4096
  ds_read_b128 a[140:143], v18 offset:6144
  v_mfma_f32_16x16x32_bf16 v[152:155], v[248:251], a[124:127], v[152:155]
  ds_read_b128 a[144:147], v19 offset:0
  ds_read_b128 a[148:151], v19 offset:2048
  v_mfma_f32_16x16x32_bf16 v[132:135], v[244:247], a[96:99], v[132:135]
  ds_read_b128 a[152:155], v19 offset:4096
  ds_read_b128 a[156:159], v19 offset:6144
  v_mfma_f32_16x16x32_bf16 v[132:135], v[252:255], a[112:115], v[132:135]
  v_mfma_f32_16x16x32_bf16 v[140:143], v[244:247], a[100:103], v[140:143]
  v_mfma_f32_16x16x32_bf16 v[140:143], v[252:255], a[116:119], v[140:143]
  v_mfma_f32_16x16x32_bf16 v[148:151], v[244:247], a[104:107], v[148:151]
  v_mfma_f32_16x16x32_bf16 v[148:151], v[252:255], a[120:123], v[148:151]
  v_mfma_f32_16x16x32_bf16 v[156:159], v[244:247], a[108:111], v[156:159]
  v_mfma_f32_16x16x32_bf16 v[156:159], v[252:255], a[124:127], v[156:159]
  s_waitcnt lgkmcnt(0)
  v_mfma_f32_16x16x32_bf16 v[32:35], v[224:227], a[128:131], v[32:35]
  s_mov_b32 s4, s62
  s_and_b32 s5, s63, 0xffff
  s_mov_b32 s6, 256
  s_mov_b32 s7, 0x20000
  v_mov_b32_e64 v4, 1
  s_lshr_b32 s78, s2, 4
  s_cmp_eq_u32 s78, 0
  s_cbranch_scc1 Lats16
Lat16:
  v_mfma_f32_16x16x32_bf16 v[32:35], v[232:235], a[144:147], v[32:35]
  ds_read_b64_tr_b16 v[240:241], v16 offset:0
  ds_read_b64_tr_b16 v[242:243], v16 offset:512
  v_mfma_f32_16x16x32_bf16 v[40:43], v[224:227], a[132:135], v[40:43]
  ds_read_b64_tr_b16 v[244:245], v17 offset:0
  ds_read_b64_tr_b16 v[246:247], v17 offset:512
  v_mfma_f32_16x16x32_bf16 v[40:43], v[232:235], a[148:151], v[40:43]
  s_add_u32 m0, s66, 0
  s_add_u32 s42, s71, 6
  v_mfma_f32_16x16x32_bf16 v[48:51], v[224:227], a[136:139], v[48:51]
  ds_read_b64_tr_b16 v[248:249], v16 offset:4096
  ds_read_b64_tr_b16 v[250:251], v16 offset:4608
  v_mfma_f32_16x16x32_bf16 v[48:51], v[232:235], a[152:155], v[48:51]
  s_and_b32 s42, s42, 7
  s_lshl_b32 s42, s42, 7
  v_mfma_f32_16x16x32_bf16 v[56:59], v[224:227], a[140:143], v[56:59]
  ds_read_b64_tr_b16 v[252:253], v17 offset:4096
  ds_read_b64_tr_b16 v[254:255], v17 offset:4608
  v_mfma_f32_16x16x32_bf16 v[56:59], v[232:235], a[156:159], v[56:59]
  s_add_u32 s42, s42, s68
  v_mfma_f32_16x16x32_bf16 v[36:39], v[228:231], a[128:131], v[36:39]
  buffer_load_dwordx4 v10, s[8:11], s42 offen offset:0 lds
  v_mfma_f32_16x16x32_bf16 v[36:39], v[236:239], a[144:147], v[36:39]
  v_mfma_f32_16x16x32_bf16 v[44:47], v[228:231], a[132:135], v[44:47]
  buffer_load_dwordx4 v11, s[8:11], s42 offen offset:1024 lds
  v_mfma_f32_16x16x32_bf16 v[44:47], v[236:239], a[148:151], v[44:47]
  v_mfma_f32_16x16x32_bf16 v[52:55], v[228:231], a[136:139], v[52:55]
  v_mfma_f32_16x16x32_bf16 v[52:55], v[236:239], a[152:155], v[52:55]
  v_mfma_f32_16x16x32_bf16 v[60:63], v[228:231], a[140:143], v[60:63]
  buffer_load_dwordx4 v12, s[8:11], s42 offen offset:2048 lds
  v_mfma_f32_16x16x32_bf16 v[60:63], v[236:239], a[156:159], v[60:63]
  s_waitcnt lgkmcnt(0)
  v_mfma_f32_16x16x32_bf16 v[64:67], v[240:243], a[128:131], v[64:67]
  s_cmp_eq_u32 s78, 1
  s_cbranch_scc1 Lats17
Lat17:
  v_mfma_f32_16x16x32_bf16 v[64:67], v[248:251], a[144:147], v[64:67]
  ds_read_b64_tr_b16 v[224:225], v14 offset:16384
  ds_read_b64_tr_b16 v[226:227], v14 offset:16896
  v_mfma_f32_16x16x32_bf16 v[72:75], v[240:243], a[132:135], v[72:75]
  ds_read_b64_tr_b16 v[228:229], v15 offset:16384
  ds_read_b64_tr_b16 v[230:231], v15 offset:16896
  v_mfma_f32_16x16x32_bf16 v[72:75], v[248:251], a[148:151], v[72:75]
  buffer_load_dwordx4 v13, s[8:11], s42 offen offset:3072 lds
  v_mfma_f32_16x16x32_bf16 v[80:83], v[240:243], a[136:139], v[80:83]
  ds_read_b64_tr_b16 v[232:233], v14 offset:20480
  ds_read_b64_tr_b16 v[234:235], v14 offset:20992
  v_mfma_f32_16x16x32_bf16 v[80:83], v[248:251], a[152:155], v[80:83]
  s_add_u32 m0, s66, 4096
  s_add_u32 s42, s42, 32768
  v_mfma_f32_16x16x32_bf16 v[88:91], v[240:243], a[140:143], v[88:91]
  ds_read_b64_tr_b16 v[236:237], v15 offset:20480
  ds_read_b64_tr_b16 v[238:239], v15 offset:20992
  v_mfma_f32_16x16x32_bf16 v[88:91], v[248:251], a[156:159], v[88:91]
  buffer_load_dwordx4 v10, s[8:11], s42 offen offset:0 lds
  v_mfma_f32_16x16x32_bf16 v[68:71], v[244:247], a[128:131], v[68:71]
  v_mfma_f32_16x16x32_bf16 v[68:71], v[252:255], a[144:147], v[68:71]
  v_mfma_f32_16x16x32_bf16 v[76:79], v[244:247], a[132:135], v[76:79]
  buffer_load_dwordx4 v11, s[8:11], s42 offen offset:1024 lds
  v_mfma_f32_16x16x32_bf16 v[76:79], v[252:255], a[148:151], v[76:79]
  v_mfma_f32_16x16x32_bf16 v[84:87], v[244:247], a[136:139], v[84:87]
  v_mfma_f32_16x16x32_bf16 v[84:87], v[252:255], a[152:155], v[84:87]
  v_mfma_f32_16x16x32_bf16 v[92:95], v[244:247], a[140:143], v[92:95]
  buffer_load_dwordx4 v12, s[8:11], s42 offen offset:2048 lds
  v_mfma_f32_16x16x32_bf16 v[92:95], v[252:255], a[156:159], v[92:95]
  s_waitcnt lgkmcnt(0)
  v_mfma_f32_16x16x32_bf16 v[96:99], v[224:227], a[128:131], v[96:99]
  s_cmp_eq_u32 s78, 2
  s_cbranch_scc1 Lats18
Lat18:
  v_mfma_f32_16x16x32_bf16 v[96:99], v[232:235], a[144:147], v[96:99]
  ds_read_b64_tr_b16 v[240:241], v16 offset:16384
  ds_read_b64_tr_b16 v[242:243], v16 offset:16896
  v_mfma_f32_16x16x32_bf16 v[104:107], v[224:227], a[132:135], v[104:107]
  ds_read_b64_tr_b16 v[244:245], v17 offset:16384
  ds_read_b64_tr_b16 v[246:247], v17 offset:16896
  v_mfma_f32_16x16x32_bf16 v[104:107], v[232:235], a[148:151], v[104:107]
  buffer_load_dwordx4 v13, s[8:11], s42 offen offset:3072 lds
  v_mfma_f32_16x16x32_bf16 v[112:115], v[224:227], a[136:139], v[112:115]
  ds_read_b64_tr_b16 v[248:249], v16 offset:20480
  ds_read_b64_tr_b16 v[250:251], v16 offset:20992
  v_mfma_f32_16x16x32_bf16 v[112:115], v[232:235], a[152:155], v[112:115]
  s_add_u32 m0, s44, 32768
  s_add_u32 s42, s81, 6
  v_mfma_f32_16x16x32_bf16 v[120:123], v[224:227], a[140:143], v[120:123]
  ds_read_b64_tr_b16 v[252:253], v17 offset:20480
  ds_read_b64_tr_b16 v[254:255], v17 offset:20992
  v_mfma_f32_16x16x32_bf16 v[120:123], v[232:235], a[156:159], v[120:123]
  s_and_b32 s42, s42, 7
  s_lshl_b32 s42, s42, 19
  v_mfma_f32_16x16x32_bf16 v[100:103], v[228:231], a[128:131], v[100:103]
  s_add_u32 s42, s42, s67
  v_mfma_f32_16x16x32_bf16 v[100:103], v[236:239], a[144:147], v[100:103]
  buffer_load_dwordx4 v6, s[16:19], s42 offen offset:0 lds
  v_mfma_f32_16x16x32_bf16 v[108:111], v[228:231], a[132:135], v[108:111]
  v_mfma_f32_16x16x32_bf16 v[108:111], v[236:239], a[148:151], v[108:111]
  buffer_load_dwordx4 v7, s[16:19], s42 offen offset:1024 lds
  v_mfma_f32_16x16x32_bf16 v[116:119], v[228:231], a[136:139], v[116:119]
  v_mfma_f32_16x16x32_bf16 v[116:119], v[236:239], a[152:155], v[116:119]
  v_mfma_f32_16x16x32_bf16 v[124:127], v[228:231], a[140:143], v[124:127]
  v_mfma_f32_16x16x32_bf16 v[124:127], v[236:239], a[156:159], v[124:127]
  buffer_load_dwordx4 v8, s[16:19], s42 offen offset:2048 lds
  s_waitcnt lgkmcnt(0)
  v_mfma_f32_16x16x32_bf16 v[128:131], v[240:243], a[128:131], v[128:131]
  s_waitcnt vmcnt(11)
  s_cmp_eq_u32 s78, 3
  s_cbranch_scc1 Lats19
Lat19:
  v_mfma_f32_16x16x32_bf16 v[128:131], v[248:251], a[144:147], v[128:131]
  ds_read_b64_tr_b16 v[224:225], v14 offset:8192
  ds_read_b64_tr_b16 v[226:227], v14 offset:8704
  v_mfma_f32_16x16x32_bf16 v[136:139], v[240:243], a[132:135], v[136:139]
  ds_read_b64_tr_b16 v[228:229], v15 offset:8192
  ds_read_b64_tr_b16 v[230:231], v15 offset:8704
  v_mfma_f32_16x16x32_bf16 v[136:139], v[248:251], a[148:151], v[136:139]
  ds_read_b64_tr_b16 v[232:233], v14 offset:12288
  ds_read_b64_tr_b16 v[234:235], v14 offset:12800
  v_mfma_f32_16x16x32_bf16 v[144:147], v[240:243], a[136:139], v[144:147]
  ds_read_b64_tr_b16 v[236:237], v15 offset:12288
  ds_read_b64_tr_b16 v[238:239], v15 offset:12800
  v_mfma_f32_16x16x32_bf16 v[144:147], v[248:251], a[152:155], v[144:147]
  ds_read_b128 a[160:163], v18 offset:8192
  ds_read_b128 a[164:167], v18 offset:10240
  v_mfma_f32_16x16x32_bf16 v[152:155], v[240:243], a[140:143], v[152:155]
  ds_read_b128 a[168:171], v18 offset:12288
  ds_read_b128 a[172:175], v18 offset:14336
  v_mfma_f32_16x16x32_bf16 v[152:155], v[248:251], a[156:159], v[152:155]
  ds_read_b128 a[176:179], v19 offset:8192
  ds_read_b128 a[180:183], v19 offset:10240
  v_mfma_f32_16x16x32_bf16 v[132:135], v[244:247], a[128:131], v[132:135]
  ds_read_b128 a[184:187], v19 offset:12288
  ds_read_b128 a[188:191], v19 offset:14336
  v_mfma_f32_16x16x32_bf16 v[132:135], v[252:255], a[144:147], v[132:135]
  buffer_load_dwordx4 v9, s[16:19], s42 offen offset:3072 lds
  v_mfma_f32_16x16x32_bf16 v[140:143], v[244:247], a[132:135], v[140:143]
  s_add_u32 m0, s44, 49152
  s_add_u32 s42, s42, 128
  v_mfma_f32_16x16x32_bf16 v[140:143], v[252:255], a[148:151], v[140:143]
  buffer_load_dwordx4 v6, s[16:19], s42 offen offset:0 lds
  v_mfma_f32_16x16x32_bf16 v[148:151], v[244:247], a[136:139], v[148:151]
  v_mfma_f32_16x16x32_bf16 v[148:151], v[252:255], a[152:155], v[148:151]
  v_mfma_f32_16x16x32_bf16 v[156:159], v[244:247], a[140:143], v[156:159]
  v_mfma_f32_16x16x32_bf16 v[156:159], v[252:255], a[156:159], v[156:159]
  buffer_load_dwordx4 v7, s[16:19], s42 offen offset:1024 lds
  s_waitcnt lgkmcnt(0)
  v_mfma_f32_16x16x32_bf16 v[32:35], v[224:227], a[160:163], v[32:35]
  s_cmp_eq_u32 s78, 4
  s_cbranch_scc1 Lats20
Lat20:
  v_mfma_f32_16x16x32_bf16 v[32:35], v[232:235], a[176:179], v[32:35]
  ds_read_b64_tr_b16 v[240:241], v16 offset:8192
  ds_read_b64_tr_b16 v[242:243], v16 offset:8704
  v_mfma_f32_16x16x32_bf16 v[40:43], v[224:227], a[164:167], v[40:43]
  ds_read_b64_tr_b16 v[244:245], v17 offset:8192
  ds_read_b64_tr_b16 v[246:247], v17 offset:8704
  v_mfma_f32_16x16x32_bf16 v[40:43], v[232:235], a[180:183], v[40:43]
  buffer_load_dwordx4 v8, s[16:19], s42 offen offset:2048 lds
  v_mfma_f32_16x16x32_bf16 v[48:51], v[224:227], a[168:171], v[48:51]
  ds_read_b64_tr_b16 v[248:249], v16 offset:12288
  ds_read_b64_tr_b16 v[250:251], v16 offset:12800
  v_mfma_f32_16x16x32_bf16 v[48:51], v[232:235], a[184:187], v[48:51]
  v_mfma_f32_16x16x32_bf16 v[56:59], v[224:227], a[172:175], v[56:59]
  ds_read_b64_tr_b16 v[252:253], v17 offset:12288
  ds_read_b64_tr_b16 v[254:255], v17 offset:12800
  v_mfma_f32_16x16x32_bf16 v[56:59], v[232:235], a[188:191], v[56:59]
  buffer_load_dwordx4 v9, s[16:19], s42 offen offset:3072 lds
  v_mfma_f32_16x16x32_bf16 v[36:39], v[228:231], a[160:163], v[36:39]
  s_add_u32 m0, s66, 8192
  s_add_u32 s42, s71, 7
  v_mfma_f32_16x16x32_bf16 v[36:39], v[236:239], a[176:179], v[36:39]
  s_and_b32 s42, s42, 7
  s_lshl_b32 s42, s42, 7
  v_mfma_f32_16x16x32_bf16 v[44:47], v[228:231], a[164:167], v[44:47]
  s_add_u32 s42, s42, s68
  v_mfma_f32_16x16x32_bf16 v[44:47], v[236:239], a[180:183], v[44:47]
  buffer_load_dwordx4 v10, s[8:11], s42 offen offset:0 lds
  v_mfma_f32_16x16x32_bf16 v[52:55], v[228:231], a[168:171], v[52:55]
  v_mfma_f32_16x16x32_bf16 v[52:55], v[236:239], a[184:187], v[52:55]
  v_mfma_f32_16x16x32_bf16 v[60:63], v[228:231], a[172:175], v[60:63]
  v_mfma_f32_16x16x32_bf16 v[60:63], v[236:239], a[188:191], v[60:63]
  buffer_load_dwordx4 v11, s[8:11], s42 offen offset:1024 lds
  s_waitcnt lgkmcnt(0)
  v_mfma_f32_16x16x32_bf16 v[64:67], v[240:243], a[160:163], v[64:67]
  s_cmp_eq_u32 s78, 5
  s_cbranch_scc1 Lats21
Lat21:
  v_mfma_f32_16x16x32_bf16 v[64:67], v[248:251], a[176:179], v[64:67]
  ds_read_b64_tr_b16 v[224:225], v14 offset:24576
  ds_read_b64_tr_b16 v[226:227], v14 offset:25088
  v_mfma_f32_16x16x32_bf16 v[72:75], v[240:243], a[164:167], v[72:75]
  ds_read_b64_tr_b16 v[228:229], v15 offset:24576
  ds_read_b64_tr_b16 v[230:231], v15 offset:25088
  v_mfma_f32_16x16x32_bf16 v[72:75], v[248:251], a[180:183], v[72:75]
  buffer_load_dwordx4 v12, s[8:11], s42 offen offset:2048 lds
  v_mfma_f32_16x16x32_bf16 v[80:83], v[240:243], a[168:171], v[80:83]
  ds_read_b64_tr_b16 v[232:233], v14 offset:28672
  ds_read_b64_tr_b16 v[234:235], v14 offset:29184
  v_mfma_f32_16x16x32_bf16 v[80:83], v[248:251], a[184:187], v[80:83]
  v_mfma_f32_16x16x32_bf16 v[88:91], v[240:243], a[172:175], v[88:91]
  ds_read_b64_tr_b16 v[236:237], v15 offset:28672
  ds_read_b64_tr_b16 v[238:239], v15 offset:29184
  v_mfma_f32_16x16x32_bf16 v[88:91], v[248:251], a[188:191], v[88:91]
  buffer_load_dwordx4 v13, s[8:11], s42 offen offset:3072 lds
  v_mfma_f32_16x16x32_bf16 v[68:71], v[244:247], a[160:163], v[68:71]
  s_add_u32 m0, s66, 12288
  s_add_u32 s42, s42, 32768
  v_mfma_f32_16x16x32_bf16 v[68:71], v[252:255], a[176:179], v[68:71]
  v_mfma_f32_16x16x32_bf16 v[76:79], v[244:247], a[164:167], v[76:79]
  v_mfma_f32_16x16x32_bf16 v[76:79], v[252:255], a[180:183], v[76:79]
  buffer_load_dwordx4 v10, s[8:11], s42 offen offset:0 lds
  v_mfma_f32_16x16x32_bf16 v[84:87], v[244:247], a[168:171], v[84:87]
  v_mfma_f32_16x16x32_bf16 v[84:87], v[252:255], a[184:187], v[84:87]
  v_mfma_f32_16x16x32_bf16 v[92:95], v[244:247], a[172:175], v[92:95]
  v_mfma_f32_16x16x32_bf16 v[92:95], v[252:255], a[188:191], v[92:95]
  buffer_load_dwordx4 v11, s[8:11], s42 offen offset:1024 lds
  s_waitcnt lgkmcnt(0)
  v_mfma_f32_16x16x32_bf16 v[96:99], v[224:227], a[160:163], v[96:99]
  s_cmp_eq_u32 s78, 6
  s_cbranch_scc1 Lats22
Lat22:
  v_mfma_f32_16x16x32_bf16 v[96:99], v[232:235], a[176:179], v[96:99]
  ds_read_b64_tr_b16 v[240:241], v16 offset:24576
  ds_read_b64_tr_b16 v[242:243], v16 offset:25088
  v_mfma_f32_16x16x32_bf16 v[104:107], v[224:227], a[164:167], v[104:107]
  ds_read_b64_tr_b16 v[244:245], v17 offset:24576
  ds_read_b64_tr_b16 v[246:247], v17 offset:25088
  v_mfma_f32_16x16x32_bf16 v[104:107], v[232:235], a[180:183], v[104:107]
  buffer_load_dwordx4 v12, s[8:11], s42 offen offset:2048 lds
  v_mfma_f32_16x16x32_bf16 v[112:115], v[224:227], a[168:171], v[112:115]
  ds_read_b64_tr_b16 v[248:249], v16 offset:28672
  ds_read_b64_tr_b16 v[250:251], v16 offset:29184
  v_mfma_f32_16x16x32_bf16 v[112:115], v[232:235], a[184:187], v[112:115]
  v_mfma_f32_16x16x32_bf16 v[120:123], v[224:227], a[172:175], v[120:123]
  ds_read_b64_tr_b16 v[252:253], v17 offset:28672
  ds_read_b64_tr_b16 v[254:255], v17 offset:29184
  v_mfma_f32_16x16x32_bf16 v[120:123], v[232:235], a[188:191], v[120:123]
  buffer_load_dwordx4 v13, s[8:11], s42 offen offset:3072 lds
  v_mfma_f32_16x16x32_bf16 v[100:103], v[228:231], a[160:163], v[100:103]
  v_mfma_f32_16x16x32_bf16 v[100:103], v[236:239], a[176:179], v[100:103]
  v_mfma_f32_16x16x32_bf16 v[108:111], v[228:231], a[164:167], v[108:111]
  v_mfma_f32_16x16x32_bf16 v[108:111], v[236:239], a[180:183], v[108:111]
  v_mfma_f32_16x16x32_bf16 v[116:119], v[228:231], a[168:171], v[116:119]
  v_mfma_f32_16x16x32_bf16 v[116:119], v[236:239], a[184:187], v[116:119]
  v_mfma_f32_16x16x32_bf16 v[124:127], v[228:231], a[172:175], v[124:127]
  v_mfma_f32_16x16x32_bf16 v[124:127], v[236:239], a[188:191], v[124:127]
  s_waitcnt lgkmcnt(0)
  v_mfma_f32_16x16x32_bf16 v[128:131], v[240:243], a[160:163], v[128:131]
  s_waitcnt vmcnt(8)
  s_barrier
  s_cmp_eq_u32 s78, 7
  s_cbranch_scc1 Lats23
Lat23:
  v_mfma_f32_16x16x32_bf16 v[128:131], v[248:251], a[176:179], v[128:131]
  ds_read_b64_tr_b16 v[224:225], v14 offset:32768
  ds_read_b64_tr_b16 v[226:227], v14 offset:33280
  v_mfma_f32_16x16x32_bf16 v[136:139], v[240:243], a[164:167], v[136:139]
  ds_read_b64_tr_b16 v[228:229], v15 offset:32768
  ds_read_b64_tr_b16 v[230:231], v15 offset:33280
  v_mfma_f32_16x16x32_bf16 v[136:139], v[248:251], a[180:183], v[136:139]
  ds_read_b64_tr_b16 v[232:233], v14 offset:36864
  ds_read_b64_tr_b16 v[234:235], v14 offset:37376
  v_mfma_f32_16x16x32_bf16 v[144:147], v[240:243], a[168:171], v[144:147]
  ds_read_b64_tr_b16 v[236:237], v15 offset:36864
  ds_read_b64_tr_b16 v[238:239], v15 offset:37376
  v_mfma_f32_16x16x32_bf16 v[144:147], v[248:251], a[184:187], v[144:147]
  ds_read_b128 a[192:195], v18 offset:0
  ds_read_b128 a[196:199], v18 offset:2048
  v_mfma_f32_16x16x32_bf16 v[152:155], v[240:243], a[172:175], v[152:155]
  ds_read_b128 a[200:203], v18 offset:4096
  ds_read_b128 a[204:207], v18 offset:6144
  v_mfma_f32_16x16x32_bf16 v[152:155], v[248:251], a[188:191], v[152:155]
  ds_read_b128 a[208:211], v19 offset:0
  ds_read_b128 a[212:215], v19 offset:2048
  v_mfma_f32_16x16x32_bf16 v[132:135], v[244:247], a[160:163], v[132:135]
  ds_read_b128 a[216:219], v19 offset:4096
  ds_read_b128 a[220:223], v19 offset:6144
  v_mfma_f32_16x16x32_bf16 v[132:135], v[252:255], a[176:179], v[132:135]
  v_mfma_f32_16x16x32_bf16 v[140:143], v[244:247], a[164:167], v[140:143]
  v_mfma_f32_16x16x32_bf16 v[140:143], v[252:255], a[180:183], v[140:143]
  v_mfma_f32_16x16x32_bf16 v[148:151], v[244:247], a[168:171], v[148:151]
  v_mfma_f32_16x16x32_bf16 v[148:151], v[252:255], a[184:187], v[148:151]
  v_mfma_f32_16x16x32_bf16 v[156:159], v[244:247], a[172:175], v[156:159]
  v_mfma_f32_16x16x32_bf16 v[156:159], v[252:255], a[188:191], v[156:159]
  s_waitcnt lgkmcnt(0)
  v_mfma_f32_16x16x32_bf16 v[32:35], v[224:227], a[192:195], v[32:35]
  s_cmp_eq_u32 s78, 8
  s_cbranch_scc1 Lats24
Lat24:
  v_mfma_f32_16x16x32_bf16 v[32:35], v[232:235], a[208:211], v[32:35]
  ds_read_b64_tr_b16 v[240:241], v16 offset:32768
  ds_read_b64_tr_b16 v[242:243], v16 offset:33280
  v_mfma_f32_16x16x32_bf16 v[40:43], v[224:227], a[196:199], v[40:43]
  ds_read_b64_tr_b16 v[244:245], v17 offset:32768
  ds_read_b64_tr_b16 v[246:247], v17 offset:33280
  v_mfma_f32_16x16x32_bf16 v[40:43], v[232:235], a[212:215], v[40:43]
  global_load_dword v27, v2, s[88:89]
  v_mfma_f32_16x16x32_bf16 v[48:51], v[224:227], a[200:203], v[48:51]
  ds_read_b64_tr_b16 v[248:249], v16 offset:36864
  ds_read_b64_tr_b16 v[250:251], v16 offset:37376
  v_mfma_f32_16x16x32_bf16 v[48:51], v[232:235], a[216:219], v[48:51]
  s_add_u32 m0, s44, 81920
  s_add_u32 s42, s81, 2
  v_mfma_f32_16x16x32_bf16 v[56:59], v[224:227], a[204:207], v[56:59]
  ds_read_b64_tr_b16 v[252:253], v17 offset:36864
  ds_read_b64_tr_b16 v[254:255], v17 offset:37376
  v_mfma_f32_16x16x32_bf16 v[56:59], v[232:235], a[220:223], v[56:59]
  s_and_b32 s42, s42, 7
  s_lshl_b32 s42, s42, 19
  v_mfma_f32_16x16x32_bf16 v[36:39], v[228:231], a[192:195], v[36:39]
  s_add_u32 s42, s42, s67
  s_xor_b32 s42, s42, 256
  v_mfma_f32_16x16x32_bf16 v[36:39], v[236:239], a[208:211], v[36:39]
  buffer_load_dwordx4 v6, s[20:23], s42 offen offset:0 lds
  v_mfma_f32_16x16x32_bf16 v[44:47], v[228:231], a[196:199], v[44:47]
  v_mfma_f32_16x16x32_bf16 v[44:47], v[236:239], a[212:215], v[44:47]
  buffer_load_dwordx4 v7, s[20:23], s42 offen offset:1024 lds
  v_mfma_f32_16x16x32_bf16 v[52:55], v[228:231], a[200:203], v[52:55]
  v_mfma_f32_16x16x32_bf16 v[52:55], v[236:239], a[216:219], v[52:55]
  v_mfma_f32_16x16x32_bf16 v[60:63], v[228:231], a[204:207], v[60:63]
  v_mfma_f32_16x16x32_bf16 v[60:63], v[236:239], a[220:223], v[60:63]
  buffer_load_dwordx4 v8, s[20:23], s42 offen offset:2048 lds
  s_waitcnt lgkmcnt(0)
  v_mfma_f32_16x16x32_bf16 v[64:67], v[240:243], a[192:195], v[64:67]
  s_cmp_eq_u32 s78, 9
  s_cbranch_scc1 Lats25
Lat25:
  v_mfma_f32_16x16x32_bf16 v[64:67], v[248:251], a[208:211], v[64:67]
  ds_read_b64_tr_b16 v[224:225], v14 offset:49152
  ds_read_b64_tr_b16 v[226:227], v14 offset:49664
  v_mfma_f32_16x16x32_bf16 v[72:75], v[240:243], a[196:199], v[72:75]
  ds_read_b64_tr_b16 v[228:229], v15 offset:49152
  ds_read_b64_tr_b16 v[230:231], v15 offset:49664
  v_mfma_f32_16x16x32_bf16 v[72:75], v[248:251], a[212:215], v[72:75]
  buffer_load_dwordx4 v9, s[20:23], s42 offen offset:3072 lds
  v_mfma_f32_16x16x32_bf16 v[80:83], v[240:243], a[200:203], v[80:83]
  ds_read_b64_tr_b16 v[232:233], v14 offset:53248
  ds_read_b64_tr_b16 v[234:235], v14 offset:53760
  v_mfma_f32_16x16x32_bf16 v[80:83], v[248:251], a[216:219], v[80:83]
  v_mfma_f32_16x16x32_bf16 v[88:91], v[240:243], a[204:207], v[88:91]
  ds_read_b64_tr_b16 v[236:237], v15 offset:53248
  ds_read_b64_tr_b16 v[238:239], v15 offset:53760
  v_mfma_f32_16x16x32_bf16 v[88:91], v[248:251], a[220:223], v[88:91]
  v_mfma_f32_16x16x32_bf16 v[68:71], v[244:247], a[192:195], v[68:71]
  v_mfma_f32_16x16x32_bf16 v[68:71], v[252:255], a[208:211], v[68:71]
  v_mfma_f32_16x16x32_bf16 v[76:79], v[244:247], a[196:199], v[76:79]
  v_mfma_f32_16x16x32_bf16 v[76:79], v[252:255], a[212:215], v[76:79]
  v_mfma_f32_16x16x32_bf16 v[84:87], v[244:247], a[200:203], v[84:87]
  v_mfma_f32_16x16x32_bf16 v[84:87], v[252:255], a[216:219], v[84:87]
  v_mfma_f32_16x16x32_bf16 v[92:95], v[244:247], a[204:207], v[92:95]
  v_mfma_f32_16x16x32_bf16 v[92:95], v[252:255], a[220:223], v[92:95]
  s_waitcnt lgkmcnt(0)
  v_mfma_f32_16x16x32_bf16 v[96:99], v[224:227], a[192:195], v[96:99]
  s_cmp_eq_u32 s78, 10
  s_cbranch_scc1 Lats26
Lat26:
  v_mfma_f32_16x16x32_bf16 v[96:99], v[232:235], a[208:211], v[96:99]
  ds_read_b64_tr_b16 v[240:241], v16 offset:49152
  ds_read_b64_tr_b16 v[242:243], v16 offset:49664
  v_mfma_f32_16x16x32_bf16 v[104:107], v[224:227], a[196:199], v[104:107]
  ds_read_b64_tr_b16 v[244:245], v17 offset:49152
  ds_read_b64_tr_b16 v[246:247], v17 offset:49664
  v_mfma_f32_16x16x32_bf16 v[104:107], v[232:235], a[212:215], v[104:107]
  v_mfma_f32_16x16x32_bf16 v[112:115], v[224:227], a[200:203], v[112:115]
  ds_read_b64_tr_b16 v[248:249], v16 offset:53248
  ds_read_b64_tr_b16 v[250:251], v16 offset:53760
  v_mfma_f32_16x16x32_bf16 v[112:115], v[232:235], a[216:219], v[112:115]
  v_mfma_f32_16x16x32_bf16 v[120:123], v[224:227], a[204:207], v[120:123]
  ds_read_b64_tr_b16 v[252:253], v17 offset:53248
  ds_read_b64_tr_b16 v[254:255], v17 offset:53760
  v_mfma_f32_16x16x32_bf16 v[120:123], v[232:235], a[220:223], v[120:123]
  v_mfma_f32_16x16x32_bf16 v[100:103], v[228:231], a[192:195], v[100:103]
  v_mfma_f32_16x16x32_bf16 v[100:103], v[236:239], a[208:211], v[100:103]
  v_mfma_f32_16x16x32_bf16 v[108:111], v[228:231], a[196:199], v[108:111]
  v_mfma_f32_16x16x32_bf16 v[108:111], v[236:239], a[212:215], v[108:111]
  v_mfma_f32_16x16x32_bf16 v[116:119], v[228:231], a[200:203], v[116:119]
  v_mfma_f32_16x16x32_bf16 v[116:119], v[236:239], a[216:219], v[116:119]
  v_mfma_f32_16x16x32_bf16 v[124:127], v[228:231], a[204:207], v[124:127]
  v_mfma_f32_16x16x32_bf16 v[124:127], v[236:239], a[220:223], v[124:127]
  s_waitcnt lgkmcnt(0)
  v_mfma_f32_16x16x32_bf16 v[128:131], v[240:243], a[192:195], v[128:131]
  s_waitcnt vmcnt(5)
  s_cmp_eq_u32 s78, 11
  s_cbranch_scc1 Lats27
Lat27:
  v_mfma_f32_16x16x32_bf16 v[128:131], v[248:251], a[208:211], v[128:131]
  ds_read_b64_tr_b16 v[224:225], v14 offset:40960
  ds_read_b64_tr_b16 v[226:227], v14 offset:41472
  v_mfma_f32_16x16x32_bf16 v[136:139], v[240:243], a[196:199], v[136:139]
  ds_read_b64_tr_b16 v[228:229], v15 offset:40960
  ds_read_b64_tr_b16 v[230:231], v15 offset:41472
  v_mfma_f32_16x16x32_bf16 v[136:139], v[248:251], a[212:215], v[136:139]
  ds_read_b64_tr_b16 v[232:233], v14 offset:45056
  ds_read_b64_tr_b16 v[234:235], v14 offset:45568
  v_mfma_f32_16x16x32_bf16 v[144:147], v[240:243], a[200:203], v[144:147]
  ds_read_b64_tr_b16 v[236:237], v15 offset:45056
  ds_read_b64_tr_b16 v[238:239], v15 offset:45568
  v_mfma_f32_16x16x32_bf16 v[144:147], v[248:251], a[216:219], v[144:147]
  ds_read_b128 a[224:227], v18 offset:8192
  ds_read_b128 a[228:231], v18 offset:10240
  v_mfma_f32_16x16x32_bf16 v[152:155], v[240:243], a[204:207], v[152:155]
  ds_read_b128 a[232:235], v18 offset:12288
  ds_read_b128 a[236:239], v18 offset:14336
  v_mfma_f32_16x16x32_bf16 v[152:155], v[248:251], a[220:223], v[152:155]
  ds_read_b128 a[240:243], v19 offset:8192
  ds_read_b128 a[244:247], v19 offset:10240
  v_mfma_f32_16x16x32_bf16 v[132:135], v[244:247], a[192:195], v[132:135]
  ds_read_b128 a[248:251], v19 offset:12288
  ds_read_b128 a[252:255], v19 offset:14336
  v_mfma_f32_16x16x32_bf16 v[132:135], v[252:255], a[208:211], v[132:135]
  v_mfma_f32_16x16x32_bf16 v[140:143], v[244:247], a[196:199], v[140:143]
  v_mfma_f32_16x16x32_bf16 v[140:143], v[252:255], a[212:215], v[140:143]
  v_mfma_f32_16x16x32_bf16 v[148:151], v[244:247], a[200:203], v[148:151]
  v_mfma_f32_16x16x32_bf16 v[148:151], v[252:255], a[216:219], v[148:151]
  v_mfma_f32_16x16x32_bf16 v[156:159], v[244:247], a[204:207], v[156:159]
  v_mfma_f32_16x16x32_bf16 v[156:159], v[252:255], a[220:223], v[156:159]
  s_waitcnt lgkmcnt(0)
  v_mfma_f32_16x16x32_bf16 v[32:35], v[224:227], a[224:227], v[32:35]
  s_barrier
  s_cmp_eq_u32 s78, 12
  s_cbranch_scc1 Lats28
Lat28:
  v_mfma_f32_16x16x32_bf16 v[32:35], v[232:235], a[240:243], v[32:35]
  ds_read_b64_tr_b16 v[240:241], v16 offset:40960
  ds_read_b64_tr_b16 v[242:243], v16 offset:41472
  v_mfma_f32_16x16x32_bf16 v[40:43], v[224:227], a[228:231], v[40:43]
  ds_read_b64_tr_b16 v[244:245], v17 offset:40960
  ds_read_b64_tr_b16 v[246:247], v17 offset:41472
  v_mfma_f32_16x16x32_bf16 v[40:43], v[232:235], a[244:247], v[40:43]
  s_add_u32 m0, s44, 98304
  s_add_u32 s42, s81, 4
  v_mfma_f32_16x16x32_bf16 v[48:51], v[224:227], a[232:235], v[48:51]
  ds_read_b64_tr_b16 v[248:249], v16 offset:45056
  ds_read_b64_tr_b16 v[250:251], v16 offset:45568
  v_mfma_f32_16x16x32_bf16 v[48:51], v[232:235], a[248:251], v[48:51]
  s_and_b32 s42, s42, 7
  s_lshl_b32 s42, s42, 19
  v_mfma_f32_16x16x32_bf16 v[56:59], v[224:227], a[236:239], v[56:59]
  ds_read_b64_tr_b16 v[252:253], v17 offset:45056
  ds_read_b64_tr_b16 v[254:255], v17 offset:45568
  v_mfma_f32_16x16x32_bf16 v[56:59], v[232:235], a[252:255], v[56:59]
  s_add_u32 s42, s42, s67
  s_xor_b32 s42, s42, 256
  v_mfma_f32_16x16x32_bf16 v[36:39], v[228:231], a[224:227], v[36:39]
  buffer_load_dwordx4 v6, s[20:23], s42 offen offset:0 lds
  v_mfma_f32_16x16x32_bf16 v[36:39], v[236:239], a[240:243], v[36:39]
  v_mfma_f32_16x16x32_bf16 v[44:47], v[228:231], a[228:231], v[44:47]
  buffer_load_dwordx4 v7, s[20:23], s42 offen offset:1024 lds
  v_mfma_f32_16x16x32_bf16 v[44:47], v[236:239], a[244:247], v[44:47]
  v_mfma_f32_16x16x32_bf16 v[52:55], v[228:231], a[232:235], v[52:55]
  v_mfma_f32_16x16x32_bf16 v[52:55], v[236:239], a[248:251], v[52:55]
  v_mfma_f32_16x16x32_bf16 v[60:63], v[228:231], a[236:239], v[60:63]
  buffer_load_dwordx4 v8, s[20:23], s42 offen offset:2048 lds
  v_mfma_f32_16x16x32_bf16 v[60:63], v[236:239], a[252:255], v[60:63]
  s_waitcnt lgkmcnt(0)
  v_mfma_f32_16x16x32_bf16 v[64:67], v[240:243], a[224:227], v[64:67]
  s_cmp_eq_u32 s78, 13
  s_cbranch_scc1 Lats29
Lat29:
  v_mfma_f32_16x16x32_bf16 v[64:67], v[248:251], a[240:243], v[64:67]
  ds_read_b64_tr_b16 v[224:225], v14 offset:57344
  ds_read_b64_tr_b16 v[226:227], v14 offset:57856
  v_mfma_f32_16x16x32_bf16 v[72:75], v[240:243], a[228:231], v[72:75]
  ds_read_b64_tr_b16 v[228:229], v15 offset:57344
  ds_read_b64_tr_b16 v[230:231], v15 offset:57856
  v_mfma_f32_16x16x32_bf16 v[72:75], v[248:251], a[244:247], v[72:75]
  buffer_load_dwordx4 v9, s[20:23], s42 offen offset:3072 lds
  v_mfma_f32_16x16x32_bf16 v[80:83], v[240:243], a[232:235], v[80:83]
  ds_read_b64_tr_b16 v[232:233], v14 offset:61440
  ds_read_b64_tr_b16 v[234:235], v14 offset:61952
  v_mfma_f32_16x16x32_bf16 v[80:83], v[248:251], a[248:251], v[80:83]
  s_add_u32 m0, s44, 114688
  s_add_u32 s42, s81, 6
  v_mfma_f32_16x16x32_bf16 v[88:91], v[240:243], a[236:239], v[88:91]
  ds_read_b64_tr_b16 v[236:237], v15 offset:61440
  ds_read_b64_tr_b16 v[238:239], v15 offset:61952
  v_mfma_f32_16x16x32_bf16 v[88:91], v[248:251], a[252:255], v[88:91]
  s_and_b32 s42, s42, 7
  s_lshl_b32 s42, s42, 19
  v_mfma_f32_16x16x32_bf16 v[68:71], v[244:247], a[224:227], v[68:71]
  s_add_u32 s42, s42, s67
  s_xor_b32 s42, s42, 256
  v_mfma_f32_16x16x32_bf16 v[68:71], v[252:255], a[240:243], v[68:71]
  buffer_load_dwordx4 v6, s[20:23], s42 offen offset:0 lds
  v_mfma_f32_16x16x32_bf16 v[76:79], v[244:247], a[228:231], v[76:79]
  v_mfma_f32_16x16x32_bf16 v[76:79], v[252:255], a[244:247], v[76:79]
  buffer_load_dwordx4 v7, s[20:23], s42 offen offset:1024 lds
  v_mfma_f32_16x16x32_bf16 v[84:87], v[244:247], a[232:235], v[84:87]
  v_mfma_f32_16x16x32_bf16 v[84:87], v[252:255], a[248:251], v[84:87]
  v_mfma_f32_16x16x32_bf16 v[92:95], v[244:247], a[236:239], v[92:95]
  v_mfma_f32_16x16x32_bf16 v[92:95], v[252:255], a[252:255], v[92:95]
  buffer_load_dwordx4 v8, s[20:23], s42 offen offset:2048 lds
  s_waitcnt lgkmcnt(0)
  v_mfma_f32_16x16x32_bf16 v[96:99], v[224:227], a[224:227], v[96:99]
  s_cmp_eq_u32 s78, 14
  s_cbranch_scc1 Lats30
Lat30:
  v_mfma_f32_16x16x32_bf16 v[96:99], v[232:235], a[240:243], v[96:99]
  ds_read_b64_tr_b16 v[240:241], v16 offset:57344
  ds_read_b64_tr_b16 v[242:243], v16 offset:57856
  v_mfma_f32_16x16x32_bf16 v[104:107], v[224:227], a[228:231], v[104:107]
  ds_read_b64_tr_b16 v[244:245], v17 offset:57344
  ds_read_b64_tr_b16 v[246:247], v17 offset:57856
  v_mfma_f32_16x16x32_bf16 v[104:107], v[232:235], a[244:247], v[104:107]
  buffer_load_dwordx4 v9, s[20:23], s42 offen offset:3072 lds
  v_mfma_f32_16x16x32_bf16 v[112:115], v[224:227], a[232:235], v[112:115]
  ds_read_b64_tr_b16 v[248:249], v16 offset:61440
  ds_read_b64_tr_b16 v[250:251], v16 offset:61952
  v_mfma_f32_16x16x32_bf16 v[112:115], v[232:235], a[248:251], v[112:115]
  v_mul_f32 v32, s70, v32
  v_mul_f32 v33, s70, v33
  v_mfma_f32_16x16x32_bf16 v[120:123], v[224:227], a[236:239], v[120:123]
  ds_read_b64_tr_b16 v[252:253], v17 offset:61440
  ds_read_b64_tr_b16 v[254:255], v17 offset:61952
  v_mfma_f32_16x16x32_bf16 v[120:123], v[232:235], a[252:255], v[120:123]
  v_cvt_pk_bf16_f32 v32, v32, v33
  v_mul_f32_e64 v34, s70, v34
  v_mfma_f32_16x16x32_bf16 v[100:103], v[228:231], a[224:227], v[100:103]
  v_mul_f32_e64 v35, s70, v35
  v_cvt_pk_bf16_f32 v33, v34, v35
  v_mfma_f32_16x16x32_bf16 v[100:103], v[236:239], a[240:243], v[100:103]
  v_mul_f32 v36, s70, v36
  v_mul_f32 v37, s70, v37
  v_mfma_f32_16x16x32_bf16 v[108:111], v[228:231], a[228:231], v[108:111]
  v_cvt_pk_bf16_f32 v34, v36, v37
  v_mul_f32_e64 v38, s70, v38
  v_mfma_f32_16x16x32_bf16 v[108:111], v[236:239], a[244:247], v[108:111]
  v_mul_f32_e64 v39, s70, v39
  v_cvt_pk_bf16_f32 v35, v38, v39
  v_mfma_f32_16x16x32_bf16 v[116:119], v[228:231], a[232:235], v[116:119]
  v_mul_f32 v40, s70, v40
  v_mul_f32 v41, s70, v41
  v_mfma_f32_16x16x32_bf16 v[116:119], v[236:239], a[248:251], v[116:119]
  v_cvt_pk_bf16_f32 v40, v40, v41
  v_mul_f32_e64 v42, s70, v42
  v_mfma_f32_16x16x32_bf16 v[124:127], v[228:231], a[236:239], v[124:127]
  v_mul_f32_e64 v43, s70, v43
  v_cvt_pk_bf16_f32 v41, v42, v43
  v_mfma_f32_16x16x32_bf16 v[124:127], v[236:239], a[252:255], v[124:127]
  v_mul_f32 v44, s70, v44
  v_mul_f32_e64 v45, s70, v45
  s_waitcnt lgkmcnt(0)
  v_mfma_f32_16x16x32_bf16 v[128:131], v[240:243], a[224:227], v[128:131]
  s_waitcnt vmcnt(8)
  s_barrier
  s_cmp_eq_u32 s78, 15
  s_cbranch_scc1 Lats31
Lat31:
  v_mfma_f32_16x16x32_bf16 v[128:131], v[248:251], a[240:243], v[128:131]
  ds_read_b64_tr_b16 v[224:225], v20 offset:0
  ds_read_b64_tr_b16 v[226:227], v20 offset:512
  v_mfma_f32_16x16x32_bf16 v[136:139], v[240:243], a[228:231], v[136:139]
  ds_read_b64_tr_b16 v[228:229], v21 offset:0
  ds_read_b64_tr_b16 v[230:231], v21 offset:512
  v_mfma_f32_16x16x32_bf16 v[136:139], v[248:251], a[244:247], v[136:139]
  v_cvt_pk_bf16_f32 v42, v44, v45
  v_mul_f32_e64 v46, s70, v46
  v_mfma_f32_16x16x32_bf16 v[144:147], v[240:243], a[232:235], v[144:147]
  ds_read_b64_tr_b16 v[232:233], v20 offset:4096
  ds_read_b64_tr_b16 v[234:235], v20 offset:4608
  v_mfma_f32_16x16x32_bf16 v[144:147], v[248:251], a[248:251], v[144:147]
  v_mul_f32_e64 v47, s70, v47
  v_cvt_pk_bf16_f32 v43, v46, v47
  v_mfma_f32_16x16x32_bf16 v[152:155], v[240:243], a[236:239], v[152:155]
  ds_read_b64_tr_b16 v[236:237], v21 offset:4096
  ds_read_b64_tr_b16 v[238:239], v21 offset:4608
  v_mfma_f32_16x16x32_bf16 v[152:155], v[248:251], a[252:255], v[152:155]
  v_mul_f32 v48, s70, v48
  v_mul_f32 v49, s70, v49
  v_mfma_f32_16x16x32_bf16 v[132:135], v[244:247], a[224:227], v[132:135]
  v_cvt_pk_bf16_f32 v48, v48, v49
  v_mul_f32_e64 v50, s70, v50
  v_mfma_f32_16x16x32_bf16 v[132:135], v[252:255], a[240:243], v[132:135]
  v_mul_f32_e64 v51, s70, v51
  v_cvt_pk_bf16_f32 v49, v50, v51
  v_mfma_f32_16x16x32_bf16 v[140:143], v[244:247], a[228:231], v[140:143]
  v_mul_f32 v52, s70, v52
  v_mul_f32 v53, s70, v53
  v_mfma_f32_16x16x32_bf16 v[140:143], v[252:255], a[244:247], v[140:143]
  v_cvt_pk_bf16_f32 v50, v52, v53
  v_mul_f32_e64 v54, s70, v54
  v_mfma_f32_16x16x32_bf16 v[148:151], v[244:247], a[232:235], v[148:151]
  v_mul_f32_e64 v55, s70, v55
  v_cvt_pk_bf16_f32 v51, v54, v55
  v_mfma_f32_16x16x32_bf16 v[148:151], v[252:255], a[248:251], v[148:151]
  v_mul_f32 v56, s70, v56
  v_mul_f32 v57, s70, v57
  v_mfma_f32_16x16x32_bf16 v[156:159], v[244:247], a[236:239], v[156:159]
  v_cvt_pk_bf16_f32 v56, v56, v57
  v_mul_f32_e64 v58, s70, v58
  v_mfma_f32_16x16x32_bf16 v[156:159], v[252:255], a[252:255], v[156:159]
  v_mul_f32_e64 v59, s70, v59
  v_cvt_pk_bf16_f32 v57, v58, v59
  s_waitcnt lgkmcnt(0)
  v_mfma_f32_16x16x32_bf16 v[160:163], a[0:3], v[224:227], 0
  ds_read_b64_tr_b16 v[240:241], v20 offset:8192
  ds_read_b64_tr_b16 v[242:243], v20 offset:8704
  v_mfma_f32_16x16x32_bf16 v[160:163], a[16:19], v[232:235], v[160:163]
  ds_read_b64_tr_b16 v[244:245], v21 offset:8192
  ds_read_b64_tr_b16 v[246:247], v21 offset:8704
  v_mfma_f32_16x16x32_bf16 v[164:167], a[4:7], v[224:227], 0
  ds_read_b64_tr_b16 v[248:249], v20 offset:12288
  ds_read_b64_tr_b16 v[250:251], v20 offset:12800
  v_mfma_f32_16x16x32_bf16 v[164:167], a[20:23], v[232:235], v[164:167]
  s_add_u32 m0, s44, 0
  s_add_u32 s42, s81, 0
  v_mfma_f32_16x16x32_bf16 v[176:179], a[8:11], v[224:227], 0
  ds_read_b64_tr_b16 v[252:253], v21 offset:12288
  ds_read_b64_tr_b16 v[254:255], v21 offset:12800
  v_mfma_f32_16x16x32_bf16 v[176:179], a[24:27], v[232:235], v[176:179]
  s_and_b32 s42, s42, 7
  s_lshl_b32 s42, s42, 19
  v_mfma_f32_16x16x32_bf16 v[180:183], a[12:15], v[224:227], 0
  s_add_u32 s42, s42, s67
  s_xor_b32 s42, s42, 384
  v_mfma_f32_16x16x32_bf16 v[180:183], a[28:31], v[232:235], v[180:183]
  buffer_load_dwordx4 v6, s[20:23], s42 offen offset:0 lds
  v_mfma_f32_16x16x32_bf16 v[168:171], a[0:3], v[228:231], 0
  v_mul_f32 v60, s70, v60
  v_mul_f32 v61, s70, v61
  v_mfma_f32_16x16x32_bf16 v[168:171], a[16:19], v[236:239], v[168:171]
  v_cvt_pk_bf16_f32 v58, v60, v61
  v_mul_f32_e64 v62, s70, v62
  v_mfma_f32_16x16x32_bf16 v[172:175], a[4:7], v[228:231], 0
  v_mul_f32_e64 v63, s70, v63
  v_cvt_pk_bf16_f32 v59, v62, v63
  v_mfma_f32_16x16x32_bf16 v[172:175], a[20:23], v[236:239], v[172:175]
  s_xor_b32 s79, s96, 0
  v_mul_f32 v64, s70, v64
  v_mfma_f32_16x16x32_bf16 v[184:187], a[8:11], v[228:231], 0
  buffer_store_dwordx4 v[32:35], v1, s[24:27], s79 offen sc1
  v_mfma_f32_16x16x32_bf16 v[184:187], a[24:27], v[236:239], v[184:187]
  v_mul_f32_e64 v65, s70, v65
  v_cvt_pk_bf16_f32 v64, v64, v65
  v_mfma_f32_16x16x32_bf16 v[188:191], a[12:15], v[228:231], 0
  v_mul_f32 v66, s70, v66
  v_mul_f32 v67, s70, v67
  v_mfma_f32_16x16x32_bf16 v[188:191], a[28:31], v[236:239], v[188:191]
  buffer_load_dwordx4 v7, s[20:23], s42 offen offset:1024 lds
  s_waitcnt lgkmcnt(0)
  v_mfma_f32_16x16x32_bf16 v[160:163], a[32:35], v[240:243], v[160:163]
  ds_read_b64_tr_b16 v[224:225], v20 offset:16384
  ds_read_b64_tr_b16 v[226:227], v20 offset:16896
  v_mfma_f32_16x16x32_bf16 v[160:163], a[48:51], v[248:251], v[160:163]
  ds_read_b64_tr_b16 v[228:229], v21 offset:16384
  ds_read_b64_tr_b16 v[230:231], v21 offset:16896
  v_mfma_f32_16x16x32_bf16 v[164:167], a[36:39], v[240:243], v[164:167]
  ds_read_b64_tr_b16 v[232:233], v20 offset:20480
  ds_read_b64_tr_b16 v[234:235], v20 offset:20992
  v_mfma_f32_16x16x32_bf16 v[164:167], a[52:55], v[248:251], v[164:167]
  v_cvt_pk_bf16_f32 v65, v66, v67
  v_mul_f32 v68, s70, v68
  v_mfma_f32_16x16x32_bf16 v[176:179], a[40:43], v[240:243], v[176:179]
  ds_read_b64_tr_b16 v[236:237], v21 offset:20480
  ds_read_b64_tr_b16 v[238:239], v21 offset:20992
  v_mfma_f32_16x16x32_bf16 v[176:179], a[56:59], v[248:251], v[176:179]
  v_mul_f32_e64 v69, s70, v69
  v_cvt_pk_bf16_f32 v66, v68, v69
  v_mfma_f32_16x16x32_bf16 v[180:183], a[44:47], v[240:243], v[180:183]
  v_mul_f32 v70, s70, v70
  v_mul_f32 v71, s70, v71
  v_mfma_f32_16x16x32_bf16 v[180:183], a[60:63], v[248:251], v[180:183]
  v_cvt_pk_bf16_f32 v67, v70, v71
  v_mul_f32_e64 v72, s70, v72
  v_mfma_f32_16x16x32_bf16 v[168:171], a[32:35], v[244:247], v[168:171]
  v_mul_f32_e64 v73, s70, v73
  v_cvt_pk_bf16_f32 v72, v72, v73
  v_mfma_f32_16x16x32_bf16 v[168:171], a[48:51], v[252:255], v[168:171]
  buffer_load_dwordx4 v8, s[20:23], s42 offen offset:2048 lds
  v_mfma_f32_16x16x32_bf16 v[172:175], a[36:39], v[244:247], v[172:175]
  s_xor_b32 s79, s96, 4096
  v_mul_f32_e64 v74, s70, v74
  v_mfma_f32_16x16x32_bf16 v[172:175], a[52:55], v[252:255], v[172:175]
  v_mul_f32_e64 v75, s70, v75
  v_cvt_pk_bf16_f32 v73, v74, v75
  v_mfma_f32_16x16x32_bf16 v[184:187], a[40:43], v[244:247], v[184:187]
  buffer_store_dwordx4 v[40:43], v1, s[24:27], s79 offen sc1
  v_mfma_f32_16x16x32_bf16 v[184:187], a[56:59], v[252:255], v[184:187]
  v_mul_f32 v76, s70, v76
  v_mul_f32 v77, s70, v77
  v_mfma_f32_16x16x32_bf16 v[188:191], a[44:47], v[244:247], v[188:191]
  v_cvt_pk_bf16_f32 v74, v76, v77
  v_mul_f32_e64 v78, s70, v78
  v_mfma_f32_16x16x32_bf16 v[188:191], a[60:63], v[252:255], v[188:191]
  v_mul_f32_e64 v79, s70, v79
  v_cvt_pk_bf16_f32 v75, v78, v79
  s_waitcnt lgkmcnt(0)
  v_mfma_f32_16x16x32_bf16 v[160:163], a[64:67], v[224:227], v[160:163]
  ds_read_b64_tr_b16 v[240:241], v20 offset:24576
  ds_read_b64_tr_b16 v[242:243], v20 offset:25088
  v_mfma_f32_16x16x32_bf16 v[160:163], a[80:83], v[232:235], v[160:163]
  ds_read_b64_tr_b16 v[244:245], v21 offset:24576
  ds_read_b64_tr_b16 v[246:247], v21 offset:25088
  v_mfma_f32_16x16x32_bf16 v[164:167], a[68:71], v[224:227], v[164:167]
  ds_read_b64_tr_b16 v[248:249], v20 offset:28672
  ds_read_b64_tr_b16 v[250:251], v20 offset:29184
  v_mfma_f32_16x16x32_bf16 v[164:167], a[84:87], v[232:235], v[164:167]
  buffer_load_dwordx4 v9, s[20:23], s42 offen offset:3072 lds
  v_mfma_f32_16x16x32_bf16 v[176:179], a[72:75], v[224:227], v[176:179]
  ds_read_b64_tr_b16 v[252:253], v21 offset:28672
  ds_read_b64_tr_b16 v[254:255], v21 offset:29184
  v_mfma_f32_16x16x32_bf16 v[176:179], a[88:91], v[232:235], v[176:179]
  s_add_u32 m0, s44, 16384
  s_add_u32 s42, s81, 2
  v_mfma_f32_16x16x32_bf16 v[180:183], a[76:79], v[224:227], v[180:183]
  s_and_b32 s42, s42, 7
  s_lshl_b32 s42, s42, 19
  v_mfma_f32_16x16x32_bf16 v[180:183], a[92:95], v[232:235], v[180:183]
  s_add_u32 s42, s42, s67
  s_xor_b32 s42, s42, 384
  v_mfma_f32_16x16x32_bf16 v[168:171], a[64:67], v[228:231], v[168:171]
  v_mul_f32 v80, s70, v80
  v_mul_f32_e64 v81, s70, v81
  v_mfma_f32_16x16x32_bf16 v[168:171], a[80:83], v[236:239], v[168:171]
  v_cvt_pk_bf16_f32 v80, v80, v81
  v_mul_f32_e64 v82, s70, v82
  v_mfma_f32_16x16x32_bf16 v[172:175], a[68:71], v[228:231], v[172:175]
  s_xor_b32 s79, s96, 8192
  v_mul_f32_e64 v83, s70, v83
  v_mfma_f32_16x16x32_bf16 v[172:175], a[84:87], v[236:239], v[172:175]
  v_cvt_pk_bf16_f32 v81, v82, v83
  v_mul_f32_e64 v84, s70, v84
  v_mfma_f32_16x16x32_bf16 v[184:187], a[72:75], v[228:231], v[184:187]
  buffer_store_dwordx4 v[48:51], v1, s[24:27], s79 offen sc1
  v_mfma_f32_16x16x32_bf16 v[184:187], a[88:91], v[236:239], v[184:187]
  buffer_load_dwordx4 v6, s[20:23], s42 offen offset:0 lds
  v_mfma_f32_16x16x32_bf16 v[188:191], a[76:79], v[228:231], v[188:191]
  v_mul_f32_e64 v85, s70, v85
  v_cvt_pk_bf16_f32 v82, v84, v85
  v_mfma_f32_16x16x32_bf16 v[188:191], a[92:95], v[236:239], v[188:191]
  v_mul_f32 v86, s70, v86
  v_mul_f32_e64 v87, s70, v87
  s_waitcnt lgkmcnt(0)
  v_mfma_f32_16x16x32_bf16 v[160:163], a[96:99], v[240:243], v[160:163]
  s_waitcnt vmcnt(8)
  s_barrier
  v_mfma_f32_16x16x32_bf16 v[160:163], a[112:115], v[248:251], v[160:163]
  ds_read_b64_tr_b16 v[224:225], v20 offset:32768
  ds_read_b64_tr_b16 v[226:227], v20 offset:33280
  v_mfma_f32_16x16x32_bf16 v[164:167], a[100:103], v[240:243], v[164:167]
  ds_read_b64_tr_b16 v[228:229], v21 offset:32768
  ds_read_b64_tr_b16 v[230:231], v21 offset:33280
  v_mfma_f32_16x16x32_bf16 v[164:167], a[116:119], v[248:251], v[164:167]
  v_cvt_pk_bf16_f32 v83, v86, v87
  v_mul_f32_e64 v88, s70, v88
  v_mfma_f32_16x16x32_bf16 v[176:179], a[104:107], v[240:243], v[176:179]
  ds_read_b64_tr_b16 v[232:233], v20 offset:36864
  ds_read_b64_tr_b16 v[234:235], v20 offset:37376
  v_mfma_f32_16x16x32_bf16 v[176:179], a[120:123], v[248:251], v[176:179]
  v_mul_f32_e64 v89, s70, v89
  v_cvt_pk_bf16_f32 v88, v88, v89
  v_mfma_f32_16x16x32_bf16 v[180:183], a[108:111], v[240:243], v[180:183]
  ds_read_b64_tr_b16 v[236:237], v21 offset:36864
  ds_read_b64_tr_b16 v[238:239], v21 offset:37376
  v_mfma_f32_16x16x32_bf16 v[180:183], a[124:127], v[248:251], v[180:183]
  buffer_load_dwordx4 v7, s[20:23], s42 offen offset:1024 lds
  v_mfma_f32_16x16x32_bf16 v[168:171], a[96:99], v[244:247], v[168:171]
  v_mul_f32 v90, s70, v90
  v_mul_f32 v91, s70, v91
  v_mfma_f32_16x16x32_bf16 v[168:171], a[112:115], v[252:255], v[168:171]
  v_cvt_pk_bf16_f32 v89, v90, v91
  v_mul_f32_e64 v92, s70, v92
  v_mfma_f32_16x16x32_bf16 v[172:175], a[100:103], v[244:247], v[172:175]
  s_xor_b32 s79, s96, 12288
  v_mul_f32_e64 v93, s70, v93
  v_mfma_f32_16x16x32_bf16 v[172:175], a[116:119], v[252:255], v[172:175]
  v_cvt_pk_bf16_f32 v90, v92, v93
  v_mul_f32_e64 v94, s70, v94
  v_mfma_f32_16x16x32_bf16 v[184:187], a[104:107], v[244:247], v[184:187]
  buffer_store_dwordx4 v[56:59], v1, s[24:27], s79 offen sc1
  v_mfma_f32_16x16x32_bf16 v[184:187], a[120:123], v[252:255], v[184:187]
  v_mul_f32_e64 v95, s70, v95
  v_cvt_pk_bf16_f32 v91, v94, v95
  v_mfma_f32_16x16x32_bf16 v[188:191], a[108:111], v[244:247], v[188:191]
  v_mul_f32 v96, s70, v96
  v_mul_f32 v97, s70, v97
  v_mfma_f32_16x16x32_bf16 v[188:191], a[124:127], v[252:255], v[188:191]
  v_cvt_pk_bf16_f32 v96, v96, v97
  v_mul_f32 v98, s70, v98
  s_waitcnt lgkmcnt(0)
  v_mfma_f32_16x16x32_bf16 v[160:163], a[128:131], v[224:227], v[160:163]
  ds_read_b64_tr_b16 v[240:241], v20 offset:40960
  ds_read_b64_tr_b16 v[242:243], v20 offset:41472
  v_mfma_f32_16x16x32_bf16 v[160:163], a[144:147], v[232:235], v[160:163]
  ds_read_b64_tr_b16 v[244:245], v21 offset:40960
  ds_read_b64_tr_b16 v[246:247], v21 offset:41472
  v_mfma_f32_16x16x32_bf16 v[164:167], a[132:135], v[224:227], v[164:167]
  ds_read_b64_tr_b16 v[248:249], v20 offset:45056
  ds_read_b64_tr_b16 v[250:251], v20 offset:45568
  v_mfma_f32_16x16x32_bf16 v[164:167], a[148:151], v[232:235], v[164:167]
  buffer_load_dwordx4 v8, s[20:23], s42 offen offset:2048 lds
  v_mfma_f32_16x16x32_bf16 v[176:179], a[136:139], v[224:227], v[176:179]
  ds_read_b64_tr_b16 v[252:253], v21 offset:45056
  ds_read_b64_tr_b16 v[254:255], v21 offset:45568
  v_mfma_f32_16x16x32_bf16 v[176:179], a[152:155], v[232:235], v[176:179]
  v_mul_f32_e64 v99, s70, v99
  v_cvt_pk_bf16_f32 v97, v98, v99
  v_mfma_f32_16x16x32_bf16 v[180:183], a[140:143], v[224:227], v[180:183]
  v_mul_f32 v100, s70, v100
  v_mul_f32 v101, s70, v101
  v_mfma_f32_16x16x32_bf16 v[180:183], a[156:159], v[232:235], v[180:183]
  v_cvt_pk_bf16_f32 v98, v100, v101
  v_mul_f32_e64 v102, s70, v102
  v_mfma_f32_16x16x32_bf16 v[168:171], a[128:131], v[228:231], v[168:171]
  v_mul_f32_e64 v103, s70, v103
  v_cvt_pk_bf16_f32 v99, v102, v103
  v_mfma_f32_16x16x32_bf16 v[168:171], a[144:147], v[236:239], v[168:171]
  v_mul_f32 v104, s70, v104
  v_mul_f32 v105, s70, v105
  v_mfma_f32_16x16x32_bf16 v[172:175], a[132:135], v[228:231], v[172:175]
  s_xor_b32 s79, s96, 1024
  v_cvt_pk_bf16_f32 v104, v104, v105
  v_mfma_f32_16x16x32_bf16 v[172:175], a[148:151], v[236:239], v[172:175]
  buffer_load_dwordx4 v9, s[20:23], s42 offen offset:3072 lds
  v_mfma_f32_16x16x32_bf16 v[184:187], a[136:139], v[228:231], v[184:187]
  buffer_store_dwordx4 v[64:67], v1, s[24:27], s79 offen sc1
  v_mfma_f32_16x16x32_bf16 v[184:187], a[152:155], v[236:239], v[184:187]
  s_add_u32 m0, s44, 32768
  s_add_u32 s42, s81, 4
  v_mfma_f32_16x16x32_bf16 v[188:191], a[140:143], v[228:231], v[188:191]
  s_and_b32 s42, s42, 7
  s_lshl_b32 s42, s42, 19
  v_mfma_f32_16x16x32_bf16 v[188:191], a[156:159], v[236:239], v[188:191]
  s_add_u32 s42, s42, s67
  s_xor_b32 s42, s42, 384
  s_waitcnt lgkmcnt(0)
  v_mfma_f32_16x16x32_bf16 v[160:163], a[160:163], v[240:243], v[160:163]
  ds_read_b64_tr_b16 v[224:225], v20 offset:49152
  ds_read_b64_tr_b16 v[226:227], v20 offset:49664
  v_mfma_f32_16x16x32_bf16 v[160:163], a[176:179], v[248:251], v[160:163]
  ds_read_b64_tr_b16 v[228:229], v21 offset:49152
  ds_read_b64_tr_b16 v[230:231], v21 offset:49664
  v_mfma_f32_16x16x32_bf16 v[164:167], a[164:167], v[240:243], v[164:167]
  ds_read_b64_tr_b16 v[232:233], v20 offset:53248
  ds_read_b64_tr_b16 v[234:235], v20 offset:53760
  v_mfma_f32_16x16x32_bf16 v[164:167], a[180:183], v[248:251], v[164:167]
  v_mul_f32 v106, s70, v106
  v_mul_f32_e64 v107, s70, v107
  v_mfma_f32_16x16x32_bf16 v[176:179], a[168:171], v[240:243], v[176:179]
  ds_read_b64_tr_b16 v[236:237], v21 offset:53248
  ds_read_b64_tr_b16 v[238:239], v21 offset:53760
  v_mfma_f32_16x16x32_bf16 v[176:179], a[184:187], v[248:251], v[176:179]
  buffer_load_dwordx4 v6, s[20:23], s42 offen offset:0 lds
  v_mfma_f32_16x16x32_bf16 v[180:183], a[172:175], v[240:243], v[180:183]
  v_cvt_pk_bf16_f32 v105, v106, v107
  v_mul_f32_e64 v108, s70, v108
  v_mfma_f32_16x16x32_bf16 v[180:183], a[188:191], v[248:251], v[180:183]
  v_mul_f32_e64 v109, s70, v109
  v_cvt_pk_bf16_f32 v106, v108, v109
  v_mfma_f32_16x16x32_bf16 v[168:171], a[160:163], v[244:247], v[168:171]
  v_mul_f32 v110, s70, v110
  v_mul_f32 v111, s70, v111
  v_mfma_f32_16x16x32_bf16 v[168:171], a[176:179], v[252:255], v[168:171]
  v_cvt_pk_bf16_f32 v107, v110, v111
  v_mul_f32_e64 v112, s70, v112
  v_mfma_f32_16x16x32_bf16 v[172:175], a[164:167], v[244:247], v[172:175]
  s_xor_b32 s79, s96, 5120
  v_mul_f32_e64 v113, s70, v113
  v_mfma_f32_16x16x32_bf16 v[172:175], a[180:183], v[252:255], v[172:175]
  v_cvt_pk_bf16_f32 v112, v112, v113
  v_mul_f32_e64 v114, s70, v114
  v_mfma_f32_16x16x32_bf16 v[184:187], a[168:171], v[244:247], v[184:187]
  buffer_store_dwordx4 v[72:75], v1, s[24:27], s79 offen sc1
  v_mfma_f32_16x16x32_bf16 v[184:187], a[184:187], v[252:255], v[184:187]
  v_mul_f32_e64 v115, s70, v115
  v_cvt_pk_bf16_f32 v113, v114, v115
  v_mfma_f32_16x16x32_bf16 v[188:191], a[172:175], v[244:247], v[188:191]
  v_mul_f32 v116, s70, v116
  v_mul_f32 v117, s70, v117
  v_mfma_f32_16x16x32_bf16 v[188:191], a[188:191], v[252:255], v[188:191]
  buffer_load_dwordx4 v7, s[20:23], s42 offen offset:1024 lds
  s_waitcnt lgkmcnt(0)
  v_mfma_f32_16x16x32_bf16 v[160:163], a[192:195], v[224:227], v[160:163]
  v_mov_b32 v19, 0
  global_load_dword v18, v19, s[62:63] sc1
  v_mfma_f32_16x16x32_bf16 v[160:163], a[208:211], v[232:235], v[160:163]
  ds_read_b64_tr_b16 v[240:241], v20 offset:57344
  ds_read_b64_tr_b16 v[242:243], v20 offset:57856
  v_mfma_f32_16x16x32_bf16 v[164:167], a[196:199], v[224:227], v[164:167]
  ds_read_b64_tr_b16 v[244:245], v21 offset:57344
  ds_read_b64_tr_b16 v[246:247], v21 offset:57856
  v_mfma_f32_16x16x32_bf16 v[164:167], a[212:215], v[232:235], v[164:167]
  v_cvt_pk_bf16_f32 v114, v116, v117
  v_mul_f32_e64 v118, s70, v118
  v_mfma_f32_16x16x32_bf16 v[176:179], a[200:203], v[224:227], v[176:179]
  ds_read_b64_tr_b16 v[248:249], v20 offset:61440
  ds_read_b64_tr_b16 v[250:251], v20 offset:61952
  v_mfma_f32_16x16x32_bf16 v[176:179], a[216:219], v[232:235], v[176:179]
  v_mul_f32_e64 v119, s70, v119
  v_cvt_pk_bf16_f32 v115, v118, v119
  v_mfma_f32_16x16x32_bf16 v[180:183], a[204:207], v[224:227], v[180:183]
  ds_read_b64_tr_b16 v[252:253], v21 offset:61440
  ds_read_b64_tr_b16 v[254:255], v21 offset:61952
  v_mfma_f32_16x16x32_bf16 v[180:183], a[220:223], v[232:235], v[180:183]
  v_mul_f32 v120, s70, v120
  v_mul_f32 v121, s70, v121
  v_mfma_f32_16x16x32_bf16 v[168:171], a[192:195], v[228:231], v[168:171]
  v_cvt_pk_bf16_f32 v120, v120, v121
  v_mul_f32_e64 v122, s70, v122
  v_mfma_f32_16x16x32_bf16 v[168:171], a[208:211], v[236:239], v[168:171]
  buffer_load_dwordx4 v8, s[20:23], s42 offen offset:2048 lds
  v_mfma_f32_16x16x32_bf16 v[172:175], a[196:199], v[228:231], v[172:175]
  s_xor_b32 s79, s96, 9216
  v_mul_f32_e64 v123, s70, v123
  v_mfma_f32_16x16x32_bf16 v[172:175], a[212:215], v[236:239], v[172:175]
  v_cvt_pk_bf16_f32 v121, v122, v123
  v_mul_f32_e64 v124, s70, v124
  v_mfma_f32_16x16x32_bf16 v[184:187], a[200:203], v[228:231], v[184:187]
  buffer_store_dwordx4 v[80:83], v1, s[24:27], s79 offen sc1
  v_mfma_f32_16x16x32_bf16 v[184:187], a[216:219], v[236:239], v[184:187]
  v_mul_f32_e64 v125, s70, v125
  v_cvt_pk_bf16_f32 v122, v124, v125
  v_mfma_f32_16x16x32_bf16 v[188:191], a[204:207], v[228:231], v[188:191]
  v_mul_f32 v126, s70, v126
  v_mul_f32 v127, s70, v127
  v_mfma_f32_16x16x32_bf16 v[188:191], a[220:223], v[236:239], v[188:191]
  v_cvt_pk_bf16_f32 v123, v126, v127
  v_mul_f32 v128, s70, v128
  s_waitcnt lgkmcnt(0)
  v_mfma_f32_16x16x32_bf16 v[160:163], a[224:227], v[240:243], v[160:163]
  ds_read_b64_tr_b16 v[224:225], v22 offset:0
  ds_read_b64_tr_b16 v[226:227], v22 offset:512
  v_mfma_f32_16x16x32_bf16 v[160:163], a[240:243], v[248:251], v[160:163]
  ds_read_b64_tr_b16 v[228:229], v23 offset:0
  ds_read_b64_tr_b16 v[230:231], v23 offset:512
  v_mfma_f32_16x16x32_bf16 v[164:167], a[228:231], v[240:243], v[164:167]
  ds_read_b64_tr_b16 v[232:233], v22 offset:4096
  ds_read_b64_tr_b16 v[234:235], v22 offset:4608
  v_mfma_f32_16x16x32_bf16 v[164:167], a[244:247], v[248:251], v[164:167]
  buffer_load_dwordx4 v9, s[20:23], s42 offen offset:3072 lds
  v_mfma_f32_16x16x32_bf16 v[176:179], a[232:235], v[240:243], v[176:179]
  ds_read_b64_tr_b16 v[236:237], v23 offset:4096
  ds_read_b64_tr_b16 v[238:239], v23 offset:4608
  v_mfma_f32_16x16x32_bf16 v[176:179], a[248:251], v[248:251], v[176:179]
  s_add_u32 m0, s44, 49152
  s_add_u32 s42, s81, 6
  v_mfma_f32_16x16x32_bf16 v[180:183], a[236:239], v[240:243], v[180:183]
  s_and_b32 s42, s42, 7
  s_lshl_b32 s42, s42, 19
  v_mfma_f32_16x16x32_bf16 v[180:183], a[252:255], v[248:251], v[180:183]
  s_add_u32 s42, s42, s67
  s_xor_b32 s42, s42, 384
  v_mfma_f32_16x16x32_bf16 v[168:171], a[224:227], v[244:247], v[168:171]
  v_mul_f32_e64 v129, s70, v129
  v_cvt_pk_bf16_f32 v128, v128, v129
  v_mfma_f32_16x16x32_bf16 v[168:171], a[240:243], v[252:255], v[168:171]
  v_mul_f32 v130, s70, v130
  v_mul_f32 v131, s70, v131
  v_mfma_f32_16x16x32_bf16 v[172:175], a[228:231], v[244:247], v[172:175]
  s_xor_b32 s79, s96, 13312
  v_cvt_pk_bf16_f32 v129, v130, v131
  v_mfma_f32_16x16x32_bf16 v[172:175], a[244:247], v[252:255], v[172:175]
  v_mul_f32 v132, s70, v132
  v_mul_f32 v133, s70, v133
  v_mfma_f32_16x16x32_bf16 v[184:187], a[232:235], v[244:247], v[184:187]
  buffer_store_dwordx4 v[88:91], v1, s[24:27], s79 offen sc1
  v_mfma_f32_16x16x32_bf16 v[184:187], a[248:251], v[252:255], v[184:187]
  buffer_load_dwordx4 v6, s[20:23], s42 offen offset:0 lds
  v_mfma_f32_16x16x32_bf16 v[188:191], a[236:239], v[244:247], v[188:191]
  v_cvt_pk_bf16_f32 v130, v132, v133
  v_mul_f32_e64 v134, s70, v134
  v_mfma_f32_16x16x32_bf16 v[188:191], a[252:255], v[252:255], v[188:191]
  v_mul_f32_e64 v135, s70, v135
  v_cvt_pk_bf16_f32 v131, v134, v135
  s_waitcnt lgkmcnt(0)
  v_mfma_f32_16x16x32_bf16 v[192:195], a[0:3], v[224:227], 0
  ds_read_b64_tr_b16 v[240:241], v22 offset:8192
  ds_read_b64_tr_b16 v[242:243], v22 offset:8704
  v_mfma_f32_16x16x32_bf16 v[192:195], a[16:19], v[232:235], v[192:195]
  ds_read_b64_tr_b16 v[244:245], v23 offset:8192
  ds_read_b64_tr_b16 v[246:247], v23 offset:8704
  v_mfma_f32_16x16x32_bf16 v[196:199], a[4:7], v[224:227], 0
  ds_read_b64_tr_b16 v[248:249], v22 offset:12288
  ds_read_b64_tr_b16 v[250:251], v22 offset:12800
  v_mfma_f32_16x16x32_bf16 v[196:199], a[20:23], v[232:235], v[196:199]
  v_mul_f32 v136, s70, v136
  v_mul_f32_e64 v137, s70, v137
  v_mfma_f32_16x16x32_bf16 v[208:211], a[8:11], v[224:227], 0
  ds_read_b64_tr_b16 v[252:253], v23 offset:12288
  ds_read_b64_tr_b16 v[254:255], v23 offset:12800
  v_mfma_f32_16x16x32_bf16 v[208:211], a[24:27], v[232:235], v[208:211]
  v_cvt_pk_bf16_f32 v136, v136, v137
  v_mul_f32_e64 v138, s70, v138
  v_mfma_f32_16x16x32_bf16 v[212:215], a[12:15], v[224:227], 0
  v_mul_f32_e64 v139, s70, v139
  v_cvt_pk_bf16_f32 v137, v138, v139
  v_mfma_f32_16x16x32_bf16 v[212:215], a[28:31], v[232:235], v[212:215]
  buffer_load_dwordx4 v7, s[20:23], s42 offen offset:1024 lds
  v_mfma_f32_16x16x32_bf16 v[200:203], a[0:3], v[228:231], 0
  v_mul_f32 v140, s70, v140
  v_mul_f32 v141, s70, v141
  v_mfma_f32_16x16x32_bf16 v[200:203], a[16:19], v[236:239], v[200:203]
  v_cvt_pk_bf16_f32 v138, v140, v141
  v_mul_f32_e64 v142, s70, v142
  v_mfma_f32_16x16x32_bf16 v[204:207], a[4:7], v[228:231], 0
  s_xor_b32 s79, s96, 2048
  v_mul_f32_e64 v143, s70, v143
  v_mfma_f32_16x16x32_bf16 v[204:207], a[20:23], v[236:239], v[204:207]
  v_cvt_pk_bf16_f32 v139, v142, v143
  v_mul_f32_e64 v144, s70, v144
  v_mfma_f32_16x16x32_bf16 v[216:219], a[8:11], v[228:231], 0
  buffer_store_dwordx4 v[96:99], v1, s[24:27], s79 offen sc1
  v_mfma_f32_16x16x32_bf16 v[216:219], a[24:27], v[236:239], v[216:219]
  v_mul_f32_e64 v145, s70, v145
  v_cvt_pk_bf16_f32 v144, v144, v145
  v_mfma_f32_16x16x32_bf16 v[220:223], a[12:15], v[228:231], 0
  v_mul_f32 v146, s70, v146
  v_mul_f32 v147, s70, v147
  v_mfma_f32_16x16x32_bf16 v[220:223], a[28:31], v[236:239], v[220:223]
  v_cvt_pk_bf16_f32 v145, v146, v147
  v_mul_f32 v148, s70, v148
  s_waitcnt lgkmcnt(0)
  v_mfma_f32_16x16x32_bf16 v[192:195], a[32:35], v[240:243], v[192:195]
  ds_read_b64_tr_b16 v[224:225], v22 offset:16384
  ds_read_b64_tr_b16 v[226:227], v22 offset:16896
  v_mfma_f32_16x16x32_bf16 v[192:195], a[48:51], v[248:251], v[192:195]
  ds_read_b64_tr_b16 v[228:229], v23 offset:16384
  ds_read_b64_tr_b16 v[230:231], v23 offset:16896
  v_mfma_f32_16x16x32_bf16 v[196:199], a[36:39], v[240:243], v[196:199]
  ds_read_b64_tr_b16 v[232:233], v22 offset:20480
  ds_read_b64_tr_b16 v[234:235], v22 offset:20992
  v_mfma_f32_16x16x32_bf16 v[196:199], a[52:55], v[248:251], v[196:199]
  buffer_load_dwordx4 v8, s[20:23], s42 offen offset:2048 lds
  v_mfma_f32_16x16x32_bf16 v[208:211], a[40:43], v[240:243], v[208:211]
  ds_read_b64_tr_b16 v[236:237], v23 offset:20480
  ds_read_b64_tr_b16 v[238:239], v23 offset:20992
  v_mfma_f32_16x16x32_bf16 v[208:211], a[56:59], v[248:251], v[208:211]
  v_cvt_pk_bf16_f32 v160, v160, v161
  v_cvt_pk_bf16_f32 v161, v162, v163
  v_mfma_f32_16x16x32_bf16 v[212:215], a[44:47], v[240:243], v[212:215]
  v_cvt_pk_bf16_f32 v162, v164, v165
  v_cvt_pk_bf16_f32 v163, v166, v167
  v_mfma_f32_16x16x32_bf16 v[212:215], a[60:63], v[248:251], v[212:215]
  v_cvt_pk_bf16_f32 v168, v168, v169
  v_cvt_pk_bf16_f32 v169, v170, v171
  v_mfma_f32_16x16x32_bf16 v[200:203], a[32:35], v[244:247], v[200:203]
  v_cvt_pk_bf16_f32 v170, v172, v173
  v_cvt_pk_bf16_f32 v171, v174, v175
  v_mfma_f32_16x16x32_bf16 v[200:203], a[48:51], v[252:255], v[200:203]
  v_cvt_pk_bf16_f32 v176, v176, v177
  v_cvt_pk_bf16_f32 v177, v178, v179
  v_mfma_f32_16x16x32_bf16 v[204:207], a[36:39], v[244:247], v[204:207]
  s_xor_b32 s79, s96, 6144
  v_cvt_pk_bf16_f32 v178, v180, v181
  v_mfma_f32_16x16x32_bf16 v[204:207], a[52:55], v[252:255], v[204:207]
  buffer_load_dwordx4 v9, s[20:23], s42 offen offset:3072 lds
  v_mfma_f32_16x16x32_bf16 v[216:219], a[40:43], v[244:247], v[216:219]
  buffer_store_dwordx4 v[104:107], v1, s[24:27], s79 offen sc1
  v_mfma_f32_16x16x32_bf16 v[216:219], a[56:59], v[252:255], v[216:219]
  v_cvt_pk_bf16_f32 v179, v182, v183
  v_cvt_pk_bf16_f32 v184, v184, v185
  v_mfma_f32_16x16x32_bf16 v[220:223], a[44:47], v[244:247], v[220:223]
  v_cvt_pk_bf16_f32 v185, v186, v187
  v_cvt_pk_bf16_f32 v186, v188, v189
  v_mfma_f32_16x16x32_bf16 v[220:223], a[60:63], v[252:255], v[220:223]
  v_cvt_pk_bf16_f32 v187, v190, v191
  v_mul_f32 v149, s70, v149
  s_waitcnt lgkmcnt(0)
  v_mfma_f32_16x16x32_bf16 v[192:195], a[64:67], v[224:227], v[192:195]
  ds_read_b64_tr_b16 v[240:241], v22 offset:24576
  ds_read_b64_tr_b16 v[242:243], v22 offset:25088
  v_mfma_f32_16x16x32_bf16 v[192:195], a[80:83], v[232:235], v[192:195]
  ds_read_b64_tr_b16 v[244:245], v23 offset:24576
  ds_read_b64_tr_b16 v[246:247], v23 offset:25088
  v_mfma_f32_16x16x32_bf16 v[196:199], a[68:71], v[224:227], v[196:199]
  ds_read_b64_tr_b16 v[248:249], v22 offset:28672
  ds_read_b64_tr_b16 v[250:251], v22 offset:29184
  v_mfma_f32_16x16x32_bf16 v[196:199], a[84:87], v[232:235], v[196:199]
  v_cvt_pk_bf16_f32 v146, v148, v149
  v_mul_f32_e64 v150, s70, v150
  v_mfma_f32_16x16x32_bf16 v[208:211], a[72:75], v[224:227], v[208:211]
  ds_read_b64_tr_b16 v[252:253], v23 offset:28672
  ds_read_b64_tr_b16 v[254:255], v23 offset:29184
  v_mfma_f32_16x16x32_bf16 v[208:211], a[88:91], v[232:235], v[208:211]
  v_mul_f32_e64 v151, s70, v151
  v_cvt_pk_bf16_f32 v147, v150, v151
  v_mfma_f32_16x16x32_bf16 v[212:215], a[76:79], v[224:227], v[212:215]
  v_mul_f32 v152, s70, v152
  v_mul_f32 v153, s70, v153
  v_mfma_f32_16x16x32_bf16 v[212:215], a[92:95], v[232:235], v[212:215]
  v_cvt_pk_bf16_f32 v152, v152, v153
  v_mul_f32_e64 v154, s70, v154
  v_mfma_f32_16x16x32_bf16 v[200:203], a[64:67], v[228:231], v[200:203]
  v_mul_f32_e64 v155, s70, v155
  v_cvt_pk_bf16_f32 v153, v154, v155
  v_mfma_f32_16x16x32_bf16 v[200:203], a[80:83], v[236:239], v[200:203]
  v_mul_f32 v156, s70, v156
  v_mul_f32 v157, s70, v157
  v_mfma_f32_16x16x32_bf16 v[204:207], a[68:71], v[228:231], v[204:207]
  s_xor_b32 s79, s96, 1064960
  v_cvt_pk_bf16_f32 v154, v156, v157
  v_mfma_f32_16x16x32_bf16 v[204:207], a[84:87], v[236:239], v[204:207]
  v_mul_f32 v158, s70, v158
  v_mul_f32 v159, s70, v159
  v_mfma_f32_16x16x32_bf16 v[216:219], a[72:75], v[228:231], v[216:219]
  buffer_store_dwordx4 v[160:163], v1, s[24:27], s79 offen sc1
  v_mfma_f32_16x16x32_bf16 v[216:219], a[88:91], v[236:239], v[216:219]
  v_cvt_pk_bf16_f32 v155, v158, v159
  v_mfma_f32_16x16x32_bf16 v[220:223], a[76:79], v[228:231], v[220:223]
  v_mfma_f32_16x16x32_bf16 v[220:223], a[92:95], v[236:239], v[220:223]
  s_waitcnt lgkmcnt(0)
  v_mfma_f32_16x16x32_bf16 v[192:195], a[96:99], v[240:243], v[192:195]
  ds_read_b64_tr_b16 v[224:225], v22 offset:32768
  ds_read_b64_tr_b16 v[226:227], v22 offset:33280
  v_mfma_f32_16x16x32_bf16 v[192:195], a[112:115], v[248:251], v[192:195]
  ds_read_b64_tr_b16 v[228:229], v23 offset:32768
  ds_read_b64_tr_b16 v[230:231], v23 offset:33280
  v_mfma_f32_16x16x32_bf16 v[196:199], a[100:103], v[240:243], v[196:199]
  ds_read_b64_tr_b16 v[232:233], v22 offset:36864
  ds_read_b64_tr_b16 v[234:235], v22 offset:37376
  v_mfma_f32_16x16x32_bf16 v[196:199], a[116:119], v[248:251], v[196:199]
  v_mfma_f32_16x16x32_bf16 v[208:211], a[104:107], v[240:243], v[208:211]
  ds_read_b64_tr_b16 v[236:237], v23 offset:36864
  ds_read_b64_tr_b16 v[238:239], v23 offset:37376
  v_mfma_f32_16x16x32_bf16 v[208:211], a[120:123], v[248:251], v[208:211]
  v_mfma_f32_16x16x32_bf16 v[212:215], a[108:111], v[240:243], v[212:215]
  v_mfma_f32_16x16x32_bf16 v[212:215], a[124:127], v[248:251], v[212:215]
  v_mfma_f32_16x16x32_bf16 v[200:203], a[96:99], v[244:247], v[200:203]
  v_mfma_f32_16x16x32_bf16 v[200:203], a[112:115], v[252:255], v[200:203]
  v_mfma_f32_16x16x32_bf16 v[204:207], a[100:103], v[244:247], v[204:207]
  s_xor_b32 s79, s96, 1065984
  v_mfma_f32_16x16x32_bf16 v[204:207], a[116:119], v[252:255], v[204:207]
  v_mfma_f32_16x16x32_bf16 v[216:219], a[104:107], v[244:247], v[216:219]
  buffer_store_dwordx4 v[168:171], v1, s[24:27], s79 offen sc1
  v_mfma_f32_16x16x32_bf16 v[216:219], a[120:123], v[252:255], v[216:219]
  v_mfma_f32_16x16x32_bf16 v[220:223], a[108:111], v[244:247], v[220:223]
  v_mfma_f32_16x16x32_bf16 v[220:223], a[124:127], v[252:255], v[220:223]
  s_waitcnt lgkmcnt(0)
  v_mfma_f32_16x16x32_bf16 v[192:195], a[128:131], v[224:227], v[192:195]
  ds_read_b64_tr_b16 v[240:241], v22 offset:40960
  ds_read_b64_tr_b16 v[242:243], v22 offset:41472
  v_mfma_f32_16x16x32_bf16 v[192:195], a[144:147], v[232:235], v[192:195]
  ds_read_b64_tr_b16 v[244:245], v23 offset:40960
  ds_read_b64_tr_b16 v[246:247], v23 offset:41472
  v_mfma_f32_16x16x32_bf16 v[196:199], a[132:135], v[224:227], v[196:199]
  ds_read_b64_tr_b16 v[248:249], v22 offset:45056
  ds_read_b64_tr_b16 v[250:251], v22 offset:45568
  v_mfma_f32_16x16x32_bf16 v[196:199], a[148:151], v[232:235], v[196:199]
  v_mfma_f32_16x16x32_bf16 v[208:211], a[136:139], v[224:227], v[208:211]
  ds_read_b64_tr_b16 v[252:253], v23 offset:45056
  ds_read_b64_tr_b16 v[254:255], v23 offset:45568
  v_mfma_f32_16x16x32_bf16 v[208:211], a[152:155], v[232:235], v[208:211]
  v_mfma_f32_16x16x32_bf16 v[212:215], a[140:143], v[224:227], v[212:215]
  v_mfma_f32_16x16x32_bf16 v[212:215], a[156:159], v[232:235], v[212:215]
  v_mfma_f32_16x16x32_bf16 v[200:203], a[128:131], v[228:231], v[200:203]
  v_mfma_f32_16x16x32_bf16 v[200:203], a[144:147], v[236:239], v[200:203]
  v_mfma_f32_16x16x32_bf16 v[204:207], a[132:135], v[228:231], v[204:207]
  s_xor_b32 s79, s96, 1073152
  v_mfma_f32_16x16x32_bf16 v[204:207], a[148:151], v[236:239], v[204:207]
  v_mfma_f32_16x16x32_bf16 v[216:219], a[136:139], v[228:231], v[216:219]
  buffer_store_dwordx4 v[176:179], v1, s[24:27], s79 offen sc1
  v_mfma_f32_16x16x32_bf16 v[216:219], a[152:155], v[236:239], v[216:219]
  v_mfma_f32_16x16x32_bf16 v[220:223], a[140:143], v[228:231], v[220:223]
  v_mfma_f32_16x16x32_bf16 v[220:223], a[156:159], v[236:239], v[220:223]
  s_waitcnt lgkmcnt(0)
  v_mfma_f32_16x16x32_bf16 v[192:195], a[160:163], v[240:243], v[192:195]
  ds_read_b64_tr_b16 v[224:225], v22 offset:49152
  ds_read_b64_tr_b16 v[226:227], v22 offset:49664
  v_mfma_f32_16x16x32_bf16 v[192:195], a[176:179], v[248:251], v[192:195]
  ds_read_b64_tr_b16 v[228:229], v23 offset:49152
  ds_read_b64_tr_b16 v[230:231], v23 offset:49664
  v_mfma_f32_16x16x32_bf16 v[196:199], a[164:167], v[240:243], v[196:199]
  ds_read_b64_tr_b16 v[232:233], v22 offset:53248
  ds_read_b64_tr_b16 v[234:235], v22 offset:53760
  v_mfma_f32_16x16x32_bf16 v[196:199], a[180:183], v[248:251], v[196:199]
  v_mfma_f32_16x16x32_bf16 v[208:211], a[168:171], v[240:243], v[208:211]
  ds_read_b64_tr_b16 v[236:237], v23 offset:53248
  ds_read_b64_tr_b16 v[238:239], v23 offset:53760
  v_mfma_f32_16x16x32_bf16 v[208:211], a[184:187], v[248:251], v[208:211]
  v_mfma_f32_16x16x32_bf16 v[212:215], a[172:175], v[240:243], v[212:215]
  v_mfma_f32_16x16x32_bf16 v[212:215], a[188:191], v[248:251], v[212:215]
  v_mfma_f32_16x16x32_bf16 v[200:203], a[160:163], v[244:247], v[200:203]
  v_mfma_f32_16x16x32_bf16 v[200:203], a[176:179], v[252:255], v[200:203]
  v_mfma_f32_16x16x32_bf16 v[204:207], a[164:167], v[244:247], v[204:207]
  s_xor_b32 s79, s96, 1074176
  v_mfma_f32_16x16x32_bf16 v[204:207], a[180:183], v[252:255], v[204:207]
  v_mfma_f32_16x16x32_bf16 v[216:219], a[168:171], v[244:247], v[216:219]
  buffer_store_dwordx4 v[184:187], v1, s[24:27], s79 offen sc1
  v_mfma_f32_16x16x32_bf16 v[216:219], a[184:187], v[252:255], v[216:219]
  v_mfma_f32_16x16x32_bf16 v[220:223], a[172:175], v[244:247], v[220:223]
  v_mfma_f32_16x16x32_bf16 v[220:223], a[188:191], v[252:255], v[220:223]
  s_waitcnt lgkmcnt(0)
  v_mfma_f32_16x16x32_bf16 v[192:195], a[192:195], v[224:227], v[192:195]
  s_waitcnt vmcnt(14)
  v_cmp_gt_u32 vcc, 256, v18
  s_cbranch_vccnz Lsping1
Lokg1:
  v_mfma_f32_16x16x32_bf16 v[192:195], a[208:211], v[232:235], v[192:195]
  ds_read_b64_tr_b16 v[240:241], v22 offset:57344
  ds_read_b64_tr_b16 v[242:243], v22 offset:57856
  v_mfma_f32_16x16x32_bf16 v[196:199], a[196:199], v[224:227], v[196:199]
  ds_read_b64_tr_b16 v[244:245], v23 offset:57344
  ds_read_b64_tr_b16 v[246:247], v23 offset:57856
  v_mfma_f32_16x16x32_bf16 v[196:199], a[212:215], v[232:235], v[196:199]
  s_lshl_b32 s80, s40, 11
  s_add_u32 s80, s80, 0x400000
  v_mfma_f32_16x16x32_bf16 v[208:211], a[200:203], v[224:227], v[208:211]
  ds_read_b64_tr_b16 v[248:249], v22 offset:61440
  ds_read_b64_tr_b16 v[250:251], v22 offset:61952
  v_mfma_f32_16x16x32_bf16 v[208:211], a[216:219], v[232:235], v[208:211]
  buffer_load_dwordx4 v[24:27], v1, s[12:15], s80 offen offset:0 sc1
  v_mfma_f32_16x16x32_bf16 v[212:215], a[204:207], v[224:227], v[212:215]
  ds_read_b64_tr_b16 v[252:253], v23 offset:61440
  ds_read_b64_tr_b16 v[254:255], v23 offset:61952
  v_mfma_f32_16x16x32_bf16 v[212:215], a[220:223], v[232:235], v[212:215]
  v_mfma_f32_16x16x32_bf16 v[200:203], a[192:195], v[228:231], v[200:203]
  v_mfma_f32_16x16x32_bf16 v[200:203], a[208:211], v[236:239], v[200:203]
  v_mfma_f32_16x16x32_bf16 v[204:207], a[196:199], v[228:231], v[204:207]
  s_xor_b32 s79, s96, 10240
  v_mfma_f32_16x16x32_bf16 v[204:207], a[212:215], v[236:239], v[204:207]
  v_mfma_f32_16x16x32_bf16 v[216:219], a[200:203], v[228:231], v[216:219]
  buffer_store_dwordx4 v[112:115], v1, s[24:27], s79 offen sc1
  v_mfma_f32_16x16x32_bf16 v[216:219], a[216:219], v[236:239], v[216:219]
  buffer_load_dwordx4 v[28:31], v1, s[12:15], s80 offen offset:1024 sc1
  v_mfma_f32_16x16x32_bf16 v[220:223], a[204:207], v[228:231], v[220:223]
  v_mfma_f32_16x16x32_bf16 v[220:223], a[220:223], v[236:239], v[220:223]
  s_waitcnt lgkmcnt(0)
  v_mfma_f32_16x16x32_bf16 v[192:195], a[224:227], v[240:243], v[192:195]
  s_waitcnt vmcnt(8)
  s_barrier
  v_mfma_f32_16x16x32_bf16 v[192:195], a[240:243], v[248:251], v[192:195]
  ds_read_b64_tr_b16 v[224:225], v14 offset:0
  ds_read_b64_tr_b16 v[226:227], v14 offset:512
  v_mfma_f32_16x16x32_bf16 v[196:199], a[228:231], v[240:243], v[196:199]
  ds_read_b64_tr_b16 v[228:229], v15 offset:0
  ds_read_b64_tr_b16 v[230:231], v15 offset:512
  v_mfma_f32_16x16x32_bf16 v[196:199], a[244:247], v[248:251], v[196:199]
  v_mfma_f32_16x16x32_bf16 v[208:211], a[232:235], v[240:243], v[208:211]
  ds_read_b64_tr_b16 v[232:233], v14 offset:4096
  ds_read_b64_tr_b16 v[234:235], v14 offset:4608
  v_mfma_f32_16x16x32_bf16 v[208:211], a[248:251], v[248:251], v[208:211]
  v_mfma_f32_16x16x32_bf16 v[212:215], a[236:239], v[240:243], v[212:215]
  ds_read_b64_tr_b16 v[236:237], v15 offset:4096
  ds_read_b64_tr_b16 v[238:239], v15 offset:4608
  v_mfma_f32_16x16x32_bf16 v[212:215], a[252:255], v[248:251], v[212:215]
  v_mfma_f32_16x16x32_bf16 v[200:203], a[224:227], v[244:247], v[200:203]
  v_mfma_f32_16x16x32_bf16 v[200:203], a[240:243], v[252:255], v[200:203]
  v_mfma_f32_16x16x32_bf16 v[204:207], a[228:231], v[244:247], v[204:207]
  s_xor_b32 s79, s96, 14336
  v_mfma_f32_16x16x32_bf16 v[204:207], a[244:247], v[252:255], v[204:207]
  v_mfma_f32_16x16x32_bf16 v[216:219], a[232:235], v[244:247], v[216:219]
  buffer_store_dwordx4 v[120:123], v1, s[24:27], s79 offen sc1
  v_mfma_f32_16x16x32_bf16 v[216:219], a[248:251], v[252:255], v[216:219]
  v_mfma_f32_16x16x32_bf16 v[220:223], a[236:239], v[244:247], v[220:223]
  v_mfma_f32_16x16x32_bf16 v[220:223], a[252:255], v[252:255], v[220:223]
  s_waitcnt lgkmcnt(0)
  v_mfma_f32_16x16x32_bf16 v[160:163], a[0:3], v[224:227], 0
  ds_read_b64_tr_b16 v[240:241], v14 offset:8192
  ds_read_b64_tr_b16 v[242:243], v14 offset:8704
  v_mfma_f32_16x16x32_bf16 v[160:163], a[16:19], v[232:235], v[160:163]
  ds_read_b64_tr_b16 v[244:245], v15 offset:8192
  ds_read_b64_tr_b16 v[246:247], v15 offset:8704
  v_mfma_f32_16x16x32_bf16 v[164:167], a[4:7], v[224:227], 0
  ds_read_b64_tr_b16 v[248:249], v14 offset:12288
  ds_read_b64_tr_b16 v[250:251], v14 offset:12800
  v_mfma_f32_16x16x32_bf16 v[164:167], a[20:23], v[232:235], v[164:167]
  s_mov_b32 s8, s88
  s_and_b32 s9, s89, 0xffff
  v_mfma_f32_16x16x32_bf16 v[176:179], a[8:11], v[224:227], 0
  ds_read_b64_tr_b16 v[252:253], v15 offset:12288
  ds_read_b64_tr_b16 v[254:255], v15 offset:12800
  v_mfma_f32_16x16x32_bf16 v[176:179], a[24:27], v[232:235], v[176:179]
  s_mov_b32 s10, 0x400000
  s_mov_b32 s11, 0x20000
  v_mfma_f32_16x16x32_bf16 v[180:183], a[12:15], v[224:227], 0
  s_add_u32 m0, s44, 65536
  s_add_u32 s42, s61, 0
  v_mfma_f32_16x16x32_bf16 v[180:183], a[28:31], v[232:235], v[180:183]
  s_and_b32 s42, s42, 3
  s_lshl_b32 s42, s42, 20
  v_mfma_f32_16x16x32_bf16 v[168:171], a[0:3], v[228:231], 0
  s_add_u32 s42, s42, s45
  v_mfma_f32_16x16x32_bf16 v[168:171], a[16:19], v[236:239], v[168:171]
  buffer_load_dwordx4 v6, s[8:11], s42 offen offset:0 lds
  v_mfma_f32_16x16x32_bf16 v[172:175], a[4:7], v[228:231], 0
  s_xor_b32 s79, s96, 3072
  v_mfma_f32_16x16x32_bf16 v[172:175], a[20:23], v[236:239], v[172:175]
  v_mfma_f32_16x16x32_bf16 v[184:187], a[8:11], v[228:231], 0
  buffer_store_dwordx4 v[128:131], v1, s[24:27], s79 offen sc1
  v_mfma_f32_16x16x32_bf16 v[184:187], a[24:27], v[236:239], v[184:187]
  v_mfma_f32_16x16x32_bf16 v[188:191], a[12:15], v[228:231], 0
  v_mfma_f32_16x16x32_bf16 v[188:191], a[28:31], v[236:239], v[188:191]
  buffer_load_dwordx4 v7, s[8:11], s42 offen offset:1024 lds
  s_waitcnt lgkmcnt(0)
  v_mfma_f32_16x16x32_bf16 v[160:163], a[32:35], v[240:243], v[160:163]
  ds_read_b64_tr_b16 v[224:225], v14 offset:16384
  ds_read_b64_tr_b16 v[226:227], v14 offset:16896
  v_mfma_f32_16x16x32_bf16 v[160:163], a[48:51], v[248:251], v[160:163]
  ds_read_b64_tr_b16 v[228:229], v15 offset:16384
  ds_read_b64_tr_b16 v[230:231], v15 offset:16896
  v_mfma_f32_16x16x32_bf16 v[164:167], a[36:39], v[240:243], v[164:167]
  ds_read_b64_tr_b16 v[232:233], v14 offset:20480
  ds_read_b64_tr_b16 v[234:235], v14 offset:20992
  v_mfma_f32_16x16x32_bf16 v[164:167], a[52:55], v[248:251], v[164:167]
  v_cvt_pk_bf16_f32 v192, v192, v193
  v_cvt_pk_bf16_f32 v193, v194, v195
  v_mfma_f32_16x16x32_bf16 v[176:179], a[40:43], v[240:243], v[176:179]
  ds_read_b64_tr_b16 v[236:237], v15 offset:20480
  ds_read_b64_tr_b16 v[238:239], v15 offset:20992
  v_mfma_f32_16x16x32_bf16 v[176:179], a[56:59], v[248:251], v[176:179]
  v_cvt_pk_bf16_f32 v194, v196, v197
  v_cvt_pk_bf16_f32 v195, v198, v199
  v_mfma_f32_16x16x32_bf16 v[180:183], a[44:47], v[240:243], v[180:183]
  v_cvt_pk_bf16_f32 v200, v200, v201
  v_cvt_pk_bf16_f32 v201, v202, v203
  v_mfma_f32_16x16x32_bf16 v[180:183], a[60:63], v[248:251], v[180:183]
  buffer_load_dwordx4 v8, s[8:11], s42 offen offset:2048 lds
  v_mfma_f32_16x16x32_bf16 v[168:171], a[32:35], v[244:247], v[168:171]
  v_cvt_pk_bf16_f32 v202, v204, v205
  v_cvt_pk_bf16_f32 v203, v206, v207
  v_mfma_f32_16x16x32_bf16 v[168:171], a[48:51], v[252:255], v[168:171]
  v_cvt_pk_bf16_f32 v208, v208, v209
  v_cvt_pk_bf16_f32 v209, v210, v211
  v_mfma_f32_16x16x32_bf16 v[172:175], a[36:39], v[244:247], v[172:175]
  s_xor_b32 s79, s96, 7168
  v_cvt_pk_bf16_f32 v210, v212, v213
  v_mfma_f32_16x16x32_bf16 v[172:175], a[52:55], v[252:255], v[172:175]
  v_cvt_pk_bf16_f32 v211, v214, v215
  v_cvt_pk_bf16_f32 v216, v216, v217
  v_mfma_f32_16x16x32_bf16 v[184:187], a[40:43], v[244:247], v[184:187]
  buffer_store_dwordx4 v[136:139], v1, s[24:27], s79 offen sc1
  v_mfma_f32_16x16x32_bf16 v[184:187], a[56:59], v[252:255], v[184:187]
  v_cvt_pk_bf16_f32 v217, v218, v219
  v_cvt_pk_bf16_f32 v218, v220, v221
  v_mfma_f32_16x16x32_bf16 v[188:191], a[44:47], v[244:247], v[188:191]
  v_cvt_pk_bf16_f32 v219, v222, v223
  v_mfma_f32_16x16x32_bf16 v[188:191], a[60:63], v[252:255], v[188:191]
  buffer_load_dwordx4 v9, s[8:11], s42 offen offset:3072 lds
  s_waitcnt lgkmcnt(0)
  v_mfma_f32_16x16x32_bf16 v[160:163], a[64:67], v[224:227], v[160:163]
  ds_read_b64_tr_b16 v[240:241], v14 offset:24576
  ds_read_b64_tr_b16 v[242:243], v14 offset:25088
  v_mfma_f32_16x16x32_bf16 v[160:163], a[80:83], v[232:235], v[160:163]
  ds_read_b64_tr_b16 v[244:245], v15 offset:24576
  ds_read_b64_tr_b16 v[246:247], v15 offset:25088
  v_mfma_f32_16x16x32_bf16 v[164:167], a[68:71], v[224:227], v[164:167]
  ds_read_b64_tr_b16 v[248:249], v14 offset:28672
  ds_read_b64_tr_b16 v[250:251], v14 offset:29184
  v_mfma_f32_16x16x32_bf16 v[164:167], a[84:87], v[232:235], v[164:167]
  s_add_u32 m0, s44, 81920
  s_add_u32 s42, s42, 128
  v_mfma_f32_16x16x32_bf16 v[176:179], a[72:75], v[224:227], v[176:179]
  ds_read_b64_tr_b16 v[252:253], v15 offset:28672
  ds_read_b64_tr_b16 v[254:255], v15 offset:29184
  v_mfma_f32_16x16x32_bf16 v[176:179], a[88:91], v[232:235], v[176:179]
  v_mfma_f32_16x16x32_bf16 v[180:183], a[76:79], v[224:227], v[180:183]
  v_mfma_f32_16x16x32_bf16 v[180:183], a[92:95], v[232:235], v[180:183]
  buffer_load_dwordx4 v6, s[8:11], s42 offen offset:0 lds
  v_mfma_f32_16x16x32_bf16 v[168:171], a[64:67], v[228:231], v[168:171]
  v_mfma_f32_16x16x32_bf16 v[168:171], a[80:83], v[236:239], v[168:171]
  v_mfma_f32_16x16x32_bf16 v[172:175], a[68:71], v[228:231], v[172:175]
  s_xor_b32 s79, s96, 1067008
  v_mfma_f32_16x16x32_bf16 v[172:175], a[84:87], v[236:239], v[172:175]
  v_mfma_f32_16x16x32_bf16 v[184:187], a[72:75], v[228:231], v[184:187]
  buffer_store_dwordx4 v[192:195], v1, s[24:27], s79 offen sc1
  v_mfma_f32_16x16x32_bf16 v[184:187], a[88:91], v[236:239], v[184:187]
  v_mfma_f32_16x16x32_bf16 v[188:191], a[76:79], v[228:231], v[188:191]
  v_mfma_f32_16x16x32_bf16 v[188:191], a[92:95], v[236:239], v[188:191]
  buffer_load_dwordx4 v7, s[8:11], s42 offen offset:1024 lds
  s_waitcnt lgkmcnt(0)
  v_mfma_f32_16x16x32_bf16 v[160:163], a[96:99], v[240:243], v[160:163]
  ds_read_b64_tr_b16 v[224:225], v14 offset:32768
  ds_read_b64_tr_b16 v[226:227], v14 offset:33280
  v_mfma_f32_16x16x32_bf16 v[160:163], a[112:115], v[248:251], v[160:163]
  ds_read_b64_tr_b16 v[228:229], v15 offset:32768
  ds_read_b64_tr_b16 v[230:231], v15 offset:33280
  v_mfma_f32_16x16x32_bf16 v[164:167], a[100:103], v[240:243], v[164:167]
  ds_read_b64_tr_b16 v[232:233], v14 offset:36864
  ds_read_b64_tr_b16 v[234:235], v14 offset:37376
  v_mfma_f32_16x16x32_bf16 v[164:167], a[116:119], v[248:251], v[164:167]
  v_mfma_f32_16x16x32_bf16 v[176:179], a[104:107], v[240:243], v[176:179]
  ds_read_b64_tr_b16 v[236:237], v15 offset:36864
  ds_read_b64_tr_b16 v[238:239], v15 offset:37376
  v_mfma_f32_16x16x32_bf16 v[176:179], a[120:123], v[248:251], v[176:179]
  v_mfma_f32_16x16x32_bf16 v[180:183], a[108:111], v[240:243], v[180:183]
  v_mfma_f32_16x16x32_bf16 v[180:183], a[124:127], v[248:251], v[180:183]
  buffer_load_dwordx4 v8, s[8:11], s42 offen offset:2048 lds
  v_mfma_f32_16x16x32_bf16 v[168:171], a[96:99], v[244:247], v[168:171]
  v_mfma_f32_16x16x32_bf16 v[168:171], a[112:115], v[252:255], v[168:171]
  v_mfma_f32_16x16x32_bf16 v[172:175], a[100:103], v[244:247], v[172:175]
  s_xor_b32 s79, s96, 1068032
  v_mfma_f32_16x16x32_bf16 v[172:175], a[116:119], v[252:255], v[172:175]
  v_mfma_f32_16x16x32_bf16 v[184:187], a[104:107], v[244:247], v[184:187]
  buffer_store_dwordx4 v[200:203], v1, s[24:27], s79 offen sc1
  v_mfma_f32_16x16x32_bf16 v[184:187], a[120:123], v[252:255], v[184:187]
  v_mfma_f32_16x16x32_bf16 v[188:191], a[108:111], v[244:247], v[188:191]
  v_mfma_f32_16x16x32_bf16 v[188:191], a[124:127], v[252:255], v[188:191]
  buffer_load_dwordx4 v9, s[8:11], s42 offen offset:3072 lds
  s_waitcnt lgkmcnt(0)
  v_mfma_f32_16x16x32_bf16 v[160:163], a[128:131], v[224:227], v[160:163]
  ds_read_b64_tr_b16 v[240:241], v14 offset:40960
  ds_read_b64_tr_b16 v[242:243], v14 offset:41472
  v_mfma_f32_16x16x32_bf16 v[160:163], a[144:147], v[232:235], v[160:163]
  ds_read_b64_tr_b16 v[244:245], v15 offset:40960
  ds_read_b64_tr_b16 v[246:247], v15 offset:41472
  v_mfma_f32_16x16x32_bf16 v[164:167], a[132:135], v[224:227], v[164:167]
  ds_read_b64_tr_b16 v[248:249], v14 offset:45056
  ds_read_b64_tr_b16 v[250:251], v14 offset:45568
  v_mfma_f32_16x16x32_bf16 v[164:167], a[148:151], v[232:235], v[164:167]
  s_add_u32 m0, s44, 98304
  s_add_u32 s42, s61, 1
  v_mfma_f32_16x16x32_bf16 v[176:179], a[136:139], v[224:227], v[176:179]
  ds_read_b64_tr_b16 v[252:253], v15 offset:45056
  ds_read_b64_tr_b16 v[254:255], v15 offset:45568
  v_mfma_f32_16x16x32_bf16 v[176:179], a[152:155], v[232:235], v[176:179]
  s_and_b32 s42, s42, 3
  s_lshl_b32 s42, s42, 20
  v_mfma_f32_16x16x32_bf16 v[180:183], a[140:143], v[224:227], v[180:183]
  s_add_u32 s42, s42, s45
  s_waitcnt vmcnt(13)
  v_mfma_f32_16x16x32_bf16 v[180:183], a[156:159], v[232:235], v[180:183]
  buffer_load_dwordx4 v6, s[8:11], s42 offen offset:0 lds
  v_mfma_f32_16x16x32_bf16 v[168:171], a[128:131], v[228:231], v[168:171]
  v_mov_b32 v10, -1
  v_mov_b32_e64 v2, 0
  v_mfma_f32_16x16x32_bf16 v[168:171], a[144:147], v[236:239], v[168:171]
  v_and_b32 v13, 7, v0
  v_sub_u32 v11, v10, v24
  v_mfma_f32_16x16x32_bf16 v[172:175], a[132:135], v[228:231], v[172:175]
  s_xor_b32 s79, s96, 1075200
  v_sub_u32_e64 v18, v10, v25
  v_mfma_f32_16x16x32_bf16 v[172:175], a[148:151], v[236:239], v[172:175]
  v_min_u32 v11, v11, v18
  v_sub_u32 v18, v10, v26
  v_mfma_f32_16x16x32_bf16 v[184:187], a[136:139], v[228:231], v[184:187]
  buffer_store_dwordx4 v[208:211], v1, s[24:27], s79 offen sc1
  v_mfma_f32_16x16x32_bf16 v[184:187], a[152:155], v[236:239], v[184:187]
  v_sub_u32_e64 v19, v10, v27
  v_min3_u32 v11, v11, v18, v19
  v_mfma_f32_16x16x32_bf16 v[188:191], a[140:143], v[228:231], v[188:191]
  v_sub_u32 v18, v10, v28
  v_sub_u32 v19, v10, v29
  v_mfma_f32_16x16x32_bf16 v[188:191], a[156:159], v[236:239], v[188:191]
  buffer_load_dwordx4 v7, s[8:11], s42 offen offset:1024 lds
  s_waitcnt lgkmcnt(0)
  v_mfma_f32_16x16x32_bf16 v[160:163], a[160:163], v[240:243], v[160:163]
  ds_read_b64_tr_b16 v[224:225], v14 offset:49152
  ds_read_b64_tr_b16 v[226:227], v14 offset:49664
  v_mfma_f32_16x16x32_bf16 v[160:163], a[176:179], v[248:251], v[160:163]
  ds_read_b64_tr_b16 v[228:229], v15 offset:49152
  ds_read_b64_tr_b16 v[230:231], v15 offset:49664
  v_mfma_f32_16x16x32_bf16 v[164:167], a[164:167], v[240:243], v[164:167]
  ds_read_b64_tr_b16 v[232:233], v14 offset:53248
  ds_read_b64_tr_b16 v[234:235], v14 offset:53760
  v_mfma_f32_16x16x32_bf16 v[164:167], a[180:183], v[248:251], v[164:167]
  v_min3_u32 v11, v11, v18, v19
  v_sub_u32 v18, v10, v30
  v_mfma_f32_16x16x32_bf16 v[176:179], a[168:171], v[240:243], v[176:179]
  ds_read_b64_tr_b16 v[236:237], v15 offset:53248
  ds_read_b64_tr_b16 v[238:239], v15 offset:53760
  v_mfma_f32_16x16x32_bf16 v[176:179], a[184:187], v[248:251], v[176:179]
  v_sub_u32_e64 v19, v10, v31
  v_min3_u32 v11, v11, v18, v19
  v_mfma_f32_16x16x32_bf16 v[180:183], a[172:175], v[240:243], v[180:183]
  v_cmp_eq_u32 s[32:33], 0, v13
  s_nop 0
  v_mfma_f32_16x16x32_bf16 v[180:183], a[188:191], v[248:251], v[180:183]
  buffer_load_dwordx4 v8, s[8:11], s42 offen offset:2048 lds
  v_mfma_f32_16x16x32_bf16 v[168:171], a[160:163], v[244:247], v[168:171]
  v_min_u32_dpp v11, v11, v11 row_ror:8 row_mask:0xf bank_mask:0xf
  s_nop 0
  v_mfma_f32_16x16x32_bf16 v[168:171], a[176:179], v[252:255], v[168:171]
  v_min_u32_dpp v11, v11, v11 row_ror:4 row_mask:0xf bank_mask:0xf
  s_nop 0
  v_mfma_f32_16x16x32_bf16 v[172:175], a[164:167], v[244:247], v[172:175]
  s_xor_b32 s79, s96, 1076224
  v_min_u32_dpp v11, v11, v11 row_ror:2 row_mask:0xf bank_mask:0xf
  v_mfma_f32_16x16x32_bf16 v[172:175], a[180:183], v[252:255], v[172:175]
  s_nop 0
  v_min_u32_dpp v11, v11, v11 row_ror:1 row_mask:0xf bank_mask:0xf
  v_mfma_f32_16x16x32_bf16 v[184:187], a[168:171], v[244:247], v[184:187]
  buffer_store_dwordx4 v[216:219], v1, s[24:27], s79 offen sc1
  v_mfma_f32_16x16x32_bf16 v[184:187], a[184:187], v[252:255], v[184:187]
  v_mov_b32 v12, v11
  s_nop 0
  v_mfma_f32_16x16x32_bf16 v[188:191], a[172:175], v[244:247], v[188:191]
  v_permlane16_swap_b32 v11, v12
  v_min_u32 v11, v11, v12
  v_mfma_f32_16x16x32_bf16 v[188:191], a[188:191], v[252:255], v[188:191]
  buffer_load_dwordx4 v9, s[8:11], s42 offen offset:3072 lds
  s_waitcnt lgkmcnt(0)
  v_mfma_f32_16x16x32_bf16 v[160:163], a[192:195], v[224:227], v[160:163]
  ds_read_b64_tr_b16 v[240:241], v14 offset:57344
  ds_read_b64_tr_b16 v[242:243], v14 offset:57856
  v_mfma_f32_16x16x32_bf16 v[160:163], a[208:211], v[232:235], v[160:163]
  ds_read_b64_tr_b16 v[244:245], v15 offset:57344
  ds_read_b64_tr_b16 v[246:247], v15 offset:57856
  v_mfma_f32_16x16x32_bf16 v[164:167], a[196:199], v[224:227], v[164:167]
  ds_read_b64_tr_b16 v[248:249], v14 offset:61440
  ds_read_b64_tr_b16 v[250:251], v14 offset:61952
  v_mfma_f32_16x16x32_bf16 v[164:167], a[212:215], v[232:235], v[164:167]
  s_add_u32 m0, s44, 114688
  s_add_u32 s42, s42, 128
  v_mfma_f32_16x16x32_bf16 v[176:179], a[200:203], v[224:227], v[176:179]
  ds_read_b64_tr_b16 v[252:253], v15 offset:61440
  ds_read_b64_tr_b16 v[254:255], v15 offset:61952
  v_mfma_f32_16x16x32_bf16 v[176:179], a[216:219], v[232:235], v[176:179]
  v_mov_b32_e64 v12, v11
  s_nop 0
  v_mfma_f32_16x16x32_bf16 v[180:183], a[204:207], v[224:227], v[180:183]
  v_permlane32_swap_b32 v11, v12
  v_min_u32 v11, v11, v12
  v_mfma_f32_16x16x32_bf16 v[180:183], a[220:223], v[232:235], v[180:183]
  buffer_load_dwordx4 v6, s[8:11], s42 offen offset:0 lds
  v_mfma_f32_16x16x32_bf16 v[168:171], a[192:195], v[228:231], v[168:171]
  v_sub_u32_e64 v10, v10, v11
  v_cndmask_b32 v2, v2, v10, s[32:33]
  v_mfma_f32_16x16x32_bf16 v[168:171], a[208:211], v[236:239], v[168:171]
  v_add_u32 v10, -1, v10
  v_sub_u32 v11, v10, v24
  v_mfma_f32_16x16x32_bf16 v[172:175], a[196:199], v[228:231], v[172:175]
  s_xor_b32 s79, s96, 11264
  v_sub_u32_e64 v18, v10, v25
  v_mfma_f32_16x16x32_bf16 v[172:175], a[212:215], v[236:239], v[172:175]
  v_min_u32 v11, v11, v18
  v_sub_u32 v18, v10, v26
  v_mfma_f32_16x16x32_bf16 v[184:187], a[200:203], v[228:231], v[184:187]
  buffer_store_dwordx4 v[144:147], v1, s[24:27], s79 offen sc1
  v_mfma_f32_16x16x32_bf16 v[184:187], a[216:219], v[236:239], v[184:187]
  v_sub_u32_e64 v19, v10, v27
  v_min3_u32 v11, v11, v18, v19
  v_mfma_f32_16x16x32_bf16 v[188:191], a[204:207], v[228:231], v[188:191]
  v_sub_u32 v18, v10, v28
  v_sub_u32 v19, v10, v29
  v_mfma_f32_16x16x32_bf16 v[188:191], a[220:223], v[236:239], v[188:191]
  buffer_load_dwordx4 v7, s[8:11], s42 offen offset:1024 lds
  s_waitcnt lgkmcnt(0)
  v_mfma_f32_16x16x32_bf16 v[160:163], a[224:227], v[240:243], v[160:163]
  ds_read_b64_tr_b16 v[224:225], v16 offset:0
  ds_read_b64_tr_b16 v[226:227], v16 offset:512
  v_mfma_f32_16x16x32_bf16 v[160:163], a[240:243], v[248:251], v[160:163]
  ds_read_b64_tr_b16 v[228:229], v17 offset:0
  ds_read_b64_tr_b16 v[230:231], v17 offset:512
  v_mfma_f32_16x16x32_bf16 v[164:167], a[228:231], v[240:243], v[164:167]
  ds_read_b64_tr_b16 v[232:233], v16 offset:4096
  ds_read_b64_tr_b16 v[234:235], v16 offset:4608
  v_mfma_f32_16x16x32_bf16 v[164:167], a[244:247], v[248:251], v[164:167]
  v_min3_u32 v11, v11, v18, v19
  v_sub_u32 v18, v10, v30
  v_mfma_f32_16x16x32_bf16 v[176:179], a[232:235], v[240:243], v[176:179]
  ds_read_b64_tr_b16 v[236:237], v17 offset:4096
  ds_read_b64_tr_b16 v[238:239], v17 offset:4608
  v_mfma_f32_16x16x32_bf16 v[176:179], a[248:251], v[248:251], v[176:179]
  v_sub_u32_e64 v19, v10, v31
  v_min3_u32 v11, v11, v18, v19
  v_mfma_f32_16x16x32_bf16 v[180:183], a[236:239], v[240:243], v[180:183]
  v_cmp_eq_u32 s[32:33], 1, v13
  s_nop 0
  v_mfma_f32_16x16x32_bf16 v[180:183], a[252:255], v[248:251], v[180:183]
  buffer_load_dwordx4 v8, s[8:11], s42 offen offset:2048 lds
  v_mfma_f32_16x16x32_bf16 v[168:171], a[224:227], v[244:247], v[168:171]
  v_min_u32_dpp v11, v11, v11 row_ror:8 row_mask:0xf bank_mask:0xf
  s_nop 0
  v_mfma_f32_16x16x32_bf16 v[168:171], a[240:243], v[252:255], v[168:171]
  v_min_u32_dpp v11, v11, v11 row_ror:4 row_mask:0xf bank_mask:0xf
  s_nop 0
  v_mfma_f32_16x16x32_bf16 v[172:175], a[228:231], v[244:247], v[172:175]
  s_xor_b32 s79, s96, 15360
  v_min_u32_dpp v11, v11, v11 row_ror:2 row_mask:0xf bank_mask:0xf
  v_mfma_f32_16x16x32_bf16 v[172:175], a[244:247], v[252:255], v[172:175]
  s_nop 0
  v_min_u32_dpp v11, v11, v11 row_ror:1 row_mask:0xf bank_mask:0xf
  v_mfma_f32_16x16x32_bf16 v[184:187], a[232:235], v[244:247], v[184:187]
  buffer_store_dwordx4 v[152:155], v1, s[24:27], s79 offen sc1
  v_mfma_f32_16x16x32_bf16 v[184:187], a[248:251], v[252:255], v[184:187]
  v_mov_b32 v12, v11
  s_nop 0
  v_mfma_f32_16x16x32_bf16 v[188:191], a[236:239], v[244:247], v[188:191]
  v_permlane16_swap_b32 v11, v12
  v_min_u32 v11, v11, v12
  v_mfma_f32_16x16x32_bf16 v[188:191], a[252:255], v[252:255], v[188:191]
  buffer_load_dwordx4 v9, s[8:11], s42 offen offset:3072 lds
  s_waitcnt lgkmcnt(0)
  v_mfma_f32_16x16x32_bf16 v[192:195], a[0:3], v[224:227], 0
  ds_read_b64_tr_b16 v[240:241], v16 offset:8192
  ds_read_b64_tr_b16 v[242:243], v16 offset:8704
  v_mfma_f32_16x16x32_bf16 v[192:195], a[16:19], v[232:235], v[192:195]
  ds_read_b64_tr_b16 v[244:245], v17 offset:8192
  ds_read_b64_tr_b16 v[246:247], v17 offset:8704
  v_mfma_f32_16x16x32_bf16 v[196:199], a[4:7], v[224:227], 0
  ds_read_b64_tr_b16 v[248:249], v16 offset:12288
  ds_read_b64_tr_b16 v[250:251], v16 offset:12800
  v_mfma_f32_16x16x32_bf16 v[196:199], a[20:23], v[232:235], v[196:199]
  v_mov_b32_e64 v12, v11
  s_nop 0
  v_mfma_f32_16x16x32_bf16 v[208:211], a[8:11], v[224:227], 0
  ds_read_b64_tr_b16 v[252:253], v17 offset:12288
  ds_read_b64_tr_b16 v[254:255], v17 offset:12800
  v_mfma_f32_16x16x32_bf16 v[208:211], a[24:27], v[232:235], v[208:211]
  v_permlane32_swap_b32 v11, v12
  v_min_u32 v11, v11, v12
  v_mfma_f32_16x16x32_bf16 v[212:215], a[12:15], v[224:227], 0
  v_sub_u32_e64 v10, v10, v11
  v_cndmask_b32 v2, v2, v10, s[32:33]
  v_mfma_f32_16x16x32_bf16 v[212:215], a[28:31], v[232:235], v[212:215]
  v_add_u32 v10, -1, v10
  v_sub_u32 v11, v10, v24
  v_mfma_f32_16x16x32_bf16 v[200:203], a[0:3], v[228:231], 0
  v_sub_u32 v18, v10, v25
  v_min_u32 v11, v11, v18
  v_mfma_f32_16x16x32_bf16 v[200:203], a[16:19], v[236:239], v[200:203]
  v_sub_u32 v18, v10, v26
  v_sub_u32 v19, v10, v27
  v_mfma_f32_16x16x32_bf16 v[204:207], a[4:7], v[228:231], 0
  v_min3_u32 v11, v11, v18, v19
  v_sub_u32_e64 v18, v10, v28
  v_mfma_f32_16x16x32_bf16 v[204:207], a[20:23], v[236:239], v[204:207]
  v_sub_u32_e64 v19, v10, v29
  v_min3_u32 v11, v11, v18, v19
  v_mfma_f32_16x16x32_bf16 v[216:219], a[8:11], v[228:231], 0
  v_sub_u32 v18, v10, v30
  v_sub_u32 v19, v10, v31
  v_mfma_f32_16x16x32_bf16 v[216:219], a[24:27], v[236:239], v[216:219]
  v_min3_u32 v11, v11, v18, v19
  v_cmp_eq_u32 s[32:33], 2, v13
  v_mfma_f32_16x16x32_bf16 v[220:223], a[12:15], v[228:231], 0
  s_nop 0
  v_min_u32_dpp v11, v11, v11 row_ror:8 row_mask:0xf bank_mask:0xf
  v_mfma_f32_16x16x32_bf16 v[220:223], a[28:31], v[236:239], v[220:223]
  s_nop 0
  v_min_u32_dpp v11, v11, v11 row_ror:4 row_mask:0xf bank_mask:0xf
  s_waitcnt lgkmcnt(0)
  v_mfma_f32_16x16x32_bf16 v[192:195], a[32:35], v[240:243], v[192:195]
  ds_read_b64_tr_b16 v[224:225], v16 offset:16384
  ds_read_b64_tr_b16 v[226:227], v16 offset:16896
  v_mfma_f32_16x16x32_bf16 v[192:195], a[48:51], v[248:251], v[192:195]
  ds_read_b64_tr_b16 v[228:229], v17 offset:16384
  ds_read_b64_tr_b16 v[230:231], v17 offset:16896
  v_mfma_f32_16x16x32_bf16 v[196:199], a[36:39], v[240:243], v[196:199]
  ds_read_b64_tr_b16 v[232:233], v16 offset:20480
  ds_read_b64_tr_b16 v[234:235], v16 offset:20992
  v_mfma_f32_16x16x32_bf16 v[196:199], a[52:55], v[248:251], v[196:199]
  s_add_u32 s42, s61, 0
  s_and_b32 s42, s42, 3
  v_mfma_f32_16x16x32_bf16 v[208:211], a[40:43], v[240:243], v[208:211]
  ds_read_b64_tr_b16 v[236:237], v17 offset:20480
  ds_read_b64_tr_b16 v[238:239], v17 offset:20992
  v_mfma_f32_16x16x32_bf16 v[208:211], a[56:59], v[248:251], v[208:211]
  s_lshl_b32 s42, s42, 13
  s_add_u32 s72, s42, s46
  v_mfma_f32_16x16x32_bf16 v[212:215], a[44:47], v[240:243], v[212:215]
  s_add_u32 s73, s42, s47
  v_cvt_pk_bf16_f32 v160, v160, v161
  v_mfma_f32_16x16x32_bf16 v[212:215], a[60:63], v[248:251], v[212:215]
  buffer_load_dwordx4 a[0:3], v1, s[12:15], s72 offen offset:0 sc1
  v_mfma_f32_16x16x32_bf16 v[200:203], a[32:35], v[244:247], v[200:203]
  v_cvt_pk_bf16_f32 v161, v162, v163
  v_cvt_pk_bf16_f32 v162, v164, v165
  v_mfma_f32_16x16x32_bf16 v[200:203], a[48:51], v[252:255], v[200:203]
  v_cvt_pk_bf16_f32 v163, v166, v167
  v_cvt_pk_bf16_f32 v168, v168, v169
  v_mfma_f32_16x16x32_bf16 v[204:207], a[36:39], v[244:247], v[204:207]
  v_cvt_pk_bf16_f32 v169, v170, v171
  v_cvt_pk_bf16_f32 v170, v172, v173
  v_mfma_f32_16x16x32_bf16 v[204:207], a[52:55], v[252:255], v[204:207]
  v_cvt_pk_bf16_f32 v171, v174, v175
  v_cvt_pk_bf16_f32 v176, v176, v177
  v_mfma_f32_16x16x32_bf16 v[216:219], a[40:43], v[244:247], v[216:219]
  v_cvt_pk_bf16_f32 v177, v178, v179
  v_cvt_pk_bf16_f32 v178, v180, v181
  v_mfma_f32_16x16x32_bf16 v[216:219], a[56:59], v[252:255], v[216:219]
  buffer_load_dwordx4 a[8:11], v1, s[12:15], s73 offen offset:0 sc1
  v_mfma_f32_16x16x32_bf16 v[220:223], a[44:47], v[244:247], v[220:223]
  v_cvt_pk_bf16_f32 v179, v182, v183
  v_cvt_pk_bf16_f32 v184, v184, v185
  v_mfma_f32_16x16x32_bf16 v[220:223], a[60:63], v[252:255], v[220:223]
  v_cvt_pk_bf16_f32 v185, v186, v187
  v_cvt_pk_bf16_f32 v186, v188, v189
  s_waitcnt lgkmcnt(0)
  v_mfma_f32_16x16x32_bf16 v[192:195], a[64:67], v[224:227], v[192:195]
  ds_read_b64_tr_b16 v[240:241], v16 offset:24576
  ds_read_b64_tr_b16 v[242:243], v16 offset:25088
  v_mfma_f32_16x16x32_bf16 v[192:195], a[80:83], v[232:235], v[192:195]
  ds_read_b64_tr_b16 v[244:245], v17 offset:24576
  ds_read_b64_tr_b16 v[246:247], v17 offset:25088
  v_mfma_f32_16x16x32_bf16 v[196:199], a[68:71], v[224:227], v[196:199]
  ds_read_b64_tr_b16 v[248:249], v16 offset:28672
  ds_read_b64_tr_b16 v[250:251], v16 offset:29184
  v_mfma_f32_16x16x32_bf16 v[196:199], a[84:87], v[232:235], v[196:199]
  v_cvt_pk_bf16_f32 v187, v190, v191
  s_nop 0
  v_mfma_f32_16x16x32_bf16 v[208:211], a[72:75], v[224:227], v[208:211]
  ds_read_b64_tr_b16 v[252:253], v17 offset:28672
  ds_read_b64_tr_b16 v[254:255], v17 offset:29184
  v_mfma_f32_16x16x32_bf16 v[208:211], a[88:91], v[232:235], v[208:211]
  buffer_load_dwordx4 a[4:7], v1, s[12:15], s72 offen offset:1024 sc1
  v_mfma_f32_16x16x32_bf16 v[212:215], a[76:79], v[224:227], v[212:215]
  s_xor_b32 s79, s96, 1069056
  v_min_u32_dpp v11, v11, v11 row_ror:2 row_mask:0xf bank_mask:0xf
  v_mfma_f32_16x16x32_bf16 v[212:215], a[92:95], v[232:235], v[212:215]
  buffer_store_dwordx4 v[160:163], v1, s[24:27], s79 offen sc1
  v_mfma_f32_16x16x32_bf16 v[200:203], a[64:67], v[228:231], v[200:203]
  v_min_u32_dpp v11, v11, v11 row_ror:1 row_mask:0xf bank_mask:0xf
  v_mov_b32_e64 v12, v11
  v_mfma_f32_16x16x32_bf16 v[200:203], a[80:83], v[236:239], v[200:203]
  s_nop 0
  v_permlane16_swap_b32 v11, v12
  v_mfma_f32_16x16x32_bf16 v[204:207], a[68:71], v[228:231], v[204:207]
  v_min_u32 v11, v11, v12
  v_mov_b32 v12, v11
  v_mfma_f32_16x16x32_bf16 v[204:207], a[84:87], v[236:239], v[204:207]
  s_nop 0
  v_permlane32_swap_b32 v11, v12
  v_mfma_f32_16x16x32_bf16 v[216:219], a[72:75], v[228:231], v[216:219]
  v_min_u32 v11, v11, v12
  v_sub_u32 v10, v10, v11
  v_mfma_f32_16x16x32_bf16 v[216:219], a[88:91], v[236:239], v[216:219]
  buffer_load_dwordx4 a[12:15], v1, s[12:15], s73 offen offset:1024 sc1
  v_mfma_f32_16x16x32_bf16 v[220:223], a[76:79], v[228:231], v[220:223]
  v_cndmask_b32 v2, v2, v10, s[32:33]
  v_add_u32_e64 v10, -1, v10
  v_mfma_f32_16x16x32_bf16 v[220:223], a[92:95], v[236:239], v[220:223]
  v_sub_u32 v11, v10, v24
  v_sub_u32_e64 v18, v10, v25
  s_waitcnt lgkmcnt(0)
  v_mfma_f32_16x16x32_bf16 v[192:195], a[96:99], v[240:243], v[192:195]
  ds_read_b64_tr_b16 v[224:225], v16 offset:32768
  ds_read_b64_tr_b16 v[226:227], v16 offset:33280
  v_mfma_f32_16x16x32_bf16 v[192:195], a[112:115], v[248:251], v[192:195]
  ds_read_b64_tr_b16 v[228:229], v17 offset:32768
  ds_read_b64_tr_b16 v[230:231], v17 offset:33280
  v_mfma_f32_16x16x32_bf16 v[196:199], a[100:103], v[240:243], v[196:199]
  ds_read_b64_tr_b16 v[232:233], v16 offset:36864
  ds_read_b64_tr_b16 v[234:235], v16 offset:37376
  v_mfma_f32_16x16x32_bf16 v[196:199], a[116:119], v[248:251], v[196:199]
  v_min_u32 v11, v11, v18
  v_sub_u32 v18, v10, v26
  v_mfma_f32_16x16x32_bf16 v[208:211], a[104:107], v[240:243], v[208:211]
  ds_read_b64_tr_b16 v[236:237], v17 offset:36864
  ds_read_b64_tr_b16 v[238:239], v17 offset:37376
  v_mfma_f32_16x16x32_bf16 v[208:211], a[120:123], v[248:251], v[208:211]
  buffer_load_dwordx4 a[16:19], v1, s[12:15], s72 offen offset:2048 sc1
  v_mfma_f32_16x16x32_bf16 v[212:215], a[108:111], v[240:243], v[212:215]
  s_xor_b32 s79, s96, 1070080
  v_sub_u32_e64 v19, v10, v27
  v_mfma_f32_16x16x32_bf16 v[212:215], a[124:127], v[248:251], v[212:215]
  buffer_store_dwordx4 v[168:171], v1, s[24:27], s79 offen sc1
  v_mfma_f32_16x16x32_bf16 v[200:203], a[96:99], v[244:247], v[200:203]
  v_min3_u32 v11, v11, v18, v19
  v_sub_u32_e64 v18, v10, v28
  v_mfma_f32_16x16x32_bf16 v[200:203], a[112:115], v[252:255], v[200:203]
  v_sub_u32_e64 v19, v10, v29
  v_min3_u32 v11, v11, v18, v19
  v_mfma_f32_16x16x32_bf16 v[204:207], a[100:103], v[244:247], v[204:207]
  v_sub_u32 v18, v10, v30
  v_sub_u32 v19, v10, v31
  v_mfma_f32_16x16x32_bf16 v[204:207], a[116:119], v[252:255], v[204:207]
  v_min3_u32 v11, v11, v18, v19
  v_cmp_eq_u32 s[32:33], 3, v13
  v_mfma_f32_16x16x32_bf16 v[216:219], a[104:107], v[244:247], v[216:219]
  s_nop 0
  v_min_u32_dpp v11, v11, v11 row_ror:8 row_mask:0xf bank_mask:0xf
  v_mfma_f32_16x16x32_bf16 v[216:219], a[120:123], v[252:255], v[216:219]
  buffer_load_dwordx4 a[24:27], v1, s[12:15], s73 offen offset:2048 sc1
  v_mfma_f32_16x16x32_bf16 v[220:223], a[108:111], v[244:247], v[220:223]
  v_min_u32_dpp v11, v11, v11 row_ror:4 row_mask:0xf bank_mask:0xf
  s_nop 0
  v_mfma_f32_16x16x32_bf16 v[220:223], a[124:127], v[252:255], v[220:223]
  v_min_u32_dpp v11, v11, v11 row_ror:2 row_mask:0xf bank_mask:0xf
  s_nop 0
  s_waitcnt lgkmcnt(0)
  v_mfma_f32_16x16x32_bf16 v[192:195], a[128:131], v[224:227], v[192:195]
  ds_read_b64_tr_b16 v[240:241], v16 offset:40960
  ds_read_b64_tr_b16 v[242:243], v16 offset:41472
  v_mfma_f32_16x16x32_bf16 v[192:195], a[144:147], v[232:235], v[192:195]
  ds_read_b64_tr_b16 v[244:245], v17 offset:40960
  ds_read_b64_tr_b16 v[246:247], v17 offset:41472
  v_mfma_f32_16x16x32_bf16 v[196:199], a[132:135], v[224:227], v[196:199]
  ds_read_b64_tr_b16 v[248:249], v16 offset:45056
  ds_read_b64_tr_b16 v[250:251], v16 offset:45568
  v_mfma_f32_16x16x32_bf16 v[196:199], a[148:151], v[232:235], v[196:199]
  v_min_u32_dpp v11, v11, v11 row_ror:1 row_mask:0xf bank_mask:0xf
  v_mov_b32_e64 v12, v11
  v_mfma_f32_16x16x32_bf16 v[208:211], a[136:139], v[224:227], v[208:211]
  ds_read_b64_tr_b16 v[252:253], v17 offset:45056
  ds_read_b64_tr_b16 v[254:255], v17 offset:45568
  v_mfma_f32_16x16x32_bf16 v[208:211], a[152:155], v[232:235], v[208:211]
  buffer_load_dwordx4 a[20:23], v1, s[12:15], s72 offen offset:3072 sc1
  v_mfma_f32_16x16x32_bf16 v[212:215], a[140:143], v[224:227], v[212:215]
  s_xor_b32 s79, s96, 1077248
  v_permlane16_swap_b32 v11, v12
  v_mfma_f32_16x16x32_bf16 v[212:215], a[156:159], v[232:235], v[212:215]
  buffer_store_dwordx4 v[176:179], v1, s[24:27], s79 offen sc1
  v_mfma_f32_16x16x32_bf16 v[200:203], a[128:131], v[228:231], v[200:203]
  v_min_u32 v11, v11, v12
  v_mov_b32_e64 v12, v11
  v_mfma_f32_16x16x32_bf16 v[200:203], a[144:147], v[236:239], v[200:203]
  s_nop 0
  v_permlane32_swap_b32 v11, v12
  v_mfma_f32_16x16x32_bf16 v[204:207], a[132:135], v[228:231], v[204:207]
  v_min_u32 v11, v11, v12
  v_sub_u32 v10, v10, v11
  v_mfma_f32_16x16x32_bf16 v[204:207], a[148:151], v[236:239], v[204:207]
  v_cndmask_b32 v2, v2, v10, s[32:33]
  v_add_u32_e64 v10, -1, v10
  v_mfma_f32_16x16x32_bf16 v[216:219], a[136:139], v[228:231], v[216:219]
  v_sub_u32 v11, v10, v24
  v_sub_u32 v18, v10, v25
  v_mfma_f32_16x16x32_bf16 v[216:219], a[152:155], v[236:239], v[216:219]
  buffer_load_dwordx4 a[28:31], v1, s[12:15], s73 offen offset:3072 sc1
  v_mfma_f32_16x16x32_bf16 v[220:223], a[140:143], v[228:231], v[220:223]
  s_add_u32 s42, s61, 0
  s_and_b32 s42, s42, 3
  v_mfma_f32_16x16x32_bf16 v[220:223], a[156:159], v[236:239], v[220:223]
  s_lshl_b32 s42, s42, 13
  s_add_u32 s42, s42, 4096
  s_waitcnt lgkmcnt(0)
  v_mfma_f32_16x16x32_bf16 v[192:195], a[160:163], v[240:243], v[192:195]
  ds_read_b64_tr_b16 v[224:225], v16 offset:49152
  ds_read_b64_tr_b16 v[226:227], v16 offset:49664
  v_mfma_f32_16x16x32_bf16 v[192:195], a[176:179], v[248:251], v[192:195]
  ds_read_b64_tr_b16 v[228:229], v17 offset:49152
  ds_read_b64_tr_b16 v[230:231], v17 offset:49664
  v_mfma_f32_16x16x32_bf16 v[196:199], a[164:167], v[240:243], v[196:199]
  ds_read_b64_tr_b16 v[232:233], v16 offset:53248
  ds_read_b64_tr_b16 v[234:235], v16 offset:53760
  v_mfma_f32_16x16x32_bf16 v[196:199], a[180:183], v[248:251], v[196:199]
  s_add_u32 s72, s42, s46
  s_add_u32 s73, s42, s47
  v_mfma_f32_16x16x32_bf16 v[208:211], a[168:171], v[240:243], v[208:211]
  ds_read_b64_tr_b16 v[236:237], v17 offset:53248
  ds_read_b64_tr_b16 v[238:239], v17 offset:53760
  v_mfma_f32_16x16x32_bf16 v[208:211], a[184:187], v[248:251], v[208:211]
  buffer_load_dwordx4 a[32:35], v1, s[12:15], s72 offen offset:0 sc1
  v_mfma_f32_16x16x32_bf16 v[212:215], a[172:175], v[240:243], v[212:215]
  s_xor_b32 s79, s96, 1078272
  v_min_u32_e64 v11, v11, v18
  v_mfma_f32_16x16x32_bf16 v[212:215], a[188:191], v[248:251], v[212:215]
  buffer_store_dwordx4 v[184:187], v1, s[24:27], s79 offen sc1
  v_mfma_f32_16x16x32_bf16 v[200:203], a[160:163], v[244:247], v[200:203]
  v_sub_u32 v18, v10, v26
  v_sub_u32 v19, v10, v27
  v_mfma_f32_16x16x32_bf16 v[200:203], a[176:179], v[252:255], v[200:203]
  v_min3_u32 v11, v11, v18, v19
  v_sub_u32_e64 v18, v10, v28
  v_mfma_f32_16x16x32_bf16 v[204:207], a[164:167], v[244:247], v[204:207]
  v_sub_u32_e64 v19, v10, v29
  v_min3_u32 v11, v11, v18, v19
  v_mfma_f32_16x16x32_bf16 v[204:207], a[180:183], v[252:255], v[204:207]
  v_sub_u32 v18, v10, v30
  v_sub_u32 v19, v10, v31
  v_mfma_f32_16x16x32_bf16 v[216:219], a[168:171], v[244:247], v[216:219]
  v_min3_u32 v11, v11, v18, v19
  v_cmp_eq_u32 s[32:33], 4, v13
  v_mfma_f32_16x16x32_bf16 v[216:219], a[184:187], v[252:255], v[216:219]
  buffer_load_dwordx4 a[40:43], v1, s[12:15], s73 offen offset:0 sc1
  v_mfma_f32_16x16x32_bf16 v[220:223], a[172:175], v[244:247], v[220:223]
  v_min_u32_dpp v11, v11, v11 row_ror:8 row_mask:0xf bank_mask:0xf
  s_nop 0
  v_mfma_f32_16x16x32_bf16 v[220:223], a[188:191], v[252:255], v[220:223]
  v_min_u32_dpp v11, v11, v11 row_ror:4 row_mask:0xf bank_mask:0xf
  s_nop 0
  s_waitcnt lgkmcnt(0)
  v_mfma_f32_16x16x32_bf16 v[192:195], a[192:195], v[224:227], v[192:195]
  ds_read_b64_tr_b16 v[240:241], v16 offset:57344
  ds_read_b64_tr_b16 v[242:243], v16 offset:57856
  v_mfma_f32_16x16x32_bf16 v[192:195], a[208:211], v[232:235], v[192:195]
  ds_read_b64_tr_b16 v[244:245], v17 offset:57344
  ds_read_b64_tr_b16 v[246:247], v17 offset:57856
  v_mfma_f32_16x16x32_bf16 v[196:199], a[196:199], v[224:227], v[196:199]
  ds_read_b64_tr_b16 v[248:249], v16 offset:61440
  ds_read_b64_tr_b16 v[250:251], v16 offset:61952
  v_mfma_f32_16x16x32_bf16 v[196:199], a[212:215], v[232:235], v[196:199]
  v_min_u32_dpp v11, v11, v11 row_ror:2 row_mask:0xf bank_mask:0xf
  s_nop 0
  v_mfma_f32_16x16x32_bf16 v[208:211], a[200:203], v[224:227], v[208:211]
  ds_read_b64_tr_b16 v[252:253], v17 offset:61440
  ds_read_b64_tr_b16 v[254:255], v17 offset:61952
  v_mfma_f32_16x16x32_bf16 v[208:211], a[216:219], v[232:235], v[208:211]
  buffer_load_dwordx4 a[36:39], v1, s[12:15], s72 offen offset:1024 sc1
  v_mfma_f32_16x16x32_bf16 v[212:215], a[204:207], v[224:227], v[212:215]
  v_min_u32_dpp v11, v11, v11 row_ror:1 row_mask:0xf bank_mask:0xf
  v_mov_b32_e64 v12, v11
  v_mfma_f32_16x16x32_bf16 v[212:215], a[220:223], v[232:235], v[212:215]
  s_nop 0
  v_permlane16_swap_b32 v11, v12
  v_mfma_f32_16x16x32_bf16 v[200:203], a[192:195], v[228:231], v[200:203]
  v_min_u32 v11, v11, v12
  v_mov_b32 v12, v11
  v_mfma_f32_16x16x32_bf16 v[200:203], a[208:211], v[236:239], v[200:203]
  s_nop 0
  v_permlane32_swap_b32 v11, v12
  v_mfma_f32_16x16x32_bf16 v[204:207], a[196:199], v[228:231], v[204:207]
  v_min_u32 v11, v11, v12
  v_sub_u32 v10, v10, v11
  v_mfma_f32_16x16x32_bf16 v[204:207], a[212:215], v[236:239], v[204:207]
  v_cndmask_b32 v2, v2, v10, s[32:33]
  v_add_u32_e64 v10, -1, v10
  v_mfma_f32_16x16x32_bf16 v[216:219], a[200:203], v[228:231], v[216:219]
  v_sub_u32 v11, v10, v24
  v_sub_u32 v18, v10, v25
  v_mfma_f32_16x16x32_bf16 v[216:219], a[216:219], v[236:239], v[216:219]
  buffer_load_dwordx4 a[44:47], v1, s[12:15], s73 offen offset:1024 sc1
  v_mfma_f32_16x16x32_bf16 v[220:223], a[204:207], v[228:231], v[220:223]
  v_min_u32 v11, v11, v18
  v_sub_u32 v18, v10, v26
  v_mfma_f32_16x16x32_bf16 v[220:223], a[220:223], v[236:239], v[220:223]
  v_sub_u32_e64 v19, v10, v27
  v_min3_u32 v11, v11, v18, v19
  s_waitcnt lgkmcnt(0)
  v_mfma_f32_16x16x32_bf16 v[192:195], a[224:227], v[240:243], v[192:195]
  s_waitcnt vmcnt(28)
  s_barrier
  v_mfma_f32_16x16x32_bf16 v[192:195], a[240:243], v[248:251], v[192:195]
  ds_read_b64_tr_b16 v[224:225], v20 offset:0
  ds_read_b64_tr_b16 v[226:227], v20 offset:512
  v_mfma_f32_16x16x32_bf16 v[196:199], a[228:231], v[240:243], v[196:199]
  ds_read_b64_tr_b16 v[228:229], v21 offset:0
  ds_read_b64_tr_b16 v[230:231], v21 offset:512
  v_mfma_f32_16x16x32_bf16 v[196:199], a[244:247], v[248:251], v[196:199]
  v_sub_u32 v18, v10, v28
  v_sub_u32_e64 v19, v10, v29
  v_mfma_f32_16x16x32_bf16 v[208:211], a[232:235], v[240:243], v[208:211]
  ds_read_b64_tr_b16 v[232:233], v20 offset:4096
  ds_read_b64_tr_b16 v[234:235], v20 offset:4608
  v_mfma_f32_16x16x32_bf16 v[208:211], a[248:251], v[248:251], v[208:211]
  buffer_load_dwordx4 a[48:51], v1, s[12:15], s72 offen offset:2048 sc1
  v_mfma_f32_16x16x32_bf16 v[212:215], a[236:239], v[240:243], v[212:215]
  ds_read_b64_tr_b16 v[236:237], v21 offset:4096
  ds_read_b64_tr_b16 v[238:239], v21 offset:4608
  v_mfma_f32_16x16x32_bf16 v[212:215], a[252:255], v[248:251], v[212:215]
  v_min3_u32 v11, v11, v18, v19
  v_sub_u32_e64 v18, v10, v30
  v_mfma_f32_16x16x32_bf16 v[200:203], a[224:227], v[244:247], v[200:203]
  v_sub_u32_e64 v19, v10, v31
  v_min3_u32 v11, v11, v18, v19
  v_mfma_f32_16x16x32_bf16 v[200:203], a[240:243], v[252:255], v[200:203]
  v_cmp_eq_u32 s[32:33], 5, v13
  s_nop 0
  v_mfma_f32_16x16x32_bf16 v[204:207], a[228:231], v[244:247], v[204:207]
  v_min_u32_dpp v11, v11, v11 row_ror:8 row_mask:0xf bank_mask:0xf
  s_nop 0
  v_mfma_f32_16x16x32_bf16 v[204:207], a[244:247], v[252:255], v[204:207]
  v_min_u32_dpp v11, v11, v11 row_ror:4 row_mask:0xf bank_mask:0xf
  s_nop 0
  v_mfma_f32_16x16x32_bf16 v[216:219], a[232:235], v[244:247], v[216:219]
  v_min_u32_dpp v11, v11, v11 row_ror:2 row_mask:0xf bank_mask:0xf
  s_nop 0
  v_mfma_f32_16x16x32_bf16 v[216:219], a[248:251], v[252:255], v[216:219]
  buffer_load_dwordx4 a[56:59], v1, s[12:15], s73 offen offset:2048 sc1
  v_mfma_f32_16x16x32_bf16 v[220:223], a[236:239], v[244:247], v[220:223]
  v_min_u32_dpp v11, v11, v11 row_ror:1 row_mask:0xf bank_mask:0xf
  v_mov_b32_e64 v12, v11
  v_mfma_f32_16x16x32_bf16 v[220:223], a[252:255], v[252:255], v[220:223]
  s_nop 0
  v_permlane16_swap_b32 v11, v12
  s_waitcnt vmcnt(7) lgkmcnt(0)
  v_mfma_f32_16x16x32_bf16 v[32:35], v[224:227], a[0:3], 0
  ds_read_b64_tr_b16 v[240:241], v22 offset:0
  ds_read_b64_tr_b16 v[242:243], v22 offset:512
  v_mfma_f32_16x16x32_bf16 v[32:35], v[232:235], a[16:19], v[32:35]
  ds_read_b64_tr_b16 v[244:245], v23 offset:0
  ds_read_b64_tr_b16 v[246:247], v23 offset:512
  v_mfma_f32_16x16x32_bf16 v[40:43], v[224:227], a[4:7], 0
  ds_read_b64_tr_b16 v[248:249], v22 offset:4096
  ds_read_b64_tr_b16 v[250:251], v22 offset:4608
  v_mfma_f32_16x16x32_bf16 v[40:43], v[232:235], a[20:23], v[40:43]
  v_min_u32 v11, v11, v12
  v_mov_b32_e64 v12, v11
  v_mfma_f32_16x16x32_bf16 v[48:51], v[224:227], a[8:11], 0
  ds_read_b64_tr_b16 v[252:253], v23 offset:4096
  ds_read_b64_tr_b16 v[254:255], v23 offset:4608
  v_mfma_f32_16x16x32_bf16 v[48:51], v[232:235], a[24:27], v[48:51]
  buffer_load_dwordx4 a[52:55], v1, s[12:15], s72 offen offset:3072 sc1
  v_mfma_f32_16x16x32_bf16 v[56:59], v[224:227], a[12:15], 0
  v_permlane32_swap_b32 v11, v12
  v_min_u32 v11, v11, v12
  v_mfma_f32_16x16x32_bf16 v[56:59], v[232:235], a[28:31], v[56:59]
  v_sub_u32_e64 v10, v10, v11
  v_cndmask_b32 v2, v2, v10, s[32:33]
  v_mfma_f32_16x16x32_bf16 v[36:39], v[228:231], a[0:3], 0
  v_add_u32 v10, -1, v10
  v_sub_u32 v11, v10, v24
  v_mfma_f32_16x16x32_bf16 v[36:39], v[236:239], a[16:19], v[36:39]
  v_sub_u32 v18, v10, v25
  v_min_u32 v11, v11, v18
  v_mfma_f32_16x16x32_bf16 v[44:47], v[228:231], a[4:7], 0
  buffer_load_dwordx4 a[60:63], v1, s[12:15], s73 offen offset:3072 sc1
  v_mfma_f32_16x16x32_bf16 v[44:47], v[236:239], a[20:23], v[44:47]
  s_add_u32 s42, s61, 1
  s_and_b32 s42, s42, 3
  v_mfma_f32_16x16x32_bf16 v[52:55], v[228:231], a[8:11], 0
  s_lshl_b32 s42, s42, 13
  s_add_u32 s72, s42, s46
  v_mfma_f32_16x16x32_bf16 v[52:55], v[236:239], a[24:27], v[52:55]
  s_add_u32 s73, s42, s47
  v_sub_u32 v18, v10, v26
  v_mfma_f32_16x16x32_bf16 v[60:63], v[228:231], a[12:15], 0
  v_sub_u32_e64 v19, v10, v27
  v_min3_u32 v11, v11, v18, v19
  v_mfma_f32_16x16x32_bf16 v[60:63], v[236:239], a[28:31], v[60:63]
  buffer_load_dwordx4 a[64:67], v1, s[12:15], s72 offen offset:0 sc1
  s_waitcnt lgkmcnt(0)
  v_mfma_f32_16x16x32_bf16 v[64:67], v[240:243], a[0:3], 0
  ds_read_b64_tr_b16 v[224:225], v20 offset:16384
  ds_read_b64_tr_b16 v[226:227], v20 offset:16896
  v_mfma_f32_16x16x32_bf16 v[64:67], v[248:251], a[16:19], v[64:67]
  ds_read_b64_tr_b16 v[228:229], v21 offset:16384
  ds_read_b64_tr_b16 v[230:231], v21 offset:16896
  v_mfma_f32_16x16x32_bf16 v[72:75], v[240:243], a[4:7], 0
  ds_read_b64_tr_b16 v[232:233], v20 offset:20480
  ds_read_b64_tr_b16 v[234:235], v20 offset:20992
  v_mfma_f32_16x16x32_bf16 v[72:75], v[248:251], a[20:23], v[72:75]
  buffer_load_dwordx4 a[72:75], v1, s[12:15], s73 offen offset:0 sc1
  v_mfma_f32_16x16x32_bf16 v[80:83], v[240:243], a[8:11], 0
  ds_read_b64_tr_b16 v[236:237], v21 offset:20480
  ds_read_b64_tr_b16 v[238:239], v21 offset:20992
  v_mfma_f32_16x16x32_bf16 v[80:83], v[248:251], a[24:27], v[80:83]
  v_cvt_pk_bf16_f32 v192, v192, v193
  v_cvt_pk_bf16_f32 v193, v194, v195
  v_mfma_f32_16x16x32_bf16 v[88:91], v[240:243], a[12:15], 0
  v_cvt_pk_bf16_f32 v194, v196, v197
  v_cvt_pk_bf16_f32 v195, v198, v199
  v_mfma_f32_16x16x32_bf16 v[88:91], v[248:251], a[28:31], v[88:91]
  v_cvt_pk_bf16_f32 v200, v200, v201
  v_cvt_pk_bf16_f32 v201, v202, v203
  v_mfma_f32_16x16x32_bf16 v[68:71], v[244:247], a[0:3], 0
  buffer_load_dwordx4 a[68:71], v1, s[12:15], s72 offen offset:1024 sc1
  v_mfma_f32_16x16x32_bf16 v[68:71], v[252:255], a[16:19], v[68:71]
  v_cvt_pk_bf16_f32 v202, v204, v205
  v_cvt_pk_bf16_f32 v203, v206, v207
  v_mfma_f32_16x16x32_bf16 v[76:79], v[244:247], a[4:7], 0
  v_cvt_pk_bf16_f32 v208, v208, v209
  v_cvt_pk_bf16_f32 v209, v210, v211
  v_mfma_f32_16x16x32_bf16 v[76:79], v[252:255], a[20:23], v[76:79]
  v_cvt_pk_bf16_f32 v210, v212, v213
  v_cvt_pk_bf16_f32 v211, v214, v215
  v_mfma_f32_16x16x32_bf16 v[84:87], v[244:247], a[8:11], 0
  buffer_load_dwordx4 a[76:79], v1, s[12:15], s73 offen offset:1024 sc1
  v_mfma_f32_16x16x32_bf16 v[84:87], v[252:255], a[24:27], v[84:87]
  v_cvt_pk_bf16_f32 v216, v216, v217
  v_cvt_pk_bf16_f32 v217, v218, v219
  v_mfma_f32_16x16x32_bf16 v[92:95], v[244:247], a[12:15], 0
  v_cvt_pk_bf16_f32 v218, v220, v221
  v_cvt_pk_bf16_f32 v219, v222, v223
  v_mfma_f32_16x16x32_bf16 v[92:95], v[252:255], a[28:31], v[92:95]
  s_xor_b32 s79, s96, 1071104
  v_sub_u32_e64 v18, v10, v28
  s_waitcnt lgkmcnt(0)
  v_mfma_f32_16x16x32_bf16 v[96:99], v[224:227], a[0:3], 0
  ds_read_b64_tr_b16 v[240:241], v22 offset:16384
  ds_read_b64_tr_b16 v[242:243], v22 offset:16896
  v_mfma_f32_16x16x32_bf16 v[96:99], v[232:235], a[16:19], v[96:99]
  ds_read_b64_tr_b16 v[244:245], v23 offset:16384
  ds_read_b64_tr_b16 v[246:247], v23 offset:16896
  v_mfma_f32_16x16x32_bf16 v[104:107], v[224:227], a[4:7], 0
  ds_read_b64_tr_b16 v[248:249], v22 offset:20480
  ds_read_b64_tr_b16 v[250:251], v22 offset:20992
  v_mfma_f32_16x16x32_bf16 v[104:107], v[232:235], a[20:23], v[104:107]
  buffer_store_dwordx4 v[192:195], v1, s[24:27], s79 offen sc1
  v_mfma_f32_16x16x32_bf16 v[112:115], v[224:227], a[8:11], 0
  ds_read_b64_tr_b16 v[252:253], v23 offset:20480
  ds_read_b64_tr_b16 v[254:255], v23 offset:20992
  v_mfma_f32_16x16x32_bf16 v[112:115], v[232:235], a[24:27], v[112:115]
  buffer_load_dwordx4 a[80:83], v1, s[12:15], s72 offen offset:2048 sc1
  v_mfma_f32_16x16x32_bf16 v[120:123], v[224:227], a[12:15], 0
  v_sub_u32_e64 v19, v10, v29
  v_min3_u32 v11, v11, v18, v19
  v_mfma_f32_16x16x32_bf16 v[120:123], v[232:235], a[28:31], v[120:123]
  s_xor_b32 s79, s96, 1072128
  v_sub_u32_e64 v18, v10, v30
  v_mfma_f32_16x16x32_bf16 v[100:103], v[228:231], a[0:3], 0
  buffer_load_dwordx4 a[88:91], v1, s[12:15], s73 offen offset:2048 sc1
  v_mfma_f32_16x16x32_bf16 v[100:103], v[236:239], a[16:19], v[100:103]
  buffer_store_dwordx4 v[200:203], v1, s[24:27], s79 offen sc1
  v_mfma_f32_16x16x32_bf16 v[108:111], v[228:231], a[4:7], 0
  v_sub_u32_e64 v19, v10, v31
  v_min3_u32 v11, v11, v18, v19
  v_mfma_f32_16x16x32_bf16 v[108:111], v[236:239], a[20:23], v[108:111]
  v_cmp_eq_u32 s[32:33], 6, v13
  s_nop 0
  v_mfma_f32_16x16x32_bf16 v[116:119], v[228:231], a[8:11], 0
  v_min_u32_dpp v11, v11, v11 row_ror:8 row_mask:0xf bank_mask:0xf
  s_nop 0
  v_mfma_f32_16x16x32_bf16 v[116:119], v[236:239], a[24:27], v[116:119]
  buffer_load_dwordx4 a[84:87], v1, s[12:15], s72 offen offset:3072 sc1
  v_mfma_f32_16x16x32_bf16 v[124:127], v[228:231], a[12:15], 0
  s_xor_b32 s79, s96, 1079296
  v_min_u32_dpp v11, v11, v11 row_ror:4 row_mask:0xf bank_mask:0xf
  v_mfma_f32_16x16x32_bf16 v[124:127], v[236:239], a[28:31], v[124:127]
  buffer_store_dwordx4 v[208:211], v1, s[24:27], s79 offen sc1
  s_waitcnt lgkmcnt(0)
  v_mfma_f32_16x16x32_bf16 v[128:131], v[240:243], a[0:3], 0
  ds_read_b64_tr_b16 v[224:225], v20 offset:8192
  ds_read_b64_tr_b16 v[226:227], v20 offset:8704
  v_mfma_f32_16x16x32_bf16 v[128:131], v[248:251], a[16:19], v[128:131]
  ds_read_b64_tr_b16 v[228:229], v21 offset:8192
  ds_read_b64_tr_b16 v[230:231], v21 offset:8704
  v_mfma_f32_16x16x32_bf16 v[136:139], v[240:243], a[4:7], 0
  ds_read_b64_tr_b16 v[232:233], v20 offset:12288
  ds_read_b64_tr_b16 v[234:235], v20 offset:12800
  v_mfma_f32_16x16x32_bf16 v[136:139], v[248:251], a[20:23], v[136:139]
  buffer_load_dwordx4 a[92:95], v1, s[12:15], s73 offen offset:3072 sc1
  v_mfma_f32_16x16x32_bf16 v[144:147], v[240:243], a[8:11], 0
  ds_read_b64_tr_b16 v[236:237], v21 offset:12288
  ds_read_b64_tr_b16 v[238:239], v21 offset:12800
  v_mfma_f32_16x16x32_bf16 v[144:147], v[248:251], a[24:27], v[144:147]
  s_add_u32 s42, s61, 1
  s_and_b32 s42, s42, 3
  v_mfma_f32_16x16x32_bf16 v[152:155], v[240:243], a[12:15], 0
  s_lshl_b32 s42, s42, 13
  s_add_u32 s42, s42, 4096
  v_mfma_f32_16x16x32_bf16 v[152:155], v[248:251], a[28:31], v[152:155]
  s_add_u32 s72, s42, s46
  s_add_u32 s73, s42, s47
  v_mfma_f32_16x16x32_bf16 v[132:135], v[244:247], a[0:3], 0
  buffer_load_dwordx4 a[96:99], v1, s[12:15], s72 offen offset:0 sc1
  v_mfma_f32_16x16x32_bf16 v[132:135], v[252:255], a[16:19], v[132:135]
  s_xor_b32 s79, s96, 1080320
  v_min_u32_dpp v11, v11, v11 row_ror:2 row_mask:0xf bank_mask:0xf
  v_mfma_f32_16x16x32_bf16 v[140:143], v[244:247], a[4:7], 0
  buffer_store_dwordx4 v[216:219], v1, s[24:27], s79 offen sc1
  v_mfma_f32_16x16x32_bf16 v[140:143], v[252:255], a[20:23], v[140:143]
  buffer_load_dwordx4 a[104:107], v1, s[12:15], s73 offen offset:0 sc1
  v_mfma_f32_16x16x32_bf16 v[148:151], v[244:247], a[8:11], 0
  v_min_u32_dpp v11, v11, v11 row_ror:1 row_mask:0xf bank_mask:0xf
  v_mov_b32_e64 v12, v11
  v_mfma_f32_16x16x32_bf16 v[148:151], v[252:255], a[24:27], v[148:151]
  s_nop 0
  v_permlane16_swap_b32 v11, v12
  v_mfma_f32_16x16x32_bf16 v[156:159], v[244:247], a[12:15], 0
  v_min_u32 v11, v11, v12
  v_mov_b32 v12, v11
  v_mfma_f32_16x16x32_bf16 v[156:159], v[252:255], a[28:31], v[156:159]
  s_nop 0
  v_permlane32_swap_b32 v11, v12
  s_waitcnt vmcnt(14) lgkmcnt(0)
  v_mfma_f32_16x16x32_bf16 v[32:35], v[224:227], a[32:35], v[32:35]
  ds_read_b64_tr_b16 v[240:241], v22 offset:8192
  ds_read_b64_tr_b16 v[242:243], v22 offset:8704
  v_mfma_f32_16x16x32_bf16 v[32:35], v[232:235], a[48:51], v[32:35]
  ds_read_b64_tr_b16 v[244:245], v23 offset:8192
  ds_read_b64_tr_b16 v[246:247], v23 offset:8704
  v_mfma_f32_16x16x32_bf16 v[40:43], v[224:227], a[36:39], v[40:43]
  ds_read_b64_tr_b16 v[248:249], v22 offset:12288
  ds_read_b64_tr_b16 v[250:251], v22 offset:12800
  v_mfma_f32_16x16x32_bf16 v[40:43], v[232:235], a[52:55], v[40:43]
  buffer_load_dwordx4 a[100:103], v1, s[12:15], s72 offen offset:1024 sc1
  v_mfma_f32_16x16x32_bf16 v[48:51], v[224:227], a[40:43], v[48:51]
  ds_read_b64_tr_b16 v[252:253], v23 offset:12288
  ds_read_b64_tr_b16 v[254:255], v23 offset:12800
  v_mfma_f32_16x16x32_bf16 v[48:51], v[232:235], a[56:59], v[48:51]
  v_min_u32 v11, v11, v12
  v_sub_u32_e64 v10, v10, v11
  v_mfma_f32_16x16x32_bf16 v[56:59], v[224:227], a[44:47], v[56:59]
  buffer_load_dwordx4 a[108:111], v1, s[12:15], s73 offen offset:1024 sc1
  v_mfma_f32_16x16x32_bf16 v[56:59], v[232:235], a[60:63], v[56:59]
  v_cndmask_b32 v2, v2, v10, s[32:33]
  v_add_u32_e64 v10, -1, v10
  v_mfma_f32_16x16x32_bf16 v[36:39], v[228:231], a[32:35], v[36:39]
  v_sub_u32 v11, v10, v24
  v_sub_u32 v18, v10, v25
  v_mfma_f32_16x16x32_bf16 v[36:39], v[236:239], a[48:51], v[36:39]
  v_min_u32 v11, v11, v18
  v_sub_u32 v18, v10, v26
  v_mfma_f32_16x16x32_bf16 v[44:47], v[228:231], a[36:39], v[44:47]
  v_sub_u32_e64 v19, v10, v27
  v_min3_u32 v11, v11, v18, v19
  v_mfma_f32_16x16x32_bf16 v[44:47], v[236:239], a[52:55], v[44:47]
  buffer_load_dwordx4 a[112:115], v1, s[12:15], s72 offen offset:2048 sc1
  v_mfma_f32_16x16x32_bf16 v[52:55], v[228:231], a[40:43], v[52:55]
  v_sub_u32 v18, v10, v28
  v_sub_u32 v19, v10, v29
  v_mfma_f32_16x16x32_bf16 v[52:55], v[236:239], a[56:59], v[52:55]
  v_min3_u32 v11, v11, v18, v19
  v_sub_u32_e64 v18, v10, v30
  v_mfma_f32_16x16x32_bf16 v[60:63], v[228:231], a[44:47], v[60:63]
  v_sub_u32_e64 v19, v10, v31
  v_min3_u32 v11, v11, v18, v19
  v_mfma_f32_16x16x32_bf16 v[60:63], v[236:239], a[60:63], v[60:63]
  buffer_load_dwordx4 a[120:123], v1, s[12:15], s73 offen offset:2048 sc1
  s_waitcnt lgkmcnt(0)
  v_mfma_f32_16x16x32_bf16 v[64:67], v[240:243], a[32:35], v[64:67]
  ds_read_b64_tr_b16 v[224:225], v20 offset:24576
  ds_read_b64_tr_b16 v[226:227], v20 offset:25088
  v_mfma_f32_16x16x32_bf16 v[64:67], v[248:251], a[48:51], v[64:67]
  ds_read_b64_tr_b16 v[228:229], v21 offset:24576
  ds_read_b64_tr_b16 v[230:231], v21 offset:25088
  v_mfma_f32_16x16x32_bf16 v[72:75], v[240:243], a[36:39], v[72:75]
  ds_read_b64_tr_b16 v[232:233], v20 offset:28672
  ds_read_b64_tr_b16 v[234:235], v20 offset:29184
  v_mfma_f32_16x16x32_bf16 v[72:75], v[248:251], a[52:55], v[72:75]
  v_cmp_eq_u32 s[32:33], 7, v13
  s_nop 0
  v_mfma_f32_16x16x32_bf16 v[80:83], v[240:243], a[40:43], v[80:83]
  ds_read_b64_tr_b16 v[236:237], v21 offset:28672
  ds_read_b64_tr_b16 v[238:239], v21 offset:29184
  v_mfma_f32_16x16x32_bf16 v[80:83], v[248:251], a[56:59], v[80:83]
  buffer_load_dwordx4 a[116:119], v1, s[12:15], s72 offen offset:3072 sc1
  v_mfma_f32_16x16x32_bf16 v[88:91], v[240:243], a[44:47], v[88:91]
  v_min_u32_dpp v11, v11, v11 row_ror:8 row_mask:0xf bank_mask:0xf
  s_nop 0
  v_mfma_f32_16x16x32_bf16 v[88:91], v[248:251], a[60:63], v[88:91]
  v_min_u32_dpp v11, v11, v11 row_ror:4 row_mask:0xf bank_mask:0xf
  s_nop 0
  v_mfma_f32_16x16x32_bf16 v[68:71], v[244:247], a[32:35], v[68:71]
  buffer_load_dwordx4 a[124:127], v1, s[12:15], s73 offen offset:3072 sc1
  v_mfma_f32_16x16x32_bf16 v[68:71], v[252:255], a[48:51], v[68:71]
  s_add_u32 m0, s44, 0
  s_add_u32 s42, s61, 2
  v_mfma_f32_16x16x32_bf16 v[76:79], v[244:247], a[36:39], v[76:79]
  s_and_b32 s42, s42, 3
  s_lshl_b32 s42, s42, 20
  v_mfma_f32_16x16x32_bf16 v[76:79], v[252:255], a[52:55], v[76:79]
  s_add_u32 s42, s42, s45
  v_min_u32_dpp v11, v11, v11 row_ror:2 row_mask:0xf bank_mask:0xf
  v_mfma_f32_16x16x32_bf16 v[84:87], v[244:247], a[40:43], v[84:87]
  s_nop 0
  v_min_u32_dpp v11, v11, v11 row_ror:1 row_mask:0xf bank_mask:0xf
  v_mfma_f32_16x16x32_bf16 v[84:87], v[252:255], a[56:59], v[84:87]
  buffer_load_dwordx4 v6, s[8:11], s42 offen offset:0 lds
  v_mfma_f32_16x16x32_bf16 v[92:95], v[244:247], a[44:47], v[92:95]
  v_mov_b32 v12, v11
  s_nop 0
  v_mfma_f32_16x16x32_bf16 v[92:95], v[252:255], a[60:63], v[92:95]
  v_permlane16_swap_b32 v11, v12
  v_min_u32_e64 v11, v11, v12
  s_waitcnt lgkmcnt(0)
  v_mfma_f32_16x16x32_bf16 v[96:99], v[224:227], a[32:35], v[96:99]
  ds_read_b64_tr_b16 v[240:241], v22 offset:24576
  ds_read_b64_tr_b16 v[242:243], v22 offset:25088
  v_mfma_f32_16x16x32_bf16 v[96:99], v[232:235], a[48:51], v[96:99]
  ds_read_b64_tr_b16 v[244:245], v23 offset:24576
  ds_read_b64_tr_b16 v[246:247], v23 offset:25088
  v_mfma_f32_16x16x32_bf16 v[104:107], v[224:227], a[36:39], v[104:107]
  ds_read_b64_tr_b16 v[248:249], v22 offset:28672
  ds_read_b64_tr_b16 v[250:251], v22 offset:29184
  v_mfma_f32_16x16x32_bf16 v[104:107], v[232:235], a[52:55], v[104:107]
  buffer_load_dwordx4 v7, s[8:11], s42 offen offset:1024 lds
  v_mfma_f32_16x16x32_bf16 v[112:115], v[224:227], a[40:43], v[112:115]
  ds_read_b64_tr_b16 v[252:253], v23 offset:28672
  ds_read_b64_tr_b16 v[254:255], v23 offset:29184
  v_mfma_f32_16x16x32_bf16 v[112:115], v[232:235], a[56:59], v[112:115]
  v_mov_b32 v12, v11
  s_nop 0
  v_mfma_f32_16x16x32_bf16 v[120:123], v[224:227], a[44:47], v[120:123]
  buffer_load_dwordx4 v8, s[8:11], s42 offen offset:2048 lds
  v_mfma_f32_16x16x32_bf16 v[120:123], v[232:235], a[60:63], v[120:123]
  v_permlane32_swap_b32 v11, v12
  v_min_u32 v11, v11, v12
  v_mfma_f32_16x16x32_bf16 v[100:103], v[228:231], a[32:35], v[100:103]
  v_sub_u32_e64 v10, v10, v11
  v_cndmask_b32 v2, v2, v10, s[32:33]
  v_mfma_f32_16x16x32_bf16 v[100:103], v[236:239], a[48:51], v[100:103]
  v_add_u32 v10, -1, v10
  s_lshl_b32 s43, s40, 5
  v_mfma_f32_16x16x32_bf16 v[108:111], v[228:231], a[36:39], v[108:111]
  s_add_u32 s43, s43, 131072
  v_lshlrev_b32_e64 v13, 2, v13
  v_mfma_f32_16x16x32_bf16 v[108:111], v[236:239], a[52:55], v[108:111]
  buffer_load_dwordx4 v9, s[8:11], s42 offen offset:3072 lds
  v_mfma_f32_16x16x32_bf16 v[116:119], v[228:231], a[40:43], v[116:119]
  s_add_u32 m0, s44, 16384
  s_add_u32 s42, s42, 128
  v_mfma_f32_16x16x32_bf16 v[116:119], v[236:239], a[56:59], v[116:119]
  v_add_u32_e64 v13, s43, v13
  ds_write_b32 v13, v2
  v_mfma_f32_16x16x32_bf16 v[124:127], v[228:231], a[44:47], v[124:127]
  v_and_b32 v13, 31, v0
  v_lshlrev_b32 v13, 2, v13
  v_mfma_f32_16x16x32_bf16 v[124:127], v[236:239], a[60:63], v[124:127]
  buffer_load_dwordx4 v6, s[8:11], s42 offen offset:0 lds
  s_waitcnt lgkmcnt(0)
  v_mfma_f32_16x16x32_bf16 v[128:131], v[240:243], a[32:35], v[128:131]
  s_waitcnt vmcnt(12)
  s_barrier
  v_mfma_f32_16x16x32_bf16 v[128:131], v[248:251], a[48:51], v[128:131]
  ds_read_b64_tr_b16 v[224:225], v20 offset:32768
  ds_read_b64_tr_b16 v[226:227], v20 offset:33280
  v_mfma_f32_16x16x32_bf16 v[136:139], v[240:243], a[36:39], v[136:139]
  ds_read_b64_tr_b16 v[228:229], v21 offset:32768
  ds_read_b64_tr_b16 v[230:231], v21 offset:33280
  v_mfma_f32_16x16x32_bf16 v[136:139], v[248:251], a[52:55], v[136:139]
  v_add_u32 v13, 131072, v13
  v_mfma_f32_16x16x32_bf16 v[144:147], v[240:243], a[40:43], v[144:147]
  ds_read_b64_tr_b16 v[232:233], v20 offset:36864
  ds_read_b64_tr_b16 v[234:235], v20 offset:37376
  v_mfma_f32_16x16x32_bf16 v[144:147], v[248:251], a[56:59], v[144:147]
  buffer_load_dwordx4 v7, s[8:11], s42 offen offset:1024 lds
  v_mfma_f32_16x16x32_bf16 v[152:155], v[240:243], a[44:47], v[152:155]
  ds_read_b64_tr_b16 v[236:237], v21 offset:36864
  ds_read_b64_tr_b16 v[238:239], v21 offset:37376
  v_mfma_f32_16x16x32_bf16 v[152:155], v[248:251], a[60:63], v[152:155]
  v_mfma_f32_16x16x32_bf16 v[132:135], v[244:247], a[32:35], v[132:135]
  v_mfma_f32_16x16x32_bf16 v[132:135], v[252:255], a[48:51], v[132:135]
  buffer_load_dwordx4 v8, s[8:11], s42 offen offset:2048 lds
  v_mfma_f32_16x16x32_bf16 v[140:143], v[244:247], a[36:39], v[140:143]
  v_mfma_f32_16x16x32_bf16 v[140:143], v[252:255], a[52:55], v[140:143]
  v_mfma_f32_16x16x32_bf16 v[148:151], v[244:247], a[40:43], v[148:151]
  v_mfma_f32_16x16x32_bf16 v[148:151], v[252:255], a[56:59], v[148:151]
  buffer_load_dwordx4 v9, s[8:11], s42 offen offset:3072 lds
  v_mfma_f32_16x16x32_bf16 v[156:159], v[244:247], a[44:47], v[156:159]
  s_add_u32 s42, s61, 2
  s_and_b32 s42, s42, 3
  v_mfma_f32_16x16x32_bf16 v[156:159], v[252:255], a[60:63], v[156:159]
  s_lshl_b32 s42, s42, 13
  s_add_u32 s72, s42, s46
  s_waitcnt vmcnt(17) lgkmcnt(0)
  v_mfma_f32_16x16x32_bf16 v[32:35], v[224:227], a[64:67], v[32:35]
  v_mov_b32_e64 v4, 1
  buffer_store_dword v4, v3, s[12:15], s97 offen sc1
  s_lshl_b32 s43, s59, 20
  s_add_u32 s43, s43, 0xff0000
  s_add_u32 s16, s38, s43
  s_addc_u32 s17, s39, 0
  s_and_b32 s17, s17, 0xffff
  s_sub_u32 s18, 17, s41
  s_lshl_b32 s18, s18, 16
  s_mov_b32 s19, 0x20000
  s_add_u32 s20, s38, 0x3000000
  s_addc_u32 s21, s39, 0
  s_and_b32 s21, s21, 0xffff
  s_mov_b32 s22, 0x1000000
  s_mov_b32 s23, 0x20000
  v_mfma_f32_16x16x32_bf16 v[32:35], v[232:235], a[80:83], v[32:35]
  ds_read_b64_tr_b16 v[240:241], v22 offset:32768
  ds_read_b64_tr_b16 v[242:243], v22 offset:33280
  v_mfma_f32_16x16x32_bf16 v[40:43], v[224:227], a[68:71], v[40:43]
  ds_read_b64_tr_b16 v[244:245], v23 offset:32768
  ds_read_b64_tr_b16 v[246:247], v23 offset:33280
  v_mfma_f32_16x16x32_bf16 v[40:43], v[232:235], a[84:87], v[40:43]
  s_add_u32 s73, s42, s47
  v_mfma_f32_16x16x32_bf16 v[48:51], v[224:227], a[72:75], v[48:51]
  ds_read_b64_tr_b16 v[248:249], v22 offset:36864
  ds_read_b64_tr_b16 v[250:251], v22 offset:37376
  v_mfma_f32_16x16x32_bf16 v[48:51], v[232:235], a[88:91], v[48:51]
  buffer_load_dwordx4 a[128:131], v1, s[12:15], s72 offen offset:0 sc1
  v_mfma_f32_16x16x32_bf16 v[56:59], v[224:227], a[76:79], v[56:59]
  ds_read_b64_tr_b16 v[252:253], v23 offset:36864
  ds_read_b64_tr_b16 v[254:255], v23 offset:37376
  v_mfma_f32_16x16x32_bf16 v[56:59], v[232:235], a[92:95], v[56:59]
  v_mfma_f32_16x16x32_bf16 v[36:39], v[228:231], a[64:67], v[36:39]
  buffer_load_dwordx4 a[136:139], v1, s[12:15], s73 offen offset:0 sc1
  v_mfma_f32_16x16x32_bf16 v[36:39], v[236:239], a[80:83], v[36:39]
  v_mfma_f32_16x16x32_bf16 v[44:47], v[228:231], a[68:71], v[44:47]
  v_mfma_f32_16x16x32_bf16 v[44:47], v[236:239], a[84:87], v[44:47]
  v_mfma_f32_16x16x32_bf16 v[52:55], v[228:231], a[72:75], v[52:55]
  v_mfma_f32_16x16x32_bf16 v[52:55], v[236:239], a[88:91], v[52:55]
  buffer_load_dwordx4 a[132:135], v1, s[12:15], s72 offen offset:1024 sc1
  v_mfma_f32_16x16x32_bf16 v[60:63], v[228:231], a[76:79], v[60:63]
  v_mfma_f32_16x16x32_bf16 v[60:63], v[236:239], a[92:95], v[60:63]
  s_waitcnt lgkmcnt(0)
  v_mfma_f32_16x16x32_bf16 v[64:67], v[240:243], a[64:67], v[64:67]
  ds_read_b64_tr_b16 v[224:225], v20 offset:49152
  ds_read_b64_tr_b16 v[226:227], v20 offset:49664
  v_mfma_f32_16x16x32_bf16 v[64:67], v[248:251], a[80:83], v[64:67]
  ds_read_b64_tr_b16 v[228:229], v21 offset:49152
  ds_read_b64_tr_b16 v[230:231], v21 offset:49664
  v_mfma_f32_16x16x32_bf16 v[72:75], v[240:243], a[68:71], v[72:75]
  ds_read_b64_tr_b16 v[232:233], v20 offset:53248
  ds_read_b64_tr_b16 v[234:235], v20 offset:53760
  v_mfma_f32_16x16x32_bf16 v[72:75], v[248:251], a[84:87], v[72:75]
  buffer_load_dwordx4 a[140:143], v1, s[12:15], s73 offen offset:1024 sc1
  v_mfma_f32_16x16x32_bf16 v[80:83], v[240:243], a[72:75], v[80:83]
  ds_read_b64_tr_b16 v[236:237], v21 offset:53248
  ds_read_b64_tr_b16 v[238:239], v21 offset:53760
  v_mfma_f32_16x16x32_bf16 v[80:83], v[248:251], a[88:91], v[80:83]
  v_mfma_f32_16x16x32_bf16 v[88:91], v[240:243], a[76:79], v[88:91]
  buffer_load_dwordx4 a[144:147], v1, s[12:15], s72 offen offset:2048 sc1
  v_mfma_f32_16x16x32_bf16 v[88:91], v[248:251], a[92:95], v[88:91]
  v_mfma_f32_16x16x32_bf16 v[68:71], v[244:247], a[64:67], v[68:71]
  v_mfma_f32_16x16x32_bf16 v[68:71], v[252:255], a[80:83], v[68:71]
  v_mfma_f32_16x16x32_bf16 v[76:79], v[244:247], a[68:71], v[76:79]
  v_mfma_f32_16x16x32_bf16 v[76:79], v[252:255], a[84:87], v[76:79]
  buffer_load_dwordx4 a[152:155], v1, s[12:15], s73 offen offset:2048 sc1
  v_mfma_f32_16x16x32_bf16 v[84:87], v[244:247], a[72:75], v[84:87]
  v_mfma_f32_16x16x32_bf16 v[84:87], v[252:255], a[88:91], v[84:87]
  v_mfma_f32_16x16x32_bf16 v[92:95], v[244:247], a[76:79], v[92:95]
  v_mfma_f32_16x16x32_bf16 v[92:95], v[252:255], a[92:95], v[92:95]
  buffer_load_dwordx4 a[148:151], v1, s[12:15], s72 offen offset:3072 sc1
  s_waitcnt lgkmcnt(0)
  v_mfma_f32_16x16x32_bf16 v[96:99], v[224:227], a[64:67], v[96:99]
  ds_read_b64_tr_b16 v[240:241], v22 offset:49152
  ds_read_b64_tr_b16 v[242:243], v22 offset:49664
  v_mfma_f32_16x16x32_bf16 v[96:99], v[232:235], a[80:83], v[96:99]
  ds_read_b64_tr_b16 v[244:245], v23 offset:49152
  ds_read_b64_tr_b16 v[246:247], v23 offset:49664
  v_mfma_f32_16x16x32_bf16 v[104:107], v[224:227], a[68:71], v[104:107]
  ds_read_b64_tr_b16 v[248:249], v22 offset:53248
  ds_read_b64_tr_b16 v[250:251], v22 offset:53760
  v_mfma_f32_16x16x32_bf16 v[104:107], v[232:235], a[84:87], v[104:107]
  v_mfma_f32_16x16x32_bf16 v[112:115], v[224:227], a[72:75], v[112:115]
  ds_read_b64_tr_b16 v[252:253], v23 offset:53248
  ds_read_b64_tr_b16 v[254:255], v23 offset:53760
  v_mfma_f32_16x16x32_bf16 v[112:115], v[232:235], a[88:91], v[112:115]
  buffer_load_dwordx4 a[156:159], v1, s[12:15], s73 offen offset:3072 sc1
  v_mfma_f32_16x16x32_bf16 v[120:123], v[224:227], a[76:79], v[120:123]
  s_add_u32 s42, s61, 2
  s_and_b32 s42, s42, 3
  v_mfma_f32_16x16x32_bf16 v[120:123], v[232:235], a[92:95], v[120:123]
  s_lshl_b32 s42, s42, 13
  s_add_u32 s42, s42, 4096
  v_mfma_f32_16x16x32_bf16 v[100:103], v[228:231], a[64:67], v[100:103]
  s_add_u32 s72, s42, s46
  s_add_u32 s73, s42, s47
  v_mfma_f32_16x16x32_bf16 v[100:103], v[236:239], a[80:83], v[100:103]
  buffer_load_dwordx4 a[160:163], v1, s[12:15], s72 offen offset:0 sc1
  v_mfma_f32_16x16x32_bf16 v[108:111], v[228:231], a[68:71], v[108:111]
  v_mfma_f32_16x16x32_bf16 v[108:111], v[236:239], a[84:87], v[108:111]
  v_mfma_f32_16x16x32_bf16 v[116:119], v[228:231], a[72:75], v[116:119]
  v_mfma_f32_16x16x32_bf16 v[116:119], v[236:239], a[88:91], v[116:119]
  buffer_load_dwordx4 a[168:171], v1, s[12:15], s73 offen offset:0 sc1
  v_mfma_f32_16x16x32_bf16 v[124:127], v[228:231], a[76:79], v[124:127]
  v_mfma_f32_16x16x32_bf16 v[124:127], v[236:239], a[92:95], v[124:127]
  s_waitcnt lgkmcnt(0)
  v_mfma_f32_16x16x32_bf16 v[128:131], v[240:243], a[64:67], v[128:131]
  ds_read_b64_tr_b16 v[224:225], v20 offset:40960
  ds_read_b64_tr_b16 v[226:227], v20 offset:41472
  v_mfma_f32_16x16x32_bf16 v[128:131], v[248:251], a[80:83], v[128:131]
  ds_read_b64_tr_b16 v[228:229], v21 offset:40960
  ds_read_b64_tr_b16 v[230:231], v21 offset:41472
  v_mfma_f32_16x16x32_bf16 v[136:139], v[240:243], a[68:71], v[136:139]
  ds_read_b64_tr_b16 v[232:233], v20 offset:45056
  ds_read_b64_tr_b16 v[234:235], v20 offset:45568
  v_mfma_f32_16x16x32_bf16 v[136:139], v[248:251], a[84:87], v[136:139]
  buffer_load_dwordx4 a[164:167], v1, s[12:15], s72 offen offset:1024 sc1
  v_mfma_f32_16x16x32_bf16 v[144:147], v[240:243], a[72:75], v[144:147]
  ds_read_b64_tr_b16 v[236:237], v21 offset:45056
  ds_read_b64_tr_b16 v[238:239], v21 offset:45568
  v_mfma_f32_16x16x32_bf16 v[144:147], v[248:251], a[88:91], v[144:147]
  v_mfma_f32_16x16x32_bf16 v[152:155], v[240:243], a[76:79], v[152:155]
  buffer_load_dwordx4 a[172:175], v1, s[12:15], s73 offen offset:1024 sc1
  v_mfma_f32_16x16x32_bf16 v[152:155], v[248:251], a[92:95], v[152:155]
  v_mfma_f32_16x16x32_bf16 v[132:135], v[244:247], a[64:67], v[132:135]
  v_mfma_f32_16x16x32_bf16 v[132:135], v[252:255], a[80:83], v[132:135]
  v_mfma_f32_16x16x32_bf16 v[140:143], v[244:247], a[68:71], v[140:143]
  v_mfma_f32_16x16x32_bf16 v[140:143], v[252:255], a[84:87], v[140:143]
  buffer_load_dwordx4 a[176:179], v1, s[12:15], s72 offen offset:2048 sc1
  v_mfma_f32_16x16x32_bf16 v[148:151], v[244:247], a[72:75], v[148:151]
  v_mfma_f32_16x16x32_bf16 v[148:151], v[252:255], a[88:91], v[148:151]
  v_mfma_f32_16x16x32_bf16 v[156:159], v[244:247], a[76:79], v[156:159]
  v_mfma_f32_16x16x32_bf16 v[156:159], v[252:255], a[92:95], v[156:159]
  buffer_load_dwordx4 a[184:187], v1, s[12:15], s73 offen offset:2048 sc1
  s_waitcnt vmcnt(23) lgkmcnt(0)
  v_mfma_f32_16x16x32_bf16 v[32:35], v[224:227], a[96:99], v[32:35]
  ds_read_b64_tr_b16 v[240:241], v22 offset:40960
  ds_read_b64_tr_b16 v[242:243], v22 offset:41472
  v_mfma_f32_16x16x32_bf16 v[32:35], v[232:235], a[112:115], v[32:35]
  ds_read_b64_tr_b16 v[244:245], v23 offset:40960
  ds_read_b64_tr_b16 v[246:247], v23 offset:41472
  v_mfma_f32_16x16x32_bf16 v[40:43], v[224:227], a[100:103], v[40:43]
  ds_read_b64_tr_b16 v[248:249], v22 offset:45056
  ds_read_b64_tr_b16 v[250:251], v22 offset:45568
  v_mfma_f32_16x16x32_bf16 v[40:43], v[232:235], a[116:119], v[40:43]
  v_mfma_f32_16x16x32_bf16 v[48:51], v[224:227], a[104:107], v[48:51]
  ds_read_b64_tr_b16 v[252:253], v23 offset:45056
  ds_read_b64_tr_b16 v[254:255], v23 offset:45568
  v_mfma_f32_16x16x32_bf16 v[48:51], v[232:235], a[120:123], v[48:51]
  buffer_load_dwordx4 a[180:183], v1, s[12:15], s72 offen offset:3072 sc1
  v_mfma_f32_16x16x32_bf16 v[56:59], v[224:227], a[108:111], v[56:59]
  v_mfma_f32_16x16x32_bf16 v[56:59], v[232:235], a[124:127], v[56:59]
  v_mfma_f32_16x16x32_bf16 v[36:39], v[228:231], a[96:99], v[36:39]
  v_mfma_f32_16x16x32_bf16 v[36:39], v[236:239], a[112:115], v[36:39]
  buffer_load_dwordx4 a[188:191], v1, s[12:15], s73 offen offset:3072 sc1
  v_mfma_f32_16x16x32_bf16 v[44:47], v[228:231], a[100:103], v[44:47]
  s_add_u32 m0, s44, 32768
  s_add_u32 s42, s61, 3
  v_mfma_f32_16x16x32_bf16 v[44:47], v[236:239], a[116:119], v[44:47]
  s_and_b32 s42, s42, 3
  s_lshl_b32 s42, s42, 20
  v_mfma_f32_16x16x32_bf16 v[52:55], v[228:231], a[104:107], v[52:55]
  s_add_u32 s42, s42, s45
  v_mfma_f32_16x16x32_bf16 v[52:55], v[236:239], a[120:123], v[52:55]
  buffer_load_dwordx4 v6, s[8:11], s42 offen offset:0 lds
  v_mfma_f32_16x16x32_bf16 v[60:63], v[228:231], a[108:111], v[60:63]
  v_mfma_f32_16x16x32_bf16 v[60:63], v[236:239], a[124:127], v[60:63]
  s_waitcnt lgkmcnt(0)
  v_mfma_f32_16x16x32_bf16 v[64:67], v[240:243], a[96:99], v[64:67]
  ds_read_b64_tr_b16 v[224:225], v20 offset:57344
  ds_read_b64_tr_b16 v[226:227], v20 offset:57856
  v_mfma_f32_16x16x32_bf16 v[64:67], v[248:251], a[112:115], v[64:67]
  ds_read_b64_tr_b16 v[228:229], v21 offset:57344
  ds_read_b64_tr_b16 v[230:231], v21 offset:57856
  v_mfma_f32_16x16x32_bf16 v[72:75], v[240:243], a[100:103], v[72:75]
  ds_read_b64_tr_b16 v[232:233], v20 offset:61440
  ds_read_b64_tr_b16 v[234:235], v20 offset:61952
  v_mfma_f32_16x16x32_bf16 v[72:75], v[248:251], a[116:119], v[72:75]
  buffer_load_dwordx4 v7, s[8:11], s42 offen offset:1024 lds
  v_mfma_f32_16x16x32_bf16 v[80:83], v[240:243], a[104:107], v[80:83]
  ds_read_b64_tr_b16 v[236:237], v21 offset:61440
  ds_read_b64_tr_b16 v[238:239], v21 offset:61952
  v_mfma_f32_16x16x32_bf16 v[80:83], v[248:251], a[120:123], v[80:83]
  v_mfma_f32_16x16x32_bf16 v[88:91], v[240:243], a[108:111], v[88:91]
  buffer_load_dwordx4 v8, s[8:11], s42 offen offset:2048 lds
  v_mfma_f32_16x16x32_bf16 v[88:91], v[248:251], a[124:127], v[88:91]
  v_mfma_f32_16x16x32_bf16 v[68:71], v[244:247], a[96:99], v[68:71]
  v_mfma_f32_16x16x32_bf16 v[68:71], v[252:255], a[112:115], v[68:71]
  v_mfma_f32_16x16x32_bf16 v[76:79], v[244:247], a[100:103], v[76:79]
  v_mfma_f32_16x16x32_bf16 v[76:79], v[252:255], a[116:119], v[76:79]
  buffer_load_dwordx4 v9, s[8:11], s42 offen offset:3072 lds
  v_mfma_f32_16x16x32_bf16 v[84:87], v[244:247], a[104:107], v[84:87]
  s_add_u32 m0, s44, 49152
  s_add_u32 s42, s42, 128
  v_mfma_f32_16x16x32_bf16 v[84:87], v[252:255], a[120:123], v[84:87]
  v_mfma_f32_16x16x32_bf16 v[92:95], v[244:247], a[108:111], v[92:95]
  v_mfma_f32_16x16x32_bf16 v[92:95], v[252:255], a[124:127], v[92:95]
  s_waitcnt lgkmcnt(0)
  v_mfma_f32_16x16x32_bf16 v[96:99], v[224:227], a[96:99], v[96:99]
  ds_read_b64_tr_b16 v[240:241], v22 offset:57344
  ds_read_b64_tr_b16 v[242:243], v22 offset:57856
  v_mfma_f32_16x16x32_bf16 v[96:99], v[232:235], a[112:115], v[96:99]
  ds_read_b64_tr_b16 v[244:245], v23 offset:57344
  ds_read_b64_tr_b16 v[246:247], v23 offset:57856
  v_mfma_f32_16x16x32_bf16 v[104:107], v[224:227], a[100:103], v[104:107]
  ds_read_b64_tr_b16 v[248:249], v22 offset:61440
  ds_read_b64_tr_b16 v[250:251], v22 offset:61952
  v_mfma_f32_16x16x32_bf16 v[104:107], v[232:235], a[116:119], v[104:107]
  buffer_load_dwordx4 v6, s[8:11], s42 offen offset:0 lds
  v_mfma_f32_16x16x32_bf16 v[112:115], v[224:227], a[104:107], v[112:115]
  ds_read_b64_tr_b16 v[252:253], v23 offset:61440
  ds_read_b64_tr_b16 v[254:255], v23 offset:61952
  v_mfma_f32_16x16x32_bf16 v[112:115], v[232:235], a[120:123], v[112:115]
  v_mfma_f32_16x16x32_bf16 v[120:123], v[224:227], a[108:111], v[120:123]
  buffer_load_dwordx4 v7, s[8:11], s42 offen offset:1024 lds
  v_mfma_f32_16x16x32_bf16 v[120:123], v[232:235], a[124:127], v[120:123]
  v_mfma_f32_16x16x32_bf16 v[100:103], v[228:231], a[96:99], v[100:103]
  v_mfma_f32_16x16x32_bf16 v[100:103], v[236:239], a[112:115], v[100:103]
  v_mfma_f32_16x16x32_bf16 v[108:111], v[228:231], a[100:103], v[108:111]
  v_mfma_f32_16x16x32_bf16 v[108:111], v[236:239], a[116:119], v[108:111]
  buffer_load_dwordx4 v8, s[8:11], s42 offen offset:2048 lds
  v_mfma_f32_16x16x32_bf16 v[116:119], v[228:231], a[104:107], v[116:119]
  v_mfma_f32_16x16x32_bf16 v[116:119], v[236:239], a[120:123], v[116:119]
  v_mfma_f32_16x16x32_bf16 v[124:127], v[228:231], a[108:111], v[124:127]
  v_mfma_f32_16x16x32_bf16 v[124:127], v[236:239], a[124:127], v[124:127]
  buffer_load_dwordx4 v9, s[8:11], s42 offen offset:3072 lds
  s_waitcnt lgkmcnt(0)
  v_mfma_f32_16x16x32_bf16 v[128:131], v[240:243], a[96:99], v[128:131]
  s_waitcnt vmcnt(25)
  s_barrier
  ds_read_b32 v24, v13
  v_mfma_f32_16x16x32_bf16 v[128:131], v[248:251], a[112:115], v[128:131]
  ds_read_b64_tr_b16 v[224:225], v14 offset:0
  ds_read_b64_tr_b16 v[226:227], v14 offset:512
  v_mfma_f32_16x16x32_bf16 v[136:139], v[240:243], a[100:103], v[136:139]
  ds_read_b64_tr_b16 v[228:229], v15 offset:0
  ds_read_b64_tr_b16 v[230:231], v15 offset:512
  v_mfma_f32_16x16x32_bf16 v[136:139], v[248:251], a[116:119], v[136:139]
  s_add_u32 s42, s61, 3
  s_and_b32 s42, s42, 3
  v_mfma_f32_16x16x32_bf16 v[144:147], v[240:243], a[104:107], v[144:147]
  ds_read_b64_tr_b16 v[232:233], v14 offset:4096
  ds_read_b64_tr_b16 v[234:235], v14 offset:4608
  v_mfma_f32_16x16x32_bf16 v[144:147], v[248:251], a[120:123], v[144:147]
  s_lshl_b32 s42, s42, 13
  s_add_u32 s72, s42, s46
  v_mfma_f32_16x16x32_bf16 v[152:155], v[240:243], a[108:111], v[152:155]
  ds_read_b64_tr_b16 v[236:237], v15 offset:4096
  ds_read_b64_tr_b16 v[238:239], v15 offset:4608
  v_mfma_f32_16x16x32_bf16 v[152:155], v[248:251], a[124:127], v[152:155]
  s_add_u32 s73, s42, s47
  v_mfma_f32_16x16x32_bf16 v[132:135], v[244:247], a[96:99], v[132:135]
  buffer_load_dwordx4 a[192:195], v1, s[12:15], s72 offen offset:0 sc1
  v_mfma_f32_16x16x32_bf16 v[132:135], v[252:255], a[112:115], v[132:135]
  v_mfma_f32_16x16x32_bf16 v[140:143], v[244:247], a[100:103], v[140:143]
  v_mfma_f32_16x16x32_bf16 v[140:143], v[252:255], a[116:119], v[140:143]
  buffer_load_dwordx4 a[200:203], v1, s[12:15], s73 offen offset:0 sc1
  v_mfma_f32_16x16x32_bf16 v[148:151], v[244:247], a[104:107], v[148:151]
  v_mfma_f32_16x16x32_bf16 v[148:151], v[252:255], a[120:123], v[148:151]
  v_mfma_f32_16x16x32_bf16 v[156:159], v[244:247], a[108:111], v[156:159]
  v_mfma_f32_16x16x32_bf16 v[156:159], v[252:255], a[124:127], v[156:159]
  s_waitcnt vmcnt(18) lgkmcnt(0)
  v_mfma_f32_16x16x32_bf16 v[32:35], v[224:227], a[128:131], v[32:35]
  ds_read_b64_tr_b16 v[240:241], v16 offset:0
  ds_read_b64_tr_b16 v[242:243], v16 offset:512
  v_mfma_f32_16x16x32_bf16 v[32:35], v[232:235], a[144:147], v[32:35]
  ds_read_b64_tr_b16 v[244:245], v17 offset:0
  ds_read_b64_tr_b16 v[246:247], v17 offset:512
  v_mfma_f32_16x16x32_bf16 v[40:43], v[224:227], a[132:135], v[40:43]
  ds_read_b64_tr_b16 v[248:249], v16 offset:4096
  ds_read_b64_tr_b16 v[250:251], v16 offset:4608
  v_mfma_f32_16x16x32_bf16 v[40:43], v[232:235], a[148:151], v[40:43]
  buffer_load_dwordx4 a[196:199], v1, s[12:15], s72 offen offset:1024 sc1
  v_mfma_f32_16x16x32_bf16 v[48:51], v[224:227], a[136:139], v[48:51]
  ds_read_b64_tr_b16 v[252:253], v17 offset:4096
  ds_read_b64_tr_b16 v[254:255], v17 offset:4608
  v_mfma_f32_16x16x32_bf16 v[48:51], v[232:235], a[152:155], v[48:51]
  v_mov_b32 v164, -1
  v_mov_b32_e64 v2, 0
  v_mfma_f32_16x16x32_bf16 v[56:59], v[224:227], a[140:143], v[56:59]
  buffer_load_dwordx4 a[204:207], v1, s[12:15], s73 offen offset:1024 sc1
  v_mfma_f32_16x16x32_bf16 v[56:59], v[232:235], a[156:159], v[56:59]
  v_and_b32 v167, 7, v0
  v_sub_u32 v165, v164, v24
  v_mfma_f32_16x16x32_bf16 v[36:39], v[228:231], a[128:131], v[36:39]
  v_cmp_eq_u32 s[32:33], 0, v167
  s_nop 0
  v_mfma_f32_16x16x32_bf16 v[36:39], v[236:239], a[144:147], v[36:39]
  v_min_u32_dpp v165, v165, v165 row_ror:8 row_mask:0xf bank_mask:0xf
  s_nop 0
  v_mfma_f32_16x16x32_bf16 v[44:47], v[228:231], a[132:135], v[44:47]
  v_min_u32_dpp v165, v165, v165 row_ror:4 row_mask:0xf bank_mask:0xf
  s_nop 0
  v_mfma_f32_16x16x32_bf16 v[44:47], v[236:239], a[148:151], v[44:47]
  buffer_load_dwordx4 a[208:211], v1, s[12:15], s72 offen offset:2048 sc1
  v_mfma_f32_16x16x32_bf16 v[52:55], v[228:231], a[136:139], v[52:55]
  v_min_u32_dpp v165, v165, v165 row_ror:2 row_mask:0xf bank_mask:0xf
  s_nop 0
  v_mfma_f32_16x16x32_bf16 v[52:55], v[236:239], a[152:155], v[52:55]
  v_min_u32_dpp v165, v165, v165 row_ror:1 row_mask:0xf bank_mask:0xf
  v_mov_b32_e64 v166, v165
  v_mfma_f32_16x16x32_bf16 v[60:63], v[228:231], a[140:143], v[60:63]
  s_nop 0
  v_permlane16_swap_b32 v165, v166
  v_mfma_f32_16x16x32_bf16 v[60:63], v[236:239], a[156:159], v[60:63]
  buffer_load_dwordx4 a[216:219], v1, s[12:15], s73 offen offset:2048 sc1
  s_waitcnt lgkmcnt(0)
  v_mfma_f32_16x16x32_bf16 v[64:67], v[240:243], a[128:131], v[64:67]
  ds_read_b64_tr_b16 v[224:225], v14 offset:16384
  ds_read_b64_tr_b16 v[226:227], v14 offset:16896
  v_mfma_f32_16x16x32_bf16 v[64:67], v[248:251], a[144:147], v[64:67]
  ds_read_b64_tr_b16 v[228:229], v15 offset:16384
  ds_read_b64_tr_b16 v[230:231], v15 offset:16896
  v_mfma_f32_16x16x32_bf16 v[72:75], v[240:243], a[132:135], v[72:75]
  ds_read_b64_tr_b16 v[232:233], v14 offset:20480
  ds_read_b64_tr_b16 v[234:235], v14 offset:20992
  v_mfma_f32_16x16x32_bf16 v[72:75], v[248:251], a[148:151], v[72:75]
  v_min_u32 v165, v165, v166
  v_sub_u32_e64 v164, v164, v165
  v_mfma_f32_16x16x32_bf16 v[80:83], v[240:243], a[136:139], v[80:83]
  ds_read_b64_tr_b16 v[236:237], v15 offset:20480
  ds_read_b64_tr_b16 v[238:239], v15 offset:20992
  v_mfma_f32_16x16x32_bf16 v[80:83], v[248:251], a[152:155], v[80:83]
  buffer_load_dwordx4 a[212:215], v1, s[12:15], s72 offen offset:3072 sc1
  v_mfma_f32_16x16x32_bf16 v[88:91], v[240:243], a[140:143], v[88:91]
  v_cndmask_b32 v2, v2, v164, s[32:33]
  v_add_u32_e64 v164, -1, v164
  v_mfma_f32_16x16x32_bf16 v[88:91], v[248:251], a[156:159], v[88:91]
  v_sub_u32_e64 v165, v164, v24
  v_cmp_eq_u32 s[32:33], 1, v167
  v_mfma_f32_16x16x32_bf16 v[68:71], v[244:247], a[128:131], v[68:71]
  buffer_load_dwordx4 a[220:223], v1, s[12:15], s73 offen offset:3072 sc1
  v_mfma_f32_16x16x32_bf16 v[68:71], v[252:255], a[144:147], v[68:71]
  s_add_u32 s42, s61, 3
  s_and_b32 s42, s42, 3
  v_mfma_f32_16x16x32_bf16 v[76:79], v[244:247], a[132:135], v[76:79]
  s_lshl_b32 s42, s42, 13
  s_add_u32 s42, s42, 4096
  v_mfma_f32_16x16x32_bf16 v[76:79], v[252:255], a[148:151], v[76:79]
  s_add_u32 s72, s42, s46
  s_add_u32 s73, s42, s47
  v_mfma_f32_16x16x32_bf16 v[84:87], v[244:247], a[136:139], v[84:87]
  v_min_u32_dpp v165, v165, v165 row_ror:8 row_mask:0xf bank_mask:0xf
  s_nop 0
  v_mfma_f32_16x16x32_bf16 v[84:87], v[252:255], a[152:155], v[84:87]
  buffer_load_dwordx4 a[224:227], v1, s[12:15], s72 offen offset:0 sc1
  v_mfma_f32_16x16x32_bf16 v[92:95], v[244:247], a[140:143], v[92:95]
  v_min_u32_dpp v165, v165, v165 row_ror:4 row_mask:0xf bank_mask:0xf
  s_nop 0
  v_mfma_f32_16x16x32_bf16 v[92:95], v[252:255], a[156:159], v[92:95]
  v_min_u32_dpp v165, v165, v165 row_ror:2 row_mask:0xf bank_mask:0xf
  s_nop 0
  s_waitcnt lgkmcnt(0)
  v_mfma_f32_16x16x32_bf16 v[96:99], v[224:227], a[128:131], v[96:99]
  v_and_b32 v19, 15, v0
  v_lshlrev_b32_e64 v19, 2, v19
  s_lshr_b32 s35, s59, 1
  s_lshl_b32 s35, s35, 6
  s_add_u32 s35, s35, 0x430000
  buffer_load_dword v18, v19, s[12:15], s35 offen sc1
  v_mfma_f32_16x16x32_bf16 v[96:99], v[232:235], a[144:147], v[96:99]
  ds_read_b64_tr_b16 v[240:241], v16 offset:16384
  ds_read_b64_tr_b16 v[242:243], v16 offset:16896
  v_mfma_f32_16x16x32_bf16 v[104:107], v[224:227], a[132:135], v[104:107]
  ds_read_b64_tr_b16 v[244:245], v17 offset:16384
  ds_read_b64_tr_b16 v[246:247], v17 offset:16896
  v_mfma_f32_16x16x32_bf16 v[104:107], v[232:235], a[148:151], v[104:107]
  buffer_load_dwordx4 a[232:235], v1, s[12:15], s73 offen offset:0 sc1
  v_mfma_f32_16x16x32_bf16 v[112:115], v[224:227], a[136:139], v[112:115]
  ds_read_b64_tr_b16 v[248:249], v16 offset:20480
  ds_read_b64_tr_b16 v[250:251], v16 offset:20992
  v_mfma_f32_16x16x32_bf16 v[112:115], v[232:235], a[152:155], v[112:115]
  v_min_u32_dpp v165, v165, v165 row_ror:1 row_mask:0xf bank_mask:0xf
  v_mov_b32_e64 v166, v165
  v_mfma_f32_16x16x32_bf16 v[120:123], v[224:227], a[140:143], v[120:123]
  ds_read_b64_tr_b16 v[252:253], v17 offset:20480
  ds_read_b64_tr_b16 v[254:255], v17 offset:20992
  v_mfma_f32_16x16x32_bf16 v[120:123], v[232:235], a[156:159], v[120:123]
  buffer_load_dwordx4 a[228:231], v1, s[12:15], s72 offen offset:1024 sc1
  v_mfma_f32_16x16x32_bf16 v[100:103], v[228:231], a[128:131], v[100:103]
  v_permlane16_swap_b32 v165, v166
  v_min_u32 v165, v165, v166
  v_mfma_f32_16x16x32_bf16 v[100:103], v[236:239], a[144:147], v[100:103]
  v_sub_u32_e64 v164, v164, v165
  v_cndmask_b32 v2, v2, v164, s[32:33]
  v_mfma_f32_16x16x32_bf16 v[108:111], v[228:231], a[132:135], v[108:111]
  v_add_u32 v164, -1, v164
  v_sub_u32 v165, v164, v24
  v_mfma_f32_16x16x32_bf16 v[108:111], v[236:239], a[148:151], v[108:111]
  buffer_load_dwordx4 a[236:239], v1, s[12:15], s73 offen offset:1024 sc1
  v_mfma_f32_16x16x32_bf16 v[116:119], v[228:231], a[136:139], v[116:119]
  v_cmp_eq_u32 s[32:33], 2, v167
  s_nop 0
  v_mfma_f32_16x16x32_bf16 v[116:119], v[236:239], a[152:155], v[116:119]
  v_min_u32_dpp v165, v165, v165 row_ror:8 row_mask:0xf bank_mask:0xf
  s_nop 0
  v_mfma_f32_16x16x32_bf16 v[124:127], v[228:231], a[140:143], v[124:127]
  v_min_u32_dpp v165, v165, v165 row_ror:4 row_mask:0xf bank_mask:0xf
  s_nop 0
  v_mfma_f32_16x16x32_bf16 v[124:127], v[236:239], a[156:159], v[124:127]
  buffer_load_dwordx4 a[240:243], v1, s[12:15], s72 offen offset:2048 sc1
  s_waitcnt lgkmcnt(0)
  v_mfma_f32_16x16x32_bf16 v[128:131], v[240:243], a[128:131], v[128:131]
  ds_read_b64_tr_b16 v[224:225], v14 offset:8192
  ds_read_b64_tr_b16 v[226:227], v14 offset:8704
  v_mfma_f32_16x16x32_bf16 v[128:131], v[248:251], a[144:147], v[128:131]
  ds_read_b64_tr_b16 v[228:229], v15 offset:8192
  ds_read_b64_tr_b16 v[230:231], v15 offset:8704
  v_mfma_f32_16x16x32_bf16 v[136:139], v[240:243], a[132:135], v[136:139]
  ds_read_b64_tr_b16 v[232:233], v14 offset:12288
  ds_read_b64_tr_b16 v[234:235], v14 offset:12800
  v_mfma_f32_16x16x32_bf16 v[136:139], v[248:251], a[148:151], v[136:139]
  v_min_u32_dpp v165, v165, v165 row_ror:2 row_mask:0xf bank_mask:0xf
  s_nop 0
  v_mfma_f32_16x16x32_bf16 v[144:147], v[240:243], a[136:139], v[144:147]
  ds_read_b64_tr_b16 v[236:237], v15 offset:12288
  ds_read_b64_tr_b16 v[238:239], v15 offset:12800
  v_mfma_f32_16x16x32_bf16 v[144:147], v[248:251], a[152:155], v[144:147]
  buffer_load_dwordx4 a[248:251], v1, s[12:15], s73 offen offset:2048 sc1
  v_mfma_f32_16x16x32_bf16 v[152:155], v[240:243], a[140:143], v[152:155]
  v_min_u32_dpp v165, v165, v165 row_ror:1 row_mask:0xf bank_mask:0xf
  v_mov_b32 v166, v165
  v_mfma_f32_16x16x32_bf16 v[152:155], v[248:251], a[156:159], v[152:155]
  s_nop 0
  v_permlane16_swap_b32 v165, v166
  v_mfma_f32_16x16x32_bf16 v[132:135], v[244:247], a[128:131], v[132:135]
  v_min_u32 v165, v165, v166
  v_sub_u32 v164, v164, v165
  v_mfma_f32_16x16x32_bf16 v[132:135], v[252:255], a[144:147], v[132:135]
  buffer_load_dwordx4 a[244:247], v1, s[12:15], s72 offen offset:3072 sc1
  v_mfma_f32_16x16x32_bf16 v[140:143], v[244:247], a[132:135], v[140:143]
  v_cndmask_b32 v2, v2, v164, s[32:33]
  v_add_u32_e64 v164, -1, v164
  v_mfma_f32_16x16x32_bf16 v[140:143], v[252:255], a[148:151], v[140:143]
  v_sub_u32_e64 v165, v164, v24
  v_cmp_eq_u32 s[32:33], 3, v167
  v_mfma_f32_16x16x32_bf16 v[148:151], v[244:247], a[136:139], v[148:151]
  s_nop 0
  v_min_u32_dpp v165, v165, v165 row_ror:8 row_mask:0xf bank_mask:0xf
  v_mfma_f32_16x16x32_bf16 v[148:151], v[252:255], a[152:155], v[148:151]
  buffer_load_dwordx4 a[252:255], v1, s[12:15], s73 offen offset:3072 sc1
  v_mfma_f32_16x16x32_bf16 v[156:159], v[244:247], a[140:143], v[156:159]
  v_min_u32_dpp v165, v165, v165 row_ror:4 row_mask:0xf bank_mask:0xf
  s_nop 0
  v_mfma_f32_16x16x32_bf16 v[156:159], v[252:255], a[156:159], v[156:159]
  v_min_u32_dpp v165, v165, v165 row_ror:2 row_mask:0xf bank_mask:0xf
  s_nop 0
  s_waitcnt vmcnt(25) lgkmcnt(0)
  v_mfma_f32_16x16x32_bf16 v[32:35], v[224:227], a[160:163], v[32:35]
  ds_read_b64_tr_b16 v[240:241], v16 offset:8192
  ds_read_b64_tr_b16 v[242:243], v16 offset:8704
  v_mfma_f32_16x16x32_bf16 v[32:35], v[232:235], a[176:179], v[32:35]
  ds_read_b64_tr_b16 v[244:245], v17 offset:8192
  ds_read_b64_tr_b16 v[246:247], v17 offset:8704
  v_mfma_f32_16x16x32_bf16 v[40:43], v[224:227], a[164:167], v[40:43]
  ds_read_b64_tr_b16 v[248:249], v16 offset:12288
  ds_read_b64_tr_b16 v[250:251], v16 offset:12800
  v_mfma_f32_16x16x32_bf16 v[40:43], v[232:235], a[180:183], v[40:43]
  v_min_u32_dpp v165, v165, v165 row_ror:1 row_mask:0xf bank_mask:0xf
  v_mov_b32_e64 v166, v165
  v_mfma_f32_16x16x32_bf16 v[48:51], v[224:227], a[168:171], v[48:51]
  ds_read_b64_tr_b16 v[252:253], v17 offset:12288
  ds_read_b64_tr_b16 v[254:255], v17 offset:12800
  v_mfma_f32_16x16x32_bf16 v[48:51], v[232:235], a[184:187], v[48:51]
  v_permlane16_swap_b32 v165, v166
  v_min_u32 v165, v165, v166
  v_mfma_f32_16x16x32_bf16 v[56:59], v[224:227], a[172:175], v[56:59]
  v_sub_u32_e64 v164, v164, v165
  v_cndmask_b32 v2, v2, v164, s[32:33]
  v_mfma_f32_16x16x32_bf16 v[56:59], v[232:235], a[188:191], v[56:59]
  v_add_u32 v164, -1, v164
  v_sub_u32 v165, v164, v24
  v_mfma_f32_16x16x32_bf16 v[36:39], v[228:231], a[160:163], v[36:39]
  v_cmp_eq_u32 s[32:33], 4, v167
  s_nop 0
  v_mfma_f32_16x16x32_bf16 v[36:39], v[236:239], a[176:179], v[36:39]
  v_min_u32_dpp v165, v165, v165 row_ror:8 row_mask:0xf bank_mask:0xf
  s_nop 0
  v_mfma_f32_16x16x32_bf16 v[44:47], v[228:231], a[164:167], v[44:47]
  v_min_u32_dpp v165, v165, v165 row_ror:4 row_mask:0xf bank_mask:0xf
  s_nop 0
  v_mfma_f32_16x16x32_bf16 v[44:47], v[236:239], a[180:183], v[44:47]
  v_min_u32_dpp v165, v165, v165 row_ror:2 row_mask:0xf bank_mask:0xf
  s_nop 0
  v_mfma_f32_16x16x32_bf16 v[52:55], v[228:231], a[168:171], v[52:55]
  v_min_u32_dpp v165, v165, v165 row_ror:1 row_mask:0xf bank_mask:0xf
  v_mov_b32_e64 v166, v165
  v_mfma_f32_16x16x32_bf16 v[52:55], v[236:239], a[184:187], v[52:55]
  s_nop 0
  v_permlane16_swap_b32 v165, v166
  v_mfma_f32_16x16x32_bf16 v[60:63], v[228:231], a[172:175], v[60:63]
  v_min_u32 v165, v165, v166
  v_sub_u32 v164, v164, v165
  v_mfma_f32_16x16x32_bf16 v[60:63], v[236:239], a[188:191], v[60:63]
  v_cndmask_b32 v2, v2, v164, s[32:33]
  v_add_u32 v164, -1, v164
  s_waitcnt lgkmcnt(0)
  v_mfma_f32_16x16x32_bf16 v[64:67], v[240:243], a[160:163], v[64:67]
  ds_read_b64_tr_b16 v[224:225], v14 offset:24576
  ds_read_b64_tr_b16 v[226:227], v14 offset:25088
  v_mfma_f32_16x16x32_bf16 v[64:67], v[248:251], a[176:179], v[64:67]
  ds_read_b64_tr_b16 v[228:229], v15 offset:24576
  ds_read_b64_tr_b16 v[230:231], v15 offset:25088
  v_mfma_f32_16x16x32_bf16 v[72:75], v[240:243], a[164:167], v[72:75]
  ds_read_b64_tr_b16 v[232:233], v14 offset:28672
  ds_read_b64_tr_b16 v[234:235], v14 offset:29184
  v_mfma_f32_16x16x32_bf16 v[72:75], v[248:251], a[180:183], v[72:75]
  v_sub_u32_e64 v165, v164, v24
  v_cmp_eq_u32 s[32:33], 5, v167
  v_mfma_f32_16x16x32_bf16 v[80:83], v[240:243], a[168:171], v[80:83]
  ds_read_b64_tr_b16 v[236:237], v15 offset:28672
  ds_read_b64_tr_b16 v[238:239], v15 offset:29184
  v_mfma_f32_16x16x32_bf16 v[80:83], v[248:251], a[184:187], v[80:83]
  v_min_u32_dpp v165, v165, v165 row_ror:8 row_mask:0xf bank_mask:0xf
  s_nop 0
  v_mfma_f32_16x16x32_bf16 v[88:91], v[240:243], a[172:175], v[88:91]
  v_min_u32_dpp v165, v165, v165 row_ror:4 row_mask:0xf bank_mask:0xf
  s_nop 0
  v_mfma_f32_16x16x32_bf16 v[88:91], v[248:251], a[188:191], v[88:91]
  v_min_u32_dpp v165, v165, v165 row_ror:2 row_mask:0xf bank_mask:0xf
  s_nop 0
  v_mfma_f32_16x16x32_bf16 v[68:71], v[244:247], a[160:163], v[68:71]
  v_min_u32_dpp v165, v165, v165 row_ror:1 row_mask:0xf bank_mask:0xf
  v_mov_b32 v166, v165
  v_mfma_f32_16x16x32_bf16 v[68:71], v[252:255], a[176:179], v[68:71]
  s_nop 0
  v_permlane16_swap_b32 v165, v166
  v_mfma_f32_16x16x32_bf16 v[76:79], v[244:247], a[164:167], v[76:79]
  v_min_u32 v165, v165, v166
  v_sub_u32 v164, v164, v165
  v_mfma_f32_16x16x32_bf16 v[76:79], v[252:255], a[180:183], v[76:79]
  v_cndmask_b32 v2, v2, v164, s[32:33]
  v_add_u32_e64 v164, -1, v164
  v_mfma_f32_16x16x32_bf16 v[84:87], v[244:247], a[168:171], v[84:87]
  v_sub_u32_e64 v165, v164, v24
  v_cmp_eq_u32 s[32:33], 6, v167
  v_mfma_f32_16x16x32_bf16 v[84:87], v[252:255], a[184:187], v[84:87]
  s_nop 0
  v_min_u32_dpp v165, v165, v165 row_ror:8 row_mask:0xf bank_mask:0xf
  v_mfma_f32_16x16x32_bf16 v[92:95], v[244:247], a[172:175], v[92:95]
  s_nop 0
  v_min_u32_dpp v165, v165, v165 row_ror:4 row_mask:0xf bank_mask:0xf
  v_mfma_f32_16x16x32_bf16 v[92:95], v[252:255], a[188:191], v[92:95]
  s_nop 0
  v_min_u32_dpp v165, v165, v165 row_ror:2 row_mask:0xf bank_mask:0xf
  s_waitcnt lgkmcnt(0)
  v_mfma_f32_16x16x32_bf16 v[96:99], v[224:227], a[160:163], v[96:99]
  s_waitcnt vmcnt(7)
  v_cmp_gt_u32_e64 vcc, 1, v18
  s_cbranch_vccnz Lspinkv
Lokkv:
  v_mfma_f32_16x16x32_bf16 v[96:99], v[232:235], a[176:179], v[96:99]
  ds_read_b64_tr_b16 v[240:241], v16 offset:24576
  ds_read_b64_tr_b16 v[242:243], v16 offset:25088
  v_mfma_f32_16x16x32_bf16 v[104:107], v[224:227], a[164:167], v[104:107]
  ds_read_b64_tr_b16 v[244:245], v17 offset:24576
  ds_read_b64_tr_b16 v[246:247], v17 offset:25088
  v_mfma_f32_16x16x32_bf16 v[104:107], v[232:235], a[180:183], v[104:107]
  s_and_b32 m0, s48, 0x1ffff
  v_min_u32_dpp v165, v165, v165 row_ror:1 row_mask:0xf bank_mask:0xf
  v_mfma_f32_16x16x32_bf16 v[112:115], v[224:227], a[168:171], v[112:115]
  ds_read_b64_tr_b16 v[248:249], v16 offset:28672
  ds_read_b64_tr_b16 v[250:251], v16 offset:29184
  v_mfma_f32_16x16x32_bf16 v[112:115], v[232:235], a[184:187], v[112:115]
  buffer_load_dwordx4 v1, s[16:19], s48 offen offset:0 sc1 lds
  v_mfma_f32_16x16x32_bf16 v[120:123], v[224:227], a[172:175], v[120:123]
  ds_read_b64_tr_b16 v[252:253], v17 offset:28672
  ds_read_b64_tr_b16 v[254:255], v17 offset:29184
  v_mfma_f32_16x16x32_bf16 v[120:123], v[232:235], a[188:191], v[120:123]
  v_mov_b32 v166, v165
  s_nop 0
  v_mfma_f32_16x16x32_bf16 v[100:103], v[228:231], a[160:163], v[100:103]
  buffer_load_dwordx4 v1, s[16:19], s48 offen offset:1024 sc1 lds
  v_mfma_f32_16x16x32_bf16 v[100:103], v[236:239], a[176:179], v[100:103]
  v_permlane16_swap_b32 v165, v166
  v_min_u32 v165, v165, v166
  v_mfma_f32_16x16x32_bf16 v[108:111], v[228:231], a[164:167], v[108:111]
  v_sub_u32_e64 v164, v164, v165
  v_cndmask_b32 v2, v2, v164, s[32:33]
  v_mfma_f32_16x16x32_bf16 v[108:111], v[236:239], a[180:183], v[108:111]
  v_add_u32 v164, -1, v164
  v_sub_u32 v165, v164, v24
  v_mfma_f32_16x16x32_bf16 v[116:119], v[228:231], a[168:171], v[116:119]
  v_cmp_eq_u32 s[32:33], 7, v167
  s_nop 0
  v_mfma_f32_16x16x32_bf16 v[116:119], v[236:239], a[184:187], v[116:119]
  buffer_load_dwordx4 v1, s[16:19], s48 offen offset:2048 sc1 lds
  v_mfma_f32_16x16x32_bf16 v[124:127], v[228:231], a[172:175], v[124:127]
  v_min_u32_dpp v165, v165, v165 row_ror:8 row_mask:0xf bank_mask:0xf
  s_nop 0
  v_mfma_f32_16x16x32_bf16 v[124:127], v[236:239], a[188:191], v[124:127]
  v_min_u32_dpp v165, v165, v165 row_ror:4 row_mask:0xf bank_mask:0xf
  s_nop 0
  s_waitcnt lgkmcnt(0)
  v_mfma_f32_16x16x32_bf16 v[128:131], v[240:243], a[160:163], v[128:131]
  s_waitcnt vmcnt(20)
  s_barrier
  v_mfma_f32_16x16x32_bf16 v[128:131], v[248:251], a[176:179], v[128:131]
  ds_read_b64_tr_b16 v[224:225], v14 offset:32768
  ds_read_b64_tr_b16 v[226:227], v14 offset:33280
  v_mfma_f32_16x16x32_bf16 v[136:139], v[240:243], a[164:167], v[136:139]
  ds_read_b64_tr_b16 v[228:229], v15 offset:32768
  ds_read_b64_tr_b16 v[230:231], v15 offset:33280
  v_mfma_f32_16x16x32_bf16 v[136:139], v[248:251], a[180:183], v[136:139]
  buffer_load_dwordx4 v1, s[16:19], s48 offen offset:3072 sc1 lds
  v_mfma_f32_16x16x32_bf16 v[144:147], v[240:243], a[168:171], v[144:147]
  ds_read_b64_tr_b16 v[232:233], v14 offset:36864
  ds_read_b64_tr_b16 v[234:235], v14 offset:37376
  v_mfma_f32_16x16x32_bf16 v[144:147], v[248:251], a[184:187], v[144:147]
  s_add_u32 s48, s48, 32768
  s_and_b32 m0, s48, 0x1ffff
  v_mfma_f32_16x16x32_bf16 v[152:155], v[240:243], a[172:175], v[152:155]
  ds_read_b64_tr_b16 v[236:237], v15 offset:36864
  ds_read_b64_tr_b16 v[238:239], v15 offset:37376
  v_mfma_f32_16x16x32_bf16 v[152:155], v[248:251], a[188:191], v[152:155]
  buffer_load_dwordx4 v1, s[16:19], s48 offen offset:0 sc1 lds
  v_mfma_f32_16x16x32_bf16 v[132:135], v[244:247], a[160:163], v[132:135]
  v_min_u32_dpp v165, v165, v165 row_ror:2 row_mask:0xf bank_mask:0xf
  s_nop 0
  v_mfma_f32_16x16x32_bf16 v[132:135], v[252:255], a[176:179], v[132:135]
  v_min_u32_dpp v165, v165, v165 row_ror:1 row_mask:0xf bank_mask:0xf
  v_mov_b32 v166, v165
  v_mfma_f32_16x16x32_bf16 v[140:143], v[244:247], a[164:167], v[140:143]
  s_nop 0
  v_permlane16_swap_b32 v165, v166
  v_mfma_f32_16x16x32_bf16 v[140:143], v[252:255], a[180:183], v[140:143]
  buffer_load_dwordx4 v1, s[16:19], s48 offen offset:1024 sc1 lds
  v_mfma_f32_16x16x32_bf16 v[148:151], v[244:247], a[168:171], v[148:151]
  v_min_u32 v165, v165, v166
  v_sub_u32 v164, v164, v165
  v_mfma_f32_16x16x32_bf16 v[148:151], v[252:255], a[184:187], v[148:151]
  v_cndmask_b32 v2, v2, v164, s[32:33]
  v_add_u32_e64 v164, -1, v164
  v_mfma_f32_16x16x32_bf16 v[156:159], v[244:247], a[172:175], v[156:159]
  v_mfma_f32_16x16x32_bf16 v[156:159], v[252:255], a[188:191], v[156:159]
  buffer_load_dwordx4 v1, s[16:19], s48 offen offset:2048 sc1 lds
  s_waitcnt vmcnt(16) lgkmcnt(0)
  v_mfma_f32_16x16x32_bf16 v[32:35], v[224:227], a[192:195], v[32:35]
  ds_read_b64_tr_b16 v[240:241], v16 offset:32768
  ds_read_b64_tr_b16 v[242:243], v16 offset:33280
  v_mfma_f32_16x16x32_bf16 v[32:35], v[232:235], a[208:211], v[32:35]
  ds_read_b64_tr_b16 v[244:245], v17 offset:32768
  ds_read_b64_tr_b16 v[246:247], v17 offset:33280
  v_mfma_f32_16x16x32_bf16 v[40:43], v[224:227], a[196:199], v[40:43]
  ds_read_b64_tr_b16 v[248:249], v16 offset:36864
  ds_read_b64_tr_b16 v[250:251], v16 offset:37376
  v_mfma_f32_16x16x32_bf16 v[40:43], v[232:235], a[212:215], v[40:43]
  v_add_u32 v10, 0x10000, v1
  v_add_u32 v11, 49152, v1
  v_mfma_f32_16x16x32_bf16 v[48:51], v[224:227], a[200:203], v[48:51]
  ds_read_b64_tr_b16 v[252:253], v17 offset:36864
  ds_read_b64_tr_b16 v[254:255], v17 offset:37376
  v_mfma_f32_16x16x32_bf16 v[48:51], v[232:235], a[216:219], v[48:51]
  buffer_load_dwordx4 v1, s[16:19], s48 offen offset:3072 sc1 lds
  v_mfma_f32_16x16x32_bf16 v[56:59], v[224:227], a[204:207], v[56:59]
  s_add_u32 s48, s48, 32768
  s_and_b32 m0, s49, 0x1ffff
  v_mfma_f32_16x16x32_bf16 v[56:59], v[232:235], a[220:223], v[56:59]
  v_mov_b32 v12, 0xff800000
  s_lshl_b32 s43, s40, 13
  v_mfma_f32_16x16x32_bf16 v[36:39], v[228:231], a[192:195], v[36:39]
  buffer_load_dwordx4 v1, s[16:19], s49 offen offset:0 sc1 lds
  v_mfma_f32_16x16x32_bf16 v[36:39], v[236:239], a[208:211], v[36:39]
  s_add_u32 s43, s43, 131072
  v_add_u32_e64 v13, s43, v1
  v_mfma_f32_16x16x32_bf16 v[44:47], v[228:231], a[196:199], v[44:47]
  s_mov_b32 s34, 0
  s_mov_b32 s32, 0xffff
  v_mfma_f32_16x16x32_bf16 v[44:47], v[236:239], a[212:215], v[44:47]
  s_lshl_b32 s29, s2, 2
  s_add_u32 s29, s29, 0x430800
  v_mfma_f32_16x16x32_bf16 v[52:55], v[228:231], a[200:203], v[52:55]
  s_mul_i32 s28, s40, 4096
  s_add_u32 s28, s28, 16
  v_mfma_f32_16x16x32_bf16 v[52:55], v[236:239], a[216:219], v[52:55]
  buffer_load_dwordx4 v1, s[16:19], s49 offen offset:1024 sc1 lds
  v_mfma_f32_16x16x32_bf16 v[60:63], v[228:231], a[204:207], v[60:63]
  s_mov_b32 s61, 8
  s_mov_b32 s53, 8
  v_mfma_f32_16x16x32_bf16 v[60:63], v[236:239], a[220:223], v[60:63]
  v_mov_b32 v18, 0
  v_mov_b32 v19, 0
  s_waitcnt lgkmcnt(0)
  v_mfma_f32_16x16x32_bf16 v[64:67], v[240:243], a[192:195], v[64:67]
  ds_read_b64_tr_b16 v[224:225], v14 offset:49152
  ds_read_b64_tr_b16 v[226:227], v14 offset:49664
  v_mfma_f32_16x16x32_bf16 v[64:67], v[248:251], a[208:211], v[64:67]
  ds_read_b64_tr_b16 v[228:229], v15 offset:49152
  ds_read_b64_tr_b16 v[230:231], v15 offset:49664
  v_mfma_f32_16x16x32_bf16 v[72:75], v[240:243], a[196:199], v[72:75]
  ds_read_b64_tr_b16 v[232:233], v14 offset:53248
  ds_read_b64_tr_b16 v[234:235], v14 offset:53760
  v_mfma_f32_16x16x32_bf16 v[72:75], v[248:251], a[212:215], v[72:75]
  buffer_load_dwordx4 v1, s[16:19], s49 offen offset:2048 sc1 lds
  v_mfma_f32_16x16x32_bf16 v[80:83], v[240:243], a[200:203], v[80:83]
  ds_read_b64_tr_b16 v[236:237], v15 offset:53248
  ds_read_b64_tr_b16 v[238:239], v15 offset:53760
  v_mfma_f32_16x16x32_bf16 v[80:83], v[248:251], a[216:219], v[80:83]
  v_mov_b32 v20, 0
  v_mov_b32 v21, 0
  v_mfma_f32_16x16x32_bf16 v[88:91], v[240:243], a[204:207], v[88:91]
  buffer_load_dwordx4 v1, s[16:19], s49 offen offset:3072 sc1 lds
  v_mfma_f32_16x16x32_bf16 v[88:91], v[248:251], a[220:223], v[88:91]
  s_add_u32 s49, s49, 32768
  s_and_b32 m0, s48, 0x1ffff
  v_mfma_f32_16x16x32_bf16 v[68:71], v[244:247], a[192:195], v[68:71]
  v_mov_b32 v22, 0
  v_mov_b32 v23, 0
  v_mfma_f32_16x16x32_bf16 v[68:71], v[252:255], a[208:211], v[68:71]
  v_mov_b32 v30, 0
  v_mov_b32 v31, 0
  v_mfma_f32_16x16x32_bf16 v[76:79], v[244:247], a[196:199], v[76:79]
  v_and_b32 v24, 15, v0
  v_lshrrev_b32 v25, 4, v0
  v_mfma_f32_16x16x32_bf16 v[76:79], v[252:255], a[212:215], v[76:79]
  buffer_load_dwordx4 v1, s[16:19], s48 offen offset:0 sc1 lds
  v_mfma_f32_16x16x32_bf16 v[84:87], v[244:247], a[200:203], v[84:87]
  v_lshlrev_b32 v25, 2, v25
  v_sub_u32 v24, v24, v25
  v_mfma_f32_16x16x32_bf16 v[84:87], v[252:255], a[216:219], v[84:87]
  v_cmp_gt_i32 s[64:65], 0, v24
  v_cmp_gt_i32 s[66:67], 1, v24
  v_mfma_f32_16x16x32_bf16 v[92:95], v[244:247], a[204:207], v[92:95]
  v_cmp_gt_i32 s[68:69], 2, v24
  v_cmp_gt_i32 s[70:71], 3, v24
  v_mfma_f32_16x16x32_bf16 v[92:95], v[252:255], a[220:223], v[92:95]
  buffer_load_dwordx4 v1, s[16:19], s48 offen offset:1024 sc1 lds
  s_waitcnt lgkmcnt(0)
  v_mfma_f32_16x16x32_bf16 v[96:99], v[224:227], a[192:195], v[96:99]
  ds_read_b64_tr_b16 v[240:241], v16 offset:49152
  ds_read_b64_tr_b16 v[242:243], v16 offset:49664
  v_mfma_f32_16x16x32_bf16 v[96:99], v[232:235], a[208:211], v[96:99]
  ds_read_b64_tr_b16 v[244:245], v17 offset:49152
  ds_read_b64_tr_b16 v[246:247], v17 offset:49664
  v_mfma_f32_16x16x32_bf16 v[104:107], v[224:227], a[196:199], v[104:107]
  ds_read_b64_tr_b16 v[248:249], v16 offset:53248
  ds_read_b64_tr_b16 v[250:251], v16 offset:53760
  v_mfma_f32_16x16x32_bf16 v[104:107], v[232:235], a[212:215], v[104:107]
  v_cmp_gt_i32 s[72:73], 16, v24
  v_cmp_gt_i32 s[74:75], 17, v24
  v_mfma_f32_16x16x32_bf16 v[112:115], v[224:227], a[200:203], v[112:115]
  ds_read_b64_tr_b16 v[252:253], v17 offset:53248
  ds_read_b64_tr_b16 v[254:255], v17 offset:53760
  v_mfma_f32_16x16x32_bf16 v[112:115], v[232:235], a[216:219], v[112:115]
  buffer_load_dwordx4 v1, s[16:19], s48 offen offset:2048 sc1 lds
  v_mfma_f32_16x16x32_bf16 v[120:123], v[224:227], a[204:207], v[120:123]
  v_cmp_gt_i32 s[76:77], 18, v24
  v_cmp_gt_i32 s[78:79], 19, v24
  v_mfma_f32_16x16x32_bf16 v[120:123], v[232:235], a[220:223], v[120:123]
  v_cmp_gt_i32 s[80:81], -16, v24
  v_cmp_gt_i32 s[82:83], -15, v24
  v_mfma_f32_16x16x32_bf16 v[100:103], v[228:231], a[192:195], v[100:103]
  v_cmp_gt_i32 s[84:85], -14, v24
  v_cmp_gt_i32 s[86:87], -13, v24
  v_mfma_f32_16x16x32_bf16 v[100:103], v[236:239], a[208:211], v[100:103]
  buffer_load_dwordx4 v1, s[16:19], s48 offen offset:3072 sc1 lds
  v_mfma_f32_16x16x32_bf16 v[108:111], v[228:231], a[196:199], v[108:111]
  s_add_u32 s48, s48, 32768
  s_and_b32 m0, s49, 0x1ffff
  v_mfma_f32_16x16x32_bf16 v[108:111], v[236:239], a[212:215], v[108:111]
  v_cmp_gt_i32 s[88:89], 0, v24
  v_cmp_gt_i32 s[90:91], 1, v24
  v_mfma_f32_16x16x32_bf16 v[116:119], v[228:231], a[200:203], v[116:119]
  v_cmp_gt_i32 s[92:93], 2, v24
  v_cmp_gt_i32 s[94:95], 3, v24
  v_mfma_f32_16x16x32_bf16 v[116:119], v[236:239], a[216:219], v[116:119]
  buffer_load_dwordx4 v1, s[16:19], s49 offen offset:0 sc1 lds
  v_mfma_f32_16x16x32_bf16 v[124:127], v[228:231], a[204:207], v[124:127]
  v_accvgpr_write_b32 a128, 0
  v_accvgpr_write_b32 a129, 0
  v_mfma_f32_16x16x32_bf16 v[124:127], v[236:239], a[220:223], v[124:127]
  v_accvgpr_write_b32 a130, 0
  v_accvgpr_write_b32 a131, 0
  s_waitcnt lgkmcnt(0)
  v_mfma_f32_16x16x32_bf16 v[128:131], v[240:243], a[192:195], v[128:131]
  ds_read_b64_tr_b16 v[224:225], v14 offset:40960
  ds_read_b64_tr_b16 v[226:227], v14 offset:41472
  v_mfma_f32_16x16x32_bf16 v[128:131], v[248:251], a[208:211], v[128:131]
  ds_read_b64_tr_b16 v[228:229], v15 offset:40960
  ds_read_b64_tr_b16 v[230:231], v15 offset:41472
  v_mfma_f32_16x16x32_bf16 v[136:139], v[240:243], a[196:199], v[136:139]
  ds_read_b64_tr_b16 v[232:233], v14 offset:45056
  ds_read_b64_tr_b16 v[234:235], v14 offset:45568
  v_mfma_f32_16x16x32_bf16 v[136:139], v[248:251], a[212:215], v[136:139]
  buffer_load_dwordx4 v1, s[16:19], s49 offen offset:1024 sc1 lds
  v_mfma_f32_16x16x32_bf16 v[144:147], v[240:243], a[200:203], v[144:147]
  ds_read_b64_tr_b16 v[236:237], v15 offset:45056
  ds_read_b64_tr_b16 v[238:239], v15 offset:45568
  v_mfma_f32_16x16x32_bf16 v[144:147], v[248:251], a[216:219], v[144:147]
  v_accvgpr_write_b32 a132, 0
  v_accvgpr_write_b32 a133, 0
  v_mfma_f32_16x16x32_bf16 v[152:155], v[240:243], a[204:207], v[152:155]
  buffer_load_dwordx4 v1, s[16:19], s49 offen offset:2048 sc1 lds
  v_mfma_f32_16x16x32_bf16 v[152:155], v[248:251], a[220:223], v[152:155]
  v_accvgpr_write_b32 a134, 0
  v_accvgpr_write_b32 a135, 0
  v_mfma_f32_16x16x32_bf16 v[132:135], v[244:247], a[192:195], v[132:135]
  v_accvgpr_write_b32 a136, 0
  v_accvgpr_write_b32 a137, 0
  v_mfma_f32_16x16x32_bf16 v[132:135], v[252:255], a[208:211], v[132:135]
  v_accvgpr_write_b32 a138, 0
  v_accvgpr_write_b32 a139, 0
  v_mfma_f32_16x16x32_bf16 v[140:143], v[244:247], a[196:199], v[140:143]
  v_accvgpr_write_b32 a140, 0
  v_accvgpr_write_b32 a141, 0
  v_mfma_f32_16x16x32_bf16 v[140:143], v[252:255], a[212:215], v[140:143]
  buffer_load_dwordx4 v1, s[16:19], s49 offen offset:3072 sc1 lds
  v_mfma_f32_16x16x32_bf16 v[148:151], v[244:247], a[200:203], v[148:151]
  s_add_u32 s49, s49, 32768
  v_accvgpr_write_b32 a142, 0
  v_mfma_f32_16x16x32_bf16 v[148:151], v[252:255], a[216:219], v[148:151]
  v_accvgpr_write_b32 a143, 0
  v_accvgpr_write_b32 a144, 0
  v_mfma_f32_16x16x32_bf16 v[156:159], v[244:247], a[204:207], v[156:159]
  v_accvgpr_write_b32 a145, 0
  v_accvgpr_write_b32 a146, 0
  v_mfma_f32_16x16x32_bf16 v[156:159], v[252:255], a[220:223], v[156:159]
  v_accvgpr_write_b32 a147, 0
  v_accvgpr_write_b32 a148, 0
  s_waitcnt vmcnt(20) lgkmcnt(0)
  v_mfma_f32_16x16x32_bf16 v[32:35], v[224:227], a[224:227], v[32:35]
  ds_read_b64_tr_b16 v[240:241], v16 offset:40960
  ds_read_b64_tr_b16 v[242:243], v16 offset:41472
  v_mfma_f32_16x16x32_bf16 v[32:35], v[232:235], a[240:243], v[32:35]
  ds_read_b64_tr_b16 v[244:245], v17 offset:40960
  ds_read_b64_tr_b16 v[246:247], v17 offset:41472
  v_mfma_f32_16x16x32_bf16 v[40:43], v[224:227], a[228:231], v[40:43]
  ds_read_b64_tr_b16 v[248:249], v16 offset:45056
  ds_read_b64_tr_b16 v[250:251], v16 offset:45568
  v_mfma_f32_16x16x32_bf16 v[40:43], v[232:235], a[244:247], v[40:43]
  v_accvgpr_write_b32 a149, 0
  v_accvgpr_write_b32 a150, 0
  v_mfma_f32_16x16x32_bf16 v[48:51], v[224:227], a[232:235], v[48:51]
  ds_read_b64_tr_b16 v[252:253], v17 offset:45056
  ds_read_b64_tr_b16 v[254:255], v17 offset:45568
  v_mfma_f32_16x16x32_bf16 v[48:51], v[232:235], a[248:251], v[48:51]
  v_accvgpr_write_b32 a151, 0
  v_accvgpr_write_b32 a152, 0
  v_mfma_f32_16x16x32_bf16 v[56:59], v[224:227], a[236:239], v[56:59]
  v_accvgpr_write_b32 a153, 0
  v_accvgpr_write_b32 a154, 0
  v_mfma_f32_16x16x32_bf16 v[56:59], v[232:235], a[252:255], v[56:59]
  v_accvgpr_write_b32 a155, 0
  v_accvgpr_write_b32 a156, 0
  v_mfma_f32_16x16x32_bf16 v[36:39], v[228:231], a[224:227], v[36:39]
  v_accvgpr_write_b32 a157, 0
  v_accvgpr_write_b32 a158, 0
  v_mfma_f32_16x16x32_bf16 v[36:39], v[236:239], a[240:243], v[36:39]
  v_accvgpr_write_b32 a159, 0
  v_accvgpr_write_b32 a160, 0
  v_mfma_f32_16x16x32_bf16 v[44:47], v[228:231], a[228:231], v[44:47]
  v_accvgpr_write_b32 a161, 0
  v_accvgpr_write_b32 a162, 0
  v_mfma_f32_16x16x32_bf16 v[44:47], v[236:239], a[244:247], v[44:47]
  v_accvgpr_write_b32 a163, 0
  v_accvgpr_write_b32 a164, 0
  v_mfma_f32_16x16x32_bf16 v[52:55], v[228:231], a[232:235], v[52:55]
  v_accvgpr_write_b32 a165, 0
  v_accvgpr_write_b32 a166, 0
  v_mfma_f32_16x16x32_bf16 v[52:55], v[236:239], a[248:251], v[52:55]
  v_accvgpr_write_b32 a167, 0
  v_accvgpr_write_b32 a168, 0
  v_mfma_f32_16x16x32_bf16 v[60:63], v[228:231], a[236:239], v[60:63]
  v_accvgpr_write_b32 a169, 0
  v_accvgpr_write_b32 a170, 0
  v_mfma_f32_16x16x32_bf16 v[60:63], v[236:239], a[252:255], v[60:63]
  v_accvgpr_write_b32 a171, 0
  v_accvgpr_write_b32 a172, 0
  s_waitcnt lgkmcnt(0)
  v_mfma_f32_16x16x32_bf16 v[64:67], v[240:243], a[224:227], v[64:67]
  ds_read_b64_tr_b16 v[224:225], v14 offset:57344
  ds_read_b64_tr_b16 v[226:227], v14 offset:57856
  v_mfma_f32_16x16x32_bf16 v[64:67], v[248:251], a[240:243], v[64:67]
  ds_read_b64_tr_b16 v[228:229], v15 offset:57344
  ds_read_b64_tr_b16 v[230:231], v15 offset:57856
  v_mfma_f32_16x16x32_bf16 v[72:75], v[240:243], a[228:231], v[72:75]
  ds_read_b64_tr_b16 v[232:233], v14 offset:61440
  ds_read_b64_tr_b16 v[234:235], v14 offset:61952
  v_mfma_f32_16x16x32_bf16 v[72:75], v[248:251], a[244:247], v[72:75]
  v_accvgpr_write_b32 a173, 0
  v_accvgpr_write_b32 a174, 0
  v_mfma_f32_16x16x32_bf16 v[80:83], v[240:243], a[232:235], v[80:83]
  ds_read_b64_tr_b16 v[236:237], v15 offset:61440
  ds_read_b64_tr_b16 v[238:239], v15 offset:61952
  v_mfma_f32_16x16x32_bf16 v[80:83], v[248:251], a[248:251], v[80:83]
  v_accvgpr_write_b32 a175, 0
  v_accvgpr_write_b32 a176, 0
  v_mfma_f32_16x16x32_bf16 v[88:91], v[240:243], a[236:239], v[88:91]
  v_accvgpr_write_b32 a177, 0
  v_accvgpr_write_b32 a178, 0
  v_mfma_f32_16x16x32_bf16 v[88:91], v[248:251], a[252:255], v[88:91]
  v_accvgpr_write_b32 a179, 0
  v_accvgpr_write_b32 a180, 0
  v_mfma_f32_16x16x32_bf16 v[68:71], v[244:247], a[224:227], v[68:71]
  v_accvgpr_write_b32 a181, 0
  v_accvgpr_write_b32 a182, 0
  v_mfma_f32_16x16x32_bf16 v[68:71], v[252:255], a[240:243], v[68:71]
  v_accvgpr_write_b32 a183, 0
  v_accvgpr_write_b32 a184, 0
  v_mfma_f32_16x16x32_bf16 v[76:79], v[244:247], a[228:231], v[76:79]
  v_accvgpr_write_b32 a185, 0
  v_accvgpr_write_b32 a186, 0
  v_mfma_f32_16x16x32_bf16 v[76:79], v[252:255], a[244:247], v[76:79]
  v_accvgpr_write_b32 a187, 0
  v_accvgpr_write_b32 a188, 0
  v_mfma_f32_16x16x32_bf16 v[84:87], v[244:247], a[232:235], v[84:87]
  v_accvgpr_write_b32 a189, 0
  v_accvgpr_write_b32 a190, 0
  v_mfma_f32_16x16x32_bf16 v[84:87], v[252:255], a[248:251], v[84:87]
  v_accvgpr_write_b32 a191, 0
  v_cvt_pk_bf16_f32 v192, v48, v49
  v_mfma_f32_16x16x32_bf16 v[92:95], v[244:247], a[236:239], v[92:95]
  v_cvt_pk_bf16_f32 v193, v50, v51
  v_cvt_pk_bf16_f32 v194, v52, v53
  v_mfma_f32_16x16x32_bf16 v[92:95], v[252:255], a[252:255], v[92:95]
  v_cvt_pk_bf16_f32 v195, v54, v55
  v_cvt_pk_bf16_f32 v208, v56, v57
  s_waitcnt lgkmcnt(0)
  v_mfma_f32_16x16x32_bf16 v[96:99], v[224:227], a[224:227], v[96:99]
  ds_read_b64_tr_b16 v[240:241], v16 offset:57344
  ds_read_b64_tr_b16 v[242:243], v16 offset:57856
  v_mfma_f32_16x16x32_bf16 v[96:99], v[232:235], a[240:243], v[96:99]
  ds_read_b64_tr_b16 v[244:245], v17 offset:57344
  ds_read_b64_tr_b16 v[246:247], v17 offset:57856
  v_mfma_f32_16x16x32_bf16 v[104:107], v[224:227], a[228:231], v[104:107]
  ds_read_b64_tr_b16 v[248:249], v16 offset:61440
  ds_read_b64_tr_b16 v[250:251], v16 offset:61952
  v_mfma_f32_16x16x32_bf16 v[104:107], v[232:235], a[244:247], v[104:107]
  v_cvt_pk_bf16_f32 v209, v58, v59
  v_cvt_pk_bf16_f32 v210, v60, v61
  v_mfma_f32_16x16x32_bf16 v[112:115], v[224:227], a[232:235], v[112:115]
  ds_read_b64_tr_b16 v[252:253], v17 offset:61440
  ds_read_b64_tr_b16 v[254:255], v17 offset:61952
  v_mfma_f32_16x16x32_bf16 v[112:115], v[232:235], a[248:251], v[112:115]
  v_cvt_pk_bf16_f32 v211, v62, v63
  v_cvt_pk_bf16_f32 v160, v32, v33
  v_mfma_f32_16x16x32_bf16 v[120:123], v[224:227], a[236:239], v[120:123]
  v_cvt_pk_bf16_f32 v161, v34, v35
  v_cvt_pk_bf16_f32 v162, v36, v37
  v_mfma_f32_16x16x32_bf16 v[120:123], v[232:235], a[252:255], v[120:123]
  v_cvt_pk_bf16_f32 v163, v38, v39
  v_mfma_f32_16x16x32_bf16 v[100:103], v[228:231], a[224:227], v[100:103]
  ds_write_b128 v13, v[192:195] offset:0
  v_cvt_pk_bf16_f32 v176, v40, v41
  v_mfma_f32_16x16x32_bf16 v[100:103], v[236:239], a[240:243], v[100:103]
  v_cvt_pk_bf16_f32 v177, v42, v43
  v_cvt_pk_bf16_f32 v178, v44, v45
  v_mfma_f32_16x16x32_bf16 v[108:111], v[228:231], a[228:231], v[108:111]
  v_cvt_pk_bf16_f32 v179, v46, v47
  v_mfma_f32_16x16x32_bf16 v[108:111], v[236:239], a[244:247], v[108:111]
  ds_write_b128 v13, v[208:211] offset:4096
  v_cvt_pk_bf16_f32 v196, v80, v81
  v_mfma_f32_16x16x32_bf16 v[116:119], v[228:231], a[232:235], v[116:119]
  v_cvt_pk_bf16_f32 v197, v82, v83
  v_cvt_pk_bf16_f32 v198, v84, v85
  v_mfma_f32_16x16x32_bf16 v[116:119], v[236:239], a[248:251], v[116:119]
  v_cvt_pk_bf16_f32 v199, v86, v87
  v_cvt_pk_bf16_f32 v212, v88, v89
  v_mfma_f32_16x16x32_bf16 v[124:127], v[228:231], a[236:239], v[124:127]
  v_cvt_pk_bf16_f32 v213, v90, v91
  v_cvt_pk_bf16_f32 v214, v92, v93
  v_mfma_f32_16x16x32_bf16 v[124:127], v[236:239], a[252:255], v[124:127]
  v_cvt_pk_bf16_f32 v215, v94, v95
  v_cvt_pk_bf16_f32 v164, v64, v65
  s_waitcnt lgkmcnt(0)
  v_mfma_f32_16x16x32_bf16 v[128:131], v[240:243], a[224:227], v[128:131]
  s_waitcnt vmcnt(16)
  s_barrier
  v_mfma_f32_16x16x32_bf16 v[128:131], v[248:251], a[240:243], v[128:131]
  ds_read_b128 a[192:195], v10 offset:0
  ds_read_b128 a[196:199], v10 offset:1024
  v_mfma_f32_16x16x32_bf16 v[136:139], v[240:243], a[228:231], v[136:139]
  ds_read_b128 a[200:203], v10 offset:2048
  ds_read_b128 a[204:207], v10 offset:3072
  v_mfma_f32_16x16x32_bf16 v[136:139], v[248:251], a[244:247], v[136:139]
  s_and_b32 m0, s48, 0x1ffff
  v_cvt_pk_bf16_f32 v165, v66, v67
  v_mfma_f32_16x16x32_bf16 v[144:147], v[240:243], a[232:235], v[144:147]
  ds_read_b128 a[208:211], v10 offset:4096
  ds_read_b128 a[212:215], v10 offset:5120
  v_mfma_f32_16x16x32_bf16 v[144:147], v[248:251], a[248:251], v[144:147]
  buffer_load_dwordx4 v1, s[16:19], s48 offen offset:0 sc1 lds
  v_mfma_f32_16x16x32_bf16 v[152:155], v[240:243], a[236:239], v[152:155]
  ds_read_b128 a[216:219], v10 offset:6144
  ds_read_b128 a[220:223], v10 offset:7168
  v_mfma_f32_16x16x32_bf16 v[152:155], v[248:251], a[252:255], v[152:155]
  buffer_load_dwordx4 v1, s[16:19], s48 offen offset:1024 sc1 lds
  v_mfma_f32_16x16x32_bf16 v[132:135], v[244:247], a[224:227], v[132:135]
  buffer_load_dwordx4 v1, s[16:19], s48 offen offset:2048 sc1 lds
  v_mfma_f32_16x16x32_bf16 v[132:135], v[252:255], a[240:243], v[132:135]
  buffer_load_dwordx4 v1, s[16:19], s48 offen offset:3072 sc1 lds
  v_mfma_f32_16x16x32_bf16 v[140:143], v[244:247], a[228:231], v[140:143]
  s_add_u32 s48, s48, 32768
  v_cvt_pk_bf16_f32 v166, v68, v69
  v_mfma_f32_16x16x32_bf16 v[140:143], v[252:255], a[244:247], v[140:143]
  v_cvt_pk_bf16_f32 v167, v70, v71
  v_mfma_f32_16x16x32_bf16 v[148:151], v[244:247], a[232:235], v[148:151]
  ds_write_b128 v13, v[196:199] offset:1024
  v_cvt_pk_bf16_f32 v180, v72, v73
  v_mfma_f32_16x16x32_bf16 v[148:151], v[252:255], a[248:251], v[148:151]
  v_cvt_pk_bf16_f32 v181, v74, v75
  v_cvt_pk_bf16_f32 v182, v76, v77
  v_mfma_f32_16x16x32_bf16 v[156:159], v[244:247], a[236:239], v[156:159]
  v_cvt_pk_bf16_f32 v183, v78, v79
  v_mfma_f32_16x16x32_bf16 v[156:159], v[252:255], a[252:255], v[156:159]
  ds_write_b128 v13, v[212:215] offset:5120
  v_cvt_pk_bf16_f32 v200, v112, v113
  s_nop 3
  s_nop 3
  v_mov_b32 v16, 0
  v_mov_b32 v17, 0
  v_mov_b32 v248, 0
  v_mov_b32 v249, 0
  v_mov_b32 v240, 0
  v_mov_b32 v244, 0
  v_mov_b32 v252, 0x3f803f80
  v_mov_b32 v253, 0x3f803f80
  v_mov_b32 v254, 0x3f803f80
  v_mov_b32 v255, 0x3f803f80
  v_cvt_pk_bf16_f32 v201, v114, v115
  v_cvt_pk_bf16_f32 v202, v116, v117
  v_cvt_pk_bf16_f32 v203, v118, v119
  v_cvt_pk_bf16_f32 v216, v120, v121
  v_cvt_pk_bf16_f32 v217, v122, v123
  v_cvt_pk_bf16_f32 v218, v124, v125
  v_cvt_pk_bf16_f32 v219, v126, v127
  v_cvt_pk_bf16_f32 v168, v96, v97
  v_cvt_pk_bf16_f32 v169, v98, v99
  v_cvt_pk_bf16_f32 v170, v100, v101
  v_cvt_pk_bf16_f32 v171, v102, v103
  ds_write_b128 v13, v[200:203] offset:2048
  v_cvt_pk_bf16_f32 v184, v104, v105
  v_cvt_pk_bf16_f32 v185, v106, v107
  v_cvt_pk_bf16_f32 v186, v108, v109
  v_cvt_pk_bf16_f32 v187, v110, v111
  ds_write_b128 v13, v[216:219] offset:6144
  v_cvt_pk_bf16_f32 v204, v144, v145
  v_cvt_pk_bf16_f32 v205, v146, v147
  v_cvt_pk_bf16_f32 v206, v148, v149
  v_cvt_pk_bf16_f32 v207, v150, v151
  v_cvt_pk_bf16_f32 v220, v152, v153
  v_cvt_pk_bf16_f32 v221, v154, v155
  v_cvt_pk_bf16_f32 v222, v156, v157
  v_cvt_pk_bf16_f32 v223, v158, v159
  v_cvt_pk_bf16_f32 v172, v128, v129
  v_cvt_pk_bf16_f32 v173, v130, v131
  v_cvt_pk_bf16_f32 v174, v132, v133
  v_cvt_pk_bf16_f32 v175, v134, v135
  ds_write_b128 v13, v[204:207] offset:3072
  v_cvt_pk_bf16_f32 v188, v136, v137
  v_cvt_pk_bf16_f32 v189, v138, v139
  v_cvt_pk_bf16_f32 v190, v140, v141
  v_cvt_pk_bf16_f32 v191, v142, v143
  ds_write_b128 v13, v[220:223] offset:7168
  s_cmp_gt_u32 s50, s51
  s_cselect_b64 s[26:27], -1, 0
  s_cmp_ge_u32 s50, s51
  s_cselect_b64 s[24:25], -1, 0
  v_cndmask_b32 v236, -v22, v12, s[26:27]
  v_cndmask_b32 v238, -v22, v12, s[24:25]
  v_cndmask_b32 v237, -v23, v12, s[26:27]
  v_cndmask_b32 v239, -v23, v12, s[24:25]
  v_cndmask_b32 v96, v236, v238, s[64:65]
  v_cndmask_b32 v97, v236, v238, s[66:67]
  v_cndmask_b32 v98, v236, v238, s[68:69]
  v_cndmask_b32 v99, v236, v238, s[70:71]
  v_cndmask_b32 v100, v236, v238, s[72:73]
  v_cndmask_b32 v101, v236, v238, s[74:75]
  v_cndmask_b32 v102, v236, v238, s[76:77]
  v_cndmask_b32 v103, v236, v238, s[78:79]
  v_cndmask_b32 v104, v237, v239, s[80:81]
  v_cndmask_b32 v105, v237, v239, s[82:83]
  v_cndmask_b32 v106, v237, v239, s[84:85]
  v_cndmask_b32 v107, v237, v239, s[86:87]
  v_cndmask_b32 v108, v237, v239, s[88:89]
  v_cndmask_b32 v109, v237, v239, s[90:91]
  v_cndmask_b32 v110, v237, v239, s[92:93]
  v_cndmask_b32 v111, v237, v239, s[94:95]
  s_nop 1
  s_load_dwordx2 s[36:37], s[0:1], 40
  s_load_dwordx2 s[98:99], s[0:1], 80
  s_and_b32 s45, s40, 1
  s_lshl_b32 s44, s45, 3
  s_add_u32 s44, s44, 64
  s_load_dwordx2 s[96:97], s[0:1], s44
  s_waitcnt lgkmcnt(0)
  v_mfma_f32_16x16x32_bf16 v[32:35], a[192:195], v[160:163], v[96:99]
  s_lshl_b32 s43, s60, 3
  v_and_b32_e64 v8, 31, v0
  v_mfma_f32_16x16x32_bf16 v[32:35], a[196:199], v[164:167], v[32:35]
  v_lshl_add_u32 v8, v8, 7, s43
  v_mfma_f32_16x16x32_bf16 v[32:35], a[200:203], v[168:171], v[32:35]
  s_and_b32 m0, s49, 0x1ffff
  s_lshr_b32 s43, s60, 9
  v_mfma_f32_16x16x32_bf16 v[32:35], a[204:207], v[172:175], v[32:35]
  s_mul_i32 s43, s43, 1408
  v_min_u32 v7, 10, v0
  v_mfma_f32_16x16x32_bf16 v[40:43], a[192:195], v[176:179], v[104:107]
  buffer_load_dwordx4 v1, s[16:19], s49 offen offset:0 sc1 lds
  v_mfma_f32_16x16x32_bf16 v[40:43], a[196:199], v[180:183], v[40:43]
  v_lshlrev_b32 v7, 7, v7
  v_add_u32 v7, s43, v7
  v_min_u32 v7, 1409020, v7
  v_mfma_f32_16x16x32_bf16 v[40:43], a[200:203], v[184:187], v[40:43]
  s_mov_b32 s8, s96
  s_and_b32 s9, s97, 0xffff
  v_mfma_f32_16x16x32_bf16 v[40:43], a[204:207], v[188:191], v[40:43]
  s_mov_b32 s10, 1409024
  v_mfma_f32_16x16x32_bf16 v[64:67], a[192:195], v[192:195], 0
  s_mov_b32 s11, 0x20000
  v_bfe_u32 v6, v0, 1, 2
  v_mfma_f32_16x16x32_bf16 v[64:67], a[196:199], v[196:199], v[64:67]
  v_mul_u32_u24 v6, 2752, v6
  v_mfma_f32_16x16x32_bf16 v[64:67], a[200:203], v[200:203], v[64:67]
  v_lshrrev_b32 v9, 3, v0
  v_lshl_add_u32 v6, v9, 5, v6
  v_mfma_f32_16x16x32_bf16 v[64:67], a[204:207], v[204:207], v[64:67]
  v_and_b32_e64 v15, 1, v0
  v_mfma_f32_16x16x32_bf16 v[72:75], a[192:195], v[208:211], 0
  buffer_load_dwordx4 v1, s[16:19], s49 offen offset:1024 sc1 lds
  v_mfma_f32_16x16x32_bf16 v[72:75], a[196:199], v[212:215], v[72:75]
  v_lshl_add_u32 v6, v15, 4, v6
  v_lshlrev_b32 v9, 14, v9
  v_and_b32 v15, 7, v0
  v_mfma_f32_16x16x32_bf16 v[72:75], a[200:203], v[216:219], v[72:75]
  v_lshl_add_u32 v9, v15, 4, v9
  s_lshr_b32 s44, s60, 9
  v_mfma_f32_16x16x32_bf16 v[72:75], a[204:207], v[220:223], v[72:75]
  s_bfe_u32 s46, s44, 0x20001
  v_mfma_f32_16x16x32_bf16 v[36:39], a[208:211], v[160:163], v[100:103]
  s_mul_i32 s46, s46, 3
  s_lshr_b32 s44, s44, 3
  v_mfma_f32_16x16x32_bf16 v[36:39], a[212:215], v[164:167], v[36:39]
  s_mul_i32 s47, s45, 1441792
  v_mfma_f32_16x16x32_bf16 v[36:39], a[216:219], v[168:171], v[36:39]
  s_add_u32 s47, s47, 0x800000
  s_lshl_b32 s45, s44, 7
  v_mfma_f32_16x16x32_bf16 v[36:39], a[220:223], v[172:175], v[36:39]
  s_add_u32 s47, s47, s45
  v_mfma_f32_16x16x32_bf16 v[44:47], a[208:211], v[176:179], v[108:111]
  buffer_load_dwordx4 v1, s[16:19], s49 offen offset:2048 sc1 lds
  v_mfma_f32_16x16x32_bf16 v[44:47], a[212:215], v[180:183], v[44:47]
  s_lshl_b32 s45, s46, 17
  s_add_u32 s47, s47, s45
  s_mul_i32 s44, s44, 11008
  v_mfma_f32_16x16x32_bf16 v[44:47], a[216:219], v[184:187], v[44:47]
  s_lshl_b32 s45, s46, 8
  v_mfma_f32_16x16x32_bf16 v[44:47], a[220:223], v[188:191], v[44:47]
  s_add_u32 s44, s44, s45
  v_mfma_f32_16x16x32_bf16 v[68:71], a[208:211], v[192:195], 0
  v_mfma_f32_16x16x32_bf16 v[68:71], a[212:215], v[196:199], v[68:71]
  v_mfma_f32_16x16x32_bf16 v[68:71], a[216:219], v[200:203], v[68:71]
  s_mov_b32 s96, s47
  s_add_u32 s97, s47, 262144
  v_mfma_f32_16x16x32_bf16 v[68:71], a[220:223], v[204:207], v[68:71]
  s_cmp_eq_u32 s46, 9
  s_cselect_b32 s97, 0x7fff0000, s97
  v_mfma_f32_16x16x32_bf16 v[76:79], a[208:211], v[208:211], 0
  buffer_load_dwordx4 v1, s[16:19], s49 offen offset:3072 sc1 lds
  v_mfma_f32_16x16x32_bf16 v[76:79], a[212:215], v[212:215], v[76:79]
  v_mfma_f32_16x16x32_bf16 v[76:79], a[216:219], v[216:219], v[76:79]
  v_mfma_f32_16x16x32_bf16 v[76:79], a[220:223], v[220:223], v[76:79]
  s_waitcnt lgkmcnt(0)
  ds_read_b128 a[192:195], v10 offset:8192
  ds_read_b128 a[196:199], v10 offset:9216
  ds_read_b128 a[200:203], v10 offset:10240
  ds_read_b128 a[204:207], v10 offset:11264
  ds_read_b128 a[208:211], v10 offset:12288
  ds_read_b128 a[212:215], v10 offset:13312
  ds_read_b128 a[216:219], v10 offset:14336
  ds_read_b128 a[220:223], v10 offset:15360
  s_add_u32 s50, s50, 1
  s_add_u32 s49, s49, 32768
  v_add_u32 v10, 0x8000, v10
  v_and_b32 v10, 0x1ffff, v10
  v_max_f32 v24, v32, v33
  v_max_f32_e64 v25, v40, v41
  v_max3_f32 v24, v24, v34, v35
  v_max3_f32 v25, v25, v42, v43
  v_max3_f32 v24, v24, v36, v37
  v_max3_f32 v25, v25, v44, v45
  v_max3_f32 v24, v24, v38, v39
  v_max3_f32 v25, v25, v46, v47
  v_mov_b32 v26, v24
  v_mov_b32 v27, v25
  s_nop 0
  v_permlane16_swap_b32 v24, v26
  v_permlane16_swap_b32 v25, v27
  v_max_f32 v24, v24, v26
  v_max_f32 v25, v25, v27
  v_mov_b32 v26, v24
  v_mov_b32 v27, v25
  s_nop 0
  v_permlane32_swap_b32 v24, v26
  v_permlane32_swap_b32 v25, v27
  v_max_f32 v24, v24, v26
  v_max_f32 v25, v25, v27
  v_max_f32 v24, 0xf149f2ca, v24
  v_max_f32 v25, 0xf149f2ca, v25
  v_add_f32 v22, v22, v24
  v_add_f32 v23, v23, v25
  s_cmp_gt_u32 s50, s51
  s_cselect_b64 s[26:27], -1, 0
  s_cmp_ge_u32 s50, s51
  s_cselect_b64 s[24:25], -1, 0
  v_cndmask_b32 v236, -v22, v12, s[26:27]
  v_cndmask_b32 v238, -v22, v12, s[24:25]
  v_cndmask_b32 v237, -v23, v12, s[26:27]
  v_cndmask_b32 v239, -v23, v12, s[24:25]
  v_cndmask_b32 v96, v236, v238, s[64:65]
  v_cndmask_b32 v97, v236, v238, s[66:67]
  v_cndmask_b32 v98, v236, v238, s[68:69]
  v_cndmask_b32 v99, v236, v238, s[70:71]
  v_cndmask_b32 v100, v236, v238, s[72:73]
  v_cndmask_b32 v101, v236, v238, s[74:75]
  v_cndmask_b32 v102, v236, v238, s[76:77]
  v_cndmask_b32 v103, v236, v238, s[78:79]
  v_cndmask_b32 v104, v237, v239, s[80:81]
  v_cndmask_b32 v105, v237, v239, s[82:83]
  v_cndmask_b32 v106, v237, v239, s[84:85]
  v_cndmask_b32 v107, v237, v239, s[86:87]
  v_cndmask_b32 v108, v237, v239, s[88:89]
  v_cndmask_b32 v109, v237, v239, s[90:91]
  v_cndmask_b32 v110, v237, v239, s[92:93]
  v_cndmask_b32 v111, v237, v239, s[94:95]
  v_sub_f32 v32, v32, v24
  v_sub_f32 v33, v33, v24
  v_sub_f32 v34, v34, v24
  v_sub_f32 v35, v35, v24
  v_sub_f32 v36, v36, v24
  v_sub_f32 v37, v37, v24
  v_sub_f32 v38, v38, v24
  v_sub_f32 v39, v39, v24
  v_sub_f32 v40, v40, v25
  v_sub_f32 v41, v41, v25
  v_sub_f32 v42, v42, v25
  v_sub_f32 v43, v43, v25
  v_sub_f32 v44, v44, v25
  v_sub_f32 v45, v45, v25
  v_sub_f32 v46, v46, v25
  v_sub_f32 v47, v47, v25
  v_max_f32 v24, v64, v65
  v_max_f32 v25, v72, v73
  v_max3_f32 v24, v24, v66, v67
  v_max3_f32 v25, v25, v74, v75
  v_max3_f32 v24, v24, v68, v69
  v_max3_f32 v25, v25, v76, v77
  v_max3_f32 v24, v24, v70, v71
  v_max3_f32 v25, v25, v78, v79
  v_mov_b32 v26, v24
  v_mov_b32 v27, v25
  s_nop 0
  v_permlane16_swap_b32 v24, v26
  v_permlane16_swap_b32 v25, v27
  v_max_f32 v24, v24, v26
  v_max_f32 v25, v25, v27
  v_mov_b32 v26, v24
  v_mov_b32 v27, v25
  s_nop 0
  v_permlane32_swap_b32 v24, v26
  v_permlane32_swap_b32 v25, v27
  v_max_f32 v24, v24, v26
  v_max_f32 v25, v25, v27
  v_max_f32 v24, 0xf149f2ca, v24
  v_max_f32 v25, 0xf149f2ca, v25
  v_add_f32 v30, v30, v24
  v_add_f32 v31, v31, v25
  v_sub_f32 v112, 0, v30
  v_sub_f32 v113, 0, v30
  v_sub_f32 v114, 0, v30
  v_sub_f32 v115, 0, v30
  v_sub_f32 v116, 0, v30
  v_sub_f32 v117, 0, v30
  v_sub_f32 v118, 0, v30
  v_sub_f32 v119, 0, v30
  v_sub_f32 v120, 0, v31
  v_sub_f32 v121, 0, v31
  v_sub_f32 v122, 0, v31
  v_sub_f32 v123, 0, v31
  v_sub_f32 v124, 0, v31
  v_sub_f32 v125, 0, v31
  v_sub_f32 v126, 0, v31
  v_sub_f32 v127, 0, v31
  v_sub_f32 v64, v64, v24
  v_sub_f32 v65, v65, v24
  v_sub_f32 v66, v66, v24
  v_sub_f32 v67, v67, v24
  v_sub_f32 v68, v68, v24
  v_sub_f32 v69, v69, v24
  v_sub_f32 v70, v70, v24
  v_sub_f32 v71, v71, v24
  v_sub_f32 v72, v72, v25
  v_sub_f32 v73, v73, v25
  v_sub_f32 v74, v74, v25
  v_sub_f32 v75, v75, v25
  v_sub_f32 v76, v76, v25
  v_sub_f32 v77, v77, v25
  v_sub_f32 v78, v78, v25
  v_sub_f32_e64 v79, v79, v25
  s_waitcnt lgkmcnt(0)
  v_mfma_f32_16x16x32_bf16 v[48:51], a[192:195], v[160:163], v[96:99]
  v_add_f32 v18, v18, v248
  v_add_f32 v19, v19, v249
  v_mfma_f32_16x16x32_bf16 v[48:51], a[196:199], v[164:167], v[48:51]
  v_add_f32 v16, v16, v240
  v_add_f32 v17, v17, v244
  v_mfma_f32_16x16x32_bf16 v[48:51], a[200:203], v[168:171], v[48:51]
  v_exp_f32_e64 v24, v32
  v_mfma_f32_16x16x32_bf16 v[48:51], a[204:207], v[172:175], v[48:51]
  v_exp_f32_e64 v25, v33
  v_mfma_f32_16x16x32_bf16 v[56:59], a[192:195], v[176:179], v[104:107]
  v_exp_f32_e64 v26, v34
  v_mfma_f32_16x16x32_bf16 v[56:59], a[196:199], v[180:183], v[56:59]
  v_cvt_pk_bf16_f32 v128, v24, v25
  v_mfma_f32_16x16x32_bf16 v[56:59], a[200:203], v[184:187], v[56:59]
  v_exp_f32_e64 v27, v35
  v_mfma_f32_16x16x32_bf16 v[56:59], a[204:207], v[188:191], v[56:59]
  v_exp_f32_e64 v28, v36
  v_cvt_pk_bf16_f32 v129, v26, v27
  v_mfma_f32_16x16x32_bf16 v[80:83], a[192:195], v[192:195], v[112:115]
  v_exp_f32_e64 v29, v37
  v_mfma_f32_16x16x32_bf16 v[80:83], a[196:199], v[196:199], v[80:83]
  v_exp_f32_e64 v24, v38
  v_mfma_f32_16x16x32_bf16 v[80:83], a[200:203], v[200:203], v[80:83]
  v_cvt_pk_bf16_f32 v130, v28, v29
  v_mfma_f32_16x16x32_bf16 v[80:83], a[204:207], v[204:207], v[80:83]
  v_exp_f32_e64 v25, v39
  v_mfma_f32_16x16x32_bf16 v[88:91], a[192:195], v[208:211], v[120:123]
  v_exp_f32_e64 v26, v40
  v_cvt_pk_bf16_f32 v131, v24, v25
  v_mfma_f32_16x16x32_bf16 v[88:91], a[196:199], v[212:215], v[88:91]
  v_exp_f32_e64 v27, v41
  v_mfma_f32_16x16x32_bf16 v[88:91], a[200:203], v[216:219], v[88:91]
  v_exp_f32_e64 v28, v42
  v_mfma_f32_16x16x32_bf16 v[88:91], a[204:207], v[220:223], v[88:91]
  v_cvt_pk_bf16_f32 v132, v26, v27
  v_mfma_f32_16x16x32_bf16 v[52:55], a[208:211], v[160:163], v[100:103]
  v_mfma_f32_16x16x32_bf16 v[240:243], v[252:255], v[128:131], 0
  v_mfma_f32_16x16x32_bf16 v[52:55], a[212:215], v[164:167], v[52:55]
  v_exp_f32_e64 v29, v43
  v_mfma_f32_16x16x32_bf16 v[52:55], a[216:219], v[168:171], v[52:55]
  s_add_u32 s50, s50, 1
  v_exp_f32 v24, v44
  v_mfma_f32_16x16x32_bf16 v[52:55], a[220:223], v[172:175], v[52:55]
  v_cvt_pk_bf16_f32 v133, v28, v29
  v_mfma_f32_16x16x32_bf16 v[60:63], a[208:211], v[176:179], v[108:111]
  v_exp_f32_e64 v25, v45
  v_mfma_f32_16x16x32_bf16 v[60:63], a[212:215], v[180:183], v[60:63]
  v_exp_f32_e64 v26, v46
  v_cvt_pk_bf16_f32 v134, v24, v25
  v_mfma_f32_16x16x32_bf16 v[60:63], a[216:219], v[184:187], v[60:63]
  v_exp_f32_e64 v27, v47
  v_mfma_f32_16x16x32_bf16 v[60:63], a[220:223], v[188:191], v[60:63]
  v_exp_f32_e64 v28, v64
  v_mfma_f32_16x16x32_bf16 v[84:87], a[208:211], v[192:195], v[116:119]
  v_cvt_pk_bf16_f32 v135, v26, v27
  v_exp_f32_e64 v29, v65
  v_mfma_f32_16x16x32_bf16 v[84:87], a[212:215], v[196:199], v[84:87]
  v_mov_b32_e64 v248, v240
  v_mfma_f32_16x16x32_bf16 v[84:87], a[216:219], v[200:203], v[84:87]
  v_exp_f32_e64 v24, v66
  v_mfma_f32_16x16x32_bf16 v[84:87], a[220:223], v[204:207], v[84:87]
  v_cvt_pk_bf16_f32 v144, v28, v29
  v_mfma_f32_16x16x32_bf16 v[92:95], a[208:211], v[208:211], v[124:127]
  v_mfma_f32_16x16x32_bf16 v[244:247], v[252:255], v[132:135], 0
  v_mfma_f32_16x16x32_bf16 v[92:95], a[212:215], v[212:215], v[92:95]
  v_exp_f32_e64 v25, v67
  v_mfma_f32_16x16x32_bf16 v[92:95], a[216:219], v[216:219], v[92:95]
  v_exp_f32_e64 v26, v68
  v_cvt_pk_bf16_f32 v145, v24, v25
  v_mfma_f32_16x16x32_bf16 v[92:95], a[220:223], v[220:223], v[92:95]
  v_exp_f32_e64 v27, v69
  s_waitcnt vmcnt(16) lgkmcnt(0)
  s_barrier
  ds_read_b128 a[192:195], v10 offset:0
  s_and_b32 m0, s48, 0x1ffff
  s_cmp_gt_u32 s50, s51
  s_cselect_b64 s[26:27], -1, 0
  s_cmp_ge_u32 s50, s51
  s_cselect_b64 s[24:25], -1, 0
  ds_read_b128 a[196:199], v10 offset:1024
  v_cndmask_b32 v236, -v22, v12, s[26:27]
  v_cndmask_b32 v238, -v22, v12, s[24:25]
  ds_read_b128 a[200:203], v10 offset:2048
  buffer_load_dwordx4 v1, s[16:19], s48 offen offset:0 sc1 lds
  v_cndmask_b32 v237, -v23, v12, s[26:27]
  v_cndmask_b32 v239, -v23, v12, s[24:25]
  ds_read_b128 a[204:207], v10 offset:3072
  v_cndmask_b32 v96, v236, v238, s[64:65]
  v_cndmask_b32 v97, v236, v238, s[66:67]
  ds_read_b128 a[208:211], v10 offset:4096
  v_cndmask_b32 v98, v236, v238, s[68:69]
  v_cndmask_b32 v99, v236, v238, s[70:71]
  ds_read_b128 a[212:215], v10 offset:5120
  v_cndmask_b32 v100, v236, v238, s[72:73]
  ds_read_b128 a[216:219], v10 offset:6144
  buffer_load_dwordx4 v1, s[16:19], s48 offen offset:1024 sc1 lds
  v_cndmask_b32 v101, v236, v238, s[74:75]
  v_cndmask_b32 v102, v236, v238, s[76:77]
  ds_read_b128 a[220:223], v10 offset:7168
  v_cndmask_b32 v103, v236, v238, s[78:79]
  v_cndmask_b32 v104, v237, v239, s[80:81]
  v_exp_f32_e64 v28, v70
  v_cvt_pk_bf16_f32 v146, v26, v27
  v_exp_f32 v29, v71
  v_exp_f32 v24, v72
  v_cvt_pk_bf16_f32 v147, v28, v29
  v_cndmask_b32 v105, v237, v239, s[82:83]
  v_cndmask_b32 v106, v237, v239, s[84:85]
  v_exp_f32 v25, v73
  v_mov_b32 v249, v244
  v_exp_f32_e64 v26, v74
  v_cvt_pk_bf16_f32 v148, v24, v25
  v_mfma_f32_16x16x32_bf16 v[240:243], v[252:255], v[144:147], 0
  v_exp_f32_e64 v27, v75
  v_add_u32 v11, 0x8000, v11
  v_and_b32 v11, 0x1ffff, v11
  v_cndmask_b32 v107, v237, v239, s[86:87]
  v_cndmask_b32 v108, v237, v239, s[88:89]
  v_exp_f32_e64 v28, v76
  v_cvt_pk_bf16_f32 v149, v26, v27
  v_exp_f32 v29, v77
  v_exp_f32 v24, v78
  v_cvt_pk_bf16_f32 v150, v28, v29
  buffer_load_dwordx4 v1, s[16:19], s48 offen offset:2048 sc1 lds
  v_exp_f32 v25, v79
  s_nop 0
  v_cvt_pk_bf16_f32 v151, v24, v25
  s_nop 1
  v_mfma_f32_16x16x32_bf16 v[244:247], v[252:255], v[148:151], 0
  v_cndmask_b32 v109, v237, v239, s[90:91]
  v_cndmask_b32 v110, v237, v239, s[92:93]
  buffer_load_dwordx4 v1, s[16:19], s48 offen offset:3072 sc1 lds
  v_cndmask_b32 v111, v237, v239, s[94:95]
  s_add_u32 s48, s48, 32768
  s_nop 7
  v_max3_f32 v15, v248, v249, v240
  v_max_f32 v15, v15, v244
  v_cmp_lt_f32 vcc, s55, v15
  s_cbranch_vccnz Lst1
Lst1r:
  s_waitcnt lgkmcnt(0)
  v_mfma_f32_16x16x32_bf16 v[32:35], a[192:195], v[160:163], v[96:99]
  ds_read_b128 a[224:227], v11 offset:0
  v_exp_f32_e64 v24, v48
  v_mfma_f32_16x16x32_bf16 v[32:35], a[196:199], v[164:167], v[32:35]
  v_add_f32 v16, v16, v240
  v_add_f32 v18, v18, v248
  v_mfma_f32_16x16x32_bf16 v[32:35], a[200:203], v[168:171], v[32:35]
  v_exp_f32_e64 v25, v49
  v_mfma_f32_16x16x32_bf16 v[32:35], a[204:207], v[172:175], v[32:35]
  v_add_f32 v17, v17, v244
  v_add_f32 v19, v19, v249
  v_cvt_pk_bf16_f32 v136, v24, v25
  v_mfma_f32_16x16x32_bf16 v[40:43], a[192:195], v[176:179], v[104:107]
  v_exp_f32_e64 v26, v50
  v_mfma_f32_16x16x32_bf16 v[40:43], a[196:199], v[180:183], v[40:43]
  ds_read_b128 a[228:231], v11 offset:1024
  s_and_b32 m0, s49, 0x1ffff
  v_mfma_f32_16x16x32_bf16 v[40:43], a[200:203], v[184:187], v[40:43]
  ds_read_b128 a[232:235], v11 offset:2048
  v_exp_f32_e64 v27, v51
  v_mfma_f32_16x16x32_bf16 v[40:43], a[204:207], v[188:191], v[40:43]
  buffer_load_dwordx4 v1, s[16:19], s49 offen offset:0 sc1 lds
  v_mfma_f32_16x16x32_bf16 v[64:67], a[192:195], v[192:195], v[112:115]
  v_exp_f32_e64 v28, v52
  v_mfma_f32_16x16x32_bf16 v[64:67], a[196:199], v[196:199], v[64:67]
  ds_read_b128 a[236:239], v11 offset:3072
  ds_read_b128 a[240:243], v11 offset:4096
  v_cvt_pk_bf16_f32 v137, v26, v27
  v_mfma_f32_16x16x32_bf16 v[64:67], a[200:203], v[200:203], v[64:67]
  v_exp_f32_e64 v29, v53
  v_mfma_f32_16x16x32_bf16 v[64:67], a[204:207], v[204:207], v[64:67]
  v_exp_f32_e64 v24, v54
  v_mfma_f32_16x16x32_bf16 v[72:75], a[192:195], v[208:211], v[120:123]
  ds_read_b128 a[244:247], v11 offset:5120
  v_cvt_pk_bf16_f32 v138, v28, v29
  v_mfma_f32_16x16x32_bf16 v[72:75], a[196:199], v[212:215], v[72:75]
  ds_read_b128 a[248:251], v11 offset:6144
  v_exp_f32_e64 v25, v55
  v_mfma_f32_16x16x32_bf16 v[72:75], a[200:203], v[216:219], v[72:75]
  buffer_load_dwordx4 v1, s[16:19], s49 offen offset:1024 sc1 lds
  v_mfma_f32_16x16x32_bf16 v[72:75], a[204:207], v[220:223], v[72:75]
  v_exp_f32_e64 v26, v56
  v_mfma_f32_16x16x32_bf16 v[36:39], a[208:211], v[160:163], v[100:103]
  ds_read_b128 a[252:255], v11 offset:7168
  v_cvt_pk_bf16_f32 v139, v24, v25
  v_mfma_f32_16x16x32_bf16 v[36:39], a[212:215], v[164:167], v[36:39]
  v_exp_f32_e64 v27, v57
  v_mfma_f32_16x16x32_bf16 v[240:243], v[252:255], v[136:139], 0
  v_cvt_pk_bf16_f32 v140, v26, v27
  v_mfma_f32_16x16x32_bf16 v[36:39], a[216:219], v[168:171], v[36:39]
  v_exp_f32 v28, v58
  s_add_u32 s50, s50, 1
  v_mfma_f32_16x16x32_bf16 v[36:39], a[220:223], v[172:175], v[36:39]
  v_exp_f32_e64 v29, v59
  v_mfma_f32_16x16x32_bf16 v[44:47], a[208:211], v[176:179], v[108:111]
  buffer_load_dwordx4 v1, s[16:19], s49 offen offset:2048 sc1 lds
  v_mfma_f32_16x16x32_bf16 v[44:47], a[212:215], v[180:183], v[44:47]
  v_exp_f32_e64 v24, v60
  v_mfma_f32_16x16x32_bf16 v[44:47], a[216:219], v[184:187], v[44:47]
  v_mov_b32_e64 v248, v240
  v_cvt_pk_bf16_f32 v141, v28, v29
  v_mfma_f32_16x16x32_bf16 v[44:47], a[220:223], v[188:191], v[44:47]
  v_exp_f32_e64 v25, v61
  v_mfma_f32_16x16x32_bf16 v[68:71], a[208:211], v[192:195], v[116:119]
  v_cvt_pk_bf16_f32 v142, v24, v25
  v_mfma_f32_16x16x32_bf16 v[68:71], a[212:215], v[196:199], v[68:71]
  v_exp_f32_e64 v26, v62
  v_mfma_f32_16x16x32_bf16 v[68:71], a[216:219], v[200:203], v[68:71]
  v_mfma_f32_16x16x32_bf16 v[68:71], a[220:223], v[204:207], v[68:71]
  v_exp_f32_e64 v27, v63
  v_mfma_f32_16x16x32_bf16 v[76:79], a[208:211], v[208:211], v[124:127]
  v_exp_f32_e64 v28, v80
  v_cvt_pk_bf16_f32 v143, v26, v27
  v_mfma_f32_16x16x32_bf16 v[76:79], a[212:215], v[212:215], v[76:79]
  buffer_load_dwordx4 v1, s[16:19], s49 offen offset:3072 sc1 lds
  v_mfma_f32_16x16x32_bf16 v[244:247], v[252:255], v[140:143], 0
  v_exp_f32_e64 v29, v81
  v_mfma_f32_16x16x32_bf16 v[76:79], a[216:219], v[216:219], v[76:79]
  v_cvt_pk_bf16_f32 v152, v28, v29
  v_mfma_f32_16x16x32_bf16 v[76:79], a[220:223], v[220:223], v[76:79]
  v_exp_f32 v24, v82
  s_waitcnt lgkmcnt(0)
  v_mfma_f32_16x16x32_bf16 a[0:3], a[224:227], v[128:131], 0
  v_mfma_f32_16x16x32_bf16 a[32:35], a[224:227], v[132:135], 0
  v_exp_f32_e64 v25, v83
  v_mfma_f32_16x16x32_bf16 a[64:67], a[224:227], v[144:147], 0
  v_mov_b32_e64 v249, v244
  v_cvt_pk_bf16_f32 v153, v24, v25
  s_cmp_gt_u32 s50, s51
  s_cselect_b64 s[26:27], -1, 0
  v_mfma_f32_16x16x32_bf16 a[96:99], a[224:227], v[148:151], 0
  s_cmp_ge_u32 s50, s51
  s_cselect_b64 s[24:25], -1, 0
  v_mfma_f32_16x16x32_bf16 a[4:7], a[228:231], v[128:131], 0
  v_cndmask_b32 v236, -v22, v12, s[26:27]
  v_mfma_f32_16x16x32_bf16 a[36:39], a[228:231], v[132:135], 0
  v_exp_f32_e64 v26, v84
  v_cndmask_b32 v238, -v22, v12, s[24:25]
  v_mfma_f32_16x16x32_bf16 a[68:71], a[228:231], v[144:147], 0
  v_exp_f32_e64 v27, v85
  v_mfma_f32_16x16x32_bf16 a[100:103], a[228:231], v[148:151], 0
  v_exp_f32_e64 v28, v86
  v_mfma_f32_16x16x32_bf16 a[8:11], a[232:235], v[128:131], 0
  v_exp_f32_e64 v29, v87
  v_cvt_pk_bf16_f32 v154, v26, v27
  v_mfma_f32_16x16x32_bf16 a[40:43], a[232:235], v[132:135], 0
  buffer_load_dwordx4 v[224:227], v6, s[8:11], s44 offen offset:0
  v_mfma_f32_16x16x32_bf16 a[72:75], a[232:235], v[144:147], 0
  v_exp_f32_e64 v24, v88
  v_mfma_f32_16x16x32_bf16 a[104:107], a[232:235], v[148:151], 0
  ds_read_b128 a[192:195], v10 offset:8192
  v_cvt_pk_bf16_f32 v155, v28, v29
  v_mfma_f32_16x16x32_bf16 a[12:15], a[236:239], v[128:131], 0
  ds_read_b128 a[196:199], v10 offset:9216
  v_exp_f32_e64 v25, v89
  v_mfma_f32_16x16x32_bf16 v[240:243], v[252:255], v[152:155], 0
  v_exp_f32_e64 v26, v90
  v_mfma_f32_16x16x32_bf16 a[44:47], a[236:239], v[132:135], 0
  ds_read_b128 a[200:203], v10 offset:10240
  v_cvt_pk_bf16_f32 v156, v24, v25
  v_mfma_f32_16x16x32_bf16 a[76:79], a[236:239], v[144:147], 0
  v_exp_f32_e64 v27, v91
  v_cndmask_b32 v237, -v23, v12, s[26:27]
  v_mfma_f32_16x16x32_bf16 a[108:111], a[236:239], v[148:151], 0
  buffer_load_dwordx4 v[228:231], v6, s[8:11], s44 offen offset:256
  v_mfma_f32_16x16x32_bf16 a[16:19], a[240:243], v[128:131], 0
  v_exp_f32_e64 v28, v92
  v_mfma_f32_16x16x32_bf16 a[48:51], a[240:243], v[132:135], 0
  ds_read_b128 a[204:207], v10 offset:11264
  ds_read_b128 a[208:211], v10 offset:12288
  v_cvt_pk_bf16_f32 v157, v26, v27
  v_mfma_f32_16x16x32_bf16 a[80:83], a[240:243], v[144:147], 0
  v_exp_f32_e64 v29, v93
  v_mfma_f32_16x16x32_bf16 a[112:115], a[240:243], v[148:151], 0
  ds_read_b128 a[212:215], v10 offset:13312
  v_cvt_pk_bf16_f32 v158, v28, v29
  v_mfma_f32_16x16x32_bf16 a[20:23], a[244:247], v[128:131], 0
  v_exp_f32_e64 v24, v94
  v_mfma_f32_16x16x32_bf16 a[52:55], a[244:247], v[132:135], 0
  v_exp_f32_e64 v25, v95
  v_cndmask_b32 v239, -v23, v12, s[24:25]
  v_mfma_f32_16x16x32_bf16 a[84:87], a[244:247], v[144:147], 0
  buffer_load_dwordx4 v[232:235], v6, s[8:11], s44 offen offset:512
  v_mfma_f32_16x16x32_bf16 a[116:119], a[244:247], v[148:151], 0
  ds_read_b128 a[216:219], v10 offset:14336
  v_cvt_pk_bf16_f32 v159, v24, v25
  v_mfma_f32_16x16x32_bf16 a[24:27], a[248:251], v[128:131], 0
  ds_read_b128 a[220:223], v10 offset:15360
  s_add_u32 s49, s49, 32768
  v_cndmask_b32 v96, v236, v238, s[64:65]
  v_mfma_f32_16x16x32_bf16 v[244:247], v[252:255], v[156:159], 0
  global_load_dword v14, v7, s[98:99]
  v_mfma_f32_16x16x32_bf16 a[56:59], a[248:251], v[132:135], 0
  v_add_u32 v10, 0x8000, v10
  v_and_b32 v10, 0x1ffff, v10
  v_mfma_f32_16x16x32_bf16 a[88:91], a[248:251], v[144:147], 0
  v_cndmask_b32 v97, v236, v238, s[66:67]
  v_cndmask_b32 v98, v236, v238, s[68:69]
  v_cndmask_b32 v99, v236, v238, s[70:71]
  v_mfma_f32_16x16x32_bf16 a[120:123], a[248:251], v[148:151], 0
  v_cndmask_b32 v100, v236, v238, s[72:73]
  v_cndmask_b32 v101, v236, v238, s[74:75]
  v_mfma_f32_16x16x32_bf16 a[28:31], a[252:255], v[128:131], 0
  v_cndmask_b32 v102, v236, v238, s[76:77]
  v_cndmask_b32 v103, v236, v238, s[78:79]
  v_mfma_f32_16x16x32_bf16 a[60:63], a[252:255], v[132:135], 0
  v_cndmask_b32 v104, v237, v239, s[80:81]
  v_cndmask_b32 v105, v237, v239, s[82:83]
  v_mfma_f32_16x16x32_bf16 a[92:95], a[252:255], v[144:147], 0
  v_cndmask_b32 v106, v237, v239, s[84:85]
  v_cndmask_b32 v107, v237, v239, s[86:87]
  v_cndmask_b32 v108, v237, v239, s[88:89]
  v_cndmask_b32 v109, v237, v239, s[90:91]
  v_cndmask_b32 v110, v237, v239, s[92:93]
  v_cndmask_b32 v111, v237, v239, s[94:95]
  v_max3_f32 v15, v248, v249, v240
  v_max_f32 v15, v15, v244
  v_cmp_lt_f32 vcc, s55, v15
  v_mfma_f32_16x16x32_bf16 a[124:127], a[252:255], v[148:151], 0
  s_cbranch_vccnz Lst2
Lst2r:
  s_waitcnt lgkmcnt(0)
  v_mfma_f32_16x16x32_bf16 v[48:51], a[192:195], v[160:163], v[96:99]
  v_exp_f32_e64 v24, v32
  v_mfma_f32_16x16x32_bf16 v[48:51], a[196:199], v[164:167], v[48:51]
  v_add_f32 v16, v16, v240
  v_add_f32 v18, v18, v248
  v_mfma_f32_16x16x32_bf16 v[48:51], a[200:203], v[168:171], v[48:51]
  v_exp_f32_e64 v25, v33
  v_mfma_f32_16x16x32_bf16 v[48:51], a[204:207], v[172:175], v[48:51]
  v_add_f32 v17, v17, v244
  v_add_f32 v19, v19, v249
  v_mfma_f32_16x16x32_bf16 v[56:59], a[192:195], v[176:179], v[104:107]
  v_exp_f32_e64 v26, v34
  v_mfma_f32_16x16x32_bf16 v[56:59], a[196:199], v[180:183], v[56:59]
  ds_read_b128 a[224:227], v11 offset:8192
  v_cvt_pk_bf16_f32 v128, v24, v25
  v_mfma_f32_16x16x32_bf16 v[56:59], a[200:203], v[184:187], v[56:59]
  v_exp_f32_e64 v27, v35
  v_mfma_f32_16x16x32_bf16 v[56:59], a[204:207], v[188:191], v[56:59]
  ds_read_b128 a[228:231], v11 offset:9216
  v_cvt_pk_bf16_f32 v129, v26, v27
  v_mfma_f32_16x16x32_bf16 v[80:83], a[192:195], v[192:195], v[112:115]
  v_exp_f32_e64 v28, v36
  v_mfma_f32_16x16x32_bf16 v[80:83], a[196:199], v[196:199], v[80:83]
  ds_read_b128 a[232:235], v11 offset:10240
  ds_read_b128 a[236:239], v11 offset:11264
  v_mfma_f32_16x16x32_bf16 v[80:83], a[200:203], v[200:203], v[80:83]
  v_exp_f32_e64 v29, v37
  v_mfma_f32_16x16x32_bf16 v[80:83], a[204:207], v[204:207], v[80:83]
  v_exp_f32_e64 v24, v38
  v_mfma_f32_16x16x32_bf16 v[88:91], a[192:195], v[208:211], v[120:123]
  ds_read_b128 a[240:243], v11 offset:12288
  v_cvt_pk_bf16_f32 v130, v28, v29
  v_mfma_f32_16x16x32_bf16 v[88:91], a[196:199], v[212:215], v[88:91]
  v_exp_f32_e64 v25, v39
  v_mfma_f32_16x16x32_bf16 v[88:91], a[200:203], v[216:219], v[88:91]
  ds_read_b128 a[244:247], v11 offset:13312
  v_cvt_pk_bf16_f32 v131, v24, v25
  v_mfma_f32_16x16x32_bf16 v[88:91], a[204:207], v[220:223], v[88:91]
  v_exp_f32_e64 v26, v40
  v_mfma_f32_16x16x32_bf16 v[240:243], v[252:255], v[128:131], 0
  ds_read_b128 a[248:251], v11 offset:14336
  ds_read_b128 a[252:255], v11 offset:15360
  v_mfma_f32_16x16x32_bf16 v[52:55], a[208:211], v[160:163], v[100:103]
  v_exp_f32_e64 v27, v41
  v_mfma_f32_16x16x32_bf16 v[52:55], a[212:215], v[164:167], v[52:55]
  v_cvt_pk_bf16_f32 v132, v26, v27
  s_getpc_b64 s[46:47]
  s_lshr_b32 s43, s2, 3
  v_mfma_f32_16x16x32_bf16 v[52:55], a[216:219], v[168:171], v[52:55]
  v_mov_b32_e64 v248, v240
  v_mfma_f32_16x16x32_bf16 v[52:55], a[220:223], v[172:175], v[52:55]
  v_exp_f32_e64 v28, v42
  v_mfma_f32_16x16x32_bf16 v[60:63], a[208:211], v[176:179], v[108:111]
  v_exp_f32_e64 v29, v43
  v_mfma_f32_16x16x32_bf16 v[60:63], a[212:215], v[180:183], v[60:63]
  v_exp_f32_e64 v24, v44
  v_mfma_f32_16x16x32_bf16 v[60:63], a[216:219], v[184:187], v[60:63]
  v_cvt_pk_bf16_f32 v133, v28, v29
  s_lshl_b32 s43, s43, 2
  v_mfma_f32_16x16x32_bf16 v[60:63], a[220:223], v[188:191], v[60:63]
  v_exp_f32 v25, v45
  v_mfma_f32_16x16x32_bf16 v[84:87], a[208:211], v[192:195], v[116:119]
  v_cvt_pk_bf16_f32 v134, v24, v25
  s_add_u32 s43, s43, s40
  v_mfma_f32_16x16x32_bf16 v[84:87], a[212:215], v[196:199], v[84:87]
  v_exp_f32 v26, v46
  v_mfma_f32_16x16x32_bf16 v[84:87], a[216:219], v[200:203], v[84:87]
  s_mul_i32 s43, s43, 384
  v_min_u32_e64 v6, 2, v0
  v_mfma_f32_16x16x32_bf16 v[84:87], a[220:223], v[204:207], v[84:87]
  v_exp_f32_e64 v27, v47
  v_mfma_f32_16x16x32_bf16 v[92:95], a[208:211], v[208:211], v[124:127]
  v_exp_f32_e64 v28, v64
  v_mfma_f32_16x16x32_bf16 v[92:95], a[212:215], v[212:215], v[92:95]
  v_cvt_pk_bf16_f32 v135, v26, v27
  v_lshlrev_b32_e64 v6, 7, v6
  v_mfma_f32_16x16x32_bf16 v[92:95], a[216:219], v[216:219], v[92:95]
  v_exp_f32_e64 v29, v65
  v_mfma_f32_16x16x32_bf16 v[244:247], v[252:255], v[132:135], 0
  v_cvt_pk_bf16_f32 v144, v28, v29
  v_add_u32_e64 v6, s43, v6
  v_mfma_f32_16x16x32_bf16 v[92:95], a[220:223], v[220:223], v[92:95]
  global_load_dword v14, v6, s[46:47]
  s_waitcnt vmcnt(21) lgkmcnt(0)
  v_mfma_f32_16x16x32_bf16 a[0:3], a[224:227], v[136:139], a[0:3]
  s_barrier
  v_mfma_f32_16x16x32_bf16 a[32:35], a[224:227], v[140:143], a[32:35]
  v_exp_f32_e64 v24, v66
  v_mfma_f32_16x16x32_bf16 a[64:67], a[224:227], v[152:155], a[64:67]
  v_exp_f32_e64 v25, v67
  v_mfma_f32_16x16x32_bf16 a[96:99], a[224:227], v[156:159], a[96:99]
  v_exp_f32_e64 v26, v68
  v_mfma_f32_16x16x32_bf16 a[4:7], a[228:231], v[136:139], a[4:7]
  v_exp_f32_e64 v27, v69
  v_mfma_f32_16x16x32_bf16 a[36:39], a[228:231], v[140:143], a[36:39]
  v_mov_b32_e64 v249, v244
  v_cvt_pk_bf16_f32 v145, v24, v25
  v_mfma_f32_16x16x32_bf16 a[68:71], a[228:231], v[152:155], a[68:71]
  v_exp_f32_e64 v28, v70
  v_mfma_f32_16x16x32_bf16 a[100:103], a[228:231], v[156:159], a[100:103]
  ds_read_b128 a[192:195], v10 offset:0
  v_cvt_pk_bf16_f32 v146, v26, v27
  v_mfma_f32_16x16x32_bf16 a[8:11], a[232:235], v[136:139], a[8:11]
  v_exp_f32_e64 v29, v71
  v_mfma_f32_16x16x32_bf16 a[40:43], a[232:235], v[140:143], a[40:43]
  v_cvt_pk_bf16_f32 v147, v28, v29
  s_and_b32 m0, s48, 0x1ffff
  v_mfma_f32_16x16x32_bf16 a[72:75], a[232:235], v[152:155], a[72:75]
  v_exp_f32_e64 v24, v72
  v_mfma_f32_16x16x32_bf16 v[240:243], v[252:255], v[144:147], 0
  ds_read_b128 a[196:199], v10 offset:1024
  ds_read_b128 a[200:203], v10 offset:2048
  v_mfma_f32_16x16x32_bf16 a[104:107], a[232:235], v[156:159], a[104:107]
  v_exp_f32_e64 v25, v73
  v_mfma_f32_16x16x32_bf16 a[12:15], a[236:239], v[136:139], a[12:15]
  v_exp_f32_e64 v26, v74
  v_mfma_f32_16x16x32_bf16 a[44:47], a[236:239], v[140:143], a[44:47]
  buffer_load_dwordx4 v1, s[16:19], s48 offen offset:0 sc1 lds
  v_mfma_f32_16x16x32_bf16 a[76:79], a[236:239], v[152:155], a[76:79]
  v_exp_f32_e64 v27, v75
  v_mfma_f32_16x16x32_bf16 a[108:111], a[236:239], v[156:159], a[108:111]
  v_cvt_pk_bf16_f32 v148, v24, v25
  v_cvt_pk_bf16_f32 v149, v26, v27
  v_mfma_f32_16x16x32_bf16 a[16:19], a[240:243], v[136:139], a[16:19]
  v_exp_f32_e64 v28, v76
  v_mfma_f32_16x16x32_bf16 a[48:51], a[240:243], v[140:143], a[48:51]
  ds_read_b128 a[204:207], v10 offset:3072
  ds_read_b128 a[208:211], v10 offset:4096
  v_mfma_f32_16x16x32_bf16 a[80:83], a[240:243], v[152:155], a[80:83]
  v_exp_f32_e64 v29, v77
  v_mfma_f32_16x16x32_bf16 a[112:115], a[240:243], v[156:159], a[112:115]
  ds_read_b128 a[212:215], v10 offset:5120
  v_cvt_pk_bf16_f32 v150, v28, v29
  v_mfma_f32_16x16x32_bf16 a[20:23], a[244:247], v[136:139], a[20:23]
  v_exp_f32_e64 v24, v78
  v_mfma_f32_16x16x32_bf16 a[52:55], a[244:247], v[140:143], a[52:55]
  v_exp_f32_e64 v25, v79
  v_mfma_f32_16x16x32_bf16 a[84:87], a[244:247], v[152:155], a[84:87]
  ds_read_b128 a[216:219], v10 offset:6144
  v_cvt_pk_bf16_f32 v151, v24, v25
  v_mfma_f32_16x16x32_bf16 a[116:119], a[244:247], v[156:159], a[116:119]
  buffer_load_dwordx4 v1, s[16:19], s48 offen offset:1024 sc1 lds
  v_mfma_f32_16x16x32_bf16 v[244:247], v[252:255], v[148:151], 0
  ds_read_b128 a[220:223], v10 offset:7168
  s_add_u32 s50, s50, 1
  v_mfma_f32_16x16x32_bf16 a[24:27], a[248:251], v[136:139], a[24:27]
  v_add_u32 v11, 0x8000, v11
  v_and_b32 v11, 0x1ffff, v11
  v_mfma_f32_16x16x32_bf16 a[56:59], a[248:251], v[140:143], a[56:59]
  buffer_load_dwordx4 v1, s[16:19], s48 offen offset:2048 sc1 lds
  v_mfma_f32_16x16x32_bf16 a[88:91], a[248:251], v[152:155], a[88:91]
  buffer_load_dwordx4 v1, s[16:19], s48 offen offset:3072 sc1 lds
  v_mfma_f32_16x16x32_bf16 a[120:123], a[248:251], v[156:159], a[120:123]
  s_add_u32 s48, s48, 32768
  v_max3_f32 v15, v248, v249, v240
  v_mfma_f32_16x16x32_bf16 a[28:31], a[252:255], v[136:139], a[28:31]
  v_max_f32 v15, v15, v244
  v_cmp_lt_f32_e64 vcc, s55, v15
  v_mfma_f32_16x16x32_bf16 a[60:63], a[252:255], v[140:143], a[60:63]
  v_mfma_f32_16x16x32_bf16 a[92:95], a[252:255], v[152:155], a[92:95]
  v_mfma_f32_16x16x32_bf16 a[124:127], a[252:255], v[156:159], a[124:127]
  s_cbranch_vccnz Lst3
Lst3r:
  s_cmp_ge_u32 s50, s54
  s_cbranch_scc1 Ltrans
  s_sub_u32 s35, s54, 4
  s_cmp_ge_u32 s50, s35
  s_cbranch_scc1 Ld1
.p2align 6
Ll1:
  s_waitcnt lgkmcnt(0)
  v_mfma_f32_16x16x32_bf16 v[32:35], a[192:195], v[160:163], v[96:99]
  v_exp_f32 v24, v48
  v_mfma_f32_16x16x32_bf16 v[32:35], a[196:199], v[164:167], v[32:35]
  v_add_f32 v16, v16, v240
  v_add_f32 v18, v18, v248
  v_mfma_f32_16x16x32_bf16 v[32:35], a[200:203], v[168:171], v[32:35]
  v_exp_f32_e64 v25, v49
  v_mfma_f32_16x16x32_bf16 v[32:35], a[204:207], v[172:175], v[32:35]
  v_add_f32 v17, v17, v244
  v_add_f32 v19, v19, v249
  v_mfma_f32_16x16x32_bf16 v[40:43], a[192:195], v[176:179], v[104:107]
  v_exp_f32_e64 v26, v50
  v_mfma_f32_16x16x32_bf16 v[40:43], a[196:199], v[180:183], v[40:43]
  ds_read_b128 a[224:227], v11 offset:0
  v_cvt_pk_bf16_f32 v136, v24, v25
  v_mfma_f32_16x16x32_bf16 v[40:43], a[200:203], v[184:187], v[40:43]
  v_exp_f32_e64 v27, v51
  v_mfma_f32_16x16x32_bf16 v[40:43], a[204:207], v[188:191], v[40:43]
  ds_read_b128 a[228:231], v11 offset:1024
  v_cvt_pk_bf16_f32 v137, v26, v27
  v_mfma_f32_16x16x32_bf16 v[64:67], a[192:195], v[192:195], v[112:115]
  v_exp_f32_e64 v28, v52
  v_mfma_f32_16x16x32_bf16 v[64:67], a[196:199], v[196:199], v[64:67]
  s_and_b32 m0, s49, 0x1ffff
  v_mfma_f32_16x16x32_bf16 v[64:67], a[200:203], v[200:203], v[64:67]
  v_exp_f32_e64 v29, v53
  v_mfma_f32_16x16x32_bf16 v[64:67], a[204:207], v[204:207], v[64:67]
  v_exp_f32_e64 v24, v54
  v_mfma_f32_16x16x32_bf16 v[72:75], a[192:195], v[208:211], v[120:123]
  ds_read_b128 a[232:235], v11 offset:2048
  v_cvt_pk_bf16_f32 v138, v28, v29
  v_mfma_f32_16x16x32_bf16 v[72:75], a[196:199], v[212:215], v[72:75]
  v_exp_f32_e64 v25, v55
  v_mfma_f32_16x16x32_bf16 v[72:75], a[200:203], v[216:219], v[72:75]
  buffer_load_dwordx4 v1, s[16:19], s49 offen offset:0 sc1 lds
  v_mfma_f32_16x16x32_bf16 v[72:75], a[204:207], v[220:223], v[72:75]
  v_exp_f32_e64 v26, v56
  v_mfma_f32_16x16x32_bf16 v[36:39], a[208:211], v[160:163], v[100:103]
  ds_read_b128 a[236:239], v11 offset:3072
  v_cvt_pk_bf16_f32 v139, v24, v25
  v_mfma_f32_16x16x32_bf16 v[36:39], a[212:215], v[164:167], v[36:39]
  v_exp_f32_e64 v27, v57
  v_mfma_f32_16x16x32_bf16 v[240:243], v[252:255], v[136:139], 0
  ds_read_b128 a[240:243], v11 offset:4096
  v_cvt_pk_bf16_f32 v140, v26, v27
  v_mfma_f32_16x16x32_bf16 v[36:39], a[216:219], v[168:171], v[36:39]
  v_exp_f32_e64 v28, v58
  v_mfma_f32_16x16x32_bf16 v[36:39], a[220:223], v[172:175], v[36:39]
  v_exp_f32_e64 v29, v59
  v_mfma_f32_16x16x32_bf16 v[44:47], a[208:211], v[176:179], v[108:111]
  ds_read_b128 a[244:247], v11 offset:5120
  v_cvt_pk_bf16_f32 v141, v28, v29
  v_mfma_f32_16x16x32_bf16 v[44:47], a[212:215], v[180:183], v[44:47]
  v_exp_f32_e64 v24, v60
  v_mfma_f32_16x16x32_bf16 v[44:47], a[216:219], v[184:187], v[44:47]
  ds_read_b128 a[248:251], v11 offset:6144
  v_mov_b32_e64 v248, v240
  v_mfma_f32_16x16x32_bf16 v[44:47], a[220:223], v[188:191], v[44:47]
  v_exp_f32_e64 v25, v61
  v_mfma_f32_16x16x32_bf16 v[68:71], a[208:211], v[192:195], v[116:119]
  buffer_load_dwordx4 v1, s[16:19], s49 offen offset:1024 sc1 lds
  v_mfma_f32_16x16x32_bf16 v[68:71], a[212:215], v[196:199], v[68:71]
  v_exp_f32_e64 v26, v62
  v_mfma_f32_16x16x32_bf16 v[68:71], a[216:219], v[200:203], v[68:71]
  ds_read_b128 a[252:255], v11 offset:7168
  v_cvt_pk_bf16_f32 v142, v24, v25
  v_mfma_f32_16x16x32_bf16 v[68:71], a[220:223], v[204:207], v[68:71]
  v_exp_f32_e64 v27, v63
  v_mfma_f32_16x16x32_bf16 v[76:79], a[208:211], v[208:211], v[124:127]
  v_exp_f32_e64 v28, v80
  v_mfma_f32_16x16x32_bf16 v[76:79], a[212:215], v[212:215], v[76:79]
  buffer_load_dwordx4 v1, s[16:19], s49 offen offset:2048 sc1 lds
  v_mfma_f32_16x16x32_bf16 v[76:79], a[216:219], v[216:219], v[76:79]
  v_exp_f32_e64 v29, v81
  v_mfma_f32_16x16x32_bf16 v[76:79], a[220:223], v[220:223], v[76:79]
  v_cvt_pk_bf16_f32 v143, v26, v27
  buffer_load_dwordx4 v1, s[16:19], s49 offen offset:3072 sc1 lds
  s_waitcnt lgkmcnt(0)
  v_mfma_f32_16x16x32_bf16 a[0:3], a[224:227], v[128:131], a[0:3]
  v_exp_f32 v24, v82
  v_mfma_f32_16x16x32_bf16 v[244:247], v[252:255], v[140:143], 0
  v_cvt_pk_bf16_f32 v152, v28, v29
  v_mfma_f32_16x16x32_bf16 a[32:35], a[224:227], v[132:135], a[32:35]
  v_exp_f32_e64 v25, v83
  v_mfma_f32_16x16x32_bf16 a[64:67], a[224:227], v[144:147], a[64:67]
  ds_read_b128 a[192:195], v10 offset:8192
  v_cvt_pk_bf16_f32 v153, v24, v25
  v_mfma_f32_16x16x32_bf16 a[96:99], a[224:227], v[148:151], a[96:99]
  v_exp_f32_e64 v26, v84
  v_mfma_f32_16x16x32_bf16 a[4:7], a[228:231], v[128:131], a[4:7]
  v_exp_f32_e64 v27, v85
  v_mfma_f32_16x16x32_bf16 a[36:39], a[228:231], v[132:135], a[36:39]
  v_mov_b32_e64 v249, v244
  v_cvt_pk_bf16_f32 v154, v26, v27
  v_mfma_f32_16x16x32_bf16 a[68:71], a[228:231], v[144:147], a[68:71]
  v_exp_f32_e64 v28, v86
  v_mfma_f32_16x16x32_bf16 a[100:103], a[228:231], v[148:151], a[100:103]
  ds_read_b128 a[196:199], v10 offset:9216
  ds_read_b128 a[200:203], v10 offset:10240
  v_mfma_f32_16x16x32_bf16 a[8:11], a[232:235], v[128:131], a[8:11]
  v_exp_f32_e64 v29, v87
  v_mfma_f32_16x16x32_bf16 a[40:43], a[232:235], v[132:135], a[40:43]
  ds_read_b128 a[204:207], v10 offset:11264
  v_cvt_pk_bf16_f32 v155, v28, v29
  v_mfma_f32_16x16x32_bf16 a[72:75], a[232:235], v[144:147], a[72:75]
  v_exp_f32_e64 v24, v88
  v_mfma_f32_16x16x32_bf16 v[240:243], v[252:255], v[152:155], 0
  ds_read_b128 a[208:211], v10 offset:12288
  v_mfma_f32_16x16x32_bf16 a[104:107], a[232:235], v[148:151], a[104:107]
  v_exp_f32_e64 v25, v89
  v_mfma_f32_16x16x32_bf16 a[12:15], a[236:239], v[128:131], a[12:15]
  v_exp_f32_e64 v26, v90
  v_mfma_f32_16x16x32_bf16 a[44:47], a[236:239], v[132:135], a[44:47]
  ds_read_b128 a[212:215], v10 offset:13312
  v_cvt_pk_bf16_f32 v156, v24, v25
  v_mfma_f32_16x16x32_bf16 a[76:79], a[236:239], v[144:147], a[76:79]
  v_exp_f32_e64 v27, v91
  v_mfma_f32_16x16x32_bf16 a[108:111], a[236:239], v[148:151], a[108:111]
  ds_read_b128 a[216:219], v10 offset:14336
  v_cvt_pk_bf16_f32 v157, v26, v27
  v_mfma_f32_16x16x32_bf16 a[16:19], a[240:243], v[128:131], a[16:19]
  v_exp_f32_e64 v28, v92
  v_mfma_f32_16x16x32_bf16 a[48:51], a[240:243], v[132:135], a[48:51]
  ds_read_b128 a[220:223], v10 offset:15360
  s_add_u32 s50, s50, 1
  v_mfma_f32_16x16x32_bf16 a[80:83], a[240:243], v[144:147], a[80:83]
  v_exp_f32 v29, v93
  v_mfma_f32_16x16x32_bf16 a[112:115], a[240:243], v[148:151], a[112:115]
  v_cvt_pk_bf16_f32 v158, v28, v29
  s_add_u32 s49, s49, 32768
  v_mfma_f32_16x16x32_bf16 a[20:23], a[244:247], v[128:131], a[20:23]
  v_exp_f32_e64 v24, v94
  v_mfma_f32_16x16x32_bf16 a[52:55], a[244:247], v[132:135], a[52:55]
  v_exp_f32_e64 v25, v95
  v_mfma_f32_16x16x32_bf16 a[84:87], a[244:247], v[144:147], a[84:87]
  v_cvt_pk_bf16_f32 v159, v24, v25
  v_mfma_f32_16x16x32_bf16 a[116:119], a[244:247], v[148:151], a[116:119]
  v_mfma_f32_16x16x32_bf16 a[24:27], a[248:251], v[128:131], a[24:27]
  v_add_u32 v10, 0x8000, v10
  v_and_b32 v10, 0x1ffff, v10
  v_mfma_f32_16x16x32_bf16 v[244:247], v[252:255], v[156:159], 0
  v_mfma_f32_16x16x32_bf16 a[56:59], a[248:251], v[132:135], a[56:59]
  v_mfma_f32_16x16x32_bf16 a[88:91], a[248:251], v[144:147], a[88:91]
  v_mfma_f32_16x16x32_bf16 a[120:123], a[248:251], v[148:151], a[120:123]
  v_mfma_f32_16x16x32_bf16 a[28:31], a[252:255], v[128:131], a[28:31]
  v_mfma_f32_16x16x32_bf16 a[60:63], a[252:255], v[132:135], a[60:63]
  v_mfma_f32_16x16x32_bf16 a[92:95], a[252:255], v[144:147], a[92:95]
  s_nop 1
  v_max3_f32 v15, v248, v249, v240
  v_max_f32 v15, v15, v244
  v_cmp_lt_f32_e64 vcc, s55, v15
  v_mfma_f32_16x16x32_bf16 a[124:127], a[252:255], v[148:151], a[124:127]
  s_cbranch_vccnz Lst4
Lst4r:
  s_waitcnt lgkmcnt(0)
  v_mfma_f32_16x16x32_bf16 v[48:51], a[192:195], v[160:163], v[96:99]
  v_exp_f32_e64 v24, v32
  v_mfma_f32_16x16x32_bf16 v[48:51], a[196:199], v[164:167], v[48:51]
  v_add_f32 v16, v16, v240
  v_add_f32 v18, v18, v248
  v_mfma_f32_16x16x32_bf16 v[48:51], a[200:203], v[168:171], v[48:51]
  v_exp_f32_e64 v25, v33
  v_mfma_f32_16x16x32_bf16 v[48:51], a[204:207], v[172:175], v[48:51]
  v_add_f32 v17, v17, v244
  v_add_f32 v19, v19, v249
  v_mfma_f32_16x16x32_bf16 v[56:59], a[192:195], v[176:179], v[104:107]
  v_exp_f32_e64 v26, v34
  v_mfma_f32_16x16x32_bf16 v[56:59], a[196:199], v[180:183], v[56:59]
  ds_read_b128 a[224:227], v11 offset:8192
  v_cvt_pk_bf16_f32 v128, v24, v25
  v_mfma_f32_16x16x32_bf16 v[56:59], a[200:203], v[184:187], v[56:59]
  v_exp_f32_e64 v27, v35
  v_mfma_f32_16x16x32_bf16 v[56:59], a[204:207], v[188:191], v[56:59]
  ds_read_b128 a[228:231], v11 offset:9216
  v_cvt_pk_bf16_f32 v129, v26, v27
  v_mfma_f32_16x16x32_bf16 v[80:83], a[192:195], v[192:195], v[112:115]
  v_exp_f32_e64 v28, v36
  v_mfma_f32_16x16x32_bf16 v[80:83], a[196:199], v[196:199], v[80:83]
  ds_read_b128 a[232:235], v11 offset:10240
  ds_read_b128 a[236:239], v11 offset:11264
  v_mfma_f32_16x16x32_bf16 v[80:83], a[200:203], v[200:203], v[80:83]
  v_exp_f32_e64 v29, v37
  v_mfma_f32_16x16x32_bf16 v[80:83], a[204:207], v[204:207], v[80:83]
  v_exp_f32_e64 v24, v38
  v_mfma_f32_16x16x32_bf16 v[88:91], a[192:195], v[208:211], v[120:123]
  ds_read_b128 a[240:243], v11 offset:12288
  v_cvt_pk_bf16_f32 v130, v28, v29
  v_mfma_f32_16x16x32_bf16 v[88:91], a[196:199], v[212:215], v[88:91]
  v_exp_f32_e64 v25, v39
  v_mfma_f32_16x16x32_bf16 v[88:91], a[200:203], v[216:219], v[88:91]
  ds_read_b128 a[244:247], v11 offset:13312
  v_cvt_pk_bf16_f32 v131, v24, v25
  v_mfma_f32_16x16x32_bf16 v[88:91], a[204:207], v[220:223], v[88:91]
  v_exp_f32_e64 v26, v40
  v_mfma_f32_16x16x32_bf16 v[240:243], v[252:255], v[128:131], 0
  ds_read_b128 a[248:251], v11 offset:14336
  ds_read_b128 a[252:255], v11 offset:15360
  v_mfma_f32_16x16x32_bf16 v[52:55], a[208:211], v[160:163], v[100:103]
  v_exp_f32_e64 v27, v41
  v_mfma_f32_16x16x32_bf16 v[52:55], a[212:215], v[164:167], v[52:55]
  v_cvt_pk_bf16_f32 v132, v26, v27
  v_mfma_f32_16x16x32_bf16 v[52:55], a[216:219], v[168:171], v[52:55]
  v_exp_f32_e64 v28, v42
  v_mfma_f32_16x16x32_bf16 v[52:55], a[220:223], v[172:175], v[52:55]
  v_exp_f32_e64 v29, v43
  v_mfma_f32_16x16x32_bf16 v[60:63], a[208:211], v[176:179], v[108:111]
  v_mov_b32_e64 v248, v240
  v_cvt_pk_bf16_f32 v133, v28, v29
  v_mfma_f32_16x16x32_bf16 v[60:63], a[212:215], v[180:183], v[60:63]
  v_exp_f32_e64 v24, v44
  v_mfma_f32_16x16x32_bf16 v[60:63], a[216:219], v[184:187], v[60:63]
  v_mfma_f32_16x16x32_bf16 v[60:63], a[220:223], v[188:191], v[60:63]
  v_exp_f32_e64 v25, v45
  v_mfma_f32_16x16x32_bf16 v[84:87], a[208:211], v[192:195], v[116:119]
  v_cvt_pk_bf16_f32 v134, v24, v25
  v_mfma_f32_16x16x32_bf16 v[84:87], a[212:215], v[196:199], v[84:87]
  v_exp_f32_e64 v26, v46
  v_mfma_f32_16x16x32_bf16 v[84:87], a[216:219], v[200:203], v[84:87]
  v_mfma_f32_16x16x32_bf16 v[84:87], a[220:223], v[204:207], v[84:87]
  v_exp_f32_e64 v27, v47
  v_mfma_f32_16x16x32_bf16 v[92:95], a[208:211], v[208:211], v[124:127]
  v_exp_f32_e64 v28, v64
  v_mfma_f32_16x16x32_bf16 v[92:95], a[212:215], v[212:215], v[92:95]
  v_cvt_pk_bf16_f32 v135, v26, v27
  v_mfma_f32_16x16x32_bf16 v[92:95], a[216:219], v[216:219], v[92:95]
  v_exp_f32_e64 v29, v65
  v_mfma_f32_16x16x32_bf16 v[244:247], v[252:255], v[132:135], 0
  v_cvt_pk_bf16_f32 v144, v28, v29
  v_mfma_f32_16x16x32_bf16 v[92:95], a[220:223], v[220:223], v[92:95]
  s_waitcnt vmcnt(16) lgkmcnt(0)
  v_mfma_f32_16x16x32_bf16 a[0:3], a[224:227], v[136:139], a[0:3]
  s_barrier
  v_mfma_f32_16x16x32_bf16 a[32:35], a[224:227], v[140:143], a[32:35]
  v_exp_f32_e64 v24, v66
  v_mfma_f32_16x16x32_bf16 a[64:67], a[224:227], v[152:155], a[64:67]
  v_exp_f32_e64 v25, v67
  v_mfma_f32_16x16x32_bf16 a[96:99], a[224:227], v[156:159], a[96:99]
  v_exp_f32_e64 v26, v68
  v_mfma_f32_16x16x32_bf16 a[4:7], a[228:231], v[136:139], a[4:7]
  v_exp_f32_e64 v27, v69
  v_mfma_f32_16x16x32_bf16 a[36:39], a[228:231], v[140:143], a[36:39]
  v_mov_b32_e64 v249, v244
  v_cvt_pk_bf16_f32 v145, v24, v25
  v_mfma_f32_16x16x32_bf16 a[68:71], a[228:231], v[152:155], a[68:71]
  v_exp_f32_e64 v28, v70
  v_mfma_f32_16x16x32_bf16 a[100:103], a[228:231], v[156:159], a[100:103]
  ds_read_b128 a[192:195], v10 offset:0
  v_cvt_pk_bf16_f32 v146, v26, v27
  v_mfma_f32_16x16x32_bf16 a[8:11], a[232:235], v[136:139], a[8:11]
  v_exp_f32_e64 v29, v71
  v_mfma_f32_16x16x32_bf16 a[40:43], a[232:235], v[140:143], a[40:43]
  v_cvt_pk_bf16_f32 v147, v28, v29
  s_and_b32 m0, s48, 0x1ffff
  v_mfma_f32_16x16x32_bf16 a[72:75], a[232:235], v[152:155], a[72:75]
  v_exp_f32_e64 v24, v72
  v_mfma_f32_16x16x32_bf16 v[240:243], v[252:255], v[144:147], 0
  ds_read_b128 a[196:199], v10 offset:1024
  ds_read_b128 a[200:203], v10 offset:2048
  v_mfma_f32_16x16x32_bf16 a[104:107], a[232:235], v[156:159], a[104:107]
  v_exp_f32_e64 v25, v73
  v_mfma_f32_16x16x32_bf16 a[12:15], a[236:239], v[136:139], a[12:15]
  v_exp_f32_e64 v26, v74
  v_mfma_f32_16x16x32_bf16 a[44:47], a[236:239], v[140:143], a[44:47]
  buffer_load_dwordx4 v1, s[16:19], s48 offen offset:0 sc1 lds
  v_mfma_f32_16x16x32_bf16 a[76:79], a[236:239], v[152:155], a[76:79]
  v_exp_f32_e64 v27, v75
  v_mfma_f32_16x16x32_bf16 a[108:111], a[236:239], v[156:159], a[108:111]
  v_cvt_pk_bf16_f32 v148, v24, v25
  v_cvt_pk_bf16_f32 v149, v26, v27
  v_mfma_f32_16x16x32_bf16 a[16:19], a[240:243], v[136:139], a[16:19]
  v_exp_f32_e64 v28, v76
  v_mfma_f32_16x16x32_bf16 a[48:51], a[240:243], v[140:143], a[48:51]
  ds_read_b128 a[204:207], v10 offset:3072
  ds_read_b128 a[208:211], v10 offset:4096
  v_mfma_f32_16x16x32_bf16 a[80:83], a[240:243], v[152:155], a[80:83]
  v_exp_f32_e64 v29, v77
  v_mfma_f32_16x16x32_bf16 a[112:115], a[240:243], v[156:159], a[112:115]
  ds_read_b128 a[212:215], v10 offset:5120
  v_cvt_pk_bf16_f32 v150, v28, v29
  v_mfma_f32_16x16x32_bf16 a[20:23], a[244:247], v[136:139], a[20:23]
  v_exp_f32_e64 v24, v78
  v_mfma_f32_16x16x32_bf16 a[52:55], a[244:247], v[140:143], a[52:55]
  v_exp_f32_e64 v25, v79
  v_mfma_f32_16x16x32_bf16 a[84:87], a[244:247], v[152:155], a[84:87]
  ds_read_b128 a[216:219], v10 offset:6144
  v_cvt_pk_bf16_f32 v151, v24, v25
  v_mfma_f32_16x16x32_bf16 a[116:119], a[244:247], v[156:159], a[116:119]
  buffer_load_dwordx4 v1, s[16:19], s48 offen offset:1024 sc1 lds
  v_mfma_f32_16x16x32_bf16 v[244:247], v[252:255], v[148:151], 0
  ds_read_b128 a[220:223], v10 offset:7168
  s_add_u32 s50, s50, 1
  v_mfma_f32_16x16x32_bf16 a[24:27], a[248:251], v[136:139], a[24:27]
  v_add_u32 v11, 0x8000, v11
  v_and_b32 v11, 0x1ffff, v11
  v_mfma_f32_16x16x32_bf16 a[56:59], a[248:251], v[140:143], a[56:59]
  buffer_load_dwordx4 v1, s[16:19], s48 offen offset:2048 sc1 lds
  v_mfma_f32_16x16x32_bf16 a[88:91], a[248:251], v[152:155], a[88:91]
  s_cmp_ge_u32 s50, s53
  s_cbranch_scc1 Lst5
Lst5r:
  v_mfma_f32_16x16x32_bf16 a[120:123], a[248:251], v[156:159], a[120:123]
  buffer_load_dwordx4 v1, s[16:19], s48 offen offset:3072 sc1 lds
  v_mfma_f32_16x16x32_bf16 a[28:31], a[252:255], v[136:139], a[28:31]
  s_add_u32 s48, s48, 32768
  v_max3_f32 v15, v248, v249, v240
  v_mfma_f32_16x16x32_bf16 a[60:63], a[252:255], v[140:143], a[60:63]
  v_max_f32 v15, v15, v244
  v_cmp_lt_f32_e64 vcc, s55, v15
  v_mfma_f32_16x16x32_bf16 a[92:95], a[252:255], v[152:155], a[92:95]
  v_mfma_f32_16x16x32_bf16 a[124:127], a[252:255], v[156:159], a[124:127]
  s_cbranch_vccnz Lst6
Lst6r:
  s_cmp_lt_u32 s50, s35
  s_cbranch_scc1 Ll1
Ld1:
  s_cmp_gt_u32 s50, s51
  s_cselect_b64 s[26:27], -1, 0
  s_cmp_ge_u32 s50, s51
  s_cselect_b64 s[24:25], -1, 0
  v_cndmask_b32 v236, -v22, v12, s[26:27]
  v_cndmask_b32 v238, -v22, v12, s[24:25]
  v_cndmask_b32 v237, -v23, v12, s[26:27]
  v_cndmask_b32 v239, -v23, v12, s[24:25]
  v_cndmask_b32 v96, v236, v238, s[64:65]
  v_cndmask_b32 v97, v236, v238, s[66:67]
  v_cndmask_b32 v98, v236, v238, s[68:69]
  v_cndmask_b32 v99, v236, v238, s[70:71]
  v_cndmask_b32 v100, v236, v238, s[72:73]
  v_cndmask_b32 v101, v236, v238, s[74:75]
  v_cndmask_b32 v102, v236, v238, s[76:77]
  v_cndmask_b32 v103, v236, v238, s[78:79]
  v_cndmask_b32 v104, v237, v239, s[80:81]
  v_cndmask_b32 v105, v237, v239, s[82:83]
  v_cndmask_b32 v106, v237, v239, s[84:85]
  v_cndmask_b32 v107, v237, v239, s[86:87]
  v_cndmask_b32 v108, v237, v239, s[88:89]
  v_cndmask_b32 v109, v237, v239, s[90:91]
  v_cndmask_b32 v110, v237, v239, s[92:93]
  v_cndmask_b32 v111, v237, v239, s[94:95]
  s_nop 1
Ld1l:
  s_waitcnt lgkmcnt(0)
  v_mfma_f32_16x16x32_bf16 v[32:35], a[192:195], v[160:163], v[96:99]
  ds_read_b128 a[224:227], v11 offset:0
  v_exp_f32 v24, v48
  v_mfma_f32_16x16x32_bf16 v[32:35], a[196:199], v[164:167], v[32:35]
  v_add_f32 v16, v16, v240
  v_add_f32 v18, v18, v248
  v_mfma_f32_16x16x32_bf16 v[32:35], a[200:203], v[168:171], v[32:35]
  v_exp_f32_e64 v25, v49
  v_mfma_f32_16x16x32_bf16 v[32:35], a[204:207], v[172:175], v[32:35]
  v_add_f32 v17, v17, v244
  v_add_f32 v19, v19, v249
  v_mfma_f32_16x16x32_bf16 v[40:43], a[192:195], v[176:179], v[104:107]
  v_exp_f32_e64 v26, v50
  v_mfma_f32_16x16x32_bf16 v[40:43], a[196:199], v[180:183], v[40:43]
  ds_read_b128 a[228:231], v11 offset:1024
  v_cvt_pk_bf16_f32 v136, v24, v25
  s_and_b32 m0, s49, 0x1ffff
  v_mfma_f32_16x16x32_bf16 v[40:43], a[200:203], v[184:187], v[40:43]
  v_exp_f32_e64 v27, v51
  v_mfma_f32_16x16x32_bf16 v[40:43], a[204:207], v[188:191], v[40:43]
  ds_read_b128 a[232:235], v11 offset:2048
  v_cvt_pk_bf16_f32 v137, v26, v27
  v_mfma_f32_16x16x32_bf16 v[64:67], a[192:195], v[192:195], v[112:115]
  v_exp_f32_e64 v28, v52
  v_mfma_f32_16x16x32_bf16 v[64:67], a[196:199], v[196:199], v[64:67]
  buffer_load_dwordx4 v1, s[16:19], s49 offen offset:0 sc1 lds
  v_mfma_f32_16x16x32_bf16 v[64:67], a[200:203], v[200:203], v[64:67]
  v_exp_f32_e64 v29, v53
  v_mfma_f32_16x16x32_bf16 v[64:67], a[204:207], v[204:207], v[64:67]
  ds_read_b128 a[236:239], v11 offset:3072
  v_exp_f32_e64 v24, v54
  v_mfma_f32_16x16x32_bf16 v[72:75], a[192:195], v[208:211], v[120:123]
  ds_read_b128 a[240:243], v11 offset:4096
  v_cvt_pk_bf16_f32 v138, v28, v29
  v_mfma_f32_16x16x32_bf16 v[72:75], a[196:199], v[212:215], v[72:75]
  v_exp_f32_e64 v25, v55
  v_mfma_f32_16x16x32_bf16 v[72:75], a[200:203], v[216:219], v[72:75]
  ds_read_b128 a[244:247], v11 offset:5120
  v_cvt_pk_bf16_f32 v139, v24, v25
  v_mfma_f32_16x16x32_bf16 v[72:75], a[204:207], v[220:223], v[72:75]
  v_exp_f32_e64 v26, v56
  v_mfma_f32_16x16x32_bf16 v[240:243], v[252:255], v[136:139], 0
  ds_read_b128 a[248:251], v11 offset:6144
  buffer_load_dwordx4 v1, s[16:19], s49 offen offset:1024 sc1 lds
  v_mfma_f32_16x16x32_bf16 v[36:39], a[208:211], v[160:163], v[100:103]
  v_exp_f32_e64 v27, v57
  v_mfma_f32_16x16x32_bf16 v[36:39], a[212:215], v[164:167], v[36:39]
  ds_read_b128 a[252:255], v11 offset:7168
  v_cvt_pk_bf16_f32 v140, v26, v27
  v_mfma_f32_16x16x32_bf16 v[36:39], a[216:219], v[168:171], v[36:39]
  v_exp_f32_e64 v28, v58
  v_mfma_f32_16x16x32_bf16 v[36:39], a[220:223], v[172:175], v[36:39]
  v_exp_f32_e64 v29, v59
  v_mfma_f32_16x16x32_bf16 v[44:47], a[208:211], v[176:179], v[108:111]
  v_mov_b32_e64 v248, v240
  v_cvt_pk_bf16_f32 v141, v28, v29
  v_mfma_f32_16x16x32_bf16 v[44:47], a[212:215], v[180:183], v[44:47]
  v_exp_f32 v24, v60
  s_add_u32 s50, s50, 1
  v_mfma_f32_16x16x32_bf16 v[44:47], a[216:219], v[184:187], v[44:47]
  buffer_load_dwordx4 v1, s[16:19], s49 offen offset:2048 sc1 lds
  v_mfma_f32_16x16x32_bf16 v[44:47], a[220:223], v[188:191], v[44:47]
  v_exp_f32_e64 v25, v61
  v_mfma_f32_16x16x32_bf16 v[68:71], a[208:211], v[192:195], v[116:119]
  v_cvt_pk_bf16_f32 v142, v24, v25
  v_mfma_f32_16x16x32_bf16 v[68:71], a[212:215], v[196:199], v[68:71]
  v_exp_f32_e64 v26, v62
  v_mfma_f32_16x16x32_bf16 v[68:71], a[216:219], v[200:203], v[68:71]
  v_mfma_f32_16x16x32_bf16 v[68:71], a[220:223], v[204:207], v[68:71]
  v_exp_f32_e64 v27, v63
  v_mfma_f32_16x16x32_bf16 v[76:79], a[208:211], v[208:211], v[124:127]
  v_exp_f32_e64 v28, v80
  v_mfma_f32_16x16x32_bf16 v[76:79], a[212:215], v[212:215], v[76:79]
  buffer_load_dwordx4 v1, s[16:19], s49 offen offset:3072 sc1 lds
  v_mfma_f32_16x16x32_bf16 v[76:79], a[216:219], v[216:219], v[76:79]
  v_exp_f32_e64 v29, v81
  v_mfma_f32_16x16x32_bf16 v[76:79], a[220:223], v[220:223], v[76:79]
  v_cvt_pk_bf16_f32 v143, v26, v27
  s_waitcnt lgkmcnt(0)
  v_mfma_f32_16x16x32_bf16 a[0:3], a[224:227], v[128:131], a[0:3]
  v_exp_f32 v24, v82
  v_cvt_pk_bf16_f32 v152, v28, v29
  v_mfma_f32_16x16x32_bf16 v[244:247], v[252:255], v[140:143], 0
  v_mfma_f32_16x16x32_bf16 a[32:35], a[224:227], v[132:135], a[32:35]
  v_exp_f32_e64 v25, v83
  v_mfma_f32_16x16x32_bf16 a[64:67], a[224:227], v[144:147], a[64:67]
  ds_read_b128 a[192:195], v10 offset:8192
  v_cvt_pk_bf16_f32 v153, v24, v25
  v_mfma_f32_16x16x32_bf16 a[96:99], a[224:227], v[148:151], a[96:99]
  v_exp_f32_e64 v26, v84
  v_mfma_f32_16x16x32_bf16 a[4:7], a[228:231], v[128:131], a[4:7]
  ds_read_b128 a[196:199], v10 offset:9216
  v_exp_f32_e64 v27, v85
  v_mfma_f32_16x16x32_bf16 a[36:39], a[228:231], v[132:135], a[36:39]
  v_mov_b32_e64 v249, v244
  v_cvt_pk_bf16_f32 v154, v26, v27
  v_mfma_f32_16x16x32_bf16 a[68:71], a[228:231], v[144:147], a[68:71]
  v_exp_f32_e64 v28, v86
  v_mfma_f32_16x16x32_bf16 a[100:103], a[228:231], v[148:151], a[100:103]
  ds_read_b128 a[200:203], v10 offset:10240
  s_cmp_gt_u32 s50, s51
  s_cselect_b64 s[26:27], -1, 0
  v_mfma_f32_16x16x32_bf16 a[8:11], a[232:235], v[128:131], a[8:11]
  ds_read_b128 a[204:207], v10 offset:11264
  v_mfma_f32_16x16x32_bf16 a[40:43], a[232:235], v[132:135], a[40:43]
  v_exp_f32_e64 v29, v87
  v_mfma_f32_16x16x32_bf16 a[72:75], a[232:235], v[144:147], a[72:75]
  ds_read_b128 a[208:211], v10 offset:12288
  v_exp_f32_e64 v24, v88
  v_mfma_f32_16x16x32_bf16 a[104:107], a[232:235], v[148:151], a[104:107]
  v_cvt_pk_bf16_f32 v155, v28, v29
  s_cmp_ge_u32 s50, s51
  s_cselect_b64 s[24:25], -1, 0
  v_mfma_f32_16x16x32_bf16 v[240:243], v[252:255], v[152:155], 0
  v_cndmask_b32 v236, -v22, v12, s[26:27]
  v_mfma_f32_16x16x32_bf16 a[12:15], a[236:239], v[128:131], a[12:15]
  v_exp_f32_e64 v25, v89
  v_mfma_f32_16x16x32_bf16 a[44:47], a[236:239], v[132:135], a[44:47]
  v_exp_f32_e64 v26, v90
  v_mfma_f32_16x16x32_bf16 a[76:79], a[236:239], v[144:147], a[76:79]
  ds_read_b128 a[212:215], v10 offset:13312
  v_exp_f32_e64 v27, v91
  v_mfma_f32_16x16x32_bf16 a[108:111], a[236:239], v[148:151], a[108:111]
  v_cvt_pk_bf16_f32 v156, v24, v25
  v_cvt_pk_bf16_f32 v157, v26, v27
  v_mfma_f32_16x16x32_bf16 a[16:19], a[240:243], v[128:131], a[16:19]
  v_exp_f32_e64 v28, v92
  v_mfma_f32_16x16x32_bf16 a[48:51], a[240:243], v[132:135], a[48:51]
  ds_read_b128 a[216:219], v10 offset:14336
  ds_read_b128 a[220:223], v10 offset:15360
  v_mfma_f32_16x16x32_bf16 a[80:83], a[240:243], v[144:147], a[80:83]
  v_exp_f32_e64 v29, v93
  v_mfma_f32_16x16x32_bf16 a[112:115], a[240:243], v[148:151], a[112:115]
  v_cvt_pk_bf16_f32 v158, v28, v29
  s_add_u32 s49, s49, 32768
  v_mfma_f32_16x16x32_bf16 a[20:23], a[244:247], v[128:131], a[20:23]
  v_exp_f32_e64 v24, v94
  v_cndmask_b32 v238, -v22, v12, s[24:25]
  v_mfma_f32_16x16x32_bf16 a[52:55], a[244:247], v[132:135], a[52:55]
  v_exp_f32_e64 v25, v95
  v_mfma_f32_16x16x32_bf16 a[84:87], a[244:247], v[144:147], a[84:87]
  v_cvt_pk_bf16_f32 v159, v24, v25
  v_cndmask_b32 v237, -v23, v12, s[26:27]
  v_mfma_f32_16x16x32_bf16 a[116:119], a[244:247], v[148:151], a[116:119]
  v_cndmask_b32 v239, -v23, v12, s[24:25]
  v_cndmask_b32 v96, v236, v238, s[64:65]
  v_mfma_f32_16x16x32_bf16 v[244:247], v[252:255], v[156:159], 0
  v_cndmask_b32 v97, v236, v238, s[66:67]
  v_cndmask_b32 v98, v236, v238, s[68:69]
  v_mfma_f32_16x16x32_bf16 a[24:27], a[248:251], v[128:131], a[24:27]
  v_add_u32 v10, 0x8000, v10
  v_and_b32 v10, 0x1ffff, v10
  v_cndmask_b32 v99, v236, v238, s[70:71]
  v_mfma_f32_16x16x32_bf16 a[56:59], a[248:251], v[132:135], a[56:59]
  v_cndmask_b32 v100, v236, v238, s[72:73]
  v_cndmask_b32 v101, v236, v238, s[74:75]
  v_mfma_f32_16x16x32_bf16 a[88:91], a[248:251], v[144:147], a[88:91]
  v_cndmask_b32 v102, v236, v238, s[76:77]
  v_cndmask_b32 v103, v236, v238, s[78:79]
  v_mfma_f32_16x16x32_bf16 a[120:123], a[248:251], v[148:151], a[120:123]
  v_cndmask_b32 v104, v237, v239, s[80:81]
  v_cndmask_b32 v105, v237, v239, s[82:83]
  v_mfma_f32_16x16x32_bf16 a[28:31], a[252:255], v[128:131], a[28:31]
  v_cndmask_b32 v106, v237, v239, s[84:85]
  v_cndmask_b32 v107, v237, v239, s[86:87]
  v_mfma_f32_16x16x32_bf16 a[60:63], a[252:255], v[132:135], a[60:63]
  v_cndmask_b32 v108, v237, v239, s[88:89]
  v_cndmask_b32 v109, v237, v239, s[90:91]
  v_mfma_f32_16x16x32_bf16 a[92:95], a[252:255], v[144:147], a[92:95]
  v_cndmask_b32 v110, v237, v239, s[92:93]
  v_cndmask_b32 v111, v237, v239, s[94:95]
  v_max3_f32 v15, v248, v249, v240
  v_max_f32 v15, v15, v244
  v_cmp_lt_f32 vcc, s55, v15
  v_mfma_f32_16x16x32_bf16 a[124:127], a[252:255], v[148:151], a[124:127]
  s_cbranch_vccnz Lst7
Lst7r:
  s_waitcnt lgkmcnt(0)
  v_mfma_f32_16x16x32_bf16 v[48:51], a[192:195], v[160:163], v[96:99]
  ds_read_b128 a[224:227], v11 offset:8192
  v_exp_f32_e64 v24, v32
  v_mfma_f32_16x16x32_bf16 v[48:51], a[196:199], v[164:167], v[48:51]
  v_add_f32 v16, v16, v240
  v_add_f32 v18, v18, v248
  v_mfma_f32_16x16x32_bf16 v[48:51], a[200:203], v[168:171], v[48:51]
  v_exp_f32_e64 v25, v33
  v_mfma_f32_16x16x32_bf16 v[48:51], a[204:207], v[172:175], v[48:51]
  v_add_f32 v17, v17, v244
  v_add_f32 v19, v19, v249
  v_mfma_f32_16x16x32_bf16 v[56:59], a[192:195], v[176:179], v[104:107]
  ds_read_b128 a[228:231], v11 offset:9216
  v_exp_f32_e64 v26, v34
  v_mfma_f32_16x16x32_bf16 v[56:59], a[196:199], v[180:183], v[56:59]
  ds_read_b128 a[232:235], v11 offset:10240
  v_cvt_pk_bf16_f32 v128, v24, v25
  v_mfma_f32_16x16x32_bf16 v[56:59], a[200:203], v[184:187], v[56:59]
  v_exp_f32_e64 v27, v35
  v_mfma_f32_16x16x32_bf16 v[56:59], a[204:207], v[188:191], v[56:59]
  ds_read_b128 a[236:239], v11 offset:11264
  v_cvt_pk_bf16_f32 v129, v26, v27
  v_mfma_f32_16x16x32_bf16 v[80:83], a[192:195], v[192:195], v[112:115]
  ds_read_b128 a[240:243], v11 offset:12288
  v_exp_f32_e64 v28, v36
  v_mfma_f32_16x16x32_bf16 v[80:83], a[196:199], v[196:199], v[80:83]
  v_mfma_f32_16x16x32_bf16 v[80:83], a[200:203], v[200:203], v[80:83]
  v_exp_f32_e64 v29, v37
  v_mfma_f32_16x16x32_bf16 v[80:83], a[204:207], v[204:207], v[80:83]
  v_exp_f32_e64 v24, v38
  v_mfma_f32_16x16x32_bf16 v[88:91], a[192:195], v[208:211], v[120:123]
  ds_read_b128 a[244:247], v11 offset:13312
  v_cvt_pk_bf16_f32 v130, v28, v29
  v_mfma_f32_16x16x32_bf16 v[88:91], a[196:199], v[212:215], v[88:91]
  ds_read_b128 a[248:251], v11 offset:14336
  v_exp_f32_e64 v25, v39
  v_mfma_f32_16x16x32_bf16 v[88:91], a[200:203], v[216:219], v[88:91]
  ds_read_b128 a[252:255], v11 offset:15360
  v_cvt_pk_bf16_f32 v131, v24, v25
  v_mfma_f32_16x16x32_bf16 v[88:91], a[204:207], v[220:223], v[88:91]
  v_exp_f32_e64 v26, v40
  v_mfma_f32_16x16x32_bf16 v[240:243], v[252:255], v[128:131], 0
  v_mfma_f32_16x16x32_bf16 v[52:55], a[208:211], v[160:163], v[100:103]
  v_exp_f32_e64 v27, v41
  v_mfma_f32_16x16x32_bf16 v[52:55], a[212:215], v[164:167], v[52:55]
  v_cvt_pk_bf16_f32 v132, v26, v27
  v_mfma_f32_16x16x32_bf16 v[52:55], a[216:219], v[168:171], v[52:55]
  v_exp_f32_e64 v28, v42
  v_mfma_f32_16x16x32_bf16 v[52:55], a[220:223], v[172:175], v[52:55]
  v_exp_f32_e64 v29, v43
  v_mfma_f32_16x16x32_bf16 v[60:63], a[208:211], v[176:179], v[108:111]
  v_mov_b32_e64 v248, v240
  v_cvt_pk_bf16_f32 v133, v28, v29
  v_mfma_f32_16x16x32_bf16 v[60:63], a[212:215], v[180:183], v[60:63]
  v_exp_f32 v24, v44
  s_add_u32 s50, s50, 1
  v_mfma_f32_16x16x32_bf16 v[60:63], a[216:219], v[184:187], v[60:63]
  v_mfma_f32_16x16x32_bf16 v[60:63], a[220:223], v[188:191], v[60:63]
  v_exp_f32_e64 v25, v45
  v_mfma_f32_16x16x32_bf16 v[84:87], a[208:211], v[192:195], v[116:119]
  v_cvt_pk_bf16_f32 v134, v24, v25
  v_mfma_f32_16x16x32_bf16 v[84:87], a[212:215], v[196:199], v[84:87]
  v_exp_f32_e64 v26, v46
  v_mfma_f32_16x16x32_bf16 v[84:87], a[216:219], v[200:203], v[84:87]
  v_mfma_f32_16x16x32_bf16 v[84:87], a[220:223], v[204:207], v[84:87]
  v_exp_f32_e64 v27, v47
  v_mfma_f32_16x16x32_bf16 v[92:95], a[208:211], v[208:211], v[124:127]
  v_exp_f32_e64 v28, v64
  v_mfma_f32_16x16x32_bf16 v[92:95], a[212:215], v[212:215], v[92:95]
  v_cvt_pk_bf16_f32 v135, v26, v27
  v_mfma_f32_16x16x32_bf16 v[92:95], a[216:219], v[216:219], v[92:95]
  v_exp_f32_e64 v29, v65
  v_mfma_f32_16x16x32_bf16 v[244:247], v[252:255], v[132:135], 0
  v_cvt_pk_bf16_f32 v144, v28, v29
  v_mfma_f32_16x16x32_bf16 v[92:95], a[220:223], v[220:223], v[92:95]
  s_waitcnt vmcnt(16) lgkmcnt(0)
  v_mfma_f32_16x16x32_bf16 a[0:3], a[224:227], v[136:139], a[0:3]
  s_barrier
  v_mfma_f32_16x16x32_bf16 a[32:35], a[224:227], v[140:143], a[32:35]
  v_exp_f32_e64 v24, v66
  v_mfma_f32_16x16x32_bf16 a[64:67], a[224:227], v[152:155], a[64:67]
  v_exp_f32_e64 v25, v67
  v_mfma_f32_16x16x32_bf16 a[96:99], a[224:227], v[156:159], a[96:99]
  v_exp_f32_e64 v26, v68
  v_mfma_f32_16x16x32_bf16 a[4:7], a[228:231], v[136:139], a[4:7]
  v_exp_f32_e64 v27, v69
  v_mfma_f32_16x16x32_bf16 a[36:39], a[228:231], v[140:143], a[36:39]
  v_mov_b32_e64 v249, v244
  v_cvt_pk_bf16_f32 v145, v24, v25
  v_cvt_pk_bf16_f32 v146, v26, v27
  v_mfma_f32_16x16x32_bf16 a[68:71], a[228:231], v[152:155], a[68:71]
  v_exp_f32_e64 v28, v70
  v_mfma_f32_16x16x32_bf16 a[100:103], a[228:231], v[156:159], a[100:103]
  ds_read_b128 a[192:195], v10 offset:0
  s_and_b32 m0, s48, 0x1ffff
  v_mfma_f32_16x16x32_bf16 a[8:11], a[232:235], v[136:139], a[8:11]
  v_exp_f32_e64 v29, v71
  v_mfma_f32_16x16x32_bf16 a[40:43], a[232:235], v[140:143], a[40:43]
  ds_read_b128 a[196:199], v10 offset:1024
  v_cvt_pk_bf16_f32 v147, v28, v29
  v_mfma_f32_16x16x32_bf16 a[72:75], a[232:235], v[152:155], a[72:75]
  ds_read_b128 a[200:203], v10 offset:2048
  v_exp_f32_e64 v24, v72
  v_mfma_f32_16x16x32_bf16 v[240:243], v[252:255], v[144:147], 0
  buffer_load_dwordx4 v1, s[16:19], s48 offen offset:0 sc1 lds
  v_mfma_f32_16x16x32_bf16 a[104:107], a[232:235], v[156:159], a[104:107]
  v_exp_f32_e64 v25, v73
  v_mfma_f32_16x16x32_bf16 a[12:15], a[236:239], v[136:139], a[12:15]
  v_exp_f32_e64 v26, v74
  v_mfma_f32_16x16x32_bf16 a[44:47], a[236:239], v[140:143], a[44:47]
  ds_read_b128 a[204:207], v10 offset:3072
  ds_read_b128 a[208:211], v10 offset:4096
  v_cvt_pk_bf16_f32 v148, v24, v25
  v_mfma_f32_16x16x32_bf16 a[76:79], a[236:239], v[152:155], a[76:79]
  v_exp_f32_e64 v27, v75
  v_mfma_f32_16x16x32_bf16 a[108:111], a[236:239], v[156:159], a[108:111]
  ds_read_b128 a[212:215], v10 offset:5120
  v_cvt_pk_bf16_f32 v149, v26, v27
  v_mfma_f32_16x16x32_bf16 a[16:19], a[240:243], v[136:139], a[16:19]
  v_exp_f32_e64 v28, v76
  v_mfma_f32_16x16x32_bf16 a[48:51], a[240:243], v[140:143], a[48:51]
  ds_read_b128 a[216:219], v10 offset:6144
  buffer_load_dwordx4 v1, s[16:19], s48 offen offset:1024 sc1 lds
  v_mfma_f32_16x16x32_bf16 a[80:83], a[240:243], v[152:155], a[80:83]
  v_exp_f32_e64 v29, v77
  v_mfma_f32_16x16x32_bf16 a[112:115], a[240:243], v[156:159], a[112:115]
  ds_read_b128 a[220:223], v10 offset:7168
  v_cvt_pk_bf16_f32 v150, v28, v29
  v_mfma_f32_16x16x32_bf16 a[20:23], a[244:247], v[136:139], a[20:23]
  v_exp_f32_e64 v24, v78
  v_mfma_f32_16x16x32_bf16 a[52:55], a[244:247], v[140:143], a[52:55]
  v_exp_f32_e64 v25, v79
  v_mfma_f32_16x16x32_bf16 a[84:87], a[244:247], v[152:155], a[84:87]
  v_cvt_pk_bf16_f32 v151, v24, v25
  v_add_u32 v11, 0x8000, v11
  v_and_b32 v11, 0x1ffff, v11
  v_mfma_f32_16x16x32_bf16 v[244:247], v[252:255], v[148:151], 0
  buffer_load_dwordx4 v1, s[16:19], s48 offen offset:2048 sc1 lds
  v_mfma_f32_16x16x32_bf16 a[116:119], a[244:247], v[156:159], a[116:119]
  s_cmp_ge_u32 s50, s53
  s_cbranch_scc1 Lst8
Lst8r:
  v_mfma_f32_16x16x32_bf16 a[24:27], a[248:251], v[136:139], a[24:27]
  s_cmp_gt_u32 s50, s51
  s_cselect_b64 s[26:27], -1, 0
  v_mfma_f32_16x16x32_bf16 a[56:59], a[248:251], v[140:143], a[56:59]
  s_cmp_ge_u32 s50, s51
  s_cselect_b64 s[24:25], -1, 0
  v_cndmask_b32 v236, -v22, v12, s[26:27]
  v_mfma_f32_16x16x32_bf16 a[88:91], a[248:251], v[152:155], a[88:91]
  buffer_load_dwordx4 v1, s[16:19], s48 offen offset:3072 sc1 lds
  v_mfma_f32_16x16x32_bf16 a[120:123], a[248:251], v[156:159], a[120:123]
  s_add_u32 s48, s48, 32768
  v_cndmask_b32 v238, -v22, v12, s[24:25]
  v_mfma_f32_16x16x32_bf16 a[28:31], a[252:255], v[136:139], a[28:31]
  v_cndmask_b32 v237, -v23, v12, s[26:27]
  v_cndmask_b32 v239, -v23, v12, s[24:25]
  v_mfma_f32_16x16x32_bf16 a[60:63], a[252:255], v[140:143], a[60:63]
  v_cndmask_b32 v96, v236, v238, s[64:65]
  v_cndmask_b32 v97, v236, v238, s[66:67]
  v_mfma_f32_16x16x32_bf16 a[92:95], a[252:255], v[152:155], a[92:95]
  v_cndmask_b32 v98, v236, v238, s[68:69]
  v_cndmask_b32 v99, v236, v238, s[70:71]
  v_cndmask_b32 v100, v236, v238, s[72:73]
  v_cndmask_b32 v101, v236, v238, s[74:75]
  v_cndmask_b32 v102, v236, v238, s[76:77]
  v_cndmask_b32 v103, v236, v238, s[78:79]
  v_cndmask_b32 v104, v237, v239, s[80:81]
  v_cndmask_b32 v105, v237, v239, s[82:83]
  v_cndmask_b32 v106, v237, v239, s[84:85]
  v_cndmask_b32 v107, v237, v239, s[86:87]
  v_cndmask_b32 v108, v237, v239, s[88:89]
  v_cndmask_b32 v109, v237, v239, s[90:91]
  v_cndmask_b32 v110, v237, v239, s[92:93]
  v_cndmask_b32 v111, v237, v239, s[94:95]
  v_max3_f32 v15, v248, v249, v240
  v_max_f32 v15, v15, v244
  v_cmp_lt_f32 vcc, s55, v15
  v_mfma_f32_16x16x32_bf16 a[124:127], a[252:255], v[156:159], a[124:127]
  s_cbranch_vccnz Lst9
Lst9r:
  s_cmp_lt_u32 s50, s54
  s_cbranch_scc1 Ld1l
Ltrans:
  v_add_u32 v10, s56, v10
  v_xor_b32 v13, 0x2000, v13
  s_waitcnt lgkmcnt(0)
  ds_read_b128 a[192:195], v10 offset:0
  ds_read_b128 a[196:199], v10 offset:1024
  ds_read_b128 a[200:203], v10 offset:2048
  ds_read_b128 a[204:207], v10 offset:3072
  ds_read_b128 a[208:211], v10 offset:4096
  ds_read_b128 a[212:215], v10 offset:5120
  ds_read_b128 a[216:219], v10 offset:6144
  ds_read_b128 a[220:223], v10 offset:7168
  ds_read_b128 v[160:163], v13 offset:0
  ds_read_b128 v[164:167], v13 offset:1024
  ds_read_b128 v[168:171], v13 offset:2048
  ds_read_b128 v[172:175], v13 offset:3072
  ds_read_b128 v[176:179], v13 offset:4096
  ds_read_b128 v[180:183], v13 offset:5120
  ds_read_b128 v[184:187], v13 offset:6144
  ds_read_b128 v[188:191], v13 offset:7168
  v_add_u32 v10, 0x8000, v10
  v_and_b32 v10, 0x1ffff, v10
  v_mov_b32 v22, 0
  v_mov_b32 v23, 0
  v_mov_b32 v7, 1
  s_lshr_b32 s42, s56, 13
  s_add_u32 s50, s50, s42
  s_xor_b32 s51, s52, 1
  s_lshl_b32 s42, s41, 2
  s_sub_u32 s54, 64, s42
  s_lshl_b32 s44, s41, 9
  s_sub_u32 s45, 7680, s44
  s_lshr_b32 s42, s59, 3
  s_lshl_b32 s42, s42, 7
  s_and_b32 s43, s59, 7
  s_lshl_b32 s43, s43, 2
  s_add_u32 s42, s42, s43
  s_add_u32 s42, s42, 0x431000
  s_add_u32 s44, s44, s42
  s_add_u32 s45, s45, s42
  s_add_u32 s32, s50, 12
  s_cmp_eq_u32 s40, 0
  s_cselect_b32 s32, s32, 0xffff
  s_min_u32 s53, s53, s32
  s_cmp_gt_u32 s50, s52
  s_cselect_b64 s[26:27], -1, 0
  s_cmp_ge_u32 s50, s52
  s_cselect_b64 s[24:25], -1, 0
  v_cndmask_b32 v236, -v30, v12, s[26:27]
  v_cndmask_b32 v238, -v30, v12, s[24:25]
  v_cndmask_b32 v237, -v31, v12, s[26:27]
  v_cndmask_b32 v239, -v31, v12, s[24:25]
  v_cndmask_b32 v112, v236, v238, s[64:65]
  v_cndmask_b32 v113, v236, v238, s[66:67]
  v_cndmask_b32 v114, v236, v238, s[68:69]
  v_cndmask_b32 v115, v236, v238, s[70:71]
  v_cndmask_b32 v116, v236, v238, s[72:73]
  v_cndmask_b32 v117, v236, v238, s[74:75]
  v_cndmask_b32 v118, v236, v238, s[76:77]
  v_cndmask_b32 v119, v236, v238, s[78:79]
  v_cndmask_b32 v120, v237, v239, s[80:81]
  v_cndmask_b32 v121, v237, v239, s[82:83]
  v_cndmask_b32 v122, v237, v239, s[84:85]
  v_cndmask_b32 v123, v237, v239, s[86:87]
  v_cndmask_b32 v124, v237, v239, s[88:89]
  v_cndmask_b32 v125, v237, v239, s[90:91]
  v_cndmask_b32 v126, v237, v239, s[92:93]
  v_cndmask_b32 v127, v237, v239, s[94:95]
  s_cmp_gt_u32 s50, s51
  s_cselect_b64 s[26:27], -1, 0
  s_cmp_ge_u32 s50, s51
  s_cselect_b64 s[24:25], -1, 0
  v_cndmask_b32 v236, -v22, v12, s[26:27]
  v_cndmask_b32 v238, -v22, v12, s[24:25]
  v_cndmask_b32 v237, -v23, v12, s[26:27]
  v_cndmask_b32 v239, -v23, v12, s[24:25]
  v_cndmask_b32 v96, v236, v238, s[64:65]
  v_cndmask_b32 v97, v236, v238, s[66:67]
  v_cndmask_b32 v98, v236, v238, s[68:69]
  v_cndmask_b32 v99, v236, v238, s[70:71]
  v_cndmask_b32 v100, v236, v238, s[72:73]
  v_cndmask_b32 v101, v236, v238, s[74:75]
  v_cndmask_b32 v102, v236, v238, s[76:77]
  v_cndmask_b32 v103, v236, v238, s[78:79]
  v_cndmask_b32 v104, v237, v239, s[80:81]
  v_cndmask_b32 v105, v237, v239, s[82:83]
  v_cndmask_b32 v106, v237, v239, s[84:85]
  v_cndmask_b32 v107, v237, v239, s[86:87]
  v_cndmask_b32 v108, v237, v239, s[88:89]
  v_cndmask_b32 v109, v237, v239, s[90:91]
  v_cndmask_b32 v110, v237, v239, s[92:93]
  v_cndmask_b32 v111, v237, v239, s[94:95]
  s_nop 1
  s_waitcnt lgkmcnt(0)
  v_mfma_f32_16x16x32_bf16 v[32:35], a[192:195], v[160:163], v[96:99]
  ds_read_b128 a[224:227], v11 offset:0
  v_exp_f32_e64 v24, v48
  v_mfma_f32_16x16x32_bf16 v[32:35], a[196:199], v[164:167], v[32:35]
  v_add_f32 v16, v16, v240
  v_add_f32 v18, v18, v248
  v_mfma_f32_16x16x32_bf16 v[32:35], a[200:203], v[168:171], v[32:35]
  ds_read_b128 a[228:231], v11 offset:1024
  v_exp_f32_e64 v25, v49
  v_mfma_f32_16x16x32_bf16 v[32:35], a[204:207], v[172:175], v[32:35]
  v_add_f32 v17, v17, v244
  v_add_f32 v19, v19, v249
  v_mfma_f32_16x16x32_bf16 v[40:43], a[192:195], v[176:179], v[104:107]
  v_exp_f32_e64 v26, v50
  v_mfma_f32_16x16x32_bf16 v[40:43], a[196:199], v[180:183], v[40:43]
  v_cvt_pk_bf16_f32 v136, v24, v25
  s_and_b32 m0, s49, 0x1ffff
  v_mfma_f32_16x16x32_bf16 v[40:43], a[200:203], v[184:187], v[40:43]
  v_exp_f32_e64 v27, v51
  v_mfma_f32_16x16x32_bf16 v[40:43], a[204:207], v[188:191], v[40:43]
  ds_read_b128 a[232:235], v11 offset:2048
  v_cvt_pk_bf16_f32 v137, v26, v27
  v_mfma_f32_16x16x32_bf16 v[64:67], a[192:195], v[192:195], v[112:115]
  v_exp_f32_e64 v28, v52
  v_mfma_f32_16x16x32_bf16 v[64:67], a[196:199], v[196:199], v[64:67]
  buffer_load_dwordx4 v1, s[16:19], s49 offen offset:0 sc1 lds
  v_mfma_f32_16x16x32_bf16 v[64:67], a[200:203], v[200:203], v[64:67]
  v_exp_f32_e64 v29, v53
  v_mfma_f32_16x16x32_bf16 v[64:67], a[204:207], v[204:207], v[64:67]
  ds_read_b128 a[236:239], v11 offset:3072
  v_exp_f32_e64 v24, v54
  v_mfma_f32_16x16x32_bf16 v[72:75], a[192:195], v[208:211], v[120:123]
  ds_read_b128 a[240:243], v11 offset:4096
  v_cvt_pk_bf16_f32 v138, v28, v29
  v_mfma_f32_16x16x32_bf16 v[72:75], a[196:199], v[212:215], v[72:75]
  v_exp_f32_e64 v25, v55
  v_mfma_f32_16x16x32_bf16 v[72:75], a[200:203], v[216:219], v[72:75]
  ds_read_b128 a[244:247], v11 offset:5120
  ds_read_b128 a[248:251], v11 offset:6144
  v_cvt_pk_bf16_f32 v139, v24, v25
  v_mfma_f32_16x16x32_bf16 v[72:75], a[204:207], v[220:223], v[72:75]
  v_exp_f32_e64 v26, v56
  v_mfma_f32_16x16x32_bf16 v[240:243], v[252:255], v[136:139], 0
  buffer_load_dwordx4 v1, s[16:19], s49 offen offset:1024 sc1 lds
  v_mfma_f32_16x16x32_bf16 v[36:39], a[208:211], v[160:163], v[100:103]
  ds_read_b128 a[252:255], v11 offset:7168
  v_exp_f32_e64 v27, v57
  v_mfma_f32_16x16x32_bf16 v[36:39], a[212:215], v[164:167], v[36:39]
  v_cvt_pk_bf16_f32 v140, v26, v27
  v_mfma_f32_16x16x32_bf16 v[36:39], a[216:219], v[168:171], v[36:39]
  v_exp_f32_e64 v28, v58
  v_mfma_f32_16x16x32_bf16 v[36:39], a[220:223], v[172:175], v[36:39]
  v_exp_f32 v29, v59
  v_mov_b32 v248, v240
  v_mfma_f32_16x16x32_bf16 v[44:47], a[208:211], v[176:179], v[108:111]
  v_cvt_pk_bf16_f32 v141, v28, v29
  s_add_u32 s50, s50, 2
  v_mfma_f32_16x16x32_bf16 v[44:47], a[212:215], v[180:183], v[44:47]
  v_exp_f32 v24, v60
  v_mfma_f32_16x16x32_bf16 v[44:47], a[216:219], v[184:187], v[44:47]
  buffer_load_dwordx4 v1, s[16:19], s49 offen offset:2048 sc1 lds
  v_mfma_f32_16x16x32_bf16 v[44:47], a[220:223], v[188:191], v[44:47]
  v_exp_f32_e64 v25, v61
  v_mfma_f32_16x16x32_bf16 v[68:71], a[208:211], v[192:195], v[116:119]
  v_cvt_pk_bf16_f32 v142, v24, v25
  v_mfma_f32_16x16x32_bf16 v[68:71], a[212:215], v[196:199], v[68:71]
  v_exp_f32_e64 v26, v62
  v_mfma_f32_16x16x32_bf16 v[68:71], a[216:219], v[200:203], v[68:71]
  v_mfma_f32_16x16x32_bf16 v[68:71], a[220:223], v[204:207], v[68:71]
  v_exp_f32_e64 v27, v63
  v_mfma_f32_16x16x32_bf16 v[76:79], a[208:211], v[208:211], v[124:127]
  v_exp_f32_e64 v28, v80
  v_mfma_f32_16x16x32_bf16 v[76:79], a[212:215], v[212:215], v[76:79]
  buffer_load_dwordx4 v1, s[16:19], s49 offen offset:3072 sc1 lds
  v_mfma_f32_16x16x32_bf16 v[76:79], a[216:219], v[216:219], v[76:79]
  v_exp_f32_e64 v29, v81
  v_cvt_pk_bf16_f32 v143, v26, v27
  v_mfma_f32_16x16x32_bf16 v[76:79], a[220:223], v[220:223], v[76:79]
  v_cvt_pk_bf16_f32 v152, v28, v29
  v_mfma_f32_16x16x32_bf16 v[244:247], v[252:255], v[140:143], 0
  s_waitcnt vmcnt(16) lgkmcnt(0)
  v_mfma_f32_16x16x32_bf16 a[0:3], a[224:227], v[128:131], a[0:3]
  s_barrier
  v_exp_f32_e64 v24, v82
  v_mfma_f32_16x16x32_bf16 a[32:35], a[224:227], v[132:135], a[32:35]
  v_exp_f32_e64 v25, v83
  v_mfma_f32_16x16x32_bf16 a[64:67], a[224:227], v[144:147], a[64:67]
  ds_read_b128 a[192:195], v10 offset:0
  v_cvt_pk_bf16_f32 v153, v24, v25
  v_mfma_f32_16x16x32_bf16 a[96:99], a[224:227], v[148:151], a[96:99]
  v_exp_f32 v26, v84
  v_mov_b32 v249, v244
  v_mfma_f32_16x16x32_bf16 a[4:7], a[228:231], v[128:131], a[4:7]
  v_exp_f32_e64 v27, v85
  v_mfma_f32_16x16x32_bf16 a[36:39], a[228:231], v[132:135], a[36:39]
  v_cvt_pk_bf16_f32 v154, v26, v27
  s_and_b32 m0, s48, 0x1ffff
  v_mfma_f32_16x16x32_bf16 a[68:71], a[228:231], v[144:147], a[68:71]
  ds_read_b128 a[196:199], v10 offset:1024
  v_exp_f32_e64 v28, v86
  v_mfma_f32_16x16x32_bf16 a[100:103], a[228:231], v[148:151], a[100:103]
  ds_read_b128 a[200:203], v10 offset:2048
  s_cmp_gt_u32 s50, s52
  s_cselect_b64 s[26:27], -1, 0
  v_mfma_f32_16x16x32_bf16 a[8:11], a[232:235], v[128:131], a[8:11]
  s_cmp_ge_u32 s50, s52
  s_cselect_b64 s[24:25], -1, 0
  v_mfma_f32_16x16x32_bf16 a[40:43], a[232:235], v[132:135], a[40:43]
  v_exp_f32_e64 v29, v87
  v_mfma_f32_16x16x32_bf16 a[72:75], a[232:235], v[144:147], a[72:75]
  v_exp_f32_e64 v24, v88
  v_mfma_f32_16x16x32_bf16 a[104:107], a[232:235], v[148:151], a[104:107]
  buffer_load_dwordx4 v1, s[16:19], s48 offen offset:0 sc1 lds
  v_cvt_pk_bf16_f32 v155, v28, v29
  v_mfma_f32_16x16x32_bf16 a[12:15], a[236:239], v[128:131], a[12:15]
  v_exp_f32_e64 v25, v89
  v_mfma_f32_16x16x32_bf16 v[240:243], v[252:255], v[152:155], 0
  v_exp_f32_e64 v26, v90
  v_mfma_f32_16x16x32_bf16 a[44:47], a[236:239], v[132:135], a[44:47]
  ds_read_b128 a[204:207], v10 offset:3072
  ds_read_b128 a[208:211], v10 offset:4096
  v_cvt_pk_bf16_f32 v156, v24, v25
  v_mfma_f32_16x16x32_bf16 a[76:79], a[236:239], v[144:147], a[76:79]
  v_exp_f32_e64 v27, v91
  v_mfma_f32_16x16x32_bf16 a[108:111], a[236:239], v[148:151], a[108:111]
  ds_read_b128 a[212:215], v10 offset:5120
  v_cvt_pk_bf16_f32 v157, v26, v27
  v_mfma_f32_16x16x32_bf16 a[16:19], a[240:243], v[128:131], a[16:19]
  ds_read_b128 a[216:219], v10 offset:6144
  v_exp_f32_e64 v28, v92
  v_mfma_f32_16x16x32_bf16 a[48:51], a[240:243], v[132:135], a[48:51]
  buffer_load_dwordx4 v1, s[16:19], s48 offen offset:1024 sc1 lds
  v_mfma_f32_16x16x32_bf16 a[80:83], a[240:243], v[144:147], a[80:83]
  v_exp_f32_e64 v29, v93
  v_mfma_f32_16x16x32_bf16 a[112:115], a[240:243], v[148:151], a[112:115]
  ds_read_b128 a[220:223], v10 offset:7168
  v_cvt_pk_bf16_f32 v158, v28, v29
  s_add_u32 s49, s49, 32768
  v_mfma_f32_16x16x32_bf16 a[20:23], a[244:247], v[128:131], a[20:23]
  v_exp_f32_e64 v24, v94
  v_mfma_f32_16x16x32_bf16 a[52:55], a[244:247], v[132:135], a[52:55]
  v_exp_f32_e64 v25, v95
  v_mfma_f32_16x16x32_bf16 a[84:87], a[244:247], v[144:147], a[84:87]
  buffer_load_dwordx4 v1, s[16:19], s48 offen offset:2048 sc1 lds
  v_cvt_pk_bf16_f32 v159, v24, v25
  v_mfma_f32_16x16x32_bf16 a[116:119], a[244:247], v[148:151], a[116:119]
  v_cndmask_b32 v236, -v30, v12, s[26:27]
  v_cndmask_b32 v238, -v30, v12, s[24:25]
  v_mfma_f32_16x16x32_bf16 v[244:247], v[252:255], v[156:159], 0
  v_cndmask_b32 v237, -v31, v12, s[26:27]
  v_cndmask_b32 v239, -v31, v12, s[24:25]
  v_mfma_f32_16x16x32_bf16 a[24:27], a[248:251], v[128:131], a[24:27]
  v_add_u32 v10, 0x8000, v10
  v_and_b32 v10, 0x1ffff, v10
  v_cndmask_b32 v112, v236, v238, s[64:65]
  v_mfma_f32_16x16x32_bf16 a[56:59], a[248:251], v[132:135], a[56:59]
  v_cndmask_b32 v113, v236, v238, s[66:67]
  v_cndmask_b32 v114, v236, v238, s[68:69]
  v_mfma_f32_16x16x32_bf16 a[88:91], a[248:251], v[144:147], a[88:91]
  buffer_load_dwordx4 v1, s[16:19], s48 offen offset:3072 sc1 lds
  v_mfma_f32_16x16x32_bf16 a[120:123], a[248:251], v[148:151], a[120:123]
  s_add_u32 s48, s48, 32768
  v_cndmask_b32 v115, v236, v238, s[70:71]
  v_cndmask_b32 v116, v236, v238, s[72:73]
  v_mfma_f32_16x16x32_bf16 a[28:31], a[252:255], v[128:131], a[28:31]
  v_cndmask_b32 v117, v236, v238, s[74:75]
  v_cndmask_b32 v118, v236, v238, s[76:77]
  v_mfma_f32_16x16x32_bf16 a[60:63], a[252:255], v[132:135], a[60:63]
  v_cndmask_b32 v119, v236, v238, s[78:79]
  v_cndmask_b32 v120, v237, v239, s[80:81]
  v_mfma_f32_16x16x32_bf16 a[92:95], a[252:255], v[144:147], a[92:95]
  v_cndmask_b32 v121, v237, v239, s[82:83]
  v_cndmask_b32 v122, v237, v239, s[84:85]
  v_cndmask_b32 v123, v237, v239, s[86:87]
  v_cndmask_b32 v124, v237, v239, s[88:89]
  v_cndmask_b32 v125, v237, v239, s[90:91]
  v_cndmask_b32 v126, v237, v239, s[92:93]
  v_cndmask_b32 v127, v237, v239, s[94:95]
  v_max3_f32 v15, v248, v249, v240
  v_max_f32 v15, v15, v244
  v_cmp_lt_f32 vcc, s55, v15
  v_mfma_f32_16x16x32_bf16 a[124:127], a[252:255], v[148:151], a[124:127]
  s_cbranch_vccnz Lst10
Lst10r:
  s_cmp_lg_u32 s41, 7
  s_cbranch_scc1 Lnotk0
  buffer_atomic_add v7, v3, s[4:7], 0 offen offset:128 sc0 sc1
  s_bfe_u32 s42, s2, 0x20001
  s_lshl_b32 s42, s42, 3
  s_add_u32 s42, s42, s41
  s_lshl_b32 s42, s42, 2
  s_add_u32 s42, s42, s40
  s_lshl_b32 s42, s42, 15
  s_bfe_u32 s43, s2, 0x20003
  s_lshl_b32 s43, s43, 8
  s_add_u32 s42, s42, s43
  v_lshrrev_b32 v6, 1, v0
  v_lshlrev_b32 v6, 10, v6
  v_and_b32_e64 v15, 1, v0
  v_lshl_add_u32 v6, v15, 7, v6
  v_add_u32_e64 v6, s42, v6
  global_load_dword v14, v6, s[36:37]
Lnotk0:
  v_max_f32 v24, v32, v33
  v_max_f32 v25, v40, v41
  v_max3_f32 v24, v24, v34, v35
  v_max3_f32 v25, v25, v42, v43
  v_max3_f32 v24, v24, v36, v37
  v_max3_f32 v25, v25, v44, v45
  v_max3_f32 v24, v24, v38, v39
  v_max3_f32 v25, v25, v46, v47
  v_mov_b32 v26, v24
  v_mov_b32 v27, v25
  s_nop 0
  v_permlane16_swap_b32 v24, v26
  v_permlane16_swap_b32 v25, v27
  v_max_f32 v24, v24, v26
  v_max_f32 v25, v25, v27
  v_mov_b32 v26, v24
  v_mov_b32 v27, v25
  s_nop 0
  v_permlane32_swap_b32 v24, v26
  v_permlane32_swap_b32 v25, v27
  v_max_f32 v24, v24, v26
  v_max_f32 v25, v25, v27
  v_max_f32 v24, 0xf149f2ca, v24
  v_max_f32 v25, 0xf149f2ca, v25
  v_add_f32 v22, v22, v24
  v_add_f32 v23, v23, v25
  s_cmp_gt_u32 s50, s51
  s_cselect_b64 s[26:27], -1, 0
  s_cmp_ge_u32 s50, s51
  s_cselect_b64 s[24:25], -1, 0
  v_cndmask_b32 v236, -v22, v12, s[26:27]
  v_cndmask_b32 v238, -v22, v12, s[24:25]
  v_cndmask_b32 v237, -v23, v12, s[26:27]
  v_cndmask_b32 v239, -v23, v12, s[24:25]
  v_cndmask_b32 v96, v236, v238, s[64:65]
  v_cndmask_b32 v97, v236, v238, s[66:67]
  v_cndmask_b32 v98, v236, v238, s[68:69]
  v_cndmask_b32 v99, v236, v238, s[70:71]
  v_cndmask_b32 v100, v236, v238, s[72:73]
  v_cndmask_b32 v101, v236, v238, s[74:75]
  v_cndmask_b32 v102, v236, v238, s[76:77]
  v_cndmask_b32 v103, v236, v238, s[78:79]
  v_cndmask_b32 v104, v237, v239, s[80:81]
  v_cndmask_b32 v105, v237, v239, s[82:83]
  v_cndmask_b32 v106, v237, v239, s[84:85]
  v_cndmask_b32 v107, v237, v239, s[86:87]
  v_cndmask_b32 v108, v237, v239, s[88:89]
  v_cndmask_b32 v109, v237, v239, s[90:91]
  v_cndmask_b32 v110, v237, v239, s[92:93]
  v_cndmask_b32 v111, v237, v239, s[94:95]
  v_sub_f32 v32, v32, v24
  v_sub_f32 v33, v33, v24
  v_sub_f32 v34, v34, v24
  v_sub_f32 v35, v35, v24
  v_sub_f32 v36, v36, v24
  v_sub_f32 v37, v37, v24
  v_sub_f32 v38, v38, v24
  v_sub_f32 v39, v39, v24
  v_sub_f32 v40, v40, v25
  v_sub_f32 v41, v41, v25
  v_sub_f32 v42, v42, v25
  v_sub_f32 v43, v43, v25
  v_sub_f32 v44, v44, v25
  v_sub_f32 v45, v45, v25
  v_sub_f32 v46, v46, v25
  v_sub_f32_e64 v47, v47, v25
  s_waitcnt lgkmcnt(0)
  v_mfma_f32_16x16x32_bf16 v[48:51], a[192:195], v[160:163], v[96:99]
  v_exp_f32_e64 v24, v32
  v_mfma_f32_16x16x32_bf16 v[48:51], a[196:199], v[164:167], v[48:51]
  v_add_f32 v16, v16, v240
  v_add_f32 v18, v18, v248
  v_mfma_f32_16x16x32_bf16 v[48:51], a[200:203], v[168:171], v[48:51]
  v_exp_f32_e64 v25, v33
  v_mfma_f32_16x16x32_bf16 v[48:51], a[204:207], v[172:175], v[48:51]
  v_add_f32 v17, v17, v244
  v_add_f32 v19, v19, v249
  v_mfma_f32_16x16x32_bf16 v[56:59], a[192:195], v[176:179], v[104:107]
  v_exp_f32_e64 v26, v34
  v_mfma_f32_16x16x32_bf16 v[56:59], a[196:199], v[180:183], v[56:59]
  ds_read_b128 a[224:227], v11 offset:8192
  v_cvt_pk_bf16_f32 v128, v24, v25
  v_mfma_f32_16x16x32_bf16 v[56:59], a[200:203], v[184:187], v[56:59]
  v_exp_f32_e64 v27, v35
  v_mfma_f32_16x16x32_bf16 v[56:59], a[204:207], v[188:191], v[56:59]
  ds_read_b128 a[228:231], v11 offset:9216
  v_cvt_pk_bf16_f32 v129, v26, v27
  v_mfma_f32_16x16x32_bf16 v[80:83], a[192:195], v[192:195], v[112:115]
  v_exp_f32_e64 v28, v36
  v_mfma_f32_16x16x32_bf16 v[80:83], a[196:199], v[196:199], v[80:83]
  ds_read_b128 a[232:235], v11 offset:10240
  ds_read_b128 a[236:239], v11 offset:11264
  v_mfma_f32_16x16x32_bf16 v[80:83], a[200:203], v[200:203], v[80:83]
  v_exp_f32_e64 v29, v37
  v_mfma_f32_16x16x32_bf16 v[80:83], a[204:207], v[204:207], v[80:83]
  v_exp_f32_e64 v24, v38
  v_mfma_f32_16x16x32_bf16 v[88:91], a[192:195], v[208:211], v[120:123]
  ds_read_b128 a[240:243], v11 offset:12288
  v_cvt_pk_bf16_f32 v130, v28, v29
  v_mfma_f32_16x16x32_bf16 v[88:91], a[196:199], v[212:215], v[88:91]
  v_exp_f32_e64 v25, v39
  v_mfma_f32_16x16x32_bf16 v[88:91], a[200:203], v[216:219], v[88:91]
  ds_read_b128 a[244:247], v11 offset:13312
  v_cvt_pk_bf16_f32 v131, v24, v25
  v_mfma_f32_16x16x32_bf16 v[88:91], a[204:207], v[220:223], v[88:91]
  v_exp_f32_e64 v26, v40
  v_mfma_f32_16x16x32_bf16 v[240:243], v[252:255], v[128:131], 0
  ds_read_b128 a[248:251], v11 offset:14336
  ds_read_b128 a[252:255], v11 offset:15360
  v_mfma_f32_16x16x32_bf16 v[52:55], a[208:211], v[160:163], v[100:103]
  v_exp_f32_e64 v27, v41
  v_mfma_f32_16x16x32_bf16 v[52:55], a[212:215], v[164:167], v[52:55]
  v_cvt_pk_bf16_f32 v132, v26, v27
  v_mfma_f32_16x16x32_bf16 v[52:55], a[216:219], v[168:171], v[52:55]
  v_exp_f32_e64 v28, v42
  v_mfma_f32_16x16x32_bf16 v[52:55], a[220:223], v[172:175], v[52:55]
  v_exp_f32_e64 v29, v43
  v_mfma_f32_16x16x32_bf16 v[60:63], a[208:211], v[176:179], v[108:111]
  v_mov_b32_e64 v248, v240
  v_cvt_pk_bf16_f32 v133, v28, v29
  v_mfma_f32_16x16x32_bf16 v[60:63], a[212:215], v[180:183], v[60:63]
  v_exp_f32_e64 v24, v44
  v_mfma_f32_16x16x32_bf16 v[60:63], a[216:219], v[184:187], v[60:63]
  v_add_u32_e64 v11, s56, v11
  v_mfma_f32_16x16x32_bf16 v[60:63], a[220:223], v[188:191], v[60:63]
  v_exp_f32_e64 v25, v45
  v_mfma_f32_16x16x32_bf16 v[84:87], a[208:211], v[192:195], v[116:119]
  v_cvt_pk_bf16_f32 v134, v24, v25
  v_mfma_f32_16x16x32_bf16 v[84:87], a[212:215], v[196:199], v[84:87]
  v_exp_f32_e64 v26, v46
  v_mfma_f32_16x16x32_bf16 v[84:87], a[216:219], v[200:203], v[84:87]
  v_mfma_f32_16x16x32_bf16 v[84:87], a[220:223], v[204:207], v[84:87]
  v_exp_f32_e64 v27, v47
  v_mfma_f32_16x16x32_bf16 v[92:95], a[208:211], v[208:211], v[124:127]
  v_exp_f32_e64 v28, v64
  v_mfma_f32_16x16x32_bf16 v[92:95], a[212:215], v[212:215], v[92:95]
  v_cvt_pk_bf16_f32 v135, v26, v27
  v_mfma_f32_16x16x32_bf16 v[92:95], a[216:219], v[216:219], v[92:95]
  v_exp_f32_e64 v29, v65
  v_mfma_f32_16x16x32_bf16 v[244:247], v[252:255], v[132:135], 0
  v_cvt_pk_bf16_f32 v144, v28, v29
  v_mfma_f32_16x16x32_bf16 v[92:95], a[220:223], v[220:223], v[92:95]
  s_waitcnt vmcnt(16) lgkmcnt(0)
  v_mfma_f32_16x16x32_bf16 a[0:3], a[224:227], v[136:139], a[0:3]
  s_barrier
  v_mfma_f32_16x16x32_bf16 a[32:35], a[224:227], v[140:143], a[32:35]
  v_exp_f32_e64 v24, v66
  v_mfma_f32_16x16x32_bf16 a[64:67], a[224:227], v[152:155], a[64:67]
  v_exp_f32_e64 v25, v67
  v_mfma_f32_16x16x32_bf16 a[96:99], a[224:227], v[156:159], a[96:99]
  v_exp_f32_e64 v26, v68
  v_mfma_f32_16x16x32_bf16 a[4:7], a[228:231], v[136:139], a[4:7]
  v_exp_f32_e64 v27, v69
  v_mfma_f32_16x16x32_bf16 a[36:39], a[228:231], v[140:143], a[36:39]
  v_mov_b32_e64 v249, v244
  v_cvt_pk_bf16_f32 v145, v24, v25
  v_mfma_f32_16x16x32_bf16 a[68:71], a[228:231], v[152:155], a[68:71]
  v_exp_f32_e64 v28, v70
  v_mfma_f32_16x16x32_bf16 a[100:103], a[228:231], v[156:159], a[100:103]
  ds_read_b128 a[192:195], v10 offset:0
  v_cvt_pk_bf16_f32 v146, v26, v27
  v_mfma_f32_16x16x32_bf16 a[8:11], a[232:235], v[136:139], a[8:11]
  v_exp_f32_e64 v29, v71
  v_mfma_f32_16x16x32_bf16 a[40:43], a[232:235], v[140:143], a[40:43]
  v_cvt_pk_bf16_f32 v147, v28, v29
  s_and_b32 m0, s48, 0x1ffff
  v_mfma_f32_16x16x32_bf16 a[72:75], a[232:235], v[152:155], a[72:75]
  v_exp_f32_e64 v24, v72
  v_mfma_f32_16x16x32_bf16 v[240:243], v[252:255], v[144:147], 0
  ds_read_b128 a[196:199], v10 offset:1024
  ds_read_b128 a[200:203], v10 offset:2048
  v_mfma_f32_16x16x32_bf16 a[104:107], a[232:235], v[156:159], a[104:107]
  v_exp_f32_e64 v25, v73
  v_mfma_f32_16x16x32_bf16 a[12:15], a[236:239], v[136:139], a[12:15]
  v_exp_f32_e64 v26, v74
  v_mfma_f32_16x16x32_bf16 a[44:47], a[236:239], v[140:143], a[44:47]
  buffer_load_dwordx4 v1, s[16:19], s48 offen offset:0 sc1 lds
  v_mfma_f32_16x16x32_bf16 a[76:79], a[236:239], v[152:155], a[76:79]
  v_exp_f32_e64 v27, v75
  v_mfma_f32_16x16x32_bf16 a[108:111], a[236:239], v[156:159], a[108:111]
  v_cvt_pk_bf16_f32 v148, v24, v25
  v_cvt_pk_bf16_f32 v149, v26, v27
  v_mfma_f32_16x16x32_bf16 a[16:19], a[240:243], v[136:139], a[16:19]
  v_exp_f32_e64 v28, v76
  v_mfma_f32_16x16x32_bf16 a[48:51], a[240:243], v[140:143], a[48:51]
  ds_read_b128 a[204:207], v10 offset:3072
  ds_read_b128 a[208:211], v10 offset:4096
  v_mfma_f32_16x16x32_bf16 a[80:83], a[240:243], v[152:155], a[80:83]
  v_exp_f32_e64 v29, v77
  v_mfma_f32_16x16x32_bf16 a[112:115], a[240:243], v[156:159], a[112:115]
  ds_read_b128 a[212:215], v10 offset:5120
  v_cvt_pk_bf16_f32 v150, v28, v29
  v_mfma_f32_16x16x32_bf16 a[20:23], a[244:247], v[136:139], a[20:23]
  v_exp_f32_e64 v24, v78
  v_mfma_f32_16x16x32_bf16 a[52:55], a[244:247], v[140:143], a[52:55]
  v_exp_f32_e64 v25, v79
  v_mfma_f32_16x16x32_bf16 a[84:87], a[244:247], v[152:155], a[84:87]
  ds_read_b128 a[216:219], v10 offset:6144
  v_cvt_pk_bf16_f32 v151, v24, v25
  v_mfma_f32_16x16x32_bf16 a[116:119], a[244:247], v[156:159], a[116:119]
  buffer_load_dwordx4 v1, s[16:19], s48 offen offset:1024 sc1 lds
  v_mfma_f32_16x16x32_bf16 v[244:247], v[252:255], v[148:151], 0
  ds_read_b128 a[220:223], v10 offset:7168
  s_add_u32 s50, s50, 2
  v_mfma_f32_16x16x32_bf16 a[24:27], a[248:251], v[136:139], a[24:27]
  v_add_u32 v11, 0x8000, v11
  v_and_b32 v11, 0x1ffff, v11
  v_mfma_f32_16x16x32_bf16 a[56:59], a[248:251], v[140:143], a[56:59]
  buffer_load_dwordx4 v1, s[16:19], s48 offen offset:2048 sc1 lds
  v_mfma_f32_16x16x32_bf16 a[88:91], a[248:251], v[152:155], a[88:91]
  s_cmp_ge_u32 s50, s53
  s_cbranch_scc1 Lst11
Lst11r:
  v_mfma_f32_16x16x32_bf16 a[120:123], a[248:251], v[156:159], a[120:123]
  v_add_u32 v10, 0x8000, v10
  v_and_b32 v10, 0x1ffff, v10
  v_mfma_f32_16x16x32_bf16 a[28:31], a[252:255], v[136:139], a[28:31]
  buffer_load_dwordx4 v1, s[16:19], s48 offen offset:3072 sc1 lds
  v_mfma_f32_16x16x32_bf16 a[60:63], a[252:255], v[140:143], a[60:63]
  s_add_u32 s48, s48, 32768
  v_max3_f32 v15, v248, v249, v240
  v_mfma_f32_16x16x32_bf16 a[92:95], a[252:255], v[152:155], a[92:95]
  v_max_f32 v15, v15, v244
  v_cmp_lt_f32_e64 vcc, s55, v15
  v_mfma_f32_16x16x32_bf16 a[124:127], a[252:255], v[156:159], a[124:127]
  s_cbranch_vccnz Lst12
Lst12r:
  v_mov_b32 v24, v18
  v_mov_b32 v26, v19
  v_rcp_f32 v24, v24
  v_rcp_f32 v26, v26
  s_nop 3
  v_accvgpr_read_b32 v224, a0
  v_accvgpr_read_b32 v225, a1
  v_accvgpr_read_b32 v226, a2
  v_accvgpr_read_b32 v227, a3
  v_accvgpr_read_b32 v228, a4
  v_accvgpr_read_b32 v229, a5
  v_accvgpr_read_b32 v230, a6
  v_accvgpr_read_b32 v231, a7
  v_pk_mul_f32 v[224:225], v[224:225], v[24:25] op_sel_hi:[1,0]
  v_pk_mul_f32 v[226:227], v[226:227], v[24:25] op_sel_hi:[1,0]
  v_pk_mul_f32 v[228:229], v[228:229], v[24:25] op_sel_hi:[1,0]
  v_pk_mul_f32 v[230:231], v[230:231], v[24:25] op_sel_hi:[1,0]
  v_cvt_pk_bf16_f32 v224, v224, v225
  v_cvt_pk_bf16_f32 v225, v226, v227
  v_cvt_pk_bf16_f32 v226, v228, v229
  v_cvt_pk_bf16_f32 v227, v230, v231
  s_add_u32 s42, s57, 0
  buffer_store_dwordx4 v[224:227], v1, s[20:23], s42 offen offset:0 sc1
  v_accvgpr_read_b32 v232, a32
  v_accvgpr_read_b32 v233, a33
  v_accvgpr_read_b32 v234, a34
  v_accvgpr_read_b32 v235, a35
  v_accvgpr_read_b32 v236, a36
  v_accvgpr_read_b32 v237, a37
  v_accvgpr_read_b32 v238, a38
  v_accvgpr_read_b32 v239, a39
  v_pk_mul_f32 v[232:233], v[232:233], v[26:27] op_sel_hi:[1,0]
  v_pk_mul_f32 v[234:235], v[234:235], v[26:27] op_sel_hi:[1,0]
  v_pk_mul_f32 v[236:237], v[236:237], v[26:27] op_sel_hi:[1,0]
  v_pk_mul_f32 v[238:239], v[238:239], v[26:27] op_sel_hi:[1,0]
  v_cvt_pk_bf16_f32 v232, v232, v233
  v_cvt_pk_bf16_f32 v233, v234, v235
  v_cvt_pk_bf16_f32 v234, v236, v237
  v_cvt_pk_bf16_f32 v235, v238, v239
  buffer_store_dwordx4 v[232:235], v1, s[20:23], s42 offen offset:1024 sc1
  v_accvgpr_read_b32 v224, a8
  v_accvgpr_read_b32 v225, a9
  v_accvgpr_read_b32 v226, a10
  v_accvgpr_read_b32 v227, a11
  v_accvgpr_read_b32 v228, a12
  v_accvgpr_read_b32 v229, a13
  v_accvgpr_read_b32 v230, a14
  v_accvgpr_read_b32 v231, a15
  v_pk_mul_f32 v[224:225], v[224:225], v[24:25] op_sel_hi:[1,0]
  v_pk_mul_f32 v[226:227], v[226:227], v[24:25] op_sel_hi:[1,0]
  v_pk_mul_f32 v[228:229], v[228:229], v[24:25] op_sel_hi:[1,0]
  v_pk_mul_f32 v[230:231], v[230:231], v[24:25] op_sel_hi:[1,0]
  v_cvt_pk_bf16_f32 v224, v224, v225
  v_cvt_pk_bf16_f32 v225, v226, v227
  v_cvt_pk_bf16_f32 v226, v228, v229
  v_cvt_pk_bf16_f32 v227, v230, v231
  buffer_store_dwordx4 v[224:227], v1, s[20:23], s42 offen offset:2048 sc1
  v_accvgpr_read_b32 v232, a40
  v_accvgpr_read_b32 v233, a41
  v_accvgpr_read_b32 v234, a42
  v_accvgpr_read_b32 v235, a43
  v_accvgpr_read_b32 v236, a44
  v_accvgpr_read_b32 v237, a45
  v_accvgpr_read_b32 v238, a46
  v_accvgpr_read_b32 v239, a47
  v_pk_mul_f32 v[232:233], v[232:233], v[26:27] op_sel_hi:[1,0]
  v_pk_mul_f32 v[234:235], v[234:235], v[26:27] op_sel_hi:[1,0]
  v_pk_mul_f32 v[236:237], v[236:237], v[26:27] op_sel_hi:[1,0]
  v_pk_mul_f32 v[238:239], v[238:239], v[26:27] op_sel_hi:[1,0]
  v_cvt_pk_bf16_f32 v232, v232, v233
  v_cvt_pk_bf16_f32 v233, v234, v235
  v_cvt_pk_bf16_f32 v234, v236, v237
  v_cvt_pk_bf16_f32 v235, v238, v239
  buffer_store_dwordx4 v[232:235], v1, s[20:23], s42 offen offset:3072 sc1
  v_accvgpr_read_b32 v224, a16
  v_accvgpr_read_b32 v225, a17
  v_accvgpr_read_b32 v226, a18
  v_accvgpr_read_b32 v227, a19
  v_accvgpr_read_b32 v228, a20
  v_accvgpr_read_b32 v229, a21
  v_accvgpr_read_b32 v230, a22
  v_accvgpr_read_b32 v231, a23
  v_pk_mul_f32 v[224:225], v[224:225], v[24:25] op_sel_hi:[1,0]
  v_pk_mul_f32 v[226:227], v[226:227], v[24:25] op_sel_hi:[1,0]
  v_pk_mul_f32 v[228:229], v[228:229], v[24:25] op_sel_hi:[1,0]
  v_pk_mul_f32 v[230:231], v[230:231], v[24:25] op_sel_hi:[1,0]
  v_cvt_pk_bf16_f32 v224, v224, v225
  v_cvt_pk_bf16_f32 v225, v226, v227
  v_cvt_pk_bf16_f32 v226, v228, v229
  v_cvt_pk_bf16_f32 v227, v230, v231
  s_add_u32 s42, s57, 4096
  buffer_store_dwordx4 v[224:227], v1, s[20:23], s42 offen offset:0 sc1
  v_accvgpr_read_b32 v232, a48
  v_accvgpr_read_b32 v233, a49
  v_accvgpr_read_b32 v234, a50
  v_accvgpr_read_b32 v235, a51
  v_accvgpr_read_b32 v236, a52
  v_accvgpr_read_b32 v237, a53
  v_accvgpr_read_b32 v238, a54
  v_accvgpr_read_b32 v239, a55
  v_pk_mul_f32 v[232:233], v[232:233], v[26:27] op_sel_hi:[1,0]
  v_pk_mul_f32 v[234:235], v[234:235], v[26:27] op_sel_hi:[1,0]
  v_pk_mul_f32 v[236:237], v[236:237], v[26:27] op_sel_hi:[1,0]
  v_pk_mul_f32 v[238:239], v[238:239], v[26:27] op_sel_hi:[1,0]
  v_cvt_pk_bf16_f32 v232, v232, v233
  v_cvt_pk_bf16_f32 v233, v234, v235
  v_cvt_pk_bf16_f32 v234, v236, v237
  v_cvt_pk_bf16_f32 v235, v238, v239
  buffer_store_dwordx4 v[232:235], v1, s[20:23], s42 offen offset:1024 sc1
  v_accvgpr_read_b32 v224, a24
  v_accvgpr_read_b32 v225, a25
  v_accvgpr_read_b32 v226, a26
  v_accvgpr_read_b32 v227, a27
  v_accvgpr_read_b32 v228, a28
  v_accvgpr_read_b32 v229, a29
  v_accvgpr_read_b32 v230, a30
  v_accvgpr_read_b32 v231, a31
  v_pk_mul_f32 v[224:225], v[224:225], v[24:25] op_sel_hi:[1,0]
  v_pk_mul_f32 v[226:227], v[226:227], v[24:25] op_sel_hi:[1,0]
  v_pk_mul_f32 v[228:229], v[228:229], v[24:25] op_sel_hi:[1,0]
  v_pk_mul_f32 v[230:231], v[230:231], v[24:25] op_sel_hi:[1,0]
  v_cvt_pk_bf16_f32 v224, v224, v225
  v_cvt_pk_bf16_f32 v225, v226, v227
  v_cvt_pk_bf16_f32 v226, v228, v229
  v_cvt_pk_bf16_f32 v227, v230, v231
  buffer_store_dwordx4 v[224:227], v1, s[20:23], s42 offen offset:2048 sc1
  v_accvgpr_read_b32 v232, a56
  v_accvgpr_read_b32 v233, a57
  v_accvgpr_read_b32 v234, a58
  v_accvgpr_read_b32 v235, a59
  v_accvgpr_read_b32 v236, a60
  v_accvgpr_read_b32 v237, a61
  v_accvgpr_read_b32 v238, a62
  v_accvgpr_read_b32 v239, a63
  v_pk_mul_f32 v[232:233], v[232:233], v[26:27] op_sel_hi:[1,0]
  v_pk_mul_f32 v[234:235], v[234:235], v[26:27] op_sel_hi:[1,0]
  v_pk_mul_f32 v[236:237], v[236:237], v[26:27] op_sel_hi:[1,0]
  v_pk_mul_f32 v[238:239], v[238:239], v[26:27] op_sel_hi:[1,0]
  v_cvt_pk_bf16_f32 v232, v232, v233
  v_cvt_pk_bf16_f32 v233, v234, v235
  v_cvt_pk_bf16_f32 v234, v236, v237
  v_cvt_pk_bf16_f32 v235, v238, v239
  buffer_store_dwordx4 v[232:235], v1, s[20:23], s42 offen offset:3072 sc1
  s_cmp_ge_u32 s50, s54
  s_cbranch_scc1 Ldrain
  s_sub_u32 s35, s54, 4
.p2align 6
Ll2:
  s_waitcnt lgkmcnt(0)
  v_mfma_f32_16x16x32_bf16 v[32:35], a[192:195], v[160:163], v[96:99]
  ds_read_b128 a[224:227], v11 offset:0
  v_exp_f32 v24, v48
  v_mfma_f32_16x16x32_bf16 v[32:35], a[196:199], v[164:167], v[32:35]
  v_add_f32 v16, v16, v240
  v_add_f32 v20, v20, v248
  v_mfma_f32_16x16x32_bf16 v[32:35], a[200:203], v[168:171], v[32:35]
  v_exp_f32_e64 v25, v49
  v_mfma_f32_16x16x32_bf16 v[32:35], a[204:207], v[172:175], v[32:35]
  v_add_f32 v17, v17, v244
  v_add_f32 v21, v21, v249
  v_mfma_f32_16x16x32_bf16 v[40:43], a[192:195], v[176:179], v[104:107]
  v_exp_f32_e64 v26, v50
  v_mfma_f32_16x16x32_bf16 v[40:43], a[196:199], v[180:183], v[40:43]
  ds_read_b128 a[228:231], v11 offset:1024
  v_cvt_pk_bf16_f32 v136, v24, v25
  v_mfma_f32_16x16x32_bf16 v[40:43], a[200:203], v[184:187], v[40:43]
  v_exp_f32_e64 v27, v51
  v_mfma_f32_16x16x32_bf16 v[40:43], a[204:207], v[188:191], v[40:43]
  v_cvt_pk_bf16_f32 v137, v26, v27
  s_and_b32 m0, s49, 0x1ffff
  v_mfma_f32_16x16x32_bf16 v[64:67], a[192:195], v[192:195], v[112:115]
  v_exp_f32_e64 v28, v52
  v_mfma_f32_16x16x32_bf16 v[64:67], a[196:199], v[196:199], v[64:67]
  ds_read_b128 a[232:235], v11 offset:2048
  v_mfma_f32_16x16x32_bf16 v[64:67], a[200:203], v[200:203], v[64:67]
  v_exp_f32_e64 v29, v53
  v_mfma_f32_16x16x32_bf16 v[64:67], a[204:207], v[204:207], v[64:67]
  v_exp_f32_e64 v24, v54
  v_mfma_f32_16x16x32_bf16 v[72:75], a[192:195], v[208:211], v[120:123]
  buffer_load_dwordx4 v1, s[16:19], s49 offen offset:0 sc1 lds
  v_mfma_f32_16x16x32_bf16 v[72:75], a[196:199], v[212:215], v[72:75]
  v_exp_f32_e64 v25, v55
  v_mfma_f32_16x16x32_bf16 v[72:75], a[200:203], v[216:219], v[72:75]
  v_cvt_pk_bf16_f32 v138, v28, v29
  v_cvt_pk_bf16_f32 v139, v24, v25
  v_mfma_f32_16x16x32_bf16 v[72:75], a[204:207], v[220:223], v[72:75]
  v_exp_f32_e64 v26, v56
  v_mfma_f32_16x16x32_bf16 v[240:243], v[252:255], v[136:139], 0
  ds_read_b128 a[236:239], v11 offset:3072
  ds_read_b128 a[240:243], v11 offset:4096
  v_mfma_f32_16x16x32_bf16 v[36:39], a[208:211], v[160:163], v[100:103]
  v_exp_f32_e64 v27, v57
  v_mfma_f32_16x16x32_bf16 v[36:39], a[212:215], v[164:167], v[36:39]
  ds_read_b128 a[244:247], v11 offset:5120
  v_cvt_pk_bf16_f32 v140, v26, v27
  v_mfma_f32_16x16x32_bf16 v[36:39], a[216:219], v[168:171], v[36:39]
  v_exp_f32_e64 v28, v58
  v_mfma_f32_16x16x32_bf16 v[36:39], a[220:223], v[172:175], v[36:39]
  v_exp_f32_e64 v29, v59
  v_mfma_f32_16x16x32_bf16 v[44:47], a[208:211], v[176:179], v[108:111]
  v_mov_b32_e64 v248, v240
  v_cvt_pk_bf16_f32 v141, v28, v29
  v_mfma_f32_16x16x32_bf16 v[44:47], a[212:215], v[180:183], v[44:47]
  v_exp_f32_e64 v24, v60
  v_mfma_f32_16x16x32_bf16 v[44:47], a[216:219], v[184:187], v[44:47]
  ds_read_b128 a[248:251], v11 offset:6144
  v_mfma_f32_16x16x32_bf16 v[44:47], a[220:223], v[188:191], v[44:47]
  v_exp_f32_e64 v25, v61
  v_mfma_f32_16x16x32_bf16 v[68:71], a[208:211], v[192:195], v[116:119]
  buffer_load_dwordx4 v1, s[16:19], s49 offen offset:1024 sc1 lds
  v_mfma_f32_16x16x32_bf16 v[68:71], a[212:215], v[196:199], v[68:71]
  v_exp_f32_e64 v26, v62
  v_mfma_f32_16x16x32_bf16 v[68:71], a[216:219], v[200:203], v[68:71]
  ds_read_b128 a[252:255], v11 offset:7168
  v_cvt_pk_bf16_f32 v142, v24, v25
  v_mfma_f32_16x16x32_bf16 v[68:71], a[220:223], v[204:207], v[68:71]
  v_exp_f32_e64 v27, v63
  v_mfma_f32_16x16x32_bf16 v[76:79], a[208:211], v[208:211], v[124:127]
  v_exp_f32_e64 v28, v80
  v_mfma_f32_16x16x32_bf16 v[76:79], a[212:215], v[212:215], v[76:79]
  buffer_load_dwordx4 v1, s[16:19], s49 offen offset:2048 sc1 lds
  v_mfma_f32_16x16x32_bf16 v[76:79], a[216:219], v[216:219], v[76:79]
  v_exp_f32_e64 v29, v81
  v_mfma_f32_16x16x32_bf16 v[76:79], a[220:223], v[220:223], v[76:79]
  v_cvt_pk_bf16_f32 v143, v26, v27
  buffer_load_dwordx4 v1, s[16:19], s49 offen offset:3072 sc1 lds
  s_waitcnt vmcnt(16) lgkmcnt(0)
  v_mfma_f32_16x16x32_bf16 a[128:131], a[224:227], v[128:131], a[128:131]
  s_barrier
  v_cvt_pk_bf16_f32 v152, v28, v29
  v_mfma_f32_16x16x32_bf16 v[244:247], v[252:255], v[140:143], 0
  v_exp_f32_e64 v24, v82
  v_mfma_f32_16x16x32_bf16 a[160:163], a[224:227], v[132:135], a[160:163]
  v_exp_f32_e64 v25, v83
  v_mfma_f32_16x16x32_bf16 a[64:67], a[224:227], v[144:147], a[64:67]
  ds_read_b128 a[192:195], v10 offset:0
  v_cvt_pk_bf16_f32 v153, v24, v25
  v_mfma_f32_16x16x32_bf16 a[96:99], a[224:227], v[148:151], a[96:99]
  v_exp_f32_e64 v26, v84
  v_mfma_f32_16x16x32_bf16 a[132:135], a[228:231], v[128:131], a[132:135]
  v_exp_f32_e64 v27, v85
  v_mfma_f32_16x16x32_bf16 a[164:167], a[228:231], v[132:135], a[164:167]
  v_mov_b32_e64 v249, v244
  v_cvt_pk_bf16_f32 v154, v26, v27
  v_mfma_f32_16x16x32_bf16 a[68:71], a[228:231], v[144:147], a[68:71]
  v_exp_f32_e64 v28, v86
  v_mfma_f32_16x16x32_bf16 a[100:103], a[228:231], v[148:151], a[100:103]
  s_and_b32 m0, s48, 0x1ffff
  v_mfma_f32_16x16x32_bf16 a[136:139], a[232:235], v[128:131], a[136:139]
  v_exp_f32_e64 v29, v87
  v_mfma_f32_16x16x32_bf16 a[168:171], a[232:235], v[132:135], a[168:171]
  ds_read_b128 a[196:199], v10 offset:1024
  v_cvt_pk_bf16_f32 v155, v28, v29
  v_mfma_f32_16x16x32_bf16 a[72:75], a[232:235], v[144:147], a[72:75]
  v_exp_f32_e64 v24, v88
  v_mfma_f32_16x16x32_bf16 v[240:243], v[252:255], v[152:155], 0
  ds_read_b128 a[200:203], v10 offset:2048
  v_mfma_f32_16x16x32_bf16 a[104:107], a[232:235], v[148:151], a[104:107]
  v_exp_f32_e64 v25, v89
  v_mfma_f32_16x16x32_bf16 a[140:143], a[236:239], v[128:131], a[140:143]
  v_exp_f32_e64 v26, v90
  v_mfma_f32_16x16x32_bf16 a[172:175], a[236:239], v[132:135], a[172:175]
  buffer_load_dwordx4 v1, s[16:19], s48 offen offset:0 sc1 lds
  v_mfma_f32_16x16x32_bf16 a[76:79], a[236:239], v[144:147], a[76:79]
  v_exp_f32_e64 v27, v91
  v_mfma_f32_16x16x32_bf16 a[108:111], a[236:239], v[148:151], a[108:111]
  v_cvt_pk_bf16_f32 v156, v24, v25
  v_cvt_pk_bf16_f32 v157, v26, v27
  v_mfma_f32_16x16x32_bf16 a[144:147], a[240:243], v[128:131], a[144:147]
  v_exp_f32_e64 v28, v92
  v_mfma_f32_16x16x32_bf16 a[176:179], a[240:243], v[132:135], a[176:179]
  ds_read_b128 a[204:207], v10 offset:3072
  ds_read_b128 a[208:211], v10 offset:4096
  v_mfma_f32_16x16x32_bf16 a[80:83], a[240:243], v[144:147], a[80:83]
  v_exp_f32_e64 v29, v93
  v_mfma_f32_16x16x32_bf16 a[112:115], a[240:243], v[148:151], a[112:115]
  ds_read_b128 a[212:215], v10 offset:5120
  v_cvt_pk_bf16_f32 v158, v28, v29
  v_mfma_f32_16x16x32_bf16 a[148:151], a[244:247], v[128:131], a[148:151]
  v_exp_f32_e64 v24, v94
  v_mfma_f32_16x16x32_bf16 a[180:183], a[244:247], v[132:135], a[180:183]
  v_exp_f32_e64 v25, v95
  v_mfma_f32_16x16x32_bf16 a[84:87], a[244:247], v[144:147], a[84:87]
  ds_read_b128 a[216:219], v10 offset:6144
  v_cvt_pk_bf16_f32 v159, v24, v25
  v_mfma_f32_16x16x32_bf16 a[116:119], a[244:247], v[148:151], a[116:119]
  buffer_load_dwordx4 v1, s[16:19], s48 offen offset:1024 sc1 lds
  v_mfma_f32_16x16x32_bf16 v[244:247], v[252:255], v[156:159], 0
  ds_read_b128 a[220:223], v10 offset:7168
  s_add_u32 s50, s50, 2
  v_mfma_f32_16x16x32_bf16 a[152:155], a[248:251], v[128:131], a[152:155]
  s_add_u32 s49, s49, 32768
  v_add_u32 v11, 0x8000, v11
  v_mfma_f32_16x16x32_bf16 a[184:187], a[248:251], v[132:135], a[184:187]
  v_and_b32 v11, 0x1ffff, v11
  v_mfma_f32_16x16x32_bf16 a[88:91], a[248:251], v[144:147], a[88:91]
  buffer_load_dwordx4 v1, s[16:19], s48 offen offset:2048 sc1 lds
  v_mfma_f32_16x16x32_bf16 a[120:123], a[248:251], v[148:151], a[120:123]
  v_add_u32 v10, 0x8000, v10
  v_and_b32 v10, 0x1ffff, v10
  v_mfma_f32_16x16x32_bf16 a[156:159], a[252:255], v[128:131], a[156:159]
  buffer_load_dwordx4 v1, s[16:19], s48 offen offset:3072 sc1 lds
  v_mfma_f32_16x16x32_bf16 a[188:191], a[252:255], v[132:135], a[188:191]
  s_add_u32 s48, s48, 32768
  v_max3_f32 v15, v248, v249, v240
  v_mfma_f32_16x16x32_bf16 a[92:95], a[252:255], v[144:147], a[92:95]
  v_max_f32 v15, v15, v244
  v_cmp_lt_f32_e64 vcc, s55, v15
  v_mfma_f32_16x16x32_bf16 a[124:127], a[252:255], v[148:151], a[124:127]
  s_cbranch_vccnz Lst13
Lst13r:
  s_waitcnt lgkmcnt(0)
  v_mfma_f32_16x16x32_bf16 v[48:51], a[192:195], v[160:163], v[96:99]
  ds_read_b128 a[224:227], v11 offset:0
  v_exp_f32_e64 v24, v32
  v_mfma_f32_16x16x32_bf16 v[48:51], a[196:199], v[164:167], v[48:51]
  v_add_f32 v16, v16, v240
  v_add_f32 v20, v20, v248
  v_mfma_f32_16x16x32_bf16 v[48:51], a[200:203], v[168:171], v[48:51]
  v_exp_f32_e64 v25, v33
  v_mfma_f32_16x16x32_bf16 v[48:51], a[204:207], v[172:175], v[48:51]
  v_add_f32 v17, v17, v244
  v_add_f32 v21, v21, v249
  v_mfma_f32_16x16x32_bf16 v[56:59], a[192:195], v[176:179], v[104:107]
  v_exp_f32_e64 v26, v34
  v_mfma_f32_16x16x32_bf16 v[56:59], a[196:199], v[180:183], v[56:59]
  ds_read_b128 a[228:231], v11 offset:1024
  v_cvt_pk_bf16_f32 v128, v24, v25
  v_mfma_f32_16x16x32_bf16 v[56:59], a[200:203], v[184:187], v[56:59]
  v_exp_f32_e64 v27, v35
  v_mfma_f32_16x16x32_bf16 v[56:59], a[204:207], v[188:191], v[56:59]
  v_cvt_pk_bf16_f32 v129, v26, v27
  s_and_b32 m0, s49, 0x1ffff
  v_mfma_f32_16x16x32_bf16 v[80:83], a[192:195], v[192:195], v[112:115]
  v_exp_f32_e64 v28, v36
  v_mfma_f32_16x16x32_bf16 v[80:83], a[196:199], v[196:199], v[80:83]
  ds_read_b128 a[232:235], v11 offset:2048
  v_mfma_f32_16x16x32_bf16 v[80:83], a[200:203], v[200:203], v[80:83]
  v_exp_f32_e64 v29, v37
  v_mfma_f32_16x16x32_bf16 v[80:83], a[204:207], v[204:207], v[80:83]
  v_exp_f32_e64 v24, v38
  v_mfma_f32_16x16x32_bf16 v[88:91], a[192:195], v[208:211], v[120:123]
  buffer_load_dwordx4 v1, s[16:19], s49 offen offset:0 sc1 lds
  v_mfma_f32_16x16x32_bf16 v[88:91], a[196:199], v[212:215], v[88:91]
  v_exp_f32_e64 v25, v39
  v_mfma_f32_16x16x32_bf16 v[88:91], a[200:203], v[216:219], v[88:91]
  v_cvt_pk_bf16_f32 v130, v28, v29
  v_cvt_pk_bf16_f32 v131, v24, v25
  v_mfma_f32_16x16x32_bf16 v[88:91], a[204:207], v[220:223], v[88:91]
  v_exp_f32_e64 v26, v40
  v_mfma_f32_16x16x32_bf16 v[240:243], v[252:255], v[128:131], 0
  ds_read_b128 a[236:239], v11 offset:3072
  ds_read_b128 a[240:243], v11 offset:4096
  v_mfma_f32_16x16x32_bf16 v[52:55], a[208:211], v[160:163], v[100:103]
  v_exp_f32_e64 v27, v41
  v_mfma_f32_16x16x32_bf16 v[52:55], a[212:215], v[164:167], v[52:55]
  ds_read_b128 a[244:247], v11 offset:5120
  v_cvt_pk_bf16_f32 v132, v26, v27
  v_mfma_f32_16x16x32_bf16 v[52:55], a[216:219], v[168:171], v[52:55]
  v_exp_f32_e64 v28, v42
  v_mfma_f32_16x16x32_bf16 v[52:55], a[220:223], v[172:175], v[52:55]
  v_exp_f32_e64 v29, v43
  v_mfma_f32_16x16x32_bf16 v[60:63], a[208:211], v[176:179], v[108:111]
  v_mov_b32_e64 v248, v240
  v_cvt_pk_bf16_f32 v133, v28, v29
  v_mfma_f32_16x16x32_bf16 v[60:63], a[212:215], v[180:183], v[60:63]
  ds_read_b128 a[248:251], v11 offset:6144
  v_exp_f32_e64 v24, v44
  v_mfma_f32_16x16x32_bf16 v[60:63], a[216:219], v[184:187], v[60:63]
  buffer_load_dwordx4 v1, s[16:19], s49 offen offset:1024 sc1 lds
  v_mfma_f32_16x16x32_bf16 v[60:63], a[220:223], v[188:191], v[60:63]
  v_exp_f32_e64 v25, v45
  v_mfma_f32_16x16x32_bf16 v[84:87], a[208:211], v[192:195], v[116:119]
  ds_read_b128 a[252:255], v11 offset:7168
  v_cvt_pk_bf16_f32 v134, v24, v25
  v_mfma_f32_16x16x32_bf16 v[84:87], a[212:215], v[196:199], v[84:87]
  v_exp_f32_e64 v26, v46
  v_mfma_f32_16x16x32_bf16 v[84:87], a[216:219], v[200:203], v[84:87]
  buffer_load_dwordx4 v1, s[16:19], s49 offen offset:2048 sc1 lds
  v_mfma_f32_16x16x32_bf16 v[84:87], a[220:223], v[204:207], v[84:87]
  v_exp_f32_e64 v27, v47
  v_mfma_f32_16x16x32_bf16 v[92:95], a[208:211], v[208:211], v[124:127]
  v_exp_f32_e64 v28, v64
  v_mfma_f32_16x16x32_bf16 v[92:95], a[212:215], v[212:215], v[92:95]
  buffer_load_dwordx4 v1, s[16:19], s49 offen offset:3072 sc1 lds
  v_mfma_f32_16x16x32_bf16 v[92:95], a[216:219], v[216:219], v[92:95]
  v_exp_f32_e64 v29, v65
  v_mfma_f32_16x16x32_bf16 v[92:95], a[220:223], v[220:223], v[92:95]
  v_cvt_pk_bf16_f32 v135, v26, v27
  s_waitcnt vmcnt(16) lgkmcnt(0)
  v_mfma_f32_16x16x32_bf16 a[128:131], a[224:227], v[136:139], a[128:131]
  s_barrier
  v_cvt_pk_bf16_f32 v144, v28, v29
  v_mfma_f32_16x16x32_bf16 v[244:247], v[252:255], v[132:135], 0
  v_exp_f32_e64 v24, v66
  v_mfma_f32_16x16x32_bf16 a[160:163], a[224:227], v[140:143], a[160:163]
  v_exp_f32_e64 v25, v67
  v_mfma_f32_16x16x32_bf16 a[64:67], a[224:227], v[152:155], a[64:67]
  ds_read_b128 a[192:195], v10 offset:0
  v_cvt_pk_bf16_f32 v145, v24, v25
  v_mfma_f32_16x16x32_bf16 a[96:99], a[224:227], v[156:159], a[96:99]
  v_exp_f32_e64 v26, v68
  v_mfma_f32_16x16x32_bf16 a[132:135], a[228:231], v[136:139], a[132:135]
  v_exp_f32_e64 v27, v69
  v_mfma_f32_16x16x32_bf16 a[164:167], a[228:231], v[140:143], a[164:167]
  v_mov_b32_e64 v249, v244
  v_cvt_pk_bf16_f32 v146, v26, v27
  v_mfma_f32_16x16x32_bf16 a[68:71], a[228:231], v[152:155], a[68:71]
  v_exp_f32_e64 v28, v70
  v_mfma_f32_16x16x32_bf16 a[100:103], a[228:231], v[156:159], a[100:103]
  s_and_b32 m0, s48, 0x1ffff
  v_mfma_f32_16x16x32_bf16 a[136:139], a[232:235], v[136:139], a[136:139]
  v_exp_f32_e64 v29, v71
  v_mfma_f32_16x16x32_bf16 a[168:171], a[232:235], v[140:143], a[168:171]
  ds_read_b128 a[196:199], v10 offset:1024
  v_cvt_pk_bf16_f32 v147, v28, v29
  v_mfma_f32_16x16x32_bf16 a[72:75], a[232:235], v[152:155], a[72:75]
  ds_read_b128 a[200:203], v10 offset:2048
  v_exp_f32_e64 v24, v72
  v_mfma_f32_16x16x32_bf16 v[240:243], v[252:255], v[144:147], 0
  buffer_load_dwordx4 v1, s[16:19], s48 offen offset:0 sc1 lds
  v_mfma_f32_16x16x32_bf16 a[104:107], a[232:235], v[156:159], a[104:107]
  v_exp_f32_e64 v25, v73
  v_mfma_f32_16x16x32_bf16 a[140:143], a[236:239], v[136:139], a[140:143]
  v_exp_f32_e64 v26, v74
  v_mfma_f32_16x16x32_bf16 a[172:175], a[236:239], v[140:143], a[172:175]
  ds_read_b128 a[204:207], v10 offset:3072
  v_cvt_pk_bf16_f32 v148, v24, v25
  v_mfma_f32_16x16x32_bf16 a[76:79], a[236:239], v[152:155], a[76:79]
  v_exp_f32_e64 v27, v75
  v_mfma_f32_16x16x32_bf16 a[108:111], a[236:239], v[156:159], a[108:111]
  ds_read_b128 a[208:211], v10 offset:4096
  v_cvt_pk_bf16_f32 v149, v26, v27
  v_mfma_f32_16x16x32_bf16 a[144:147], a[240:243], v[136:139], a[144:147]
  v_exp_f32_e64 v28, v76
  v_mfma_f32_16x16x32_bf16 a[176:179], a[240:243], v[140:143], a[176:179]
  ds_read_b128 a[212:215], v10 offset:5120
  ds_read_b128 a[216:219], v10 offset:6144
  v_mfma_f32_16x16x32_bf16 a[80:83], a[240:243], v[152:155], a[80:83]
  v_exp_f32_e64 v29, v77
  v_mfma_f32_16x16x32_bf16 a[112:115], a[240:243], v[156:159], a[112:115]
  buffer_load_dwordx4 v1, s[16:19], s48 offen offset:1024 sc1 lds
  v_mfma_f32_16x16x32_bf16 a[148:151], a[244:247], v[136:139], a[148:151]
  v_exp_f32_e64 v24, v78
  v_mfma_f32_16x16x32_bf16 a[180:183], a[244:247], v[140:143], a[180:183]
  v_exp_f32_e64 v25, v79
  v_mfma_f32_16x16x32_bf16 a[84:87], a[244:247], v[152:155], a[84:87]
  v_cvt_pk_bf16_f32 v150, v28, v29
  v_cvt_pk_bf16_f32 v151, v24, v25
  v_mfma_f32_16x16x32_bf16 a[116:119], a[244:247], v[156:159], a[116:119]
  ds_read_b128 a[220:223], v10 offset:7168
  s_add_u32 s50, s50, 2
  v_mfma_f32_16x16x32_bf16 v[244:247], v[252:255], v[148:151], 0
  s_add_u32 s49, s49, 32768
  v_add_u32 v11, 0x8000, v11
  v_mfma_f32_16x16x32_bf16 a[152:155], a[248:251], v[136:139], a[152:155]
  v_and_b32 v11, 0x1ffff, v11
  v_mfma_f32_16x16x32_bf16 a[184:187], a[248:251], v[140:143], a[184:187]
  buffer_load_dwordx4 v1, s[16:19], s48 offen offset:2048 sc1 lds
  v_mfma_f32_16x16x32_bf16 a[88:91], a[248:251], v[152:155], a[88:91]
  s_cmp_ge_u32 s50, s53
  s_cbranch_scc1 Lst14
Lst14r:
  v_mfma_f32_16x16x32_bf16 a[120:123], a[248:251], v[156:159], a[120:123]
  v_add_u32 v10, 0x8000, v10
  v_and_b32 v10, 0x1ffff, v10
  v_mfma_f32_16x16x32_bf16 a[156:159], a[252:255], v[136:139], a[156:159]
  buffer_load_dwordx4 v1, s[16:19], s48 offen offset:3072 sc1 lds
  v_mfma_f32_16x16x32_bf16 a[188:191], a[252:255], v[140:143], a[188:191]
  s_add_u32 s48, s48, 32768
  v_max3_f32 v15, v248, v249, v240
  v_mfma_f32_16x16x32_bf16 a[92:95], a[252:255], v[152:155], a[92:95]
  v_max_f32 v15, v15, v244
  v_cmp_lt_f32_e64 vcc, s55, v15
  v_mfma_f32_16x16x32_bf16 a[124:127], a[252:255], v[156:159], a[124:127]
  s_cbranch_vccnz Lst15
Lst15r:
  s_cmp_lt_u32 s50, s35
  s_cbranch_scc1 Ll2
  buffer_atomic_add v7, v3, s[4:7], 0 offen offset:128 sc0 sc1
  s_bfe_u32 s42, s2, 0x20001
  s_lshl_b32 s42, s42, 3
  s_add_u32 s42, s42, s41
  s_lshl_b32 s42, s42, 2
  s_add_u32 s42, s42, s40
  s_lshl_b32 s42, s42, 15
  s_bfe_u32 s43, s2, 0x20003
  s_lshl_b32 s43, s43, 8
  s_add_u32 s42, s42, s43
  v_lshrrev_b32 v6, 1, v0
  v_lshlrev_b32 v6, 10, v6
  v_and_b32_e64 v15, 1, v0
  v_lshl_add_u32 v6, v15, 7, v6
  v_add_u32_e64 v6, s42, v6
  global_load_dword v14, v6, s[36:37]
  s_and_b32 s61, s44, 0xffffff80
  v_and_b32 v9, 7, v0
  v_lshlrev_b32 v9, 2, v9
  buffer_load_dword v8, v9, s[12:15], s61 offen sc1
  s_cmp_gt_u32 s50, s51
  s_cselect_b64 s[26:27], -1, 0
  s_cmp_ge_u32 s50, s51
  s_cselect_b64 s[24:25], -1, 0
  v_cndmask_b32 v236, -v22, v12, s[26:27]
  v_cndmask_b32 v238, -v22, v12, s[24:25]
  v_cndmask_b32 v237, -v23, v12, s[26:27]
  v_cndmask_b32 v239, -v23, v12, s[24:25]
  v_cndmask_b32 v96, v236, v238, s[64:65]
  v_cndmask_b32 v97, v236, v238, s[66:67]
  v_cndmask_b32 v98, v236, v238, s[68:69]
  v_cndmask_b32 v99, v236, v238, s[70:71]
  v_cndmask_b32 v100, v236, v238, s[72:73]
  v_cndmask_b32 v101, v236, v238, s[74:75]
  v_cndmask_b32 v102, v236, v238, s[76:77]
  v_cndmask_b32 v103, v236, v238, s[78:79]
  v_cndmask_b32 v104, v237, v239, s[80:81]
  v_cndmask_b32 v105, v237, v239, s[82:83]
  v_cndmask_b32 v106, v237, v239, s[84:85]
  v_cndmask_b32 v107, v237, v239, s[86:87]
  v_cndmask_b32 v108, v237, v239, s[88:89]
  v_cndmask_b32 v109, v237, v239, s[90:91]
  v_cndmask_b32 v110, v237, v239, s[92:93]
  v_cndmask_b32 v111, v237, v239, s[94:95]
  s_cmp_gt_u32 s50, s52
  s_cselect_b64 s[26:27], -1, 0
  s_cmp_ge_u32 s50, s52
  s_cselect_b64 s[24:25], -1, 0
  v_cndmask_b32 v236, -v30, v12, s[26:27]
  v_cndmask_b32 v238, -v30, v12, s[24:25]
  v_cndmask_b32 v237, -v31, v12, s[26:27]
  v_cndmask_b32 v239, -v31, v12, s[24:25]
  v_cndmask_b32 v112, v236, v238, s[64:65]
  v_cndmask_b32 v113, v236, v238, s[66:67]
  v_cndmask_b32 v114, v236, v238, s[68:69]
  v_cndmask_b32 v115, v236, v238, s[70:71]
  v_cndmask_b32 v116, v236, v238, s[72:73]
  v_cndmask_b32 v117, v236, v238, s[74:75]
  v_cndmask_b32 v118, v236, v238, s[76:77]
  v_cndmask_b32 v119, v236, v238, s[78:79]
  v_cndmask_b32 v120, v237, v239, s[80:81]
  v_cndmask_b32 v121, v237, v239, s[82:83]
  v_cndmask_b32 v122, v237, v239, s[84:85]
  v_cndmask_b32 v123, v237, v239, s[86:87]
  v_cndmask_b32 v124, v237, v239, s[88:89]
  v_cndmask_b32 v125, v237, v239, s[90:91]
  v_cndmask_b32 v126, v237, v239, s[92:93]
  v_cndmask_b32 v127, v237, v239, s[94:95]
  s_nop 1
  s_waitcnt lgkmcnt(0)
  v_mfma_f32_16x16x32_bf16 v[32:35], a[192:195], v[160:163], v[96:99]
  ds_read_b128 a[224:227], v11 offset:0
  v_exp_f32_e64 v24, v48
  v_mfma_f32_16x16x32_bf16 v[32:35], a[196:199], v[164:167], v[32:35]
  v_add_f32 v16, v16, v240
  v_add_f32 v20, v20, v248
  v_add_f32_e64 v17, v17, v244
  v_mfma_f32_16x16x32_bf16 v[32:35], a[200:203], v[168:171], v[32:35]
  ds_read_b128 a[228:231], v11 offset:1024
  v_exp_f32_e64 v25, v49
  v_mfma_f32_16x16x32_bf16 v[32:35], a[204:207], v[172:175], v[32:35]
  v_add_f32_e64 v21, v21, v249
  v_cvt_pk_bf16_f32 v136, v24, v25
  v_mfma_f32_16x16x32_bf16 v[40:43], a[192:195], v[176:179], v[104:107]
  v_exp_f32_e64 v26, v50
  s_and_b32 m0, s49, 0x1ffff
  v_mfma_f32_16x16x32_bf16 v[40:43], a[196:199], v[180:183], v[40:43]
  ds_read_b128 a[232:235], v11 offset:2048
  buffer_load_dwordx4 v1, s[16:19], s49 offen offset:0 sc1 lds
  v_mfma_f32_16x16x32_bf16 v[40:43], a[200:203], v[184:187], v[40:43]
  ds_read_b128 a[236:239], v11 offset:3072
  v_exp_f32_e64 v27, v51
  v_mfma_f32_16x16x32_bf16 v[40:43], a[204:207], v[188:191], v[40:43]
  v_cvt_pk_bf16_f32 v137, v26, v27
  v_mfma_f32_16x16x32_bf16 v[64:67], a[192:195], v[192:195], v[112:115]
  ds_read_b128 a[240:243], v11 offset:4096
  v_exp_f32_e64 v28, v52
  v_mfma_f32_16x16x32_bf16 v[64:67], a[196:199], v[196:199], v[64:67]
  v_mfma_f32_16x16x32_bf16 v[64:67], a[200:203], v[200:203], v[64:67]
  ds_read_b128 a[244:247], v11 offset:5120
  v_exp_f32_e64 v29, v53
  v_mfma_f32_16x16x32_bf16 v[64:67], a[204:207], v[204:207], v[64:67]
  v_exp_f32_e64 v24, v54
  v_mfma_f32_16x16x32_bf16 v[72:75], a[192:195], v[208:211], v[120:123]
  ds_read_b128 a[248:251], v11 offset:6144
  buffer_load_dwordx4 v1, s[16:19], s49 offen offset:1024 sc1 lds
  v_mfma_f32_16x16x32_bf16 v[72:75], a[196:199], v[212:215], v[72:75]
  v_exp_f32_e64 v25, v55
  v_cvt_pk_bf16_f32 v138, v28, v29
  v_mfma_f32_16x16x32_bf16 v[72:75], a[200:203], v[216:219], v[72:75]
  ds_read_b128 a[252:255], v11 offset:7168
  v_cvt_pk_bf16_f32 v139, v24, v25
  v_mfma_f32_16x16x32_bf16 v[72:75], a[204:207], v[220:223], v[72:75]
  v_exp_f32_e64 v26, v56
  v_mfma_f32_16x16x32_bf16 v[240:243], v[252:255], v[136:139], 0
  v_mfma_f32_16x16x32_bf16 v[36:39], a[208:211], v[160:163], v[100:103]
  v_exp_f32_e64 v27, v57
  v_mfma_f32_16x16x32_bf16 v[36:39], a[212:215], v[164:167], v[36:39]
  v_cvt_pk_bf16_f32 v140, v26, v27
  v_mfma_f32_16x16x32_bf16 v[36:39], a[216:219], v[168:171], v[36:39]
  v_exp_f32_e64 v28, v58
  v_mfma_f32_16x16x32_bf16 v[36:39], a[220:223], v[172:175], v[36:39]
  v_exp_f32 v29, v59
  s_add_u32 s50, s50, 2
  v_mfma_f32_16x16x32_bf16 v[44:47], a[208:211], v[176:179], v[108:111]
  v_mov_b32_e64 v248, v240
  v_cvt_pk_bf16_f32 v141, v28, v29
  v_mfma_f32_16x16x32_bf16 v[44:47], a[212:215], v[180:183], v[44:47]
  v_exp_f32_e64 v24, v60
  v_mfma_f32_16x16x32_bf16 v[44:47], a[216:219], v[184:187], v[44:47]
  buffer_load_dwordx4 v1, s[16:19], s49 offen offset:2048 sc1 lds
  v_mfma_f32_16x16x32_bf16 v[44:47], a[220:223], v[188:191], v[44:47]
  v_exp_f32_e64 v25, v61
  v_mfma_f32_16x16x32_bf16 v[68:71], a[208:211], v[192:195], v[116:119]
  v_cvt_pk_bf16_f32 v142, v24, v25
  v_mfma_f32_16x16x32_bf16 v[68:71], a[212:215], v[196:199], v[68:71]
  v_exp_f32_e64 v26, v62
  v_mfma_f32_16x16x32_bf16 v[68:71], a[216:219], v[200:203], v[68:71]
  v_mfma_f32_16x16x32_bf16 v[68:71], a[220:223], v[204:207], v[68:71]
  v_exp_f32_e64 v27, v63
  v_mfma_f32_16x16x32_bf16 v[76:79], a[208:211], v[208:211], v[124:127]
  v_exp_f32_e64 v28, v80
  v_cvt_pk_bf16_f32 v143, v26, v27
  v_mfma_f32_16x16x32_bf16 v[76:79], a[212:215], v[212:215], v[76:79]
  buffer_load_dwordx4 v1, s[16:19], s49 offen offset:3072 sc1 lds
  v_mfma_f32_16x16x32_bf16 v[244:247], v[252:255], v[140:143], 0
  v_exp_f32_e64 v29, v81
  v_mfma_f32_16x16x32_bf16 v[76:79], a[216:219], v[216:219], v[76:79]
  v_cvt_pk_bf16_f32 v152, v28, v29
  v_mfma_f32_16x16x32_bf16 v[76:79], a[220:223], v[220:223], v[76:79]
  v_exp_f32 v24, v82
  s_waitcnt vmcnt(16) lgkmcnt(0)
  v_mfma_f32_16x16x32_bf16 a[128:131], a[224:227], v[128:131], a[128:131]
  s_barrier
  v_mfma_f32_16x16x32_bf16 a[160:163], a[224:227], v[132:135], a[160:163]
  v_exp_f32 v25, v83
  v_mov_b32_e64 v249, v244
  v_mfma_f32_16x16x32_bf16 a[64:67], a[224:227], v[144:147], a[64:67]
  ds_read_b128 a[192:195], v10 offset:0
  v_cvt_pk_bf16_f32 v153, v24, v25
  s_and_b32 m0, s48, 0x1ffff
  v_mfma_f32_16x16x32_bf16 a[96:99], a[224:227], v[148:151], a[96:99]
  v_exp_f32_e64 v26, v84
  s_cmp_gt_u32 s50, s51
  s_cselect_b64 s[26:27], -1, 0
  v_mfma_f32_16x16x32_bf16 a[132:135], a[228:231], v[128:131], a[132:135]
  ds_read_b128 a[196:199], v10 offset:1024
  v_mfma_f32_16x16x32_bf16 a[164:167], a[228:231], v[132:135], a[164:167]
  v_exp_f32_e64 v27, v85
  s_cmp_ge_u32 s50, s51
  s_cselect_b64 s[24:25], -1, 0
  v_mfma_f32_16x16x32_bf16 a[68:71], a[228:231], v[144:147], a[68:71]
  v_exp_f32_e64 v28, v86
  v_mfma_f32_16x16x32_bf16 a[100:103], a[228:231], v[148:151], a[100:103]
  ds_read_b128 a[200:203], v10 offset:2048
  buffer_load_dwordx4 v1, s[16:19], s48 offen offset:0 sc1 lds
  v_mfma_f32_16x16x32_bf16 a[136:139], a[232:235], v[128:131], a[136:139]
  v_exp_f32_e64 v29, v87
  v_mfma_f32_16x16x32_bf16 a[168:171], a[232:235], v[132:135], a[168:171]
  v_cvt_pk_bf16_f32 v154, v26, v27
  v_cvt_pk_bf16_f32 v155, v28, v29
  v_cndmask_b32 v236, -v22, v12, s[26:27]
  v_mfma_f32_16x16x32_bf16 a[72:75], a[232:235], v[144:147], a[72:75]
  ds_read_b128 a[204:207], v10 offset:3072
  v_exp_f32_e64 v24, v88
  v_mfma_f32_16x16x32_bf16 v[240:243], v[252:255], v[152:155], 0
  ds_read_b128 a[208:211], v10 offset:4096
  v_cndmask_b32 v238, -v22, v12, s[24:25]
  v_cndmask_b32 v237, -v23, v12, s[26:27]
  v_mfma_f32_16x16x32_bf16 a[104:107], a[232:235], v[148:151], a[104:107]
  v_exp_f32_e64 v25, v89
  v_mfma_f32_16x16x32_bf16 a[140:143], a[236:239], v[128:131], a[140:143]
  ds_read_b128 a[212:215], v10 offset:5120
  v_exp_f32_e64 v26, v90
  v_mfma_f32_16x16x32_bf16 a[172:175], a[236:239], v[132:135], a[172:175]
  v_cvt_pk_bf16_f32 v156, v24, v25
  v_cndmask_b32 v239, -v23, v12, s[24:25]
  v_cndmask_b32 v96, v236, v238, s[64:65]
  v_mfma_f32_16x16x32_bf16 a[76:79], a[236:239], v[144:147], a[76:79]
  ds_read_b128 a[216:219], v10 offset:6144
  v_exp_f32_e64 v27, v91
  v_mfma_f32_16x16x32_bf16 a[108:111], a[236:239], v[148:151], a[108:111]
  buffer_load_dwordx4 v1, s[16:19], s48 offen offset:1024 sc1 lds
  v_mfma_f32_16x16x32_bf16 a[144:147], a[240:243], v[128:131], a[144:147]
  ds_read_b128 a[220:223], v10 offset:7168
  v_exp_f32_e64 v28, v92
  v_mfma_f32_16x16x32_bf16 a[176:179], a[240:243], v[132:135], a[176:179]
  v_cvt_pk_bf16_f32 v157, v26, v27
  v_cndmask_b32 v97, v236, v238, s[66:67]
  v_cndmask_b32 v98, v236, v238, s[68:69]
  v_mfma_f32_16x16x32_bf16 a[80:83], a[240:243], v[144:147], a[80:83]
  v_exp_f32_e64 v29, v93
  s_add_u32 s49, s49, 32768
  v_mfma_f32_16x16x32_bf16 a[112:115], a[240:243], v[148:151], a[112:115]
  v_cvt_pk_bf16_f32 v158, v28, v29
  v_cndmask_b32 v99, v236, v238, s[70:71]
  v_mfma_f32_16x16x32_bf16 a[148:151], a[244:247], v[128:131], a[148:151]
  v_exp_f32_e64 v24, v94
  v_add_u32 v11, 0x8000, v11
  v_mfma_f32_16x16x32_bf16 a[180:183], a[244:247], v[132:135], a[180:183]
  v_exp_f32_e64 v25, v95
  v_and_b32 v11, 0x1ffff, v11
  v_mfma_f32_16x16x32_bf16 a[84:87], a[244:247], v[144:147], a[84:87]
  buffer_load_dwordx4 v1, s[16:19], s48 offen offset:2048 sc1 lds
  v_cvt_pk_bf16_f32 v159, v24, v25
  v_mfma_f32_16x16x32_bf16 a[116:119], a[244:247], v[148:151], a[116:119]
  v_cndmask_b32 v100, v236, v238, s[72:73]
  v_cndmask_b32 v101, v236, v238, s[74:75]
  v_mfma_f32_16x16x32_bf16 v[244:247], v[252:255], v[156:159], 0
  v_cndmask_b32 v102, v236, v238, s[76:77]
  v_cndmask_b32 v103, v236, v238, s[78:79]
  v_cndmask_b32 v104, v237, v239, s[80:81]
  v_mfma_f32_16x16x32_bf16 a[152:155], a[248:251], v[128:131], a[152:155]
  v_add_u32 v10, 0x8000, v10
  v_and_b32 v10, 0x1ffff, v10
  v_cndmask_b32 v105, v237, v239, s[82:83]
  v_mfma_f32_16x16x32_bf16 a[184:187], a[248:251], v[132:135], a[184:187]
  v_cndmask_b32 v106, v237, v239, s[84:85]
  v_cndmask_b32 v107, v237, v239, s[86:87]
  v_cndmask_b32 v108, v237, v239, s[88:89]
  v_mfma_f32_16x16x32_bf16 a[88:91], a[248:251], v[144:147], a[88:91]
  buffer_load_dwordx4 v1, s[16:19], s48 offen offset:3072 sc1 lds
  v_mfma_f32_16x16x32_bf16 a[120:123], a[248:251], v[148:151], a[120:123]
  s_add_u32 s48, s48, 32768
  v_cndmask_b32 v109, v237, v239, s[90:91]
  v_cndmask_b32 v110, v237, v239, s[92:93]
  v_mfma_f32_16x16x32_bf16 a[156:159], a[252:255], v[128:131], a[156:159]
  v_cndmask_b32 v111, v237, v239, s[94:95]
  s_cmp_gt_u32 s50, s52
  s_cselect_b64 s[26:27], -1, 0
  v_mfma_f32_16x16x32_bf16 a[188:191], a[252:255], v[132:135], a[188:191]
  s_cmp_ge_u32 s50, s52
  s_cselect_b64 s[24:25], -1, 0
  v_mfma_f32_16x16x32_bf16 a[92:95], a[252:255], v[144:147], a[92:95]
  v_cndmask_b32 v236, -v30, v12, s[26:27]
  v_cndmask_b32 v238, -v30, v12, s[24:25]
  v_cndmask_b32 v237, -v31, v12, s[26:27]
  v_cndmask_b32 v239, -v31, v12, s[24:25]
  v_cndmask_b32 v112, v236, v238, s[64:65]
  v_cndmask_b32 v113, v236, v238, s[66:67]
  v_cndmask_b32 v114, v236, v238, s[68:69]
  v_cndmask_b32 v115, v236, v238, s[70:71]
  v_cndmask_b32 v116, v236, v238, s[72:73]
  v_cndmask_b32 v117, v236, v238, s[74:75]
  v_cndmask_b32 v118, v236, v238, s[76:77]
  v_cndmask_b32 v119, v236, v238, s[78:79]
  v_cndmask_b32 v120, v237, v239, s[80:81]
  v_cndmask_b32 v121, v237, v239, s[82:83]
  v_cndmask_b32 v122, v237, v239, s[84:85]
  v_cndmask_b32 v123, v237, v239, s[86:87]
  v_cndmask_b32 v124, v237, v239, s[88:89]
  v_cndmask_b32 v125, v237, v239, s[90:91]
  v_cndmask_b32 v126, v237, v239, s[92:93]
  v_cndmask_b32 v127, v237, v239, s[94:95]
  v_max3_f32 v15, v248, v249, v240
  v_max_f32 v15, v15, v244
  v_cmp_lt_f32 vcc, s55, v15
  v_mfma_f32_16x16x32_bf16 a[124:127], a[252:255], v[148:151], a[124:127]
  s_cbranch_vccnz Lst16
Lst16r:
  s_waitcnt vmcnt(8)
  v_cmp_gt_u32 vcc, 1, v8
  s_lshl_b32 s42, s41, 1
  s_and_b32 s43, s2, 1
  s_add_u32 s42, s42, s43
  s_lshl_b32 s42, s42, 1
  s_lshr_b32 s43, s40, 1
  s_add_u32 s42, s42, s43
  s_lshl_b32 s42, s42, 2
  s_bfe_u32 s43, s2, 0x20001
  s_add_u32 s42, s42, s43
  s_lshl_b32 s42, s42, 2
  s_bfe_u32 s43, s2, 0x20003
  s_add_u32 s42, s42, s43
  s_lshl_b32 s42, s42, 14
  s_add_u32 s42, s42, s56
  v_lshlrev_b32_e64 v6, 7, v0
  s_cbranch_vccnz Lnoct
  buffer_load_dword v14, v6, s[20:23], s42 offen sc1
Lnoct:
  s_waitcnt lgkmcnt(0)
  v_mfma_f32_16x16x32_bf16 v[48:51], a[192:195], v[160:163], v[96:99]
  ds_read_b128 a[224:227], v11 offset:0
  v_exp_f32 v24, v32
  v_mfma_f32_16x16x32_bf16 v[48:51], a[196:199], v[164:167], v[48:51]
  v_add_f32 v16, v16, v240
  v_add_f32 v20, v20, v248
  v_mfma_f32_16x16x32_bf16 v[48:51], a[200:203], v[168:171], v[48:51]
  v_exp_f32_e64 v25, v33
  v_mfma_f32_16x16x32_bf16 v[48:51], a[204:207], v[172:175], v[48:51]
  v_add_f32 v17, v17, v244
  v_add_f32 v21, v21, v249
  v_mfma_f32_16x16x32_bf16 v[56:59], a[192:195], v[176:179], v[104:107]
  v_exp_f32_e64 v26, v34
  v_mfma_f32_16x16x32_bf16 v[56:59], a[196:199], v[180:183], v[56:59]
  ds_read_b128 a[228:231], v11 offset:1024
  v_cvt_pk_bf16_f32 v128, v24, v25
  v_mfma_f32_16x16x32_bf16 v[56:59], a[200:203], v[184:187], v[56:59]
  v_exp_f32_e64 v27, v35
  v_mfma_f32_16x16x32_bf16 v[56:59], a[204:207], v[188:191], v[56:59]
  v_cvt_pk_bf16_f32 v129, v26, v27
  s_and_b32 m0, s49, 0x1ffff
  v_mfma_f32_16x16x32_bf16 v[80:83], a[192:195], v[192:195], v[112:115]
  v_exp_f32_e64 v28, v36
  v_mfma_f32_16x16x32_bf16 v[80:83], a[196:199], v[196:199], v[80:83]
  ds_read_b128 a[232:235], v11 offset:2048
  v_mfma_f32_16x16x32_bf16 v[80:83], a[200:203], v[200:203], v[80:83]
  v_exp_f32_e64 v29, v37
  v_mfma_f32_16x16x32_bf16 v[80:83], a[204:207], v[204:207], v[80:83]
  v_exp_f32_e64 v24, v38
  v_mfma_f32_16x16x32_bf16 v[88:91], a[192:195], v[208:211], v[120:123]
  buffer_load_dwordx4 v1, s[16:19], s49 offen offset:0 sc1 lds
  v_mfma_f32_16x16x32_bf16 v[88:91], a[196:199], v[212:215], v[88:91]
  v_exp_f32_e64 v25, v39
  v_mfma_f32_16x16x32_bf16 v[88:91], a[200:203], v[216:219], v[88:91]
  v_cvt_pk_bf16_f32 v130, v28, v29
  v_cvt_pk_bf16_f32 v131, v24, v25
  v_mfma_f32_16x16x32_bf16 v[88:91], a[204:207], v[220:223], v[88:91]
  v_exp_f32_e64 v26, v40
  v_mfma_f32_16x16x32_bf16 v[240:243], v[252:255], v[128:131], 0
  ds_read_b128 a[236:239], v11 offset:3072
  ds_read_b128 a[240:243], v11 offset:4096
  v_mfma_f32_16x16x32_bf16 v[52:55], a[208:211], v[160:163], v[100:103]
  v_exp_f32_e64 v27, v41
  v_mfma_f32_16x16x32_bf16 v[52:55], a[212:215], v[164:167], v[52:55]
  ds_read_b128 a[244:247], v11 offset:5120
  v_cvt_pk_bf16_f32 v132, v26, v27
  v_mfma_f32_16x16x32_bf16 v[52:55], a[216:219], v[168:171], v[52:55]
  v_exp_f32_e64 v28, v42
  v_mfma_f32_16x16x32_bf16 v[52:55], a[220:223], v[172:175], v[52:55]
  v_exp_f32_e64 v29, v43
  v_mfma_f32_16x16x32_bf16 v[60:63], a[208:211], v[176:179], v[108:111]
  v_mov_b32_e64 v248, v240
  v_cvt_pk_bf16_f32 v133, v28, v29
  v_mfma_f32_16x16x32_bf16 v[60:63], a[212:215], v[180:183], v[60:63]
  v_exp_f32_e64 v24, v44
  v_mfma_f32_16x16x32_bf16 v[60:63], a[216:219], v[184:187], v[60:63]
  ds_read_b128 a[248:251], v11 offset:6144
  v_mfma_f32_16x16x32_bf16 v[60:63], a[220:223], v[188:191], v[60:63]
  v_exp_f32_e64 v25, v45
  v_mfma_f32_16x16x32_bf16 v[84:87], a[208:211], v[192:195], v[116:119]
  buffer_load_dwordx4 v1, s[16:19], s49 offen offset:1024 sc1 lds
  v_mfma_f32_16x16x32_bf16 v[84:87], a[212:215], v[196:199], v[84:87]
  v_exp_f32_e64 v26, v46
  v_mfma_f32_16x16x32_bf16 v[84:87], a[216:219], v[200:203], v[84:87]
  ds_read_b128 a[252:255], v11 offset:7168
  v_cvt_pk_bf16_f32 v134, v24, v25
  v_mfma_f32_16x16x32_bf16 v[84:87], a[220:223], v[204:207], v[84:87]
  v_exp_f32_e64 v27, v47
  v_mfma_f32_16x16x32_bf16 v[92:95], a[208:211], v[208:211], v[124:127]
  v_exp_f32_e64 v28, v64
  v_mfma_f32_16x16x32_bf16 v[92:95], a[212:215], v[212:215], v[92:95]
  buffer_load_dwordx4 v1, s[16:19], s49 offen offset:2048 sc1 lds
  v_mfma_f32_16x16x32_bf16 v[92:95], a[216:219], v[216:219], v[92:95]
  v_exp_f32_e64 v29, v65
  v_mfma_f32_16x16x32_bf16 v[92:95], a[220:223], v[220:223], v[92:95]
  v_cvt_pk_bf16_f32 v135, v26, v27
  buffer_load_dwordx4 v1, s[16:19], s49 offen offset:3072 sc1 lds
  s_waitcnt vmcnt(16) lgkmcnt(0)
  v_mfma_f32_16x16x32_bf16 a[128:131], a[224:227], v[136:139], a[128:131]
  s_barrier
  v_cvt_pk_bf16_f32 v144, v28, v29
  v_mfma_f32_16x16x32_bf16 v[244:247], v[252:255], v[132:135], 0
  v_exp_f32_e64 v24, v66
  v_mfma_f32_16x16x32_bf16 a[160:163], a[224:227], v[140:143], a[160:163]
  v_exp_f32_e64 v25, v67
  v_mfma_f32_16x16x32_bf16 a[64:67], a[224:227], v[152:155], a[64:67]
  ds_read_b128 a[192:195], v10 offset:0
  v_cvt_pk_bf16_f32 v145, v24, v25
  v_mfma_f32_16x16x32_bf16 a[96:99], a[224:227], v[156:159], a[96:99]
  v_exp_f32_e64 v26, v68
  v_mfma_f32_16x16x32_bf16 a[132:135], a[228:231], v[136:139], a[132:135]
  v_exp_f32_e64 v27, v69
  v_mfma_f32_16x16x32_bf16 a[164:167], a[228:231], v[140:143], a[164:167]
  v_mov_b32_e64 v249, v244
  v_cvt_pk_bf16_f32 v146, v26, v27
  v_mfma_f32_16x16x32_bf16 a[68:71], a[228:231], v[152:155], a[68:71]
  v_exp_f32_e64 v28, v70
  v_mfma_f32_16x16x32_bf16 a[100:103], a[228:231], v[156:159], a[100:103]
  s_and_b32 m0, s48, 0x1ffff
  v_mfma_f32_16x16x32_bf16 a[136:139], a[232:235], v[136:139], a[136:139]
  v_exp_f32_e64 v29, v71
  v_mfma_f32_16x16x32_bf16 a[168:171], a[232:235], v[140:143], a[168:171]
  ds_read_b128 a[196:199], v10 offset:1024
  v_cvt_pk_bf16_f32 v147, v28, v29
  v_mfma_f32_16x16x32_bf16 a[72:75], a[232:235], v[152:155], a[72:75]
  v_exp_f32_e64 v24, v72
  v_mfma_f32_16x16x32_bf16 v[240:243], v[252:255], v[144:147], 0
  ds_read_b128 a[200:203], v10 offset:2048
  v_mfma_f32_16x16x32_bf16 a[104:107], a[232:235], v[156:159], a[104:107]
  v_exp_f32_e64 v25, v73
  v_mfma_f32_16x16x32_bf16 a[140:143], a[236:239], v[136:139], a[140:143]
  v_exp_f32_e64 v26, v74
  v_mfma_f32_16x16x32_bf16 a[172:175], a[236:239], v[140:143], a[172:175]
  buffer_load_dwordx4 v1, s[16:19], s48 offen offset:0 sc1 lds
  v_mfma_f32_16x16x32_bf16 a[76:79], a[236:239], v[152:155], a[76:79]
  v_exp_f32_e64 v27, v75
  v_mfma_f32_16x16x32_bf16 a[108:111], a[236:239], v[156:159], a[108:111]
  v_cvt_pk_bf16_f32 v148, v24, v25
  v_cvt_pk_bf16_f32 v149, v26, v27
  v_mfma_f32_16x16x32_bf16 a[144:147], a[240:243], v[136:139], a[144:147]
  v_exp_f32_e64 v28, v76
  v_mfma_f32_16x16x32_bf16 a[176:179], a[240:243], v[140:143], a[176:179]
  ds_read_b128 a[204:207], v10 offset:3072
  ds_read_b128 a[208:211], v10 offset:4096
  v_mfma_f32_16x16x32_bf16 a[80:83], a[240:243], v[152:155], a[80:83]
  v_exp_f32_e64 v29, v77
  v_mfma_f32_16x16x32_bf16 a[112:115], a[240:243], v[156:159], a[112:115]
  ds_read_b128 a[212:215], v10 offset:5120
  v_cvt_pk_bf16_f32 v150, v28, v29
  v_mfma_f32_16x16x32_bf16 a[148:151], a[244:247], v[136:139], a[148:151]
  v_exp_f32_e64 v24, v78
  v_mfma_f32_16x16x32_bf16 a[180:183], a[244:247], v[140:143], a[180:183]
  v_exp_f32_e64 v25, v79
  v_mfma_f32_16x16x32_bf16 a[84:87], a[244:247], v[152:155], a[84:87]
  ds_read_b128 a[216:219], v10 offset:6144
  v_cvt_pk_bf16_f32 v151, v24, v25
  v_mfma_f32_16x16x32_bf16 a[116:119], a[244:247], v[156:159], a[116:119]
  buffer_load_dwordx4 v1, s[16:19], s48 offen offset:1024 sc1 lds
  v_mfma_f32_16x16x32_bf16 v[244:247], v[252:255], v[148:151], 0
  ds_read_b128 a[220:223], v10 offset:7168
  s_add_u32 s50, s50, 2
  v_mfma_f32_16x16x32_bf16 a[152:155], a[248:251], v[136:139], a[152:155]
  s_add_u32 s49, s49, 32768
  v_add_u32 v11, 0x8000, v11
  v_mfma_f32_16x16x32_bf16 a[184:187], a[248:251], v[140:143], a[184:187]
  v_and_b32 v11, 0x1ffff, v11
  v_mfma_f32_16x16x32_bf16 a[88:91], a[248:251], v[152:155], a[88:91]
  buffer_load_dwordx4 v1, s[16:19], s48 offen offset:2048 sc1 lds
  v_mfma_f32_16x16x32_bf16 a[120:123], a[248:251], v[156:159], a[120:123]
  v_add_u32 v10, 0x8000, v10
  v_and_b32 v10, 0x1ffff, v10
  v_mfma_f32_16x16x32_bf16 a[156:159], a[252:255], v[136:139], a[156:159]
  buffer_load_dwordx4 v1, s[16:19], s48 offen offset:3072 sc1 lds
  v_mfma_f32_16x16x32_bf16 a[188:191], a[252:255], v[140:143], a[188:191]
  s_add_u32 s48, s48, 32768
  v_max3_f32 v15, v248, v249, v240
  v_mfma_f32_16x16x32_bf16 a[92:95], a[252:255], v[152:155], a[92:95]
  v_max_f32 v15, v15, v244
  v_cmp_lt_f32_e64 vcc, s55, v15
  v_mfma_f32_16x16x32_bf16 a[124:127], a[252:255], v[156:159], a[124:127]
  s_cbranch_vccnz Lst17
Lst17r:
Ldrain:
  s_mov_b32 s35, 0x430800
  buffer_load_dwordx4 v[224:227], v1, s[12:15], s35 offen sc1
  s_waitcnt lgkmcnt(0)
  ds_read_b128 a[224:227], v11 offset:0
  ds_read_b128 a[228:231], v11 offset:1024
  ds_read_b128 a[232:235], v11 offset:2048
  ds_read_b128 a[236:239], v11 offset:3072
  ds_read_b128 a[240:243], v11 offset:4096
  ds_read_b128 a[244:247], v11 offset:5120
  ds_read_b128 a[248:251], v11 offset:6144
  ds_read_b128 a[252:255], v11 offset:7168
  v_add_f32 v20, v20, v248
  v_add_f32 v21, v21, v249
  v_add_f32 v16, v16, v240
  v_add_f32 v17, v17, v244
  v_exp_f32 v24, v48
  v_exp_f32 v25, v49
  v_exp_f32_e64 v26, v50
  s_and_b32 s61, s44, 0xffffff80
  v_and_b32 v9, 7, v0
  v_lshlrev_b32 v9, 2, v9
  v_cvt_pk_bf16_f32 v136, v24, v25
  v_exp_f32 v27, v51
  v_exp_f32 v28, v52
  v_cvt_pk_bf16_f32 v137, v26, v27
  v_exp_f32 v29, v53
  v_exp_f32 v24, v54
  v_cvt_pk_bf16_f32 v138, v28, v29
  v_exp_f32 v25, v55
  v_exp_f32 v26, v56
  v_cvt_pk_bf16_f32 v139, v24, v25
  v_exp_f32 v27, v57
  v_exp_f32 v28, v58
  v_cvt_pk_bf16_f32 v140, v26, v27
  v_mfma_f32_16x16x32_bf16 v[240:243], v[252:255], v[136:139], 0
  v_exp_f32 v29, v59
  v_exp_f32 v24, v60
  v_cvt_pk_bf16_f32 v141, v28, v29
  v_exp_f32_e64 v25, v61
  v_add_u32 v11, 0x8000, v11
  v_and_b32 v11, 0x1ffff, v11
  v_exp_f32_e64 v26, v62
  v_cvt_pk_bf16_f32 v142, v24, v25
  v_exp_f32 v27, v63
  s_waitcnt vmcnt(1) lgkmcnt(0)
  v_mfma_f32_16x16x32_bf16 a[128:131], a[224:227], v[128:131], a[128:131]
  s_barrier
  v_mov_b32 v4, 1
  v_mfma_f32_16x16x32_bf16 a[160:163], a[224:227], v[132:135], a[160:163]
  buffer_store_dword v4, v3, s[12:15], s44 offen sc1
  v_mfma_f32_16x16x32_bf16 a[64:67], a[224:227], v[144:147], a[64:67]
  ds_read_b128 a[192:195], v11 offset:0
  v_exp_f32_e64 v28, v80
  v_mfma_f32_16x16x32_bf16 a[96:99], a[224:227], v[148:151], a[96:99]
  v_cvt_pk_bf16_f32 v143, v26, v27
  v_mfma_f32_16x16x32_bf16 a[132:135], a[228:231], v[128:131], a[132:135]
  ds_read_b128 a[196:199], v11 offset:1024
  v_exp_f32_e64 v29, v81
  v_mfma_f32_16x16x32_bf16 a[164:167], a[228:231], v[132:135], a[164:167]
  v_mov_b32_e64 v248, v240
  v_mfma_f32_16x16x32_bf16 a[68:71], a[228:231], v[144:147], a[68:71]
  ds_read_b128 a[200:203], v11 offset:2048
  v_exp_f32_e64 v24, v82
  v_mfma_f32_16x16x32_bf16 a[100:103], a[228:231], v[148:151], a[100:103]
  v_cvt_pk_bf16_f32 v152, v28, v29
  v_mfma_f32_16x16x32_bf16 a[136:139], a[232:235], v[128:131], a[136:139]
  ds_read_b128 a[204:207], v11 offset:3072
  v_mfma_f32_16x16x32_bf16 v[244:247], v[252:255], v[140:143], 0
  v_mfma_f32_16x16x32_bf16 a[168:171], a[232:235], v[132:135], a[168:171]
  v_exp_f32_e64 v25, v83
  v_mfma_f32_16x16x32_bf16 a[72:75], a[232:235], v[144:147], a[72:75]
  ds_read_b128 a[208:211], v11 offset:4096
  v_exp_f32_e64 v26, v84
  v_mfma_f32_16x16x32_bf16 a[104:107], a[232:235], v[148:151], a[104:107]
  v_cvt_pk_bf16_f32 v153, v24, v25
  v_mfma_f32_16x16x32_bf16 a[140:143], a[236:239], v[128:131], a[140:143]
  ds_read_b128 a[212:215], v11 offset:5120
  v_mfma_f32_16x16x32_bf16 a[172:175], a[236:239], v[132:135], a[172:175]
  v_exp_f32_e64 v27, v85
  v_mfma_f32_16x16x32_bf16 a[76:79], a[236:239], v[144:147], a[76:79]
  ds_read_b128 a[216:219], v11 offset:6144
  v_exp_f32_e64 v28, v86
  v_mfma_f32_16x16x32_bf16 a[108:111], a[236:239], v[148:151], a[108:111]
  v_cvt_pk_bf16_f32 v154, v26, v27
  v_mfma_f32_16x16x32_bf16 a[144:147], a[240:243], v[128:131], a[144:147]
  ds_read_b128 a[220:223], v11 offset:7168
  v_exp_f32_e64 v29, v87
  v_mfma_f32_16x16x32_bf16 a[176:179], a[240:243], v[132:135], a[176:179]
  v_exp_f32_e64 v24, v88
  v_mfma_f32_16x16x32_bf16 a[80:83], a[240:243], v[144:147], a[80:83]
  v_cvt_pk_bf16_f32 v155, v28, v29
  v_exp_f32_e64 v25, v89
  v_mfma_f32_16x16x32_bf16 a[112:115], a[240:243], v[148:151], a[112:115]
  v_mov_b32_e64 v249, v244
  v_mfma_f32_16x16x32_bf16 a[148:151], a[244:247], v[128:131], a[148:151]
  v_exp_f32_e64 v26, v90
  v_mfma_f32_16x16x32_bf16 a[180:183], a[244:247], v[132:135], a[180:183]
  v_cvt_pk_bf16_f32 v156, v24, v25
  v_mfma_f32_16x16x32_bf16 a[84:87], a[244:247], v[144:147], a[84:87]
  buffer_load_dword v8, v9, s[12:15], s61 offen sc1
  v_mfma_f32_16x16x32_bf16 a[116:119], a[244:247], v[148:151], a[116:119]
  v_mfma_f32_16x16x32_bf16 v[240:243], v[252:255], v[152:155], 0
  v_exp_f32_e64 v27, v91
  v_mfma_f32_16x16x32_bf16 a[152:155], a[248:251], v[128:131], a[152:155]
  v_exp_f32_e64 v28, v92
  v_cvt_pk_bf16_f32 v157, v26, v27
  v_exp_f32 v29, v93
  v_exp_f32 v24, v94
  v_mfma_f32_16x16x32_bf16 a[184:187], a[248:251], v[132:135], a[184:187]
  v_cvt_pk_bf16_f32 v158, v28, v29
  v_exp_f32 v25, v95
  s_nop 0
  v_cvt_pk_bf16_f32 v159, v24, v25
  s_nop 1
  v_mfma_f32_16x16x32_bf16 v[244:247], v[252:255], v[156:159], 0
  v_mfma_f32_16x16x32_bf16 a[88:91], a[248:251], v[144:147], a[88:91]
  v_mfma_f32_16x16x32_bf16 a[120:123], a[248:251], v[148:151], a[120:123]
  v_mfma_f32_16x16x32_bf16 a[156:159], a[252:255], v[128:131], a[156:159]
  s_nop 7
  v_max3_f32 v15, v248, v249, v240
  v_mfma_f32_16x16x32_bf16 a[188:191], a[252:255], v[132:135], a[188:191]
  v_max_f32 v15, v15, v244
  v_cmp_lt_f32 vcc, s55, v15
  v_mfma_f32_16x16x32_bf16 a[92:95], a[252:255], v[144:147], a[92:95]
  v_mfma_f32_16x16x32_bf16 a[124:127], a[252:255], v[148:151], a[124:127]
  s_cbranch_vccnz Lst18
Lst18r:
  v_add_f32 v20, v20, v248
  v_add_f32 v21, v21, v249
  v_add_f32 v16, v16, v240
  v_add_f32 v17, v17, v244
  s_cmp_lg_u32 s40, 0
  s_cbranch_scc1 Lnotk
  v_lshlrev_b32 v6, 2, v0
  v_add_u32 v6, 133120, v6
  ds_write_b32 v6, v7
Lnotk:
  s_waitcnt lgkmcnt(0)
  s_barrier
  v_mov_b32 v6, 133120
  ds_read_b128 v[232:235], v6
  v_mfma_f32_16x16x32_bf16 a[128:131], a[192:195], v[136:139], a[128:131]
  s_lshl_b32 s42, s40, 14
  v_add_u32 v26, s42, v1
  v_xor_b32 v27, 0x4000, v26
  v_mfma_f32_16x16x32_bf16 a[132:135], a[196:199], v[136:139], a[132:135]
  s_lshl_b32 s54, s40, 12
  s_xor_b32 s42, s54, 135168
  v_add_u32 v13, s42, v1
  v_mfma_f32_16x16x32_bf16 a[136:139], a[200:203], v[136:139], a[136:139]
  ds_write_b128 v13, v[20:23]
  v_xor_b32 v13, 0x1000, v13
  s_bfe_u32 s48, s2, 0x20001
  v_mfma_f32_16x16x32_bf16 a[140:143], a[204:207], v[136:139], a[140:143]
  s_waitcnt lgkmcnt(1)
  v_readfirstlane_b32 s46, v232
  s_nop 1
  v_mfma_f32_16x16x32_bf16 a[144:147], a[208:211], v[136:139], a[144:147]
  s_and_b32 s46, s46, 255
  s_and_b32 s88, s45, 0xffffff80
  s_bfe_u32 s50, s2, 0x20003
  v_mfma_f32_16x16x32_bf16 a[148:151], a[212:215], v[136:139], a[148:151]
  s_lshl_b32 s51, s50, 1
  s_lshr_b32 s42, s40, 1
  s_add_u32 s51, s51, s42
  v_mfma_f32_16x16x32_bf16 a[152:155], a[216:219], v[136:139], a[152:155]
  s_lshl_b32 s51, s51, 7
  s_lshl_b32 s43, s48, 20
  s_add_u32 s51, s51, s43
  v_mfma_f32_16x16x32_bf16 a[156:159], a[220:223], v[136:139], a[156:159]
  s_lshl_b32 s43, s56, 2
  s_add_u32 s51, s51, s43
  s_and_b32 s49, s2, 1
  v_mfma_f32_16x16x32_bf16 a[160:163], a[192:195], v[140:143], a[160:163]
  s_lshl_b32 s43, s49, 1
  s_add_u32 s42, s42, s43
  v_mfma_f32_16x16x32_bf16 a[164:167], a[196:199], v[140:143], a[164:167]
  ds_write_b128 v26, a[128:131] offset:0
  s_lshl_b32 s42, s42, 18
  v_mfma_f32_16x16x32_bf16 a[168:171], a[200:203], v[140:143], a[168:171]
  ds_write_b128 v26, a[132:135] offset:1024
  s_lshl_b32 s43, s48, 16
  v_mfma_f32_16x16x32_bf16 a[172:175], a[204:207], v[140:143], a[172:175]
  s_add_u32 s42, s42, s43
  s_lshr_b32 s43, s56, 1
  v_mfma_f32_16x16x32_bf16 a[176:179], a[208:211], v[140:143], a[176:179]
  ds_write_b128 v26, a[136:139] offset:2048
  s_add_u32 s42, s42, s43
  v_mfma_f32_16x16x32_bf16 a[180:183], a[212:215], v[140:143], a[180:183]
  ds_write_b128 v26, a[140:143] offset:3072
  s_lshl_b32 s43, s41, 20
  v_mfma_f32_16x16x32_bf16 a[184:187], a[216:219], v[140:143], a[184:187]
  s_add_u32 s52, s42, s43
  s_sub_u32 s89, s42, s43
  v_mfma_f32_16x16x32_bf16 a[188:191], a[220:223], v[140:143], a[188:191]
  ds_write_b128 v26, a[144:147] offset:4096
  s_add_u32 s89, s89, 15663104
  v_mfma_f32_16x16x32_bf16 a[64:67], a[192:195], v[152:155], a[64:67]
  ds_write_b128 v26, a[148:151] offset:5120
  s_mov_b32 s8, s36
  v_mfma_f32_16x16x32_bf16 a[68:71], a[196:199], v[152:155], a[68:71]
  s_and_b32 s9, s37, 0xffff
  s_mov_b32 s10, 0x400000
  v_mfma_f32_16x16x32_bf16 a[72:75], a[200:203], v[152:155], a[72:75]
  ds_write_b128 v26, a[152:155] offset:6144
  s_mov_b32 s11, 0x20000
  v_mfma_f32_16x16x32_bf16 a[76:79], a[204:207], v[152:155], a[76:79]
  ds_write_b128 v26, a[156:159] offset:7168
  v_lshrrev_b32 v248, 3, v0
  v_mfma_f32_16x16x32_bf16 a[80:83], a[208:211], v[152:155], a[80:83]
  v_lshlrev_b32_e64 v248, 10, v248
  v_bfe_u32 v249, v0, 1, 2
  v_mfma_f32_16x16x32_bf16 a[84:87], a[212:215], v[152:155], a[84:87]
  ds_write_b128 v26, a[160:163] offset:8192
  v_lshrrev_b32_e64 v250, 4, v0
  v_mfma_f32_16x16x32_bf16 a[88:91], a[216:219], v[152:155], a[88:91]
  ds_write_b128 v26, a[164:167] offset:9216
  v_xor_b32_e64 v249, v249, v250
  v_mfma_f32_16x16x32_bf16 a[92:95], a[220:223], v[152:155], a[92:95]
  v_lshl_add_u32 v248, v249, 5, v248
  v_and_b32_e64 v249, 1, v0
  v_mfma_f32_16x16x32_bf16 a[96:99], a[192:195], v[156:159], a[96:99]
  ds_write_b128 v26, a[168:171] offset:10240
  v_lshl_add_u32 v244, v249, 4, v248
  v_mfma_f32_16x16x32_bf16 a[100:103], a[196:199], v[156:159], a[100:103]
  ds_write_b128 v26, a[172:175] offset:11264
  v_add_u32 v245, 7168, v244
  v_mfma_f32_16x16x32_bf16 a[104:107], a[200:203], v[156:159], a[104:107]
  v_add_u32 v246, 14336, v244
  v_add_u32 v247, 21504, v244
  v_mfma_f32_16x16x32_bf16 a[108:111], a[204:207], v[156:159], a[108:111]
  ds_write_b128 v26, a[176:179] offset:12288
  s_mov_b32 s64, s98
  v_mfma_f32_16x16x32_bf16 a[112:115], a[208:211], v[156:159], a[112:115]
  ds_write_b128 v26, a[180:183] offset:13312
  s_and_b32 s65, s99, 0xffff
  v_mfma_f32_16x16x32_bf16 a[116:119], a[212:215], v[156:159], a[116:119]
  s_mov_b32 s66, 0x158000
  s_mov_b32 s67, 0x20000
  v_mfma_f32_16x16x32_bf16 a[120:123], a[216:219], v[156:159], a[120:123]
  ds_write_b128 v26, a[184:187] offset:14336
  v_mfma_f32_16x16x32_bf16 a[124:127], a[220:223], v[156:159], a[124:127]
  ds_write_b128 v26, a[188:191] offset:15360
  s_add_u32 s24, s38, 0x4000000
  s_addc_u32 s25, s39, 0
  s_and_b32 s25, s25, 0xffff
  s_mov_b32 s26, 0xc00000
  s_mov_b32 s27, 0x20000
  s_waitcnt vmcnt(2)
  v_and_b32 v224, v224, v225
  v_and_b32 v226, v226, v227
  v_and_b32 v224, v224, v226
  v_cmp_ne_u32 vcc, 1, v224
  s_cbranch_vccnz Lsping2
Lokg2:
  s_cmp_lt_u32 s46, 86
  s_cselect_b64 vcc, -1, 0
  s_load_dwordx2 s[36:37], s[0:1], 0
  s_load_dwordx2 s[98:99], s[0:1], 88
  s_nop 3
  s_cbranch_vccnz Lwm1
  s_add_u32 m0, s54, 65536
  s_add_u32 s42, s51, 0
  buffer_load_dwordx4 v244, s[8:11], s42 offen offset:0 lds
  buffer_load_dwordx4 v245, s[8:11], s42 offen offset:1024 lds
Lwp1:
  v_accvgpr_read_b32 v96, a64
  v_accvgpr_read_b32 v97, a65
  v_accvgpr_read_b32 v98, a66
  v_accvgpr_read_b32 v99, a67
  v_accvgpr_read_b32 v100, a68
  v_accvgpr_read_b32 v101, a69
  v_accvgpr_read_b32 v102, a70
  v_accvgpr_read_b32 v103, a71
  s_cbranch_vccnz Lwm2
  buffer_load_dwordx4 v246, s[8:11], s42 offen offset:2048 lds
  buffer_load_dwordx4 v247, s[8:11], s42 offen offset:3072 lds
Lwp2:
  v_accvgpr_read_b32 v104, a72
  v_accvgpr_read_b32 v105, a73
  v_accvgpr_read_b32 v106, a74
  v_accvgpr_read_b32 v107, a75
  v_accvgpr_read_b32 v108, a76
  v_accvgpr_read_b32 v109, a77
  v_accvgpr_read_b32 v110, a78
  v_accvgpr_read_b32 v111, a79
  s_cbranch_vccnz Lwm3
  s_add_u32 m0, s54, 81920
  s_add_u32 s42, s51, 65536
  buffer_load_dwordx4 v244, s[8:11], s42 offen offset:0 lds
  buffer_load_dwordx4 v245, s[8:11], s42 offen offset:1024 lds
Lwp3:
  v_accvgpr_read_b32 v112, a80
  v_accvgpr_read_b32 v113, a81
  v_accvgpr_read_b32 v114, a82
  v_accvgpr_read_b32 v115, a83
  v_accvgpr_read_b32 v116, a84
  v_accvgpr_read_b32 v117, a85
  v_accvgpr_read_b32 v118, a86
  v_accvgpr_read_b32 v119, a87
  s_cbranch_vccnz Lwm4
  buffer_load_dwordx4 v246, s[8:11], s42 offen offset:2048 lds
  buffer_load_dwordx4 v247, s[8:11], s42 offen offset:3072 lds
Lwp4:
  v_accvgpr_read_b32 v120, a88
  v_accvgpr_read_b32 v121, a89
  v_accvgpr_read_b32 v122, a90
  v_accvgpr_read_b32 v123, a91
  v_accvgpr_read_b32 v124, a92
  v_accvgpr_read_b32 v125, a93
  v_accvgpr_read_b32 v126, a94
  v_accvgpr_read_b32 v127, a95
  s_cbranch_vccnz Lwm5
  s_add_u32 m0, s54, 98304
  s_add_u32 s42, s51, 131072
  buffer_load_dwordx4 v244, s[8:11], s42 offen offset:0 lds
  buffer_load_dwordx4 v245, s[8:11], s42 offen offset:1024 lds
Lwp5:
  v_accvgpr_read_b32 v128, a96
  v_accvgpr_read_b32 v129, a97
  v_accvgpr_read_b32 v130, a98
  v_accvgpr_read_b32 v131, a99
  v_accvgpr_read_b32 v132, a100
  v_accvgpr_read_b32 v133, a101
  v_accvgpr_read_b32 v134, a102
  v_accvgpr_read_b32 v135, a103
  s_cbranch_vccnz Lwm6
  buffer_load_dwordx4 v246, s[8:11], s42 offen offset:2048 lds
  buffer_load_dwordx4 v247, s[8:11], s42 offen offset:3072 lds
Lwp6:
  v_accvgpr_read_b32 v136, a104
  v_accvgpr_read_b32 v137, a105
  v_accvgpr_read_b32 v138, a106
  v_accvgpr_read_b32 v139, a107
  v_accvgpr_read_b32 v140, a108
  v_accvgpr_read_b32 v141, a109
  v_accvgpr_read_b32 v142, a110
  v_accvgpr_read_b32 v143, a111
  s_cbranch_vccnz Lwm7
  s_add_u32 m0, s54, 114688
  s_add_u32 s42, s51, 196608
  buffer_load_dwordx4 v244, s[8:11], s42 offen offset:0 lds
  buffer_load_dwordx4 v245, s[8:11], s42 offen offset:1024 lds
Lwp7:
  v_accvgpr_read_b32 v144, a112
  v_accvgpr_read_b32 v145, a113
  v_accvgpr_read_b32 v146, a114
  v_accvgpr_read_b32 v147, a115
  v_accvgpr_read_b32 v148, a116
  v_accvgpr_read_b32 v149, a117
  v_accvgpr_read_b32 v150, a118
  v_accvgpr_read_b32 v151, a119
  s_cbranch_vccnz Lwm8
  buffer_load_dwordx4 v246, s[8:11], s42 offen offset:2048 lds
  buffer_load_dwordx4 v247, s[8:11], s42 offen offset:3072 lds
Lwp8:
  v_accvgpr_read_b32 v152, a120
  v_accvgpr_read_b32 v153, a121
  v_accvgpr_read_b32 v154, a122
  v_accvgpr_read_b32 v155, a123
  v_accvgpr_read_b32 v156, a124
  v_accvgpr_read_b32 v157, a125
  v_accvgpr_read_b32 v158, a126
  v_accvgpr_read_b32 v159, a127
  s_waitcnt lgkmcnt(0)
  s_barrier
  ds_read_b128 v[224:227], v13
  ds_read_b128 v[32:35], v27 offset:0
  ds_read_b128 v[36:39], v27 offset:1024
  ds_read_b128 v[40:43], v27 offset:2048
  ds_read_b128 v[44:47], v27 offset:3072
  ds_read_b128 v[48:51], v27 offset:4096
  ds_read_b128 v[52:55], v27 offset:5120
  ds_read_b128 v[56:59], v27 offset:6144
  ds_read_b128 v[60:63], v27 offset:7168
  ds_read_b128 v[64:67], v27 offset:8192
  ds_read_b128 v[68:71], v27 offset:9216
  ds_read_b128 v[72:75], v27 offset:10240
  ds_read_b128 v[76:79], v27 offset:11264
  ds_read_b128 v[80:83], v27 offset:12288
  ds_read_b128 v[84:87], v27 offset:13312
  ds_read_b128 v[88:91], v27 offset:14336
  ds_read_b128 v[92:95], v27 offset:15360
  s_waitcnt vmcnt(16)
  v_cmp_gt_u32_e64 vcc, 1, v8
  s_cbranch_vccnz Lspinca
Lokca:
  s_waitcnt lgkmcnt(15)
  s_add_u32 m0, s54, 131072
  s_add_u32 s42, s52, 0
  buffer_load_dwordx4 v1, s[20:23], s42 offen offset:0 sc1 lds
  buffer_load_dwordx4 v1, s[20:23], s42 offen offset:1024 sc1 lds
  v_max_f32 v236, v30, v226
  v_max_f32 v237, v31, v227
  v_sub_f32 v228, v30, v236
  v_sub_f32 v230, v31, v237
  v_sub_f32 v232, v226, v236
  v_sub_f32 v234, v227, v237
  v_exp_f32 v228, v228
  v_exp_f32 v230, v230
  v_exp_f32 v232, v232
  v_exp_f32 v234, v234
  v_mul_f32 v16, v16, v228
  v_mul_f32 v17, v17, v230
  v_fmac_f32 v16, v224, v232
  v_fmac_f32 v17, v225, v234
  v_mov_b32 v236, v16
  v_mov_b32 v237, v17
  v_rcp_f32 v236, v236
  v_rcp_f32 v237, v237
  s_nop 0
  v_mul_f32 v228, v228, v236
  v_mul_f32 v230, v230, v237
  v_mul_f32 v232, v232, v236
  v_mul_f32 v234, v234, v237
  buffer_load_dwordx4 v1, s[20:23], s42 offen offset:2048 sc1 lds
  v_pk_mul_f32 v[96:97], v[96:97], v[228:229] op_sel_hi:[1,0]
  v_pk_mul_f32 v[98:99], v[98:99], v[228:229] op_sel_hi:[1,0]
  v_pk_mul_f32 v[100:101], v[100:101], v[228:229] op_sel_hi:[1,0]
  v_pk_mul_f32 v[102:103], v[102:103], v[228:229] op_sel_hi:[1,0]
  v_pk_mul_f32 v[104:105], v[104:105], v[228:229] op_sel_hi:[1,0]
  buffer_load_dwordx4 v1, s[20:23], s42 offen offset:3072 sc1 lds
  v_pk_mul_f32 v[106:107], v[106:107], v[228:229] op_sel_hi:[1,0]
  v_pk_mul_f32 v[108:109], v[108:109], v[228:229] op_sel_hi:[1,0]
  v_pk_mul_f32 v[110:111], v[110:111], v[228:229] op_sel_hi:[1,0]
  v_pk_mul_f32 v[112:113], v[112:113], v[228:229] op_sel_hi:[1,0]
  v_pk_mul_f32 v[114:115], v[114:115], v[228:229] op_sel_hi:[1,0]
  s_add_u32 m0, s54, 147456
  s_add_u32 s42, s52, 8192
  buffer_load_dwordx4 v1, s[20:23], s42 offen offset:0 sc1 lds
  v_pk_mul_f32 v[116:117], v[116:117], v[228:229] op_sel_hi:[1,0]
  v_pk_mul_f32 v[118:119], v[118:119], v[228:229] op_sel_hi:[1,0]
  v_pk_mul_f32 v[120:121], v[120:121], v[228:229] op_sel_hi:[1,0]
  v_pk_mul_f32 v[122:123], v[122:123], v[228:229] op_sel_hi:[1,0]
  v_pk_mul_f32 v[124:125], v[124:125], v[228:229] op_sel_hi:[1,0]
  buffer_load_dwordx4 v1, s[20:23], s42 offen offset:1024 sc1 lds
  v_pk_mul_f32 v[126:127], v[126:127], v[228:229] op_sel_hi:[1,0]
  v_pk_mul_f32 v[128:129], v[128:129], v[230:231] op_sel_hi:[1,0]
  v_pk_mul_f32 v[130:131], v[130:131], v[230:231] op_sel_hi:[1,0]
  v_pk_mul_f32 v[132:133], v[132:133], v[230:231] op_sel_hi:[1,0]
  v_pk_mul_f32 v[134:135], v[134:135], v[230:231] op_sel_hi:[1,0]
  buffer_load_dwordx4 v1, s[20:23], s42 offen offset:2048 sc1 lds
  v_pk_mul_f32 v[136:137], v[136:137], v[230:231] op_sel_hi:[1,0]
  v_pk_mul_f32 v[138:139], v[138:139], v[230:231] op_sel_hi:[1,0]
  v_pk_mul_f32 v[140:141], v[140:141], v[230:231] op_sel_hi:[1,0]
  v_pk_mul_f32 v[142:143], v[142:143], v[230:231] op_sel_hi:[1,0]
  v_pk_mul_f32 v[144:145], v[144:145], v[230:231] op_sel_hi:[1,0]
  buffer_load_dwordx4 v1, s[20:23], s42 offen offset:3072 sc1 lds
  v_pk_mul_f32 v[146:147], v[146:147], v[230:231] op_sel_hi:[1,0]
  v_pk_mul_f32 v[148:149], v[148:149], v[230:231] op_sel_hi:[1,0]
  v_pk_mul_f32 v[150:151], v[150:151], v[230:231] op_sel_hi:[1,0]
  v_pk_mul_f32 v[152:153], v[152:153], v[230:231] op_sel_hi:[1,0]
  v_pk_mul_f32 v[154:155], v[154:155], v[230:231] op_sel_hi:[1,0]
  v_pk_mul_f32 v[156:157], v[156:157], v[230:231] op_sel_hi:[1,0]
  v_pk_mul_f32 v[158:159], v[158:159], v[230:231] op_sel_hi:[1,0]
  s_add_u32 s42, s58, 4096
  s_waitcnt lgkmcnt(12)
  v_pk_fma_f32 v[96:97], v[32:33], v[232:233], v[96:97] op_sel_hi:[1,0,1]
  v_pk_fma_f32 v[98:99], v[34:35], v[232:233], v[98:99] op_sel_hi:[1,0,1]
  v_pk_fma_f32 v[100:101], v[36:37], v[232:233], v[100:101] op_sel_hi:[1,0,1]
  v_pk_fma_f32 v[102:103], v[38:39], v[232:233], v[102:103] op_sel_hi:[1,0,1]
  v_cvt_pk_bf16_f32 v96, v96, v97
  v_cvt_pk_bf16_f32 v97, v98, v99
  v_cvt_pk_bf16_f32 v98, v100, v101
  v_cvt_pk_bf16_f32 v99, v102, v103
  buffer_store_dwordx4 v[96:99], v1, s[20:23], s58 offen offset:0 sc1
  v_pk_fma_f32 v[104:105], v[40:41], v[232:233], v[104:105] op_sel_hi:[1,0,1]
  v_pk_fma_f32 v[106:107], v[42:43], v[232:233], v[106:107] op_sel_hi:[1,0,1]
  v_pk_fma_f32 v[108:109], v[44:45], v[232:233], v[108:109] op_sel_hi:[1,0,1]
  v_pk_fma_f32 v[110:111], v[46:47], v[232:233], v[110:111] op_sel_hi:[1,0,1]
  v_cvt_pk_bf16_f32 v104, v104, v105
  v_cvt_pk_bf16_f32 v105, v106, v107
  v_cvt_pk_bf16_f32 v106, v108, v109
  v_cvt_pk_bf16_f32 v107, v110, v111
  buffer_store_dwordx4 v[104:107], v1, s[20:23], s58 offen offset:2048 sc1
  s_waitcnt lgkmcnt(8)
  v_pk_fma_f32 v[112:113], v[48:49], v[232:233], v[112:113] op_sel_hi:[1,0,1]
  v_pk_fma_f32 v[114:115], v[50:51], v[232:233], v[114:115] op_sel_hi:[1,0,1]
  v_pk_fma_f32 v[116:117], v[52:53], v[232:233], v[116:117] op_sel_hi:[1,0,1]
  v_pk_fma_f32 v[118:119], v[54:55], v[232:233], v[118:119] op_sel_hi:[1,0,1]
  v_cvt_pk_bf16_f32 v112, v112, v113
  v_cvt_pk_bf16_f32 v113, v114, v115
  v_cvt_pk_bf16_f32 v114, v116, v117
  v_cvt_pk_bf16_f32 v115, v118, v119
  buffer_store_dwordx4 v[112:115], v1, s[20:23], s42 offen offset:0 sc1
  v_pk_fma_f32 v[120:121], v[56:57], v[232:233], v[120:121] op_sel_hi:[1,0,1]
  v_pk_fma_f32 v[122:123], v[58:59], v[232:233], v[122:123] op_sel_hi:[1,0,1]
  v_pk_fma_f32 v[124:125], v[60:61], v[232:233], v[124:125] op_sel_hi:[1,0,1]
  v_pk_fma_f32 v[126:127], v[62:63], v[232:233], v[126:127] op_sel_hi:[1,0,1]
  v_cvt_pk_bf16_f32 v120, v120, v121
  v_cvt_pk_bf16_f32 v121, v122, v123
  v_cvt_pk_bf16_f32 v122, v124, v125
  v_cvt_pk_bf16_f32 v123, v126, v127
  buffer_store_dwordx4 v[120:123], v1, s[20:23], s42 offen offset:2048 sc1
  s_waitcnt lgkmcnt(4)
  v_pk_fma_f32 v[128:129], v[64:65], v[234:235], v[128:129] op_sel_hi:[1,0,1]
  v_pk_fma_f32 v[130:131], v[66:67], v[234:235], v[130:131] op_sel_hi:[1,0,1]
  v_pk_fma_f32 v[132:133], v[68:69], v[234:235], v[132:133] op_sel_hi:[1,0,1]
  v_pk_fma_f32 v[134:135], v[70:71], v[234:235], v[134:135] op_sel_hi:[1,0,1]
  v_cvt_pk_bf16_f32 v128, v128, v129
  v_cvt_pk_bf16_f32 v129, v130, v131
  v_cvt_pk_bf16_f32 v130, v132, v133
  v_cvt_pk_bf16_f32 v131, v134, v135
  buffer_store_dwordx4 v[128:131], v1, s[20:23], s58 offen offset:1024 sc1
  v_pk_fma_f32 v[136:137], v[72:73], v[234:235], v[136:137] op_sel_hi:[1,0,1]
  v_pk_fma_f32 v[138:139], v[74:75], v[234:235], v[138:139] op_sel_hi:[1,0,1]
  v_pk_fma_f32 v[140:141], v[76:77], v[234:235], v[140:141] op_sel_hi:[1,0,1]
  v_pk_fma_f32 v[142:143], v[78:79], v[234:235], v[142:143] op_sel_hi:[1,0,1]
  v_cvt_pk_bf16_f32 v136, v136, v137
  v_cvt_pk_bf16_f32 v137, v138, v139
  v_cvt_pk_bf16_f32 v138, v140, v141
  v_cvt_pk_bf16_f32 v139, v142, v143
  buffer_store_dwordx4 v[136:139], v1, s[20:23], s58 offen offset:3072 sc1
  s_waitcnt lgkmcnt(0)
  v_pk_fma_f32 v[144:145], v[80:81], v[234:235], v[144:145] op_sel_hi:[1,0,1]
  v_pk_fma_f32 v[146:147], v[82:83], v[234:235], v[146:147] op_sel_hi:[1,0,1]
  v_pk_fma_f32 v[148:149], v[84:85], v[234:235], v[148:149] op_sel_hi:[1,0,1]
  v_pk_fma_f32 v[150:151], v[86:87], v[234:235], v[150:151] op_sel_hi:[1,0,1]
  v_cvt_pk_bf16_f32 v144, v144, v145
  v_cvt_pk_bf16_f32 v145, v146, v147
  v_cvt_pk_bf16_f32 v146, v148, v149
  v_cvt_pk_bf16_f32 v147, v150, v151
  buffer_store_dwordx4 v[144:147], v1, s[20:23], s42 offen offset:1024 sc1
  v_pk_fma_f32 v[152:153], v[88:89], v[234:235], v[152:153] op_sel_hi:[1,0,1]
  v_pk_fma_f32 v[154:155], v[90:91], v[234:235], v[154:155] op_sel_hi:[1,0,1]
  v_pk_fma_f32 v[156:157], v[92:93], v[234:235], v[156:157] op_sel_hi:[1,0,1]
  v_pk_fma_f32 v[158:159], v[94:95], v[234:235], v[158:159] op_sel_hi:[1,0,1]
  v_cvt_pk_bf16_f32 v152, v152, v153
  v_cvt_pk_bf16_f32 v153, v154, v155
  v_cvt_pk_bf16_f32 v154, v156, v157
  v_cvt_pk_bf16_f32 v155, v158, v159
  buffer_store_dwordx4 v[152:155], v1, s[20:23], s42 offen offset:3072 sc1
  s_mov_b32 s79, 0x7fff0000
  s_cmp_ge_u32 s46, 86
  s_cbranch_scc1 Lnomoe2
  v_lshrrev_b32 v6, 5, v0
  v_bfe_u32 v7, v0, 2, 2
  v_bfe_u32 v11, v0, 4, 1
  v_and_b32_e64 v12, 3, v0
  v_lshl_add_u32 v14, v6, 3, v7
  v_lshlrev_b32_e64 v14, 5, v14
  v_lshl_add_u32 v14, v11, 12, v14
  v_lshl_add_u32 v14, v12, 3, v14
  v_add_u32_e64 v14, s35, v14
  v_lshl_add_u32 v15, v6, 2, v7
  v_lshlrev_b32_e64 v15, 8, v15
  v_lshl_add_u32 v15, v11, 5, v15
  v_lshl_add_u32 v15, v12, 3, v15
  v_add_u32 v15, s35, v15
  s_waitcnt vmcnt(16)
  ds_read_b64_tr_b16 v[48:49], v14 offset:0
  ds_read_b64_tr_b16 v[50:51], v14 offset:128
  ds_read_b64_tr_b16 v[52:53], v14 offset:512
  ds_read_b64_tr_b16 v[54:55], v14 offset:640
  ds_read_b64_tr_b16 v[56:57], v14 offset:1024
  ds_read_b64_tr_b16 v[58:59], v14 offset:1152
  ds_read_b64_tr_b16 v[60:61], v14 offset:1536
  ds_read_b64_tr_b16 v[62:63], v14 offset:1664
  ds_read_b64_tr_b16 v[64:65], v14 offset:2048
  ds_read_b64_tr_b16 v[66:67], v14 offset:2176
  ds_read_b64_tr_b16 v[68:69], v14 offset:2560
  ds_read_b64_tr_b16 v[70:71], v14 offset:2688
  ds_read_b64_tr_b16 v[72:73], v14 offset:3072
  ds_read_b64_tr_b16 v[74:75], v14 offset:3200
  ds_read_b64_tr_b16 v[76:77], v14 offset:3584
  ds_read_b64_tr_b16 v[78:79], v14 offset:3712
  s_waitcnt lgkmcnt(0)
  v_mfma_f32_32x32x16_bf16 v[32:47], v[48:51], a[192:195], 0
  v_mfma_f32_32x32x16_bf16 v[32:47], v[52:55], a[196:199], v[32:47]
  v_mfma_f32_32x32x16_bf16 v[32:47], v[56:59], a[200:203], v[32:47]
  v_mfma_f32_32x32x16_bf16 v[32:47], v[60:63], a[204:207], v[32:47]
  v_mfma_f32_32x32x16_bf16 v[32:47], v[64:67], a[208:211], v[32:47]
  v_mfma_f32_32x32x16_bf16 v[32:47], v[68:71], a[212:215], v[32:47]
  v_mfma_f32_32x32x16_bf16 v[32:47], v[72:75], a[216:219], v[32:47]
  v_mfma_f32_32x32x16_bf16 v[32:47], v[76:79], a[220:223], v[32:47]
  ds_read_b64_tr_b16 v[224:225], v15 offset:8192
  ds_read_b64_tr_b16 v[226:227], v15 offset:10240
  ds_read_b64_tr_b16 v[228:229], v15 offset:8256
  ds_read_b64_tr_b16 v[230:231], v15 offset:10304
  ds_read_b64_tr_b16 v[232:233], v15 offset:8320
  ds_read_b64_tr_b16 v[234:235], v15 offset:10368
  ds_read_b64_tr_b16 v[236:237], v15 offset:8384
  ds_read_b64_tr_b16 v[238:239], v15 offset:10432
  s_nop 7
  ds_write_b128 v27, v[32:35] offset:0
  ds_write_b128 v27, v[36:39] offset:1024
  ds_write_b128 v27, v[40:43] offset:2048
  ds_write_b128 v27, v[44:47] offset:3072
  s_waitcnt lgkmcnt(0)
  s_barrier
  ds_read_b128 v[160:163], v1 offset:0
  ds_read_b128 v[164:167], v1 offset:1024
  ds_read_b128 v[168:171], v1 offset:2048
  ds_read_b128 v[172:175], v1 offset:3072
  ds_read_b128 v[176:179], v1 offset:16384
  ds_read_b128 v[180:183], v1 offset:17408
  ds_read_b128 v[184:187], v1 offset:18432
  ds_read_b128 v[188:191], v1 offset:19456
  ds_read_b128 v[192:195], v1 offset:32768
  ds_read_b128 v[196:199], v1 offset:33792
  ds_read_b128 v[200:203], v1 offset:34816
  ds_read_b128 v[204:207], v1 offset:35840
  ds_read_b128 v[208:211], v1 offset:49152
  ds_read_b128 v[212:215], v1 offset:50176
  ds_read_b128 v[216:219], v1 offset:51200
  ds_read_b128 v[220:223], v1 offset:52224
  s_add_u32 m0, s54, 65536
  s_add_u32 s42, s51, 0
  buffer_load_dwordx4 v244, s[8:11], s42 offen offset:0 lds
  buffer_load_dwordx4 v245, s[8:11], s42 offen offset:1024 lds
  buffer_load_dwordx4 v246, s[8:11], s42 offen offset:2048 lds
  s_waitcnt lgkmcnt(8)
  v_pk_add_f32 v[160:161], v[160:161], v[176:177]
  v_pk_add_f32 v[162:163], v[162:163], v[178:179]
  v_pk_add_f32 v[164:165], v[164:165], v[180:181]
  v_pk_add_f32 v[166:167], v[166:167], v[182:183]
  v_pk_add_f32 v[168:169], v[168:169], v[184:185]
  v_pk_add_f32 v[170:171], v[170:171], v[186:187]
  v_pk_add_f32 v[172:173], v[172:173], v[188:189]
  v_pk_add_f32 v[174:175], v[174:175], v[190:191]
  buffer_load_dwordx4 v247, s[8:11], s42 offen offset:3072 lds
  s_waitcnt lgkmcnt(0)
  v_pk_add_f32 v[192:193], v[192:193], v[208:209]
  v_pk_add_f32 v[194:195], v[194:195], v[210:211]
  v_pk_add_f32 v[196:197], v[196:197], v[212:213]
  v_pk_add_f32 v[198:199], v[198:199], v[214:215]
  v_pk_add_f32 v[200:201], v[200:201], v[216:217]
  v_pk_add_f32 v[202:203], v[202:203], v[218:219]
  v_pk_add_f32 v[204:205], v[204:205], v[220:221]
  v_pk_add_f32 v[206:207], v[206:207], v[222:223]
  s_add_u32 m0, s54, 81920
  s_add_u32 s42, s51, 65536
  buffer_load_dwordx4 v244, s[8:11], s42 offen offset:0 lds
  v_pk_add_f32 v[32:33], v[160:161], v[192:193]
  v_pk_add_f32 v[34:35], v[162:163], v[194:195]
  v_pk_add_f32 v[36:37], v[164:165], v[196:197]
  v_pk_add_f32 v[38:39], v[166:167], v[198:199]
  v_pk_add_f32 v[40:41], v[168:169], v[200:201]
  v_pk_add_f32 v[42:43], v[170:171], v[202:203]
  v_pk_add_f32 v[44:45], v[172:173], v[204:205]
  v_pk_add_f32 v[46:47], v[174:175], v[206:207]
  buffer_load_dwordx4 v245, s[8:11], s42 offen offset:1024 lds
  v_cvt_pk_bf16_f32 v33, v32, v33
  v_cvt_pk_bf16_f32 v35, v34, v35
  v_cvt_pk_bf16_f32 v37, v36, v37
  v_cvt_pk_bf16_f32 v39, v38, v39
  v_cvt_pk_bf16_f32 v41, v40, v41
  v_cvt_pk_bf16_f32 v43, v42, v43
  v_cvt_pk_bf16_f32 v45, v44, v45
  v_cvt_pk_bf16_f32 v47, v46, v47
  buffer_load_dwordx4 v246, s[8:11], s42 offen offset:2048 lds
  v_lshlrev_b32 v32, 16, v33
  v_lshlrev_b32 v34, 16, v35
  v_lshlrev_b32 v36, 16, v37
  v_lshlrev_b32 v38, 16, v39
  v_lshlrev_b32 v40, 16, v41
  v_lshlrev_b32 v42, 16, v43
  v_lshlrev_b32 v44, 16, v45
  v_lshlrev_b32_e64 v46, 16, v47
  v_and_b32 v33, 0xffff0000, v33
  v_and_b32 v35, 0xffff0000, v35
  v_and_b32 v37, 0xffff0000, v37
  v_and_b32 v39, 0xffff0000, v39
  v_and_b32 v41, 0xffff0000, v41
  v_and_b32 v43, 0xffff0000, v43
  v_and_b32 v45, 0xffff0000, v45
  v_and_b32 v47, 0xffff0000, v47
  s_waitcnt vmcnt(7)
  s_barrier
  v_mov_b32_e64 v4, 1
  buffer_store_dword v4, v3, s[12:15], s45 offen sc1
  buffer_load_dwordx4 v247, s[8:11], s42 offen offset:3072 lds
  v_mul_f32 v84, 0xbfb8aa3b, v32
  v_mul_f32 v85, 0xbfb8aa3b, v33
  v_mul_f32 v86, 0xbfb8aa3b, v34
  v_mul_f32 v87, 0xbfb8aa3b, v35
  v_mul_f32 v88, 0xbfb8aa3b, v36
  v_mul_f32 v89, 0xbfb8aa3b, v37
  v_mul_f32 v90, 0xbfb8aa3b, v38
  v_mul_f32 v91, 0xbfb8aa3b, v39
  s_add_u32 m0, s54, 98304
  s_add_u32 s42, s51, 131072
  buffer_load_dwordx4 v244, s[8:11], s42 offen offset:0 lds
  v_exp_f32 v84, v84
  v_exp_f32 v85, v85
  v_exp_f32 v86, v86
  v_exp_f32 v87, v87
  v_exp_f32 v88, v88
  v_exp_f32 v89, v89
  v_exp_f32 v90, v90
  v_exp_f32 v91, v91
  buffer_load_dwordx4 v245, s[8:11], s42 offen offset:1024 lds
  v_add_f32 v84, 1.0, v84
  v_add_f32 v85, 1.0, v85
  v_add_f32 v86, 1.0, v86
  v_add_f32 v87, 1.0, v87
  v_add_f32 v88, 1.0, v88
  v_add_f32 v89, 1.0, v89
  v_add_f32 v90, 1.0, v90
  v_add_f32 v91, 1.0, v91
  buffer_load_dwordx4 v246, s[8:11], s42 offen offset:2048 lds
  v_rcp_f32 v84, v84
  v_rcp_f32 v85, v85
  v_rcp_f32 v86, v86
  v_rcp_f32 v87, v87
  v_rcp_f32 v88, v88
  v_rcp_f32 v89, v89
  v_rcp_f32 v90, v90
  v_rcp_f32 v91, v91
  buffer_load_dwordx4 v247, s[8:11], s42 offen offset:3072 lds
  v_mul_f32 v32, v32, v84
  v_mul_f32 v33, v33, v85
  v_mul_f32 v34, v34, v86
  v_mul_f32 v35, v35, v87
  v_mul_f32 v36, v36, v88
  v_mul_f32 v37, v37, v89
  v_mul_f32 v38, v38, v90
  v_mul_f32 v39, v39, v91
  s_add_u32 m0, s54, 114688
  s_add_u32 s42, s51, 196608
  buffer_load_dwordx4 v244, s[8:11], s42 offen offset:0 lds
  v_cvt_pk_bf16_f32 v33, v32, v33
  v_cvt_pk_bf16_f32 v35, v34, v35
  v_cvt_pk_bf16_f32 v37, v36, v37
  v_cvt_pk_bf16_f32 v39, v38, v39
  buffer_load_dwordx4 v245, s[8:11], s42 offen offset:1024 lds
  v_lshlrev_b32 v32, 16, v33
  v_lshlrev_b32 v34, 16, v35
  v_lshlrev_b32 v36, 16, v37
  v_lshlrev_b32 v38, 16, v39
  v_and_b32 v33, 0xffff0000, v33
  v_and_b32 v35, 0xffff0000, v35
  v_and_b32 v37, 0xffff0000, v37
  v_and_b32 v39, 0xffff0000, v39
  buffer_load_dwordx4 v246, s[8:11], s42 offen offset:2048 lds
  v_mul_f32 v32, v32, v40
  v_mul_f32 v33, v33, v41
  v_mul_f32 v34, v34, v42
  v_mul_f32 v35, v35, v43
  v_mul_f32 v36, v36, v44
  v_mul_f32 v37, v37, v45
  v_mul_f32 v38, v38, v46
  v_mul_f32 v39, v39, v47
  buffer_load_dwordx4 v247, s[8:11], s42 offen offset:3072 lds
  v_cvt_pk_bf16_f32 v80, v32, v33
  v_cvt_pk_bf16_f32 v81, v34, v35
  v_cvt_pk_bf16_f32 v82, v36, v37
  v_cvt_pk_bf16_f32 v83, v38, v39
  v_and_b32 v16, 31, v0
  v_lshlrev_b32 v16, 2, v16
  v_lshl_add_u32 v16, v6, 13, v16
  v_mfma_f32_32x32x16_bf16 v[160:175], v[80:83], v[224:227], 0
  v_mfma_f32_32x32x16_bf16 v[176:191], v[80:83], v[228:231], 0
  v_mfma_f32_32x32x16_bf16 v[192:207], v[80:83], v[232:235], 0
  v_mfma_f32_32x32x16_bf16 v[208:223], v[80:83], v[236:239], 0
  s_lshl_b32 s42, s46, 14
  s_lshl_b32 s43, s40, 9
  s_add_u32 s42, s42, s43
  s_add_u32 s42, s42, 0x500000
  s_add_u32 s43, s42, 4096
  s_lshl_b32 s79, s46, 2
  s_add_u32 s79, s79, 0x430400
  s_nop 7
  buffer_store_dword v160, v16, s[12:15], s42 offen offset:0 sc1
  buffer_store_dword v161, v16, s[12:15], s42 offen offset:2048 sc1
  buffer_store_dword v162, v16, s[12:15], s43 offen offset:0 sc1
  buffer_store_dword v163, v16, s[12:15], s43 offen offset:2048 sc1
  buffer_store_dword v176, v16, s[12:15], s42 offen offset:128 sc1
  buffer_store_dword v177, v16, s[12:15], s42 offen offset:2176 sc1
  buffer_store_dword v178, v16, s[12:15], s43 offen offset:128 sc1
  buffer_store_dword v179, v16, s[12:15], s43 offen offset:2176 sc1
  buffer_store_dword v192, v16, s[12:15], s42 offen offset:256 sc1
  buffer_store_dword v193, v16, s[12:15], s42 offen offset:2304 sc1
  buffer_store_dword v194, v16, s[12:15], s43 offen offset:256 sc1
  buffer_store_dword v195, v16, s[12:15], s43 offen offset:2304 sc1
  buffer_store_dword v208, v16, s[12:15], s42 offen offset:384 sc1
  buffer_store_dword v209, v16, s[12:15], s42 offen offset:2432 sc1
  buffer_store_dword v210, v16, s[12:15], s43 offen offset:384 sc1
  buffer_store_dword v211, v16, s[12:15], s43 offen offset:2432 sc1
  s_waitcnt vmcnt(16)
  s_branch Lnomoe3
Lnomoe2:
  s_waitcnt vmcnt(8)
Lnomoe3:
  v_lshrrev_b32 v41, 2, v0
  v_lshlrev_b32 v41, 7, v41
  v_bfe_u32 v42, v0, 3, 2
  v_lshl_add_u32 v41, v42, 5, v41
  v_and_b32_e64 v43, 3, v0
  v_lshl_add_u32 v41, v43, 3, v41
  s_lshr_b32 s43, s40, 1
  s_lshl_b32 s43, s43, 13
  s_add_u32 s43, s43, 65536
  v_add_u32 v252, 0x20000, v1
  s_lshr_b32 s35, s56, 7
  v_xor_b32 v41, s35, v41
  v_add_u32 v248, s43, v41
  v_xor_b32 v249, 32, v248
  v_subrev_u32 v250, 0x10000, v248
  v_subrev_u32 v251, 0x10000, v249
  s_barrier
  ds_read_b64_tr_b16 a[0:1], v248 offset:0
  ds_read_b64_tr_b16 a[2:3], v248 offset:2048
  ds_read_b64_tr_b16 a[4:5], v249 offset:0
  ds_read_b64_tr_b16 a[6:7], v249 offset:2048
  ds_read_b128 v[104:107], v252 offset:0
  ds_read_b128 v[108:111], v252 offset:1024
  ds_read_b128 v[112:115], v252 offset:8192
  ds_read_b128 v[116:119], v252 offset:9216
  ds_read_b64_tr_b16 a[8:9], v248 offset:4096
  ds_read_b64_tr_b16 a[10:11], v248 offset:6144
  ds_read_b64_tr_b16 a[12:13], v249 offset:4096
  ds_read_b64_tr_b16 a[14:15], v249 offset:6144
  ds_read_b128 v[120:123], v252 offset:2048
  ds_read_b128 v[124:127], v252 offset:3072
  ds_read_b128 v[128:131], v252 offset:10240
  ds_read_b128 v[132:135], v252 offset:11264
  s_waitcnt lgkmcnt(0)
  v_mfma_f32_16x16x32_bf16 v[40:43], a[0:3], v[104:107], 0
  ds_read_b64_tr_b16 a[16:17], v248 offset:16384
  ds_read_b64_tr_b16 a[18:19], v248 offset:18432
  s_add_u32 m0, s54, 0
  s_add_u32 s42, s51, 262144
  v_mfma_f32_16x16x32_bf16 v[40:43], a[8:11], v[120:123], v[40:43]
  ds_read_b64_tr_b16 a[20:21], v249 offset:16384
  ds_read_b64_tr_b16 a[22:23], v249 offset:18432
  v_mfma_f32_16x16x32_bf16 v[48:51], a[0:3], v[108:111], 0
  ds_read_b128 v[136:139], v252 offset:4096
  ds_read_b128 v[140:143], v252 offset:5120
  v_mfma_f32_16x16x32_bf16 v[48:51], a[8:11], v[124:127], v[48:51]
  buffer_load_dwordx4 v244, s[8:11], s42 offen offset:0 lds
  v_mfma_f32_16x16x32_bf16 v[56:59], a[0:3], v[112:115], 0
  ds_read_b128 v[144:147], v252 offset:12288
  ds_read_b128 v[148:151], v252 offset:13312
  v_mfma_f32_16x16x32_bf16 v[56:59], a[8:11], v[128:131], v[56:59]
  ds_read_b64_tr_b16 a[24:25], v248 offset:20480
  ds_read_b64_tr_b16 a[26:27], v248 offset:22528
  v_mfma_f32_16x16x32_bf16 v[64:67], a[0:3], v[116:119], 0
  ds_read_b64_tr_b16 a[28:29], v249 offset:20480
  ds_read_b64_tr_b16 a[30:31], v249 offset:22528
  v_mfma_f32_16x16x32_bf16 v[64:67], a[8:11], v[132:135], v[64:67]
  buffer_load_dwordx4 v245, s[8:11], s42 offen offset:1024 lds
  v_mfma_f32_16x16x32_bf16 v[44:47], a[4:7], v[104:107], 0
  ds_read_b128 v[152:155], v252 offset:6144
  ds_read_b128 v[156:159], v252 offset:7168
  v_mfma_f32_16x16x32_bf16 v[44:47], a[12:15], v[120:123], v[44:47]
  ds_read_b128 v[160:163], v252 offset:14336
  ds_read_b128 v[164:167], v252 offset:15360
  v_mfma_f32_16x16x32_bf16 v[52:55], a[4:7], v[108:111], 0
  buffer_load_dwordx4 v246, s[8:11], s42 offen offset:2048 lds
  v_mfma_f32_16x16x32_bf16 v[52:55], a[12:15], v[124:127], v[52:55]
  v_and_b32_e64 v235, 3, v0
  s_lshr_b32 s43, s2, 3
  v_mfma_f32_16x16x32_bf16 v[60:63], a[4:7], v[112:115], 0
  buffer_load_dwordx4 v247, s[8:11], s42 offen offset:3072 lds
  s_add_u32 m0, s54, 32768
  s_add_u32 s42, s52, 16384
  v_mfma_f32_16x16x32_bf16 v[60:63], a[12:15], v[128:131], v[60:63]
  buffer_load_dwordx4 v1, s[20:23], s42 offen offset:0 sc1 lds
  v_mfma_f32_16x16x32_bf16 v[68:71], a[4:7], v[116:119], 0
  buffer_load_dwordx4 v1, s[20:23], s42 offen offset:1024 sc1 lds
  v_mfma_f32_16x16x32_bf16 v[68:71], a[12:15], v[132:135], v[68:71]
  buffer_load_dwordx4 v1, s[20:23], s42 offen offset:2048 sc1 lds
  s_waitcnt lgkmcnt(0)
  v_mfma_f32_16x16x32_bf16 v[40:43], a[16:19], v[136:139], v[40:43]
  s_barrier
  v_mfma_f32_16x16x32_bf16 v[40:43], a[24:27], v[152:155], v[40:43]
  ds_read_b64_tr_b16 a[32:33], v248 offset:32768
  ds_read_b64_tr_b16 a[34:35], v248 offset:34816
  v_mfma_f32_16x16x32_bf16 v[48:51], a[16:19], v[140:143], v[48:51]
  ds_read_b64_tr_b16 a[36:37], v249 offset:32768
  ds_read_b64_tr_b16 a[38:39], v249 offset:34816
  v_mfma_f32_16x16x32_bf16 v[48:51], a[24:27], v[156:159], v[48:51]
  buffer_load_dwordx4 v1, s[20:23], s42 offen offset:3072 sc1 lds
  s_add_u32 m0, s54, 16384
  s_add_u32 s42, s51, 327680
  v_mfma_f32_16x16x32_bf16 v[56:59], a[16:19], v[144:147], v[56:59]
  ds_read_b128 v[104:107], v252 offset:16384
  ds_read_b128 v[108:111], v252 offset:17408
  v_mfma_f32_16x16x32_bf16 v[56:59], a[24:27], v[160:163], v[56:59]
  ds_read_b128 v[112:115], v252 offset:24576
  ds_read_b128 v[116:119], v252 offset:25600
  v_mfma_f32_16x16x32_bf16 v[64:67], a[16:19], v[148:151], v[64:67]
  ds_read_b64_tr_b16 a[40:41], v248 offset:36864
  ds_read_b64_tr_b16 a[42:43], v248 offset:38912
  v_mfma_f32_16x16x32_bf16 v[64:67], a[24:27], v[164:167], v[64:67]
  buffer_load_dwordx4 v244, s[8:11], s42 offen offset:0 lds
  v_mfma_f32_16x16x32_bf16 v[44:47], a[20:23], v[136:139], v[44:47]
  ds_read_b64_tr_b16 a[44:45], v249 offset:36864
  ds_read_b64_tr_b16 a[46:47], v249 offset:38912
  v_mfma_f32_16x16x32_bf16 v[44:47], a[28:31], v[152:155], v[44:47]
  ds_read_b128 v[120:123], v252 offset:18432
  ds_read_b128 v[124:127], v252 offset:19456
  v_mfma_f32_16x16x32_bf16 v[52:55], a[20:23], v[140:143], v[52:55]
  buffer_load_dwordx4 v245, s[8:11], s42 offen offset:1024 lds
  v_mfma_f32_16x16x32_bf16 v[52:55], a[28:31], v[156:159], v[52:55]
  ds_read_b128 v[128:131], v252 offset:26624
  ds_read_b128 v[132:135], v252 offset:27648
  v_mfma_f32_16x16x32_bf16 v[60:63], a[20:23], v[144:147], v[60:63]
  buffer_load_dwordx4 v246, s[8:11], s42 offen offset:2048 lds
  v_mfma_f32_16x16x32_bf16 v[60:63], a[28:31], v[160:163], v[60:63]
  buffer_load_dwordx4 v247, s[8:11], s42 offen offset:3072 lds
  s_add_u32 m0, s54, 49152
  s_add_u32 s42, s52, 24576
  v_mfma_f32_16x16x32_bf16 v[68:71], a[20:23], v[148:151], v[68:71]
  buffer_load_dwordx4 v1, s[20:23], s42 offen offset:0 sc1 lds
  v_mfma_f32_16x16x32_bf16 v[68:71], a[28:31], v[164:167], v[68:71]
  buffer_load_dwordx4 v1, s[20:23], s42 offen offset:1024 sc1 lds
  s_waitcnt lgkmcnt(0)
  v_mfma_f32_16x16x32_bf16 v[40:43], a[32:35], v[104:107], v[40:43]
  ds_read_b64_tr_b16 a[48:49], v248 offset:49152
  ds_read_b64_tr_b16 a[50:51], v248 offset:51200
  v_mfma_f32_16x16x32_bf16 v[40:43], a[40:43], v[120:123], v[40:43]
  ds_read_b64_tr_b16 a[52:53], v249 offset:49152
  ds_read_b64_tr_b16 a[54:55], v249 offset:51200
  v_mfma_f32_16x16x32_bf16 v[48:51], a[32:35], v[108:111], v[48:51]
  ds_read_b128 v[136:139], v252 offset:20480
  ds_read_b128 v[140:143], v252 offset:21504
  v_mfma_f32_16x16x32_bf16 v[48:51], a[40:43], v[124:127], v[48:51]
  buffer_load_dwordx4 v1, s[20:23], s42 offen offset:2048 sc1 lds
  v_mfma_f32_16x16x32_bf16 v[56:59], a[32:35], v[112:115], v[56:59]
  ds_read_b128 v[144:147], v252 offset:28672
  ds_read_b128 v[148:151], v252 offset:29696
  v_mfma_f32_16x16x32_bf16 v[56:59], a[40:43], v[128:131], v[56:59]
  ds_read_b64_tr_b16 a[56:57], v248 offset:53248
  ds_read_b64_tr_b16 a[58:59], v248 offset:55296
  v_mfma_f32_16x16x32_bf16 v[64:67], a[32:35], v[116:119], v[64:67]
  ds_read_b64_tr_b16 a[60:61], v249 offset:53248
  ds_read_b64_tr_b16 a[62:63], v249 offset:55296
  v_mfma_f32_16x16x32_bf16 v[64:67], a[40:43], v[132:135], v[64:67]
  buffer_load_dwordx4 v1, s[20:23], s42 offen offset:3072 sc1 lds
  s_add_u32 m0, s54, 65536
  s_add_u32 s42, s51, 393216
  v_mfma_f32_16x16x32_bf16 v[44:47], a[36:39], v[104:107], v[44:47]
  ds_read_b128 v[152:155], v252 offset:22528
  ds_read_b128 v[156:159], v252 offset:23552
  v_mfma_f32_16x16x32_bf16 v[44:47], a[44:47], v[120:123], v[44:47]
  ds_read_b128 v[160:163], v252 offset:30720
  ds_read_b128 v[164:167], v252 offset:31744
  v_mfma_f32_16x16x32_bf16 v[52:55], a[36:39], v[108:111], v[52:55]
  buffer_load_dwordx4 v244, s[8:11], s42 offen offset:0 lds
  v_mfma_f32_16x16x32_bf16 v[52:55], a[44:47], v[124:127], v[52:55]
  s_lshl_b32 s43, s43, 1
  s_add_u32 s43, s43, s49
  v_mfma_f32_16x16x32_bf16 v[60:63], a[36:39], v[112:115], v[60:63]
  buffer_load_dwordx4 v245, s[8:11], s42 offen offset:1024 lds
  v_mfma_f32_16x16x32_bf16 v[60:63], a[44:47], v[128:131], v[60:63]
  buffer_load_dwordx4 v246, s[8:11], s42 offen offset:2048 lds
  v_mfma_f32_16x16x32_bf16 v[68:71], a[36:39], v[116:119], v[68:71]
  buffer_load_dwordx4 v247, s[8:11], s42 offen offset:3072 lds
  s_add_u32 m0, s54, 81920
  s_add_u32 s42, s51, 458752
  v_mfma_f32_16x16x32_bf16 v[68:71], a[44:47], v[132:135], v[68:71]
  buffer_load_dwordx4 v244, s[8:11], s42 offen offset:0 lds
  s_waitcnt lgkmcnt(0)
  v_mfma_f32_16x16x32_bf16 v[40:43], a[48:51], v[136:139], v[40:43]
  s_waitcnt vmcnt(9)
  s_barrier
  v_mov_b32_e64 v11, 1
  buffer_store_dword v11, v3, s[12:15], s45 offen sc1
  buffer_store_dword v11, v3, s[12:15], s79 offen sc1
  v_mfma_f32_16x16x32_bf16 v[40:43], a[56:59], v[152:155], v[40:43]
  ds_read_b64_tr_b16 a[64:65], v250 offset:0
  ds_read_b64_tr_b16 a[66:67], v250 offset:2048
  v_mfma_f32_16x16x32_bf16 v[48:51], a[48:51], v[140:143], v[48:51]
  ds_read_b64_tr_b16 a[68:69], v251 offset:0
  ds_read_b64_tr_b16 a[70:71], v251 offset:2048
  v_mfma_f32_16x16x32_bf16 v[48:51], a[56:59], v[156:159], v[48:51]
  buffer_load_dwordx4 v245, s[8:11], s42 offen offset:1024 lds
  v_mfma_f32_16x16x32_bf16 v[56:59], a[48:51], v[144:147], v[56:59]
  ds_read_b128 v[104:107], v1 offset:32768
  ds_read_b128 v[108:111], v1 offset:33792
  v_mfma_f32_16x16x32_bf16 v[56:59], a[56:59], v[160:163], v[56:59]
  ds_read_b128 v[112:115], v1 offset:40960
  ds_read_b128 v[116:119], v1 offset:41984
  v_mfma_f32_16x16x32_bf16 v[64:67], a[48:51], v[148:151], v[64:67]
  ds_read_b64_tr_b16 a[72:73], v250 offset:4096
  ds_read_b64_tr_b16 a[74:75], v250 offset:6144
  v_mfma_f32_16x16x32_bf16 v[64:67], a[56:59], v[164:167], v[64:67]
  buffer_load_dwordx4 v246, s[8:11], s42 offen offset:2048 lds
  v_mfma_f32_16x16x32_bf16 v[44:47], a[52:55], v[136:139], v[44:47]
  ds_read_b64_tr_b16 a[76:77], v251 offset:4096
  ds_read_b64_tr_b16 a[78:79], v251 offset:6144
  v_mfma_f32_16x16x32_bf16 v[44:47], a[60:63], v[152:155], v[44:47]
  ds_read_b128 v[120:123], v1 offset:34816
  ds_read_b128 v[124:127], v1 offset:35840
  v_mfma_f32_16x16x32_bf16 v[52:55], a[52:55], v[140:143], v[52:55]
  buffer_load_dwordx4 v247, s[8:11], s42 offen offset:3072 lds
  s_add_u32 m0, s54, 131072
  s_add_u32 s42, s52, 32768
  v_mfma_f32_16x16x32_bf16 v[52:55], a[60:63], v[156:159], v[52:55]
  ds_read_b128 v[128:131], v1 offset:43008
  ds_read_b128 v[132:135], v1 offset:44032
  v_mfma_f32_16x16x32_bf16 v[60:63], a[52:55], v[144:147], v[60:63]
  buffer_load_dwordx4 v1, s[20:23], s42 offen offset:0 sc1 lds
  v_mfma_f32_16x16x32_bf16 v[60:63], a[60:63], v[160:163], v[60:63]
  buffer_load_dwordx4 v1, s[20:23], s42 offen offset:1024 sc1 lds
  v_mfma_f32_16x16x32_bf16 v[68:71], a[52:55], v[148:151], v[68:71]
  buffer_load_dwordx4 v1, s[20:23], s42 offen offset:2048 sc1 lds
  v_mfma_f32_16x16x32_bf16 v[68:71], a[60:63], v[164:167], v[68:71]
  buffer_load_dwordx4 v1, s[20:23], s42 offen offset:3072 sc1 lds
  s_add_u32 m0, s54, 98304
  s_add_u32 s42, s51, 524288
  s_waitcnt lgkmcnt(0)
  v_mfma_f32_16x16x32_bf16 v[40:43], a[64:67], v[104:107], v[40:43]
  ds_read_b64_tr_b16 a[80:81], v250 offset:16384
  ds_read_b64_tr_b16 a[82:83], v250 offset:18432
  v_mfma_f32_16x16x32_bf16 v[40:43], a[72:75], v[120:123], v[40:43]
  ds_read_b64_tr_b16 a[84:85], v251 offset:16384
  ds_read_b64_tr_b16 a[86:87], v251 offset:18432
  v_mfma_f32_16x16x32_bf16 v[48:51], a[64:67], v[108:111], v[48:51]
  ds_read_b128 v[136:139], v1 offset:36864
  ds_read_b128 v[140:143], v1 offset:37888
  v_mfma_f32_16x16x32_bf16 v[48:51], a[72:75], v[124:127], v[48:51]
  buffer_load_dwordx4 v244, s[8:11], s42 offen offset:0 lds
  v_mfma_f32_16x16x32_bf16 v[56:59], a[64:67], v[112:115], v[56:59]
  ds_read_b128 v[144:147], v1 offset:45056
  ds_read_b128 v[148:151], v1 offset:46080
  v_mfma_f32_16x16x32_bf16 v[56:59], a[72:75], v[128:131], v[56:59]
  ds_read_b64_tr_b16 a[88:89], v250 offset:20480
  ds_read_b64_tr_b16 a[90:91], v250 offset:22528
  v_mfma_f32_16x16x32_bf16 v[64:67], a[64:67], v[116:119], v[64:67]
  ds_read_b64_tr_b16 a[92:93], v251 offset:20480
  ds_read_b64_tr_b16 a[94:95], v251 offset:22528
  v_mfma_f32_16x16x32_bf16 v[64:67], a[72:75], v[132:135], v[64:67]
  buffer_load_dwordx4 v245, s[8:11], s42 offen offset:1024 lds
  v_mfma_f32_16x16x32_bf16 v[44:47], a[68:71], v[104:107], v[44:47]
  ds_read_b128 v[152:155], v1 offset:38912
  ds_read_b128 v[156:159], v1 offset:39936
  v_mfma_f32_16x16x32_bf16 v[44:47], a[76:79], v[120:123], v[44:47]
  ds_read_b128 v[160:163], v1 offset:47104
  ds_read_b128 v[164:167], v1 offset:48128
  v_mfma_f32_16x16x32_bf16 v[52:55], a[68:71], v[108:111], v[52:55]
  buffer_load_dwordx4 v246, s[8:11], s42 offen offset:2048 lds
  v_mfma_f32_16x16x32_bf16 v[52:55], a[76:79], v[124:127], v[52:55]
  s_lshl_b32 s43, s43, 2
  s_add_u32 s55, s43, s40
  v_mfma_f32_16x16x32_bf16 v[60:63], a[68:71], v[112:115], v[60:63]
  buffer_load_dwordx4 v247, s[8:11], s42 offen offset:3072 lds
  s_add_u32 m0, s54, 114688
  s_add_u32 s42, s51, 589824
  v_mfma_f32_16x16x32_bf16 v[60:63], a[76:79], v[128:131], v[60:63]
  buffer_load_dwordx4 v244, s[8:11], s42 offen offset:0 lds
  v_mfma_f32_16x16x32_bf16 v[68:71], a[68:71], v[116:119], v[68:71]
  buffer_load_dwordx4 v245, s[8:11], s42 offen offset:1024 lds
  v_mfma_f32_16x16x32_bf16 v[68:71], a[76:79], v[132:135], v[68:71]
  buffer_load_dwordx4 v246, s[8:11], s42 offen offset:2048 lds
  s_waitcnt lgkmcnt(0)
  v_mfma_f32_16x16x32_bf16 v[40:43], a[80:83], v[136:139], v[40:43]
  s_waitcnt vmcnt(11)
  s_barrier
  v_mfma_f32_16x16x32_bf16 v[40:43], a[88:91], v[152:155], v[40:43]
  ds_read_b64_tr_b16 a[96:97], v248 offset:0
  ds_read_b64_tr_b16 a[98:99], v248 offset:2048
  v_mfma_f32_16x16x32_bf16 v[48:51], a[80:83], v[140:143], v[48:51]
  ds_read_b64_tr_b16 a[100:101], v249 offset:0
  ds_read_b64_tr_b16 a[102:103], v249 offset:2048
  v_mfma_f32_16x16x32_bf16 v[48:51], a[88:91], v[156:159], v[48:51]
  buffer_load_dwordx4 v247, s[8:11], s42 offen offset:3072 lds
  s_add_u32 m0, s54, 147456
  s_add_u32 s42, s52, 40960
  v_mfma_f32_16x16x32_bf16 v[56:59], a[80:83], v[144:147], v[56:59]
  ds_read_b128 v[104:107], v1 offset:49152
  ds_read_b128 v[108:111], v1 offset:50176
  v_mfma_f32_16x16x32_bf16 v[56:59], a[88:91], v[160:163], v[56:59]
  ds_read_b128 v[112:115], v1 offset:57344
  ds_read_b128 v[116:119], v1 offset:58368
  v_mfma_f32_16x16x32_bf16 v[64:67], a[80:83], v[148:151], v[64:67]
  ds_read_b64_tr_b16 a[104:105], v248 offset:4096
  ds_read_b64_tr_b16 a[106:107], v248 offset:6144
  v_mfma_f32_16x16x32_bf16 v[64:67], a[88:91], v[164:167], v[64:67]
  buffer_load_dwordx4 v1, s[20:23], s42 offen offset:0 sc1 lds
  v_mfma_f32_16x16x32_bf16 v[44:47], a[84:87], v[136:139], v[44:47]
  ds_read_b64_tr_b16 a[108:109], v249 offset:4096
  ds_read_b64_tr_b16 a[110:111], v249 offset:6144
  v_mfma_f32_16x16x32_bf16 v[44:47], a[92:95], v[152:155], v[44:47]
  ds_read_b128 v[120:123], v1 offset:51200
  ds_read_b128 v[124:127], v1 offset:52224
  v_mfma_f32_16x16x32_bf16 v[52:55], a[84:87], v[140:143], v[52:55]
  buffer_load_dwordx4 v1, s[20:23], s42 offen offset:1024 sc1 lds
  v_mfma_f32_16x16x32_bf16 v[52:55], a[92:95], v[156:159], v[52:55]
  ds_read_b128 v[128:131], v1 offset:59392
  ds_read_b128 v[132:135], v1 offset:60416
  v_mfma_f32_16x16x32_bf16 v[60:63], a[84:87], v[144:147], v[60:63]
  buffer_load_dwordx4 v1, s[20:23], s42 offen offset:2048 sc1 lds
  v_mfma_f32_16x16x32_bf16 v[60:63], a[92:95], v[160:163], v[60:63]
  buffer_load_dwordx4 v1, s[20:23], s42 offen offset:3072 sc1 lds
  s_add_u32 m0, s54, 0
  s_add_u32 s42, s51, 655360
  v_mfma_f32_16x16x32_bf16 v[68:71], a[84:87], v[148:151], v[68:71]
  buffer_load_dwordx4 v244, s[8:11], s42 offen offset:0 lds
  v_mfma_f32_16x16x32_bf16 v[68:71], a[92:95], v[164:167], v[68:71]
  buffer_load_dwordx4 v245, s[8:11], s42 offen offset:1024 lds
  s_waitcnt lgkmcnt(0)
  v_mfma_f32_16x16x32_bf16 v[40:43], a[96:99], v[104:107], v[40:43]
  ds_read_b64_tr_b16 a[112:113], v248 offset:16384
  ds_read_b64_tr_b16 a[114:115], v248 offset:18432
  v_mfma_f32_16x16x32_bf16 v[40:43], a[104:107], v[120:123], v[40:43]
  ds_read_b64_tr_b16 a[116:117], v249 offset:16384
  ds_read_b64_tr_b16 a[118:119], v249 offset:18432
  v_mfma_f32_16x16x32_bf16 v[48:51], a[96:99], v[108:111], v[48:51]
  ds_read_b128 v[136:139], v1 offset:53248
  ds_read_b128 v[140:143], v1 offset:54272
  v_mfma_f32_16x16x32_bf16 v[48:51], a[104:107], v[124:127], v[48:51]
  buffer_load_dwordx4 v246, s[8:11], s42 offen offset:2048 lds
  v_mfma_f32_16x16x32_bf16 v[56:59], a[96:99], v[112:115], v[56:59]
  ds_read_b128 v[144:147], v1 offset:61440
  ds_read_b128 v[148:151], v1 offset:62464
  v_mfma_f32_16x16x32_bf16 v[56:59], a[104:107], v[128:131], v[56:59]
  ds_read_b64_tr_b16 a[120:121], v248 offset:20480
  ds_read_b64_tr_b16 a[122:123], v248 offset:22528
  v_mfma_f32_16x16x32_bf16 v[64:67], a[96:99], v[116:119], v[64:67]
  ds_read_b64_tr_b16 a[124:125], v249 offset:20480
  ds_read_b64_tr_b16 a[126:127], v249 offset:22528
  v_mfma_f32_16x16x32_bf16 v[64:67], a[104:107], v[132:135], v[64:67]
  buffer_load_dwordx4 v247, s[8:11], s42 offen offset:3072 lds
  s_add_u32 m0, s54, 16384
  s_add_u32 s42, s51, 720896
  v_mfma_f32_16x16x32_bf16 v[44:47], a[100:103], v[104:107], v[44:47]
  ds_read_b128 v[152:155], v1 offset:55296
  ds_read_b128 v[156:159], v1 offset:56320
  v_mfma_f32_16x16x32_bf16 v[44:47], a[108:111], v[120:123], v[44:47]
  ds_read_b128 v[160:163], v1 offset:63488
  ds_read_b128 v[164:167], v1 offset:64512
  v_mfma_f32_16x16x32_bf16 v[52:55], a[100:103], v[108:111], v[52:55]
  buffer_load_dwordx4 v244, s[8:11], s42 offen offset:0 lds
  v_mfma_f32_16x16x32_bf16 v[52:55], a[108:111], v[124:127], v[52:55]
  s_lshl_b32 s86, s55, 7
  s_mul_i32 s55, s55, 3
  v_mfma_f32_16x16x32_bf16 v[60:63], a[100:103], v[112:115], v[60:63]
  buffer_load_dwordx4 v245, s[8:11], s42 offen offset:1024 lds
  v_mfma_f32_16x16x32_bf16 v[60:63], a[108:111], v[128:131], v[60:63]
  buffer_load_dwordx4 v246, s[8:11], s42 offen offset:2048 lds
  v_mfma_f32_16x16x32_bf16 v[68:71], a[100:103], v[116:119], v[68:71]
  buffer_load_dwordx4 v247, s[8:11], s42 offen offset:3072 lds
  s_add_u32 m0, s54, 32768
  s_add_u32 s42, s52, 49152
  v_mfma_f32_16x16x32_bf16 v[68:71], a[108:111], v[132:135], v[68:71]
  buffer_load_dwordx4 v1, s[20:23], s42 offen offset:0 sc1 lds
  s_waitcnt lgkmcnt(0)
  v_mfma_f32_16x16x32_bf16 v[40:43], a[112:115], v[136:139], v[40:43]
  s_waitcnt vmcnt(13)
  s_barrier
  v_mfma_f32_16x16x32_bf16 v[40:43], a[120:123], v[152:155], v[40:43]
  ds_read_b64_tr_b16 a[128:129], v248 offset:32768
  ds_read_b64_tr_b16 a[130:131], v248 offset:34816
  v_mfma_f32_16x16x32_bf16 v[48:51], a[112:115], v[140:143], v[48:51]
  ds_read_b64_tr_b16 a[132:133], v249 offset:32768
  ds_read_b64_tr_b16 a[134:135], v249 offset:34816
  v_mfma_f32_16x16x32_bf16 v[48:51], a[120:123], v[156:159], v[48:51]
  buffer_load_dwordx4 v1, s[20:23], s42 offen offset:1024 sc1 lds
  v_mfma_f32_16x16x32_bf16 v[56:59], a[112:115], v[144:147], v[56:59]
  ds_read_b128 v[104:107], v252 offset:0
  ds_read_b128 v[108:111], v252 offset:1024
  v_mfma_f32_16x16x32_bf16 v[56:59], a[120:123], v[160:163], v[56:59]
  ds_read_b128 v[112:115], v252 offset:8192
  ds_read_b128 v[116:119], v252 offset:9216
  v_mfma_f32_16x16x32_bf16 v[64:67], a[112:115], v[148:151], v[64:67]
  ds_read_b64_tr_b16 a[136:137], v248 offset:36864
  ds_read_b64_tr_b16 a[138:139], v248 offset:38912
  v_mfma_f32_16x16x32_bf16 v[64:67], a[120:123], v[164:167], v[64:67]
  buffer_load_dwordx4 v1, s[20:23], s42 offen offset:2048 sc1 lds
  v_mfma_f32_16x16x32_bf16 v[44:47], a[116:119], v[136:139], v[44:47]
  ds_read_b64_tr_b16 a[140:141], v249 offset:36864
  ds_read_b64_tr_b16 a[142:143], v249 offset:38912
  v_mfma_f32_16x16x32_bf16 v[44:47], a[124:127], v[152:155], v[44:47]
  ds_read_b128 v[120:123], v252 offset:2048
  ds_read_b128 v[124:127], v252 offset:3072
  v_mfma_f32_16x16x32_bf16 v[52:55], a[116:119], v[140:143], v[52:55]
  buffer_load_dwordx4 v1, s[20:23], s42 offen offset:3072 sc1 lds
  s_add_u32 m0, s54, 65536
  s_add_u32 s42, s51, 786432
  v_mfma_f32_16x16x32_bf16 v[52:55], a[124:127], v[156:159], v[52:55]
  ds_read_b128 v[128:131], v252 offset:10240
  ds_read_b128 v[132:135], v252 offset:11264
  v_mfma_f32_16x16x32_bf16 v[60:63], a[116:119], v[144:147], v[60:63]
  buffer_load_dwordx4 v244, s[8:11], s42 offen offset:0 lds
  v_mfma_f32_16x16x32_bf16 v[60:63], a[124:127], v[160:163], v[60:63]
  buffer_load_dwordx4 v245, s[8:11], s42 offen offset:1024 lds
  v_mfma_f32_16x16x32_bf16 v[68:71], a[116:119], v[148:151], v[68:71]
  buffer_load_dwordx4 v246, s[8:11], s42 offen offset:2048 lds
  v_mfma_f32_16x16x32_bf16 v[68:71], a[124:127], v[164:167], v[68:71]
  buffer_load_dwordx4 v247, s[8:11], s42 offen offset:3072 lds
  s_add_u32 m0, s54, 81920
  s_add_u32 s42, s51, 851968
  s_waitcnt lgkmcnt(0)
  v_mfma_f32_16x16x32_bf16 v[40:43], a[128:131], v[104:107], v[40:43]
  ds_read_b64_tr_b16 a[144:145], v248 offset:49152
  ds_read_b64_tr_b16 a[146:147], v248 offset:51200
  v_mfma_f32_16x16x32_bf16 v[40:43], a[136:139], v[120:123], v[40:43]
  ds_read_b64_tr_b16 a[148:149], v249 offset:49152
  ds_read_b64_tr_b16 a[150:151], v249 offset:51200
  v_mfma_f32_16x16x32_bf16 v[48:51], a[128:131], v[108:111], v[48:51]
  ds_read_b128 v[136:139], v252 offset:4096
  ds_read_b128 v[140:143], v252 offset:5120
  v_mfma_f32_16x16x32_bf16 v[48:51], a[136:139], v[124:127], v[48:51]
  buffer_load_dwordx4 v244, s[8:11], s42 offen offset:0 lds
  v_mfma_f32_16x16x32_bf16 v[56:59], a[128:131], v[112:115], v[56:59]
  ds_read_b128 v[144:147], v252 offset:12288
  ds_read_b128 v[148:151], v252 offset:13312
  v_mfma_f32_16x16x32_bf16 v[56:59], a[136:139], v[128:131], v[56:59]
  ds_read_b64_tr_b16 a[152:153], v248 offset:53248
  ds_read_b64_tr_b16 a[154:155], v248 offset:55296
  v_mfma_f32_16x16x32_bf16 v[64:67], a[128:131], v[116:119], v[64:67]
  ds_read_b64_tr_b16 a[156:157], v249 offset:53248
  ds_read_b64_tr_b16 a[158:159], v249 offset:55296
  v_mfma_f32_16x16x32_bf16 v[64:67], a[136:139], v[132:135], v[64:67]
  buffer_load_dwordx4 v245, s[8:11], s42 offen offset:1024 lds
  v_mfma_f32_16x16x32_bf16 v[44:47], a[132:135], v[104:107], v[44:47]
  ds_read_b128 v[152:155], v252 offset:6144
  ds_read_b128 v[156:159], v252 offset:7168
  v_mfma_f32_16x16x32_bf16 v[44:47], a[140:143], v[120:123], v[44:47]
  ds_read_b128 v[160:163], v252 offset:14336
  ds_read_b128 v[164:167], v252 offset:15360
  v_mfma_f32_16x16x32_bf16 v[52:55], a[132:135], v[108:111], v[52:55]
  buffer_load_dwordx4 v246, s[8:11], s42 offen offset:2048 lds
  v_mfma_f32_16x16x32_bf16 v[52:55], a[140:143], v[124:127], v[52:55]
  s_xor_b32 s56, s48, s40
  s_add_u32 s55, s55, s56
  v_mfma_f32_16x16x32_bf16 v[60:63], a[132:135], v[112:115], v[60:63]
  buffer_load_dwordx4 v247, s[8:11], s42 offen offset:3072 lds
  s_add_u32 m0, s54, 49152
  s_add_u32 s42, s52, 57344
  v_mfma_f32_16x16x32_bf16 v[60:63], a[140:143], v[128:131], v[60:63]
  buffer_load_dwordx4 v1, s[20:23], s42 offen offset:0 sc1 lds
  v_mfma_f32_16x16x32_bf16 v[68:71], a[132:135], v[116:119], v[68:71]
  buffer_load_dwordx4 v1, s[20:23], s42 offen offset:1024 sc1 lds
  v_mfma_f32_16x16x32_bf16 v[68:71], a[140:143], v[132:135], v[68:71]
  buffer_load_dwordx4 v1, s[20:23], s42 offen offset:2048 sc1 lds
  s_waitcnt lgkmcnt(0)
  v_mfma_f32_16x16x32_bf16 v[40:43], a[144:147], v[136:139], v[40:43]
  s_waitcnt vmcnt(15)
  s_barrier
  s_mov_b32 s61, s88
  buffer_load_dword v8, v9, s[12:15], s61 offen sc1
  v_mfma_f32_16x16x32_bf16 v[40:43], a[152:155], v[152:155], v[40:43]
  ds_read_b64_tr_b16 a[160:161], v250 offset:0
  ds_read_b64_tr_b16 a[162:163], v250 offset:2048
  v_mfma_f32_16x16x32_bf16 v[48:51], a[144:147], v[140:143], v[48:51]
  ds_read_b64_tr_b16 a[164:165], v251 offset:0
  ds_read_b64_tr_b16 a[166:167], v251 offset:2048
  v_mfma_f32_16x16x32_bf16 v[48:51], a[152:155], v[156:159], v[48:51]
  buffer_load_dwordx4 v1, s[20:23], s42 offen offset:3072 sc1 lds
  s_add_u32 m0, s54, 98304
  s_add_u32 s42, s51, 917504
  v_mfma_f32_16x16x32_bf16 v[56:59], a[144:147], v[144:147], v[56:59]
  ds_read_b128 v[104:107], v252 offset:16384
  ds_read_b128 v[108:111], v252 offset:17408
  v_mfma_f32_16x16x32_bf16 v[56:59], a[152:155], v[160:163], v[56:59]
  ds_read_b128 v[112:115], v252 offset:24576
  ds_read_b128 v[116:119], v252 offset:25600
  v_mfma_f32_16x16x32_bf16 v[64:67], a[144:147], v[148:151], v[64:67]
  ds_read_b64_tr_b16 a[168:169], v250 offset:4096
  ds_read_b64_tr_b16 a[170:171], v250 offset:6144
  v_mfma_f32_16x16x32_bf16 v[64:67], a[152:155], v[164:167], v[64:67]
  buffer_load_dwordx4 v244, s[8:11], s42 offen offset:0 lds
  v_mfma_f32_16x16x32_bf16 v[44:47], a[148:151], v[136:139], v[44:47]
  ds_read_b64_tr_b16 a[172:173], v251 offset:4096
  ds_read_b64_tr_b16 a[174:175], v251 offset:6144
  v_mfma_f32_16x16x32_bf16 v[44:47], a[156:159], v[152:155], v[44:47]
  ds_read_b128 v[120:123], v252 offset:18432
  ds_read_b128 v[124:127], v252 offset:19456
  v_mfma_f32_16x16x32_bf16 v[52:55], a[148:151], v[140:143], v[52:55]
  buffer_load_dwordx4 v245, s[8:11], s42 offen offset:1024 lds
  v_mfma_f32_16x16x32_bf16 v[52:55], a[156:159], v[156:159], v[52:55]
  ds_read_b128 v[128:131], v252 offset:26624
  ds_read_b128 v[132:135], v252 offset:27648
  v_mfma_f32_16x16x32_bf16 v[60:63], a[148:151], v[144:147], v[60:63]
  buffer_load_dwordx4 v246, s[8:11], s42 offen offset:2048 lds
  v_mfma_f32_16x16x32_bf16 v[60:63], a[156:159], v[160:163], v[60:63]
  buffer_load_dwordx4 v247, s[8:11], s42 offen offset:3072 lds
  s_add_u32 m0, s54, 114688
  s_add_u32 s42, s51, 983040
  v_mfma_f32_16x16x32_bf16 v[68:71], a[148:151], v[148:151], v[68:71]
  buffer_load_dwordx4 v244, s[8:11], s42 offen offset:0 lds
  v_mfma_f32_16x16x32_bf16 v[68:71], a[156:159], v[164:167], v[68:71]
  buffer_load_dwordx4 v245, s[8:11], s42 offen offset:1024 lds
  s_waitcnt lgkmcnt(0)
  v_mfma_f32_16x16x32_bf16 v[40:43], a[160:163], v[104:107], v[40:43]
  ds_read_b64_tr_b16 a[176:177], v250 offset:16384
  ds_read_b64_tr_b16 a[178:179], v250 offset:18432
  v_mfma_f32_16x16x32_bf16 v[40:43], a[168:171], v[120:123], v[40:43]
  ds_read_b64_tr_b16 a[180:181], v251 offset:16384
  ds_read_b64_tr_b16 a[182:183], v251 offset:18432
  v_mfma_f32_16x16x32_bf16 v[48:51], a[160:163], v[108:111], v[48:51]
  ds_read_b128 v[136:139], v252 offset:20480
  ds_read_b128 v[140:143], v252 offset:21504
  v_mfma_f32_16x16x32_bf16 v[48:51], a[168:171], v[124:127], v[48:51]
  buffer_load_dwordx4 v246, s[8:11], s42 offen offset:2048 lds
  v_mfma_f32_16x16x32_bf16 v[56:59], a[160:163], v[112:115], v[56:59]
  ds_read_b128 v[144:147], v252 offset:28672
  ds_read_b128 v[148:151], v252 offset:29696
  v_mfma_f32_16x16x32_bf16 v[56:59], a[168:171], v[128:131], v[56:59]
  ds_read_b64_tr_b16 a[184:185], v250 offset:20480
  ds_read_b64_tr_b16 a[186:187], v250 offset:22528
  v_mfma_f32_16x16x32_bf16 v[64:67], a[160:163], v[116:119], v[64:67]
  ds_read_b64_tr_b16 a[188:189], v251 offset:20480
  ds_read_b64_tr_b16 a[190:191], v251 offset:22528
  v_mfma_f32_16x16x32_bf16 v[64:67], a[168:171], v[132:135], v[64:67]
  buffer_load_dwordx4 v247, s[8:11], s42 offen offset:3072 lds
  v_mfma_f32_16x16x32_bf16 v[44:47], a[164:167], v[104:107], v[44:47]
  ds_read_b128 v[152:155], v252 offset:22528
  ds_read_b128 v[156:159], v252 offset:23552
  v_mfma_f32_16x16x32_bf16 v[44:47], a[172:175], v[120:123], v[44:47]
  ds_read_b128 v[160:163], v252 offset:30720
  ds_read_b128 v[164:167], v252 offset:31744
  v_mfma_f32_16x16x32_bf16 v[52:55], a[164:167], v[108:111], v[52:55]
  s_sub_u32 s55, s55, 1
  s_lshl_b32 s55, s55, 14
  v_mfma_f32_16x16x32_bf16 v[52:55], a[172:175], v[124:127], v[52:55]
  s_cmp_eq_u32 s56, 0
  s_cselect_b32 s55, 0x7f000000, s55
  s_lshl_b32 s56, s56, 2
  v_mfma_f32_16x16x32_bf16 v[60:63], a[164:167], v[112:115], v[60:63]
  s_add_u32 s86, s86, s56
  s_add_u32 s86, s86, 0x433ffc
  v_mfma_f32_16x16x32_bf16 v[60:63], a[172:175], v[128:131], v[60:63]
  s_add_u32 s56, s43, s48
  s_lshl_b32 s87, s56, 7
  v_mfma_f32_16x16x32_bf16 v[68:71], a[164:167], v[116:119], v[68:71]
  s_add_u32 s87, s87, 0x434000
  s_mul_i32 s56, s56, 49152
  v_mfma_f32_16x16x32_bf16 v[68:71], a[172:175], v[132:135], v[68:71]
  s_add_u32 s56, s56, s54
  s_lshl_b32 s43, s49, 2
  s_waitcnt lgkmcnt(0)
  v_mfma_f32_16x16x32_bf16 v[40:43], a[176:179], v[136:139], v[40:43]
  s_waitcnt vmcnt(13)
  s_barrier
  s_waitcnt vmcnt(9)
  v_cmp_gt_u32 vcc, 1, v8
  s_cbranch_vccnz Lspinctx2
Lokctx2:
  s_add_u32 m0, s54, 131072
  s_add_u32 s42, s89, 65536
  v_mfma_f32_16x16x32_bf16 v[40:43], a[184:187], v[152:155], v[40:43]
  ds_read_b64_tr_b16 a[192:193], v248 offset:0
  ds_read_b64_tr_b16 a[194:195], v248 offset:2048
  v_mfma_f32_16x16x32_bf16 v[48:51], a[176:179], v[140:143], v[48:51]
  ds_read_b64_tr_b16 a[196:197], v249 offset:0
  ds_read_b64_tr_b16 a[198:199], v249 offset:2048
  v_mfma_f32_16x16x32_bf16 v[48:51], a[184:187], v[156:159], v[48:51]
  buffer_load_dwordx4 v1, s[20:23], s42 offen offset:0 sc1 lds
  v_mfma_f32_16x16x32_bf16 v[56:59], a[176:179], v[144:147], v[56:59]
  ds_read_b128 v[104:107], v1 offset:32768
  ds_read_b128 v[108:111], v1 offset:33792
  v_mfma_f32_16x16x32_bf16 v[56:59], a[184:187], v[160:163], v[56:59]
  ds_read_b128 v[112:115], v1 offset:40960
  ds_read_b128 v[116:119], v1 offset:41984
  v_mfma_f32_16x16x32_bf16 v[64:67], a[176:179], v[148:151], v[64:67]
  ds_read_b64_tr_b16 a[200:201], v248 offset:4096
  ds_read_b64_tr_b16 a[202:203], v248 offset:6144
  v_mfma_f32_16x16x32_bf16 v[64:67], a[184:187], v[164:167], v[64:67]
  buffer_load_dwordx4 v1, s[20:23], s42 offen offset:1024 sc1 lds
  v_mfma_f32_16x16x32_bf16 v[44:47], a[180:183], v[136:139], v[44:47]
  ds_read_b64_tr_b16 a[204:205], v249 offset:4096
  ds_read_b64_tr_b16 a[206:207], v249 offset:6144
  v_mfma_f32_16x16x32_bf16 v[44:47], a[188:191], v[152:155], v[44:47]
  ds_read_b128 v[120:123], v1 offset:34816
  ds_read_b128 v[124:127], v1 offset:35840
  v_mfma_f32_16x16x32_bf16 v[52:55], a[180:183], v[140:143], v[52:55]
  buffer_load_dwordx4 v1, s[20:23], s42 offen offset:2048 sc1 lds
  v_mfma_f32_16x16x32_bf16 v[52:55], a[188:191], v[156:159], v[52:55]
  ds_read_b128 v[128:131], v1 offset:43008
  ds_read_b128 v[132:135], v1 offset:44032
  v_mfma_f32_16x16x32_bf16 v[60:63], a[180:183], v[144:147], v[60:63]
  buffer_load_dwordx4 v1, s[20:23], s42 offen offset:3072 sc1 lds
  s_add_u32 m0, s54, 147456
  s_add_u32 s42, s89, 73728
  v_mfma_f32_16x16x32_bf16 v[60:63], a[188:191], v[160:163], v[60:63]
  buffer_load_dwordx4 v1, s[20:23], s42 offen offset:0 sc1 lds
  v_mfma_f32_16x16x32_bf16 v[68:71], a[180:183], v[148:151], v[68:71]
  buffer_load_dwordx4 v1, s[20:23], s42 offen offset:1024 sc1 lds
  v_mfma_f32_16x16x32_bf16 v[68:71], a[188:191], v[164:167], v[68:71]
  buffer_load_dwordx4 v1, s[20:23], s42 offen offset:2048 sc1 lds
  s_waitcnt lgkmcnt(0)
  v_mfma_f32_16x16x32_bf16 v[40:43], a[192:195], v[104:107], v[40:43]
  ds_read_b64_tr_b16 a[208:209], v248 offset:16384
  ds_read_b64_tr_b16 a[210:211], v248 offset:18432
  v_mfma_f32_16x16x32_bf16 v[40:43], a[200:203], v[120:123], v[40:43]
  ds_read_b64_tr_b16 a[212:213], v249 offset:16384
  ds_read_b64_tr_b16 a[214:215], v249 offset:18432
  v_mfma_f32_16x16x32_bf16 v[48:51], a[192:195], v[108:111], v[48:51]
  ds_read_b128 v[136:139], v1 offset:36864
  ds_read_b128 v[140:143], v1 offset:37888
  v_mfma_f32_16x16x32_bf16 v[48:51], a[200:203], v[124:127], v[48:51]
  buffer_load_dwordx4 v1, s[20:23], s42 offen offset:3072 sc1 lds
  v_mfma_f32_16x16x32_bf16 v[56:59], a[192:195], v[112:115], v[56:59]
  ds_read_b128 v[144:147], v1 offset:45056
  ds_read_b128 v[148:151], v1 offset:46080
  v_mfma_f32_16x16x32_bf16 v[56:59], a[200:203], v[128:131], v[56:59]
  ds_read_b64_tr_b16 a[216:217], v248 offset:20480
  ds_read_b64_tr_b16 a[218:219], v248 offset:22528
  v_mfma_f32_16x16x32_bf16 v[64:67], a[192:195], v[116:119], v[64:67]
  ds_read_b64_tr_b16 a[220:221], v249 offset:20480
  ds_read_b64_tr_b16 a[222:223], v249 offset:22528
  v_mfma_f32_16x16x32_bf16 v[64:67], a[200:203], v[132:135], v[64:67]
  ds_read_b128 v[152:155], v1 offset:38912
  ds_read_b128 v[156:159], v1 offset:39936
  v_mfma_f32_16x16x32_bf16 v[44:47], a[196:199], v[104:107], v[44:47]
  ds_read_b128 v[160:163], v1 offset:47104
  ds_read_b128 v[164:167], v1 offset:48128
  v_mfma_f32_16x16x32_bf16 v[44:47], a[204:207], v[120:123], v[44:47]
  s_add_u32 s43, s43, s40
  s_lshl_b32 s35, s41, 3
  v_mfma_f32_16x16x32_bf16 v[52:55], a[196:199], v[108:111], v[52:55]
  s_add_u32 s59, s43, s35
  s_sub_u32 s91, s43, s35
  v_mfma_f32_16x16x32_bf16 v[52:55], a[204:207], v[124:127], v[52:55]
  s_add_u32 s91, s91, 120
  s_lshl_b32 s60, s50, 2
  v_mfma_f32_16x16x32_bf16 v[60:63], a[196:199], v[112:115], v[60:63]
  s_add_u32 s60, s60, s48
  s_lshl_b32 s60, s60, 6
  v_mfma_f32_16x16x32_bf16 v[60:63], a[204:207], v[128:131], v[60:63]
  v_lshrrev_b32 v234, 2, v0
  v_lshlrev_b32 v4, 10, v234
  v_mfma_f32_16x16x32_bf16 v[68:71], a[196:199], v[116:119], v[68:71]
  v_lshl_add_u32 v4, v235, 4, v4
  s_lshl_b32 s43, s59, 4
  v_mfma_f32_16x16x32_bf16 v[68:71], a[204:207], v[132:135], v[68:71]
  v_add_u32 v10, s43, v234
  v_sub_u32 v10, 2047, v10
  s_waitcnt lgkmcnt(0)
  v_mfma_f32_16x16x32_bf16 v[40:43], a[208:211], v[136:139], v[40:43]
  s_waitcnt vmcnt(8)
  s_barrier
  s_add_u32 m0, s54, 32768
  s_add_u32 s42, s89, 81920
  v_mfma_f32_16x16x32_bf16 v[40:43], a[216:219], v[152:155], v[40:43]
  ds_read_b64_tr_b16 a[224:225], v248 offset:32768
  ds_read_b64_tr_b16 a[226:227], v248 offset:34816
  v_mfma_f32_16x16x32_bf16 v[48:51], a[208:211], v[140:143], v[48:51]
  ds_read_b64_tr_b16 a[228:229], v249 offset:32768
  ds_read_b64_tr_b16 a[230:231], v249 offset:34816
  v_mfma_f32_16x16x32_bf16 v[48:51], a[216:219], v[156:159], v[48:51]
  buffer_load_dwordx4 v1, s[20:23], s42 offen offset:0 sc1 lds
  v_mfma_f32_16x16x32_bf16 v[56:59], a[208:211], v[144:147], v[56:59]
  ds_read_b128 v[104:107], v1 offset:49152
  ds_read_b128 v[108:111], v1 offset:50176
  v_mfma_f32_16x16x32_bf16 v[56:59], a[216:219], v[160:163], v[56:59]
  ds_read_b128 v[112:115], v1 offset:57344
  ds_read_b128 v[116:119], v1 offset:58368
  v_mfma_f32_16x16x32_bf16 v[64:67], a[208:211], v[148:151], v[64:67]
  ds_read_b64_tr_b16 a[232:233], v248 offset:36864
  ds_read_b64_tr_b16 a[234:235], v248 offset:38912
  v_mfma_f32_16x16x32_bf16 v[64:67], a[216:219], v[164:167], v[64:67]
  buffer_load_dwordx4 v1, s[20:23], s42 offen offset:1024 sc1 lds
  v_mfma_f32_16x16x32_bf16 v[44:47], a[212:215], v[136:139], v[44:47]
  ds_read_b64_tr_b16 a[236:237], v249 offset:36864
  ds_read_b64_tr_b16 a[238:239], v249 offset:38912
  v_mfma_f32_16x16x32_bf16 v[44:47], a[220:223], v[152:155], v[44:47]
  ds_read_b128 v[120:123], v1 offset:51200
  ds_read_b128 v[124:127], v1 offset:52224
  v_mfma_f32_16x16x32_bf16 v[52:55], a[212:215], v[140:143], v[52:55]
  buffer_load_dwordx4 v1, s[20:23], s42 offen offset:2048 sc1 lds
  v_mfma_f32_16x16x32_bf16 v[52:55], a[220:223], v[156:159], v[52:55]
  ds_read_b128 v[128:131], v1 offset:59392
  ds_read_b128 v[132:135], v1 offset:60416
  v_mfma_f32_16x16x32_bf16 v[60:63], a[212:215], v[144:147], v[60:63]
  buffer_load_dwordx4 v1, s[20:23], s42 offen offset:3072 sc1 lds
  v_mfma_f32_16x16x32_bf16 v[60:63], a[220:223], v[160:163], v[60:63]
  s_lshl_b32 s43, s91, 4
  v_add_u32_e64 v12, s43, v234
  v_mfma_f32_16x16x32_bf16 v[68:71], a[212:215], v[148:151], v[68:71]
  v_sub_u32 v12, 2047, v12
  v_readlane_b32 s64, v2, 0
  v_mfma_f32_16x16x32_bf16 v[68:71], a[220:223], v[164:167], v[68:71]
  v_readlane_b32 s65, v2, 1
  v_readlane_b32 s66, v2, 2
  s_waitcnt lgkmcnt(0)
  v_mfma_f32_16x16x32_bf16 v[40:43], a[224:227], v[104:107], v[40:43]
  ds_read_b64_tr_b16 a[240:241], v248 offset:49152
  ds_read_b64_tr_b16 a[242:243], v248 offset:51200
  v_mfma_f32_16x16x32_bf16 v[40:43], a[232:235], v[120:123], v[40:43]
  ds_read_b64_tr_b16 a[244:245], v249 offset:49152
  ds_read_b64_tr_b16 a[246:247], v249 offset:51200
  v_mfma_f32_16x16x32_bf16 v[48:51], a[224:227], v[108:111], v[48:51]
  ds_read_b128 v[136:139], v1 offset:53248
  ds_read_b128 v[140:143], v1 offset:54272
  v_mfma_f32_16x16x32_bf16 v[48:51], a[232:235], v[124:127], v[48:51]
  ds_read_b128 v[144:147], v1 offset:61440
  ds_read_b128 v[148:151], v1 offset:62464
  v_mfma_f32_16x16x32_bf16 v[56:59], a[224:227], v[112:115], v[56:59]
  ds_read_b64_tr_b16 a[248:249], v248 offset:53248
  ds_read_b64_tr_b16 a[250:251], v248 offset:55296
  v_mfma_f32_16x16x32_bf16 v[56:59], a[232:235], v[128:131], v[56:59]
  ds_read_b64_tr_b16 a[252:253], v249 offset:53248
  ds_read_b64_tr_b16 a[254:255], v249 offset:55296
  v_mfma_f32_16x16x32_bf16 v[64:67], a[224:227], v[116:119], v[64:67]
  ds_read_b128 v[152:155], v1 offset:55296
  ds_read_b128 v[156:159], v1 offset:56320
  v_mfma_f32_16x16x32_bf16 v[64:67], a[232:235], v[132:135], v[64:67]
  ds_read_b128 v[160:163], v1 offset:63488
  ds_read_b128 v[164:167], v1 offset:64512
  v_mfma_f32_16x16x32_bf16 v[44:47], a[228:231], v[104:107], v[44:47]
  v_readlane_b32 s67, v2, 3
  v_readlane_b32 s68, v2, 4
  v_mfma_f32_16x16x32_bf16 v[44:47], a[236:239], v[120:123], v[44:47]
  v_readlane_b32 s69, v2, 5
  v_readlane_b32 s70, v2, 6
  v_mfma_f32_16x16x32_bf16 v[52:55], a[228:231], v[108:111], v[52:55]
  v_readlane_b32 s71, v2, 7
  s_mov_b32 s16, s36
  v_mfma_f32_16x16x32_bf16 v[52:55], a[236:239], v[124:127], v[52:55]
  s_and_b32 s17, s37, 0xffff
  s_mov_b32 s18, 0x200000
  v_mfma_f32_16x16x32_bf16 v[60:63], a[228:231], v[112:115], v[60:63]
  s_mov_b32 s19, 0x20000
  s_mov_b32 s80, s98
  v_mfma_f32_16x16x32_bf16 v[60:63], a[236:239], v[128:131], v[60:63]
  s_and_b32 s81, s99, 0xffff
  s_mov_b32 s82, 0x200000
  v_mfma_f32_16x16x32_bf16 v[68:71], a[228:231], v[116:119], v[68:71]
  s_mov_b32 s83, 0x20000
  s_lshl_b32 s57, s59, 14
  v_mfma_f32_16x16x32_bf16 v[68:71], a[236:239], v[132:135], v[68:71]
  s_add_u32 s57, s57, s60
  s_lshl_b32 s58, s91, 14
  s_waitcnt lgkmcnt(0)
  v_mfma_f32_16x16x32_bf16 v[40:43], a[240:243], v[136:139], v[40:43]
  s_waitcnt vmcnt(8)
  s_barrier
  s_add_u32 m0, s54, 49152
  s_add_u32 s42, s89, 90112
  v_mfma_f32_16x16x32_bf16 v[40:43], a[248:251], v[152:155], v[40:43]
  ds_read_b128 v[104:107], v252 offset:0
  ds_read_b128 v[108:111], v252 offset:1024
  v_mfma_f32_16x16x32_bf16 v[48:51], a[240:243], v[140:143], v[48:51]
  ds_read_b128 v[112:115], v252 offset:8192
  ds_read_b128 v[116:119], v252 offset:9216
  v_mfma_f32_16x16x32_bf16 v[48:51], a[248:251], v[156:159], v[48:51]
  buffer_load_dwordx4 v1, s[20:23], s42 offen offset:0 sc1 lds
  v_mfma_f32_16x16x32_bf16 v[56:59], a[240:243], v[144:147], v[56:59]
  ds_read_b128 v[120:123], v252 offset:2048
  ds_read_b128 v[124:127], v252 offset:3072
  v_mfma_f32_16x16x32_bf16 v[56:59], a[248:251], v[160:163], v[56:59]
  ds_read_b128 v[128:131], v252 offset:10240
  ds_read_b128 v[132:135], v252 offset:11264
  v_mfma_f32_16x16x32_bf16 v[64:67], a[240:243], v[148:151], v[64:67]
  s_add_u32 s58, s58, s60
  v_mov_b32 v232, 512
  v_mfma_f32_16x16x32_bf16 v[64:67], a[248:251], v[164:167], v[64:67]
  buffer_load_dwordx4 v1, s[20:23], s42 offen offset:1024 sc1 lds
  v_mfma_f32_16x16x32_bf16 v[44:47], a[244:247], v[136:139], v[44:47]
  v_mov_b32 v233, 512
  s_and_b32 s72, s64, 0xffff
  v_mfma_f32_16x16x32_bf16 v[44:47], a[252:255], v[152:155], v[44:47]
  v_mov_b32_e64 v235, 0
  v_cmp_eq_u32 s[92:93], s72, v10
  v_mfma_f32_16x16x32_bf16 v[52:55], a[244:247], v[140:143], v[52:55]
  buffer_load_dwordx4 v1, s[20:23], s42 offen offset:2048 sc1 lds
  v_mfma_f32_16x16x32_bf16 v[52:55], a[252:255], v[156:159], v[52:55]
  v_cmp_eq_u32 s[94:95], s72, v12
  s_nop 0
  v_mfma_f32_16x16x32_bf16 v[60:63], a[244:247], v[144:147], v[60:63]
  buffer_load_dwordx4 v1, s[20:23], s42 offen offset:3072 sc1 lds
  v_mfma_f32_16x16x32_bf16 v[60:63], a[252:255], v[160:163], v[60:63]
  v_cndmask_b32 v232, v232, v235, s[92:93]
  v_cndmask_b32 v233, v233, v235, s[94:95]
  v_mfma_f32_16x16x32_bf16 v[68:71], a[244:247], v[148:151], v[68:71]
  s_and_b32 s72, s65, 0xffff
  v_mov_b32 v235, 64
  v_mfma_f32_16x16x32_bf16 v[68:71], a[252:255], v[164:167], v[68:71]
  v_cmp_eq_u32 s[92:93], s72, v10
  v_cmp_eq_u32 s[94:95], s72, v12
  s_waitcnt lgkmcnt(0)
  v_mfma_f32_16x16x32_bf16 v[72:75], a[0:3], v[104:107], 0
  ds_read_b128 v[136:139], v252 offset:4096
  ds_read_b128 v[140:143], v252 offset:5120
  v_mfma_f32_16x16x32_bf16 v[72:75], a[8:11], v[120:123], v[72:75]
  ds_read_b128 v[144:147], v252 offset:12288
  ds_read_b128 v[148:151], v252 offset:13312
  v_mfma_f32_16x16x32_bf16 v[80:83], a[0:3], v[108:111], 0
  ds_read_b128 v[152:155], v252 offset:6144
  ds_read_b128 v[156:159], v252 offset:7168
  v_mfma_f32_16x16x32_bf16 v[80:83], a[8:11], v[124:127], v[80:83]
  ds_read_b128 v[160:163], v252 offset:14336
  ds_read_b128 v[164:167], v252 offset:15360
  v_mfma_f32_16x16x32_bf16 v[88:91], a[0:3], v[112:115], 0
  s_nop 0
  v_cndmask_b32 v232, v232, v235, s[92:93]
  v_mfma_f32_16x16x32_bf16 v[88:91], a[8:11], v[128:131], v[88:91]
  v_cndmask_b32 v233, v233, v235, s[94:95]
  s_and_b32 s72, s66, 0xffff
  v_mfma_f32_16x16x32_bf16 v[96:99], a[0:3], v[116:119], 0
  v_mov_b32 v235, 128
  v_cmp_eq_u32 s[92:93], s72, v10
  v_mfma_f32_16x16x32_bf16 v[96:99], a[8:11], v[132:135], v[96:99]
  v_cmp_eq_u32 s[94:95], s72, v12
  s_nop 0
  v_mfma_f32_16x16x32_bf16 v[76:79], a[4:7], v[104:107], 0
  v_cndmask_b32 v232, v232, v235, s[92:93]
  v_cndmask_b32 v233, v233, v235, s[94:95]
  v_mfma_f32_16x16x32_bf16 v[76:79], a[12:15], v[120:123], v[76:79]
  s_and_b32 s72, s67, 0xffff
  v_mov_b32 v235, 192
  v_mfma_f32_16x16x32_bf16 v[84:87], a[4:7], v[108:111], 0
  v_cmp_eq_u32 s[92:93], s72, v10
  v_cmp_eq_u32 s[94:95], s72, v12
  v_mfma_f32_16x16x32_bf16 v[84:87], a[12:15], v[124:127], v[84:87]
  s_nop 0
  v_cndmask_b32 v232, v232, v235, s[92:93]
  v_mfma_f32_16x16x32_bf16 v[92:95], a[4:7], v[112:115], 0
  v_cndmask_b32 v233, v233, v235, s[94:95]
  s_and_b32 s72, s68, 0xffff
  v_mfma_f32_16x16x32_bf16 v[92:95], a[12:15], v[128:131], v[92:95]
  v_mov_b32 v235, 256
  v_cmp_eq_u32 s[92:93], s72, v10
  v_mfma_f32_16x16x32_bf16 v[100:103], a[4:7], v[116:119], 0
  v_cmp_eq_u32 s[94:95], s72, v12
  s_nop 0
  v_mfma_f32_16x16x32_bf16 v[100:103], a[12:15], v[132:135], v[100:103]
  v_cndmask_b32 v232, v232, v235, s[92:93]
  v_cndmask_b32 v233, v233, v235, s[94:95]
  s_waitcnt lgkmcnt(0)
  v_mfma_f32_16x16x32_bf16 v[72:75], a[16:19], v[136:139], v[72:75]
  s_waitcnt vmcnt(8)
  s_barrier
  v_mfma_f32_16x16x32_bf16 v[72:75], a[24:27], v[152:155], v[72:75]
  ds_read_b128 v[104:107], v252 offset:16384
  ds_read_b128 v[108:111], v252 offset:17408
  v_mfma_f32_16x16x32_bf16 v[80:83], a[16:19], v[140:143], v[80:83]
  ds_read_b128 v[112:115], v252 offset:24576
  ds_read_b128 v[116:119], v252 offset:25600
  s_add_u32 m0, s54, 131072
  s_add_u32 s42, s89, 98304
  v_mfma_f32_16x16x32_bf16 v[80:83], a[24:27], v[156:159], v[80:83]
  buffer_load_dwordx4 v1, s[20:23], s42 offen offset:0 sc1 lds
  v_mfma_f32_16x16x32_bf16 v[88:91], a[16:19], v[144:147], v[88:91]
  ds_read_b128 v[120:123], v252 offset:18432
  ds_read_b128 v[124:127], v252 offset:19456
  v_mfma_f32_16x16x32_bf16 v[88:91], a[24:27], v[160:163], v[88:91]
  ds_read_b128 v[128:131], v252 offset:26624
  ds_read_b128 v[132:135], v252 offset:27648
  v_mfma_f32_16x16x32_bf16 v[96:99], a[16:19], v[148:151], v[96:99]
  s_and_b32 s72, s69, 0xffff
  v_mov_b32 v235, 320
  v_mfma_f32_16x16x32_bf16 v[96:99], a[24:27], v[164:167], v[96:99]
  buffer_load_dwordx4 v1, s[20:23], s42 offen offset:1024 sc1 lds
  v_mfma_f32_16x16x32_bf16 v[76:79], a[20:23], v[136:139], v[76:79]
  v_cmp_eq_u32 s[92:93], s72, v10
  v_cmp_eq_u32 s[94:95], s72, v12
  v_mfma_f32_16x16x32_bf16 v[76:79], a[28:31], v[152:155], v[76:79]
  s_nop 0
  v_cndmask_b32 v232, v232, v235, s[92:93]
  v_mfma_f32_16x16x32_bf16 v[84:87], a[20:23], v[140:143], v[84:87]
  v_cndmask_b32 v233, v233, v235, s[94:95]
  s_and_b32 s72, s70, 0xffff
  v_mfma_f32_16x16x32_bf16 v[84:87], a[28:31], v[156:159], v[84:87]
  buffer_load_dwordx4 v1, s[20:23], s42 offen offset:2048 sc1 lds
  v_mfma_f32_16x16x32_bf16 v[92:95], a[20:23], v[144:147], v[92:95]
  v_mov_b32 v235, 384
  v_cmp_eq_u32 s[92:93], s72, v10
  v_mfma_f32_16x16x32_bf16 v[92:95], a[28:31], v[160:163], v[92:95]
  v_cmp_eq_u32 s[94:95], s72, v12
  s_nop 0
  v_mfma_f32_16x16x32_bf16 v[100:103], a[20:23], v[148:151], v[100:103]
  v_cndmask_b32 v232, v232, v235, s[92:93]
  v_cndmask_b32 v233, v233, v235, s[94:95]
  v_mfma_f32_16x16x32_bf16 v[100:103], a[28:31], v[164:167], v[100:103]
  buffer_load_dwordx4 v1, s[20:23], s42 offen offset:3072 sc1 lds
  s_waitcnt lgkmcnt(0)
  v_mfma_f32_16x16x32_bf16 v[72:75], a[32:35], v[104:107], v[72:75]
  ds_read_b128 v[136:139], v252 offset:20480
  ds_read_b128 v[140:143], v252 offset:21504
  v_mfma_f32_16x16x32_bf16 v[72:75], a[40:43], v[120:123], v[72:75]
  ds_read_b128 v[144:147], v252 offset:28672
  ds_read_b128 v[148:151], v252 offset:29696
  v_mfma_f32_16x16x32_bf16 v[80:83], a[32:35], v[108:111], v[80:83]
  ds_read_b128 v[152:155], v252 offset:22528
  ds_read_b128 v[156:159], v252 offset:23552
  s_add_u32 s90, s55, 0
  v_mfma_f32_16x16x32_bf16 v[80:83], a[40:43], v[124:127], v[80:83]
  buffer_store_dwordx4 v[40:43], v1, s[24:27], s90 offen offset:0 sc1
  v_mfma_f32_16x16x32_bf16 v[88:91], a[32:35], v[112:115], v[88:91]
  ds_read_b128 v[160:163], v252 offset:30720
  ds_read_b128 v[164:167], v252 offset:31744
  v_mfma_f32_16x16x32_bf16 v[88:91], a[40:43], v[128:131], v[88:91]
  s_and_b32 s72, s71, 0xffff
  v_mov_b32 v235, 448
  v_mfma_f32_16x16x32_bf16 v[96:99], a[32:35], v[116:119], v[96:99]
  v_cmp_eq_u32 s[92:93], s72, v10
  v_cmp_eq_u32 s[94:95], s72, v12
  v_mfma_f32_16x16x32_bf16 v[96:99], a[40:43], v[132:135], v[96:99]
  buffer_store_dwordx4 v[44:47], v1, s[24:27], s90 offen offset:1024 sc1
  v_mfma_f32_16x16x32_bf16 v[76:79], a[36:39], v[104:107], v[76:79]
  s_add_u32 s90, s55, 4096
  s_nop 0
  v_mfma_f32_16x16x32_bf16 v[76:79], a[44:47], v[120:123], v[76:79]
  v_cndmask_b32 v232, v232, v235, s[92:93]
  v_cndmask_b32 v233, v233, v235, s[94:95]
  v_mfma_f32_16x16x32_bf16 v[84:87], a[36:39], v[108:111], v[84:87]
  v_and_b32 v235, 3, v0
  v_lshl_add_u32 v232, v235, 4, v232
  v_mfma_f32_16x16x32_bf16 v[84:87], a[44:47], v[124:127], v[84:87]
  buffer_store_dwordx4 v[48:51], v1, s[24:27], s90 offen offset:0 sc1
  v_mfma_f32_16x16x32_bf16 v[92:95], a[36:39], v[112:115], v[92:95]
  v_lshl_add_u32 v233, v235, 4, v233
  v_mfma_f32_16x16x32_bf16 v[92:95], a[44:47], v[128:131], v[92:95]
  v_mfma_f32_16x16x32_bf16 v[100:103], a[36:39], v[116:119], v[100:103]
  v_mfma_f32_16x16x32_bf16 v[100:103], a[44:47], v[132:135], v[100:103]
  buffer_store_dwordx4 v[52:55], v1, s[24:27], s90 offen offset:1024 sc1
  s_waitcnt lgkmcnt(0)
  v_mfma_f32_16x16x32_bf16 v[72:75], a[48:51], v[136:139], v[72:75]
  s_waitcnt vmcnt(12)
  s_barrier
  v_mfma_f32_16x16x32_bf16 v[72:75], a[56:59], v[152:155], v[72:75]
  ds_read_b128 v[104:107], v1 offset:32768
  ds_read_b128 v[108:111], v1 offset:33792
  v_mfma_f32_16x16x32_bf16 v[80:83], a[48:51], v[140:143], v[80:83]
  ds_read_b128 v[112:115], v1 offset:40960
  ds_read_b128 v[116:119], v1 offset:41984
  s_add_u32 s90, s55, 8192
  v_mfma_f32_16x16x32_bf16 v[80:83], a[56:59], v[156:159], v[80:83]
  buffer_store_dwordx4 v[56:59], v1, s[24:27], s90 offen offset:0 sc1
  v_mfma_f32_16x16x32_bf16 v[88:91], a[48:51], v[144:147], v[88:91]
  ds_read_b128 v[120:123], v1 offset:34816
  ds_read_b128 v[124:127], v1 offset:35840
  v_mfma_f32_16x16x32_bf16 v[88:91], a[56:59], v[160:163], v[88:91]
  ds_read_b128 v[128:131], v1 offset:43008
  ds_read_b128 v[132:135], v1 offset:44032
  v_mfma_f32_16x16x32_bf16 v[96:99], a[48:51], v[148:151], v[96:99]
  v_mfma_f32_16x16x32_bf16 v[96:99], a[56:59], v[164:167], v[96:99]
  buffer_store_dwordx4 v[60:63], v1, s[24:27], s90 offen offset:1024 sc1
  v_mfma_f32_16x16x32_bf16 v[76:79], a[52:55], v[136:139], v[76:79]
  s_add_u32 s90, s55, 12288
  v_mfma_f32_16x16x32_bf16 v[76:79], a[60:63], v[152:155], v[76:79]
  v_mfma_f32_16x16x32_bf16 v[84:87], a[52:55], v[140:143], v[84:87]
  v_mfma_f32_16x16x32_bf16 v[84:87], a[60:63], v[156:159], v[84:87]
  buffer_store_dwordx4 v[64:67], v1, s[24:27], s90 offen offset:0 sc1
  v_mfma_f32_16x16x32_bf16 v[92:95], a[52:55], v[144:147], v[92:95]
  v_mfma_f32_16x16x32_bf16 v[92:95], a[60:63], v[160:163], v[92:95]
  v_mfma_f32_16x16x32_bf16 v[100:103], a[52:55], v[148:151], v[100:103]
  v_mfma_f32_16x16x32_bf16 v[100:103], a[60:63], v[164:167], v[100:103]
  buffer_store_dwordx4 v[68:71], v1, s[24:27], s90 offen offset:1024 sc1
  s_waitcnt lgkmcnt(0)
  v_mfma_f32_16x16x32_bf16 v[72:75], a[64:67], v[104:107], v[72:75]
  ds_read_b128 v[136:139], v1 offset:36864
  ds_read_b128 v[140:143], v1 offset:37888
  v_mfma_f32_16x16x32_bf16 v[72:75], a[72:75], v[120:123], v[72:75]
  ds_read_b128 v[144:147], v1 offset:45056
  ds_read_b128 v[148:151], v1 offset:46080
  v_mfma_f32_16x16x32_bf16 v[80:83], a[64:67], v[108:111], v[80:83]
  ds_read_b128 v[152:155], v1 offset:38912
  ds_read_b128 v[156:159], v1 offset:39936
  s_add_u32 m0, s54, 147456
  s_add_u32 s42, s89, 106496
  v_mfma_f32_16x16x32_bf16 v[80:83], a[72:75], v[124:127], v[80:83]
  buffer_load_dwordx4 v1, s[20:23], s42 offen offset:0 sc1 lds
  v_mfma_f32_16x16x32_bf16 v[88:91], a[64:67], v[112:115], v[88:91]
  ds_read_b128 v[160:163], v1 offset:47104
  ds_read_b128 v[164:167], v1 offset:48128
  v_mfma_f32_16x16x32_bf16 v[88:91], a[72:75], v[128:131], v[88:91]
  v_mfma_f32_16x16x32_bf16 v[96:99], a[64:67], v[116:119], v[96:99]
  v_mfma_f32_16x16x32_bf16 v[96:99], a[72:75], v[132:135], v[96:99]
  buffer_load_dwordx4 v1, s[20:23], s42 offen offset:1024 sc1 lds
  v_mfma_f32_16x16x32_bf16 v[76:79], a[68:71], v[104:107], v[76:79]
  v_mfma_f32_16x16x32_bf16 v[76:79], a[76:79], v[120:123], v[76:79]
  v_mfma_f32_16x16x32_bf16 v[84:87], a[68:71], v[108:111], v[84:87]
  v_mfma_f32_16x16x32_bf16 v[84:87], a[76:79], v[124:127], v[84:87]
  buffer_load_dwordx4 v1, s[20:23], s42 offen offset:2048 sc1 lds
  v_mfma_f32_16x16x32_bf16 v[92:95], a[68:71], v[112:115], v[92:95]
  v_mfma_f32_16x16x32_bf16 v[92:95], a[76:79], v[128:131], v[92:95]
  v_mfma_f32_16x16x32_bf16 v[100:103], a[68:71], v[116:119], v[100:103]
  v_mfma_f32_16x16x32_bf16 v[100:103], a[76:79], v[132:135], v[100:103]
  buffer_load_dwordx4 v1, s[20:23], s42 offen offset:3072 sc1 lds
  s_waitcnt lgkmcnt(0)
  v_mfma_f32_16x16x32_bf16 v[72:75], a[80:83], v[136:139], v[72:75]
  s_waitcnt vmcnt(16)
  s_barrier
  v_mfma_f32_16x16x32_bf16 v[72:75], a[88:91], v[152:155], v[72:75]
  ds_read_b128 v[104:107], v1 offset:49152
  ds_read_b128 v[108:111], v1 offset:50176
  v_mfma_f32_16x16x32_bf16 v[80:83], a[80:83], v[140:143], v[80:83]
  ds_read_b128 v[112:115], v1 offset:57344
  ds_read_b128 v[116:119], v1 offset:58368
  s_add_u32 m0, s54, 32768
  s_add_u32 s42, s89, 114688
  v_mfma_f32_16x16x32_bf16 v[80:83], a[88:91], v[156:159], v[80:83]
  buffer_load_dwordx4 v1, s[20:23], s42 offen offset:0 sc1 lds
  v_mfma_f32_16x16x32_bf16 v[88:91], a[80:83], v[144:147], v[88:91]
  ds_read_b128 v[120:123], v1 offset:51200
  ds_read_b128 v[124:127], v1 offset:52224
  v_mfma_f32_16x16x32_bf16 v[88:91], a[88:91], v[160:163], v[88:91]
  ds_read_b128 v[128:131], v1 offset:59392
  ds_read_b128 v[132:135], v1 offset:60416
  v_mfma_f32_16x16x32_bf16 v[96:99], a[80:83], v[148:151], v[96:99]
  v_mfma_f32_16x16x32_bf16 v[96:99], a[88:91], v[164:167], v[96:99]
  buffer_load_dwordx4 v1, s[20:23], s42 offen offset:1024 sc1 lds
  v_mfma_f32_16x16x32_bf16 v[76:79], a[84:87], v[136:139], v[76:79]
  v_mfma_f32_16x16x32_bf16 v[76:79], a[92:95], v[152:155], v[76:79]
  v_mfma_f32_16x16x32_bf16 v[84:87], a[84:87], v[140:143], v[84:87]
  v_mfma_f32_16x16x32_bf16 v[84:87], a[92:95], v[156:159], v[84:87]
  buffer_load_dwordx4 v1, s[20:23], s42 offen offset:2048 sc1 lds
  v_mfma_f32_16x16x32_bf16 v[92:95], a[84:87], v[144:147], v[92:95]
  v_mfma_f32_16x16x32_bf16 v[92:95], a[92:95], v[160:163], v[92:95]
  v_mfma_f32_16x16x32_bf16 v[100:103], a[84:87], v[148:151], v[100:103]
  v_mfma_f32_16x16x32_bf16 v[100:103], a[92:95], v[164:167], v[100:103]
  buffer_load_dwordx4 v1, s[20:23], s42 offen offset:3072 sc1 lds
  s_waitcnt lgkmcnt(0)
  v_mfma_f32_16x16x32_bf16 v[72:75], a[96:99], v[104:107], v[72:75]
  ds_read_b128 v[136:139], v1 offset:53248
  ds_read_b128 v[140:143], v1 offset:54272
  v_mfma_f32_16x16x32_bf16 v[72:75], a[104:107], v[120:123], v[72:75]
  ds_read_b128 v[144:147], v1 offset:61440
  ds_read_b128 v[148:151], v1 offset:62464
  v_mfma_f32_16x16x32_bf16 v[80:83], a[96:99], v[108:111], v[80:83]
  ds_read_b128 v[152:155], v1 offset:55296
  ds_read_b128 v[156:159], v1 offset:56320
  v_mfma_f32_16x16x32_bf16 v[80:83], a[104:107], v[124:127], v[80:83]
  ds_read_b128 v[160:163], v1 offset:63488
  ds_read_b128 v[164:167], v1 offset:64512
  v_mfma_f32_16x16x32_bf16 v[88:91], a[96:99], v[112:115], v[88:91]
  v_mfma_f32_16x16x32_bf16 v[88:91], a[104:107], v[128:131], v[88:91]
  v_mfma_f32_16x16x32_bf16 v[96:99], a[96:99], v[116:119], v[96:99]
  v_mfma_f32_16x16x32_bf16 v[96:99], a[104:107], v[132:135], v[96:99]
  v_mfma_f32_16x16x32_bf16 v[76:79], a[100:103], v[104:107], v[76:79]
  v_mfma_f32_16x16x32_bf16 v[76:79], a[108:111], v[120:123], v[76:79]
  v_mfma_f32_16x16x32_bf16 v[84:87], a[100:103], v[108:111], v[84:87]
  v_mfma_f32_16x16x32_bf16 v[84:87], a[108:111], v[124:127], v[84:87]
  v_mfma_f32_16x16x32_bf16 v[92:95], a[100:103], v[112:115], v[92:95]
  v_mfma_f32_16x16x32_bf16 v[92:95], a[108:111], v[128:131], v[92:95]
  v_mfma_f32_16x16x32_bf16 v[100:103], a[100:103], v[116:119], v[100:103]
  v_mfma_f32_16x16x32_bf16 v[100:103], a[108:111], v[132:135], v[100:103]
  s_waitcnt lgkmcnt(0)
  v_mfma_f32_16x16x32_bf16 v[72:75], a[112:115], v[136:139], v[72:75]
  s_waitcnt vmcnt(16)
  s_barrier
  v_mfma_f32_16x16x32_bf16 v[72:75], a[120:123], v[152:155], v[72:75]
  ds_read_b128 v[104:107], v252 offset:0
  ds_read_b128 v[108:111], v252 offset:1024
  v_mfma_f32_16x16x32_bf16 v[80:83], a[112:115], v[140:143], v[80:83]
  ds_read_b128 v[112:115], v252 offset:8192
  ds_read_b128 v[116:119], v252 offset:9216
  s_add_u32 m0, s54, 49152
  s_add_u32 s42, s89, 122880
  v_mfma_f32_16x16x32_bf16 v[80:83], a[120:123], v[156:159], v[80:83]
  buffer_load_dwordx4 v1, s[20:23], s42 offen offset:0 sc1 lds
  v_mfma_f32_16x16x32_bf16 v[88:91], a[112:115], v[144:147], v[88:91]
  ds_read_b128 v[120:123], v252 offset:2048
  ds_read_b128 v[124:127], v252 offset:3072
  v_mfma_f32_16x16x32_bf16 v[88:91], a[120:123], v[160:163], v[88:91]
  ds_read_b128 v[128:131], v252 offset:10240
  ds_read_b128 v[132:135], v252 offset:11264
  v_mfma_f32_16x16x32_bf16 v[96:99], a[112:115], v[148:151], v[96:99]
  v_mfma_f32_16x16x32_bf16 v[96:99], a[120:123], v[164:167], v[96:99]
  buffer_load_dwordx4 v1, s[20:23], s42 offen offset:1024 sc1 lds
  v_mfma_f32_16x16x32_bf16 v[76:79], a[116:119], v[136:139], v[76:79]
  v_mfma_f32_16x16x32_bf16 v[76:79], a[124:127], v[152:155], v[76:79]
  v_mfma_f32_16x16x32_bf16 v[84:87], a[116:119], v[140:143], v[84:87]
  v_mfma_f32_16x16x32_bf16 v[84:87], a[124:127], v[156:159], v[84:87]
  buffer_load_dwordx4 v1, s[20:23], s42 offen offset:2048 sc1 lds
  v_mfma_f32_16x16x32_bf16 v[92:95], a[116:119], v[144:147], v[92:95]
  v_mfma_f32_16x16x32_bf16 v[92:95], a[124:127], v[160:163], v[92:95]
  v_mfma_f32_16x16x32_bf16 v[100:103], a[116:119], v[148:151], v[100:103]
  v_mfma_f32_16x16x32_bf16 v[100:103], a[124:127], v[164:167], v[100:103]
  buffer_load_dwordx4 v1, s[20:23], s42 offen offset:3072 sc1 lds
  s_waitcnt lgkmcnt(0)
  v_mfma_f32_16x16x32_bf16 v[72:75], a[128:131], v[104:107], v[72:75]
  ds_read_b128 v[136:139], v252 offset:4096
  ds_read_b128 v[140:143], v252 offset:5120
  v_mfma_f32_16x16x32_bf16 v[72:75], a[136:139], v[120:123], v[72:75]
  ds_read_b128 v[144:147], v252 offset:12288
  ds_read_b128 v[148:151], v252 offset:13312
  v_mfma_f32_16x16x32_bf16 v[80:83], a[128:131], v[108:111], v[80:83]
  ds_read_b128 v[152:155], v252 offset:6144
  ds_read_b128 v[156:159], v252 offset:7168
  v_mfma_f32_16x16x32_bf16 v[80:83], a[136:139], v[124:127], v[80:83]
  ds_read_b128 v[160:163], v252 offset:14336
  ds_read_b128 v[164:167], v252 offset:15360
  v_mfma_f32_16x16x32_bf16 v[88:91], a[128:131], v[112:115], v[88:91]
  v_mfma_f32_16x16x32_bf16 v[88:91], a[136:139], v[128:131], v[88:91]
  v_mfma_f32_16x16x32_bf16 v[96:99], a[128:131], v[116:119], v[96:99]
  v_mfma_f32_16x16x32_bf16 v[96:99], a[136:139], v[132:135], v[96:99]
  v_mfma_f32_16x16x32_bf16 v[76:79], a[132:135], v[104:107], v[76:79]
  v_mfma_f32_16x16x32_bf16 v[76:79], a[140:143], v[120:123], v[76:79]
  v_mfma_f32_16x16x32_bf16 v[84:87], a[132:135], v[108:111], v[84:87]
  v_mfma_f32_16x16x32_bf16 v[84:87], a[140:143], v[124:127], v[84:87]
  v_mfma_f32_16x16x32_bf16 v[92:95], a[132:135], v[112:115], v[92:95]
  v_mfma_f32_16x16x32_bf16 v[92:95], a[140:143], v[128:131], v[92:95]
  v_mfma_f32_16x16x32_bf16 v[100:103], a[132:135], v[116:119], v[100:103]
  v_mfma_f32_16x16x32_bf16 v[100:103], a[140:143], v[132:135], v[100:103]
  s_waitcnt lgkmcnt(0)
  v_mfma_f32_16x16x32_bf16 v[72:75], a[144:147], v[136:139], v[72:75]
  s_waitcnt vmcnt(8)
  s_barrier
  v_mfma_f32_16x16x32_bf16 v[72:75], a[152:155], v[152:155], v[72:75]
  ds_read_b128 v[104:107], v252 offset:16384
  ds_read_b128 v[108:111], v252 offset:17408
  v_mfma_f32_16x16x32_bf16 v[80:83], a[144:147], v[140:143], v[80:83]
  ds_read_b128 v[112:115], v252 offset:24576
  ds_read_b128 v[116:119], v252 offset:25600
  v_and_b32 v11, 3, v0
  v_lshlrev_b32 v11, 8, v11
  v_lshrrev_b32 v13, 2, v0
  v_lshl_add_u32 v11, v13, 4, v11
  s_lshr_b32 s43, s59, 1
  s_lshl_b32 s43, s43, 15
  s_lshl_b32 s35, s60, 5
  s_add_u32 s43, s43, s35
  s_and_b32 s35, s59, 1
  s_lshl_b32 s35, s35, 10
  s_add_u32 s43, s43, s35
  v_mfma_f32_16x16x32_bf16 v[80:83], a[152:155], v[156:159], v[80:83]
  buffer_load_dwordx4 v[24:27], v4, s[16:19], s57 offen
  v_mfma_f32_16x16x32_bf16 v[88:91], a[144:147], v[144:147], v[88:91]
  ds_read_b128 v[120:123], v252 offset:18432
  ds_read_b128 v[124:127], v252 offset:19456
  v_mfma_f32_16x16x32_bf16 v[88:91], a[152:155], v[160:163], v[88:91]
  ds_read_b128 v[128:131], v252 offset:26624
  ds_read_b128 v[132:135], v252 offset:27648
  v_mfma_f32_16x16x32_bf16 v[96:99], a[144:147], v[148:151], v[96:99]
  v_mfma_f32_16x16x32_bf16 v[96:99], a[152:155], v[164:167], v[96:99]
  buffer_load_dwordx4 v[32:35], v11, s[12:15], s43 offen sc1
  v_mfma_f32_16x16x32_bf16 v[76:79], a[148:151], v[136:139], v[76:79]
  s_lshr_b32 s43, s91, 1
  s_lshl_b32 s43, s43, 15
  v_mfma_f32_16x16x32_bf16 v[76:79], a[156:159], v[152:155], v[76:79]
  s_lshl_b32 s35, s60, 5
  s_add_u32 s43, s43, s35
  v_mfma_f32_16x16x32_bf16 v[84:87], a[148:151], v[140:143], v[84:87]
  s_and_b32 s35, s91, 1
  s_lshl_b32 s35, s35, 10
  s_add_u32 s43, s43, s35
  v_mfma_f32_16x16x32_bf16 v[84:87], a[156:159], v[156:159], v[84:87]
  buffer_load_dwordx4 v[28:31], v4, s[16:19], s58 offen
  v_mfma_f32_16x16x32_bf16 v[92:95], a[148:151], v[144:147], v[92:95]
  v_mfma_f32_16x16x32_bf16 v[92:95], a[156:159], v[160:163], v[92:95]
  v_mfma_f32_16x16x32_bf16 v[100:103], a[148:151], v[148:151], v[100:103]
  v_mfma_f32_16x16x32_bf16 v[100:103], a[156:159], v[164:167], v[100:103]
  buffer_load_dwordx4 v[36:39], v11, s[12:15], s43 offen sc1
  s_waitcnt lgkmcnt(0)
  v_mfma_f32_16x16x32_bf16 v[72:75], a[160:163], v[104:107], v[72:75]
  ds_read_b128 v[136:139], v252 offset:20480
  ds_read_b128 v[140:143], v252 offset:21504
  v_mfma_f32_16x16x32_bf16 v[72:75], a[168:171], v[120:123], v[72:75]
  ds_read_b128 v[144:147], v252 offset:28672
  ds_read_b128 v[148:151], v252 offset:29696
  v_mfma_f32_16x16x32_bf16 v[80:83], a[160:163], v[108:111], v[80:83]
  ds_read_b128 v[152:155], v252 offset:22528
  ds_read_b128 v[156:159], v252 offset:23552
  v_mfma_f32_16x16x32_bf16 v[80:83], a[168:171], v[124:127], v[80:83]
  ds_read_b128 v[160:163], v252 offset:30720
  ds_read_b128 v[164:167], v252 offset:31744
  v_mfma_f32_16x16x32_bf16 v[88:91], a[160:163], v[112:115], v[88:91]
  v_mfma_f32_16x16x32_bf16 v[88:91], a[168:171], v[128:131], v[88:91]
  v_mfma_f32_16x16x32_bf16 v[96:99], a[160:163], v[116:119], v[96:99]
  v_mfma_f32_16x16x32_bf16 v[96:99], a[168:171], v[132:135], v[96:99]
  v_mfma_f32_16x16x32_bf16 v[76:79], a[164:167], v[104:107], v[76:79]
  v_mfma_f32_16x16x32_bf16 v[76:79], a[172:175], v[120:123], v[76:79]
  v_mfma_f32_16x16x32_bf16 v[84:87], a[164:167], v[108:111], v[84:87]
  v_mfma_f32_16x16x32_bf16 v[84:87], a[172:175], v[124:127], v[84:87]
  v_mfma_f32_16x16x32_bf16 v[92:95], a[164:167], v[112:115], v[92:95]
  v_mfma_f32_16x16x32_bf16 v[92:95], a[172:175], v[128:131], v[92:95]
  v_mfma_f32_16x16x32_bf16 v[100:103], a[164:167], v[116:119], v[100:103]
  v_mfma_f32_16x16x32_bf16 v[100:103], a[172:175], v[132:135], v[100:103]
  s_waitcnt lgkmcnt(0)
  v_mfma_f32_16x16x32_bf16 v[72:75], a[176:179], v[136:139], v[72:75]
  s_waitcnt vmcnt(8)
  s_barrier
  v_mfma_f32_16x16x32_bf16 v[72:75], a[184:187], v[152:155], v[72:75]
  ds_read_b128 v[104:107], v1 offset:32768
  ds_read_b128 v[108:111], v1 offset:33792
  v_mfma_f32_16x16x32_bf16 v[80:83], a[176:179], v[140:143], v[80:83]
  ds_read_b128 v[112:115], v1 offset:40960
  ds_read_b128 v[116:119], v1 offset:41984
  v_lshlrev_b32 v200, 2, v0
  v_min_u32 v201, 21, v0
  v_lshlrev_b32_e64 v201, 2, v201
  s_mov_b32 s76, 0x430400
  v_mfma_f32_16x16x32_bf16 v[80:83], a[184:187], v[156:159], v[80:83]
  buffer_load_dword v202, v200, s[12:15], s76 offen sc1
  v_mfma_f32_16x16x32_bf16 v[88:91], a[176:179], v[144:147], v[88:91]
  ds_read_b128 v[120:123], v1 offset:34816
  ds_read_b128 v[124:127], v1 offset:35840
  v_mfma_f32_16x16x32_bf16 v[88:91], a[184:187], v[160:163], v[88:91]
  ds_read_b128 v[128:131], v1 offset:43008
  ds_read_b128 v[132:135], v1 offset:44032
  v_mfma_f32_16x16x32_bf16 v[96:99], a[176:179], v[148:151], v[96:99]
  v_mfma_f32_16x16x32_bf16 v[96:99], a[184:187], v[164:167], v[96:99]
  buffer_load_dword v203, v201, s[12:15], s76 offen offset:256 sc1
  v_mfma_f32_16x16x32_bf16 v[76:79], a[180:183], v[136:139], v[76:79]
  v_mfma_f32_16x16x32_bf16 v[76:79], a[188:191], v[152:155], v[76:79]
  v_mfma_f32_16x16x32_bf16 v[84:87], a[180:183], v[140:143], v[84:87]
  v_mfma_f32_16x16x32_bf16 v[84:87], a[188:191], v[156:159], v[84:87]
  v_mfma_f32_16x16x32_bf16 v[92:95], a[180:183], v[144:147], v[92:95]
  v_mfma_f32_16x16x32_bf16 v[92:95], a[188:191], v[160:163], v[92:95]
  v_mfma_f32_16x16x32_bf16 v[100:103], a[180:183], v[148:151], v[100:103]
  v_mfma_f32_16x16x32_bf16 v[100:103], a[188:191], v[164:167], v[100:103]
  s_waitcnt lgkmcnt(0)
  v_mfma_f32_16x16x32_bf16 v[72:75], a[192:195], v[104:107], v[72:75]
  ds_read_b128 v[136:139], v1 offset:36864
  ds_read_b128 v[140:143], v1 offset:37888
  v_mfma_f32_16x16x32_bf16 v[72:75], a[200:203], v[120:123], v[72:75]
  ds_read_b128 v[144:147], v1 offset:45056
  ds_read_b128 v[148:151], v1 offset:46080
  v_mfma_f32_16x16x32_bf16 v[80:83], a[192:195], v[108:111], v[80:83]
  ds_read_b128 v[152:155], v1 offset:38912
  ds_read_b128 v[156:159], v1 offset:39936
  v_mfma_f32_16x16x32_bf16 v[80:83], a[200:203], v[124:127], v[80:83]
  ds_read_b128 v[160:163], v1 offset:47104
  ds_read_b128 v[164:167], v1 offset:48128
  v_mfma_f32_16x16x32_bf16 v[88:91], a[192:195], v[112:115], v[88:91]
  v_mfma_f32_16x16x32_bf16 v[88:91], a[200:203], v[128:131], v[88:91]
  v_mfma_f32_16x16x32_bf16 v[96:99], a[192:195], v[116:119], v[96:99]
  v_mfma_f32_16x16x32_bf16 v[96:99], a[200:203], v[132:135], v[96:99]
  v_mfma_f32_16x16x32_bf16 v[76:79], a[196:199], v[104:107], v[76:79]
  v_mfma_f32_16x16x32_bf16 v[76:79], a[204:207], v[120:123], v[76:79]
  v_mfma_f32_16x16x32_bf16 v[84:87], a[196:199], v[108:111], v[84:87]
  v_mfma_f32_16x16x32_bf16 v[84:87], a[204:207], v[124:127], v[84:87]
  v_mfma_f32_16x16x32_bf16 v[92:95], a[196:199], v[112:115], v[92:95]
  v_mfma_f32_16x16x32_bf16 v[92:95], a[204:207], v[128:131], v[92:95]
  v_mfma_f32_16x16x32_bf16 v[100:103], a[196:199], v[116:119], v[100:103]
  v_mfma_f32_16x16x32_bf16 v[100:103], a[204:207], v[132:135], v[100:103]
  s_waitcnt lgkmcnt(0)
  v_mfma_f32_16x16x32_bf16 v[72:75], a[208:211], v[136:139], v[72:75]
  s_waitcnt vmcnt(6)
  s_barrier
  v_mfma_f32_16x16x32_bf16 v[72:75], a[216:219], v[152:155], v[72:75]
  ds_read_b128 v[104:107], v1 offset:49152
  ds_read_b128 v[108:111], v1 offset:50176
  v_mfma_f32_16x16x32_bf16 v[80:83], a[208:211], v[140:143], v[80:83]
  ds_read_b128 v[112:115], v1 offset:57344
  ds_read_b128 v[116:119], v1 offset:58368
  v_mfma_f32_16x16x32_bf16 v[80:83], a[216:219], v[156:159], v[80:83]
  ds_read_b128 v[120:123], v1 offset:51200
  ds_read_b128 v[124:127], v1 offset:52224
  v_mfma_f32_16x16x32_bf16 v[88:91], a[208:211], v[144:147], v[88:91]
  ds_read_b128 v[128:131], v1 offset:59392
  ds_read_b128 v[132:135], v1 offset:60416
  v_mfma_f32_16x16x32_bf16 v[88:91], a[216:219], v[160:163], v[88:91]
  v_mfma_f32_16x16x32_bf16 v[96:99], a[208:211], v[148:151], v[96:99]
  v_mfma_f32_16x16x32_bf16 v[96:99], a[216:219], v[164:167], v[96:99]
  v_mfma_f32_16x16x32_bf16 v[76:79], a[212:215], v[136:139], v[76:79]
  v_mfma_f32_16x16x32_bf16 v[76:79], a[220:223], v[152:155], v[76:79]
  v_mfma_f32_16x16x32_bf16 v[84:87], a[212:215], v[140:143], v[84:87]
  v_mfma_f32_16x16x32_bf16 v[84:87], a[220:223], v[156:159], v[84:87]
  v_mfma_f32_16x16x32_bf16 v[92:95], a[212:215], v[144:147], v[92:95]
  v_mfma_f32_16x16x32_bf16 v[92:95], a[220:223], v[160:163], v[92:95]
  v_mfma_f32_16x16x32_bf16 v[100:103], a[212:215], v[148:151], v[100:103]
  v_mfma_f32_16x16x32_bf16 v[100:103], a[220:223], v[164:167], v[100:103]
  s_waitcnt lgkmcnt(0)
  v_mfma_f32_16x16x32_bf16 v[72:75], a[224:227], v[104:107], v[72:75]
  ds_read_b128 v[136:139], v1 offset:53248
  ds_read_b128 v[140:143], v1 offset:54272
  v_mfma_f32_16x16x32_bf16 v[72:75], a[232:235], v[120:123], v[72:75]
  ds_read_b128 v[144:147], v1 offset:61440
  ds_read_b128 v[148:151], v1 offset:62464
  v_mfma_f32_16x16x32_bf16 v[80:83], a[224:227], v[108:111], v[80:83]
  ds_read_b128 v[152:155], v1 offset:55296
  ds_read_b128 v[156:159], v1 offset:56320
  v_mfma_f32_16x16x32_bf16 v[80:83], a[232:235], v[124:127], v[80:83]
  ds_read_b128 v[160:163], v1 offset:63488
  ds_read_b128 v[164:167], v1 offset:64512
  v_mfma_f32_16x16x32_bf16 v[88:91], a[224:227], v[112:115], v[88:91]
  v_mfma_f32_16x16x32_bf16 v[88:91], a[232:235], v[128:131], v[88:91]
  v_mfma_f32_16x16x32_bf16 v[96:99], a[224:227], v[116:119], v[96:99]
  v_mfma_f32_16x16x32_bf16 v[96:99], a[232:235], v[132:135], v[96:99]
  v_mfma_f32_16x16x32_bf16 v[76:79], a[228:231], v[104:107], v[76:79]
  v_mfma_f32_16x16x32_bf16 v[76:79], a[236:239], v[120:123], v[76:79]
  v_mfma_f32_16x16x32_bf16 v[84:87], a[228:231], v[108:111], v[84:87]
  v_mfma_f32_16x16x32_bf16 v[84:87], a[236:239], v[124:127], v[84:87]
  v_mfma_f32_16x16x32_bf16 v[92:95], a[228:231], v[112:115], v[92:95]
  v_mfma_f32_16x16x32_bf16 v[92:95], a[236:239], v[128:131], v[92:95]
  v_mfma_f32_16x16x32_bf16 v[100:103], a[228:231], v[116:119], v[100:103]
  v_mfma_f32_16x16x32_bf16 v[100:103], a[236:239], v[132:135], v[100:103]
  s_waitcnt lgkmcnt(0)
  v_mfma_f32_16x16x32_bf16 v[72:75], a[240:243], v[136:139], v[72:75]
  v_mfma_f32_16x16x32_bf16 v[72:75], a[248:251], v[152:155], v[72:75]
  v_mfma_f32_16x16x32_bf16 v[80:83], a[240:243], v[140:143], v[80:83]
  v_mfma_f32_16x16x32_bf16 v[80:83], a[248:251], v[156:159], v[80:83]
  v_mfma_f32_16x16x32_bf16 v[88:91], a[240:243], v[144:147], v[88:91]
  v_mfma_f32_16x16x32_bf16 v[88:91], a[248:251], v[160:163], v[88:91]
  v_mfma_f32_16x16x32_bf16 v[96:99], a[240:243], v[148:151], v[96:99]
  v_mfma_f32_16x16x32_bf16 v[96:99], a[248:251], v[164:167], v[96:99]
  v_mfma_f32_16x16x32_bf16 v[76:79], a[244:247], v[136:139], v[76:79]
  v_mfma_f32_16x16x32_bf16 v[76:79], a[252:255], v[152:155], v[76:79]
  v_mfma_f32_16x16x32_bf16 v[84:87], a[244:247], v[140:143], v[84:87]
  v_mfma_f32_16x16x32_bf16 v[84:87], a[252:255], v[156:159], v[84:87]
  v_mfma_f32_16x16x32_bf16 v[92:95], a[244:247], v[144:147], v[92:95]
  v_mfma_f32_16x16x32_bf16 v[92:95], a[252:255], v[160:163], v[92:95]
  v_mfma_f32_16x16x32_bf16 v[100:103], a[244:247], v[148:151], v[100:103]
  v_mfma_f32_16x16x32_bf16 v[100:103], a[252:255], v[164:167], v[100:103]
  s_waitcnt vmcnt(0)
  s_nop 7
  s_cmp_eq_u32 s40, s48
  s_cbranch_scc1 Lown
  s_add_u32 s90, s55, 0
  buffer_store_dwordx4 v[72:75], v1, s[24:27], s90 offen offset:2048 sc1
  buffer_store_dwordx4 v[76:79], v1, s[24:27], s90 offen offset:3072 sc1
  s_add_u32 s90, s55, 4096
  buffer_store_dwordx4 v[80:83], v1, s[24:27], s90 offen offset:2048 sc1
  buffer_store_dwordx4 v[84:87], v1, s[24:27], s90 offen offset:3072 sc1
  s_add_u32 s90, s55, 8192
  buffer_store_dwordx4 v[88:91], v1, s[24:27], s90 offen offset:2048 sc1
  buffer_store_dwordx4 v[92:95], v1, s[24:27], s90 offen offset:3072 sc1
  s_add_u32 s90, s55, 12288
  buffer_store_dwordx4 v[96:99], v1, s[24:27], s90 offen offset:2048 sc1
  buffer_store_dwordx4 v[100:103], v1, s[24:27], s90 offen offset:3072 sc1
  s_waitcnt vmcnt(0)
  v_mov_b32 v11, 1
  v_mov_b32_e64 v13, 0
  s_mov_b64 exec, 1
  buffer_store_dword v11, v13, s[12:15], s86 offen sc1
  s_mov_b64 exec, -1
  s_branch Lown2
Lown:
  ds_write_b128 v1, v[40:43] offset:0
  ds_write_b128 v1, v[44:47] offset:1024
  ds_write_b128 v1, v[48:51] offset:4096
  ds_write_b128 v1, v[52:55] offset:5120
  ds_write_b128 v1, v[56:59] offset:8192
  ds_write_b128 v1, v[60:63] offset:9216
  ds_write_b128 v1, v[64:67] offset:12288
  ds_write_b128 v1, v[68:71] offset:13312
  ds_write_b128 v1, v[72:75] offset:2048
  ds_write_b128 v1, v[76:79] offset:3072
  ds_write_b128 v1, v[80:83] offset:6144
  ds_write_b128 v1, v[84:87] offset:7168
  ds_write_b128 v1, v[88:91] offset:10240
  ds_write_b128 v1, v[92:95] offset:11264
  ds_write_b128 v1, v[96:99] offset:14336
  ds_write_b128 v1, v[100:103] offset:15360
  v_lshlrev_b32 v13, 2, v0
  v_mov_b32 v11, 0
  ds_write_b32 v13, v11 offset:33280
  s_lshr_b32 s78, s59, 2
  s_lshr_b32 s79, s91, 2
  s_and_b32 s72, s64, 0xffff
  s_sub_u32 s73, 2047, s72
  s_lshr_b32 s73, s73, 6
  s_cmp_eq_u32 s73, s79
  s_cselect_b32 s73, s78, s73
  s_cmp_lg_u32 s73, s78
  s_cbranch_scc1 Lnt0
  s_mov_b32 s74, s64
  s_mov_b32 s75, 0x500000
  s_mov_b32 s72, 32768
  s_call_b64 s[30:31], Lmoered
Lnt0:
  s_and_b32 s72, s65, 0xffff
  s_sub_u32 s73, 2047, s72
  s_lshr_b32 s73, s73, 6
  s_cmp_eq_u32 s73, s79
  s_cselect_b32 s73, s78, s73
  s_cmp_lg_u32 s73, s78
  s_cbranch_scc1 Lnt1
  s_mov_b32 s74, s65
  s_mov_b32 s75, 0x500800
  s_mov_b32 s72, 32832
  s_call_b64 s[30:31], Lmoered
Lnt1:
  s_and_b32 s72, s66, 0xffff
  s_sub_u32 s73, 2047, s72
  s_lshr_b32 s73, s73, 6
  s_cmp_eq_u32 s73, s79
  s_cselect_b32 s73, s78, s73
  s_cmp_lg_u32 s73, s78
  s_cbranch_scc1 Lnt2
  s_mov_b32 s74, s66
  s_mov_b32 s75, 0x501000
  s_mov_b32 s72, 32896
  s_call_b64 s[30:31], Lmoered
Lnt2:
  s_and_b32 s72, s67, 0xffff
  s_sub_u32 s73, 2047, s72
  s_lshr_b32 s73, s73, 6
  s_cmp_eq_u32 s73, s79
  s_cselect_b32 s73, s78, s73
  s_cmp_lg_u32 s73, s78
  s_cbranch_scc1 Lnt3
  s_mov_b32 s74, s67
  s_mov_b32 s75, 0x501800
  s_mov_b32 s72, 32960
  s_call_b64 s[30:31], Lmoered
Lnt3:
  s_and_b32 s72, s68, 0xffff
  s_sub_u32 s73, 2047, s72
  s_lshr_b32 s73, s73, 6
  s_cmp_eq_u32 s73, s79
  s_cselect_b32 s73, s78, s73
  s_cmp_lg_u32 s73, s78
  s_cbranch_scc1 Lnt4
  s_mov_b32 s74, s68
  s_mov_b32 s75, 0x502000
  s_mov_b32 s72, 33024
  s_call_b64 s[30:31], Lmoered
Lnt4:
  s_and_b32 s72, s69, 0xffff
  s_sub_u32 s73, 2047, s72
  s_lshr_b32 s73, s73, 6
  s_cmp_eq_u32 s73, s79
  s_cselect_b32 s73, s78, s73
  s_cmp_lg_u32 s73, s78
  s_cbranch_scc1 Lnt5
  s_mov_b32 s74, s69
  s_mov_b32 s75, 0x502800
  s_mov_b32 s72, 33088
  s_call_b64 s[30:31], Lmoered
Lnt5:
  s_and_b32 s72, s70, 0xffff
  s_sub_u32 s73, 2047, s72
  s_lshr_b32 s73, s73, 6
  s_cmp_eq_u32 s73, s79
  s_cselect_b32 s73, s78, s73
  s_cmp_lg_u32 s73, s78
  s_cbranch_scc1 Lnt6
  s_mov_b32 s74, s70
  s_mov_b32 s75, 0x503000
  s_mov_b32 s72, 33152
  s_call_b64 s[30:31], Lmoered
Lnt6:
  s_and_b32 s72, s71, 0xffff
  s_sub_u32 s73, 2047, s72
  s_lshr_b32 s73, s73, 6
  s_cmp_eq_u32 s73, s79
  s_cselect_b32 s73, s78, s73
  s_cmp_lg_u32 s73, s78
  s_cbranch_scc1 Lnt7
  s_mov_b32 s74, s71
  s_mov_b32 s75, 0x503800
  s_mov_b32 s72, 33216
  s_call_b64 s[30:31], Lmoered
Lnt7:
Lown2:
  s_add_u32 s76, s56, 16384
  s_add_u32 s77, s56, 32768
  s_waitcnt lgkmcnt(0)
  s_barrier
  v_add_u32_e64 v11, s54, v1
  ds_read_b128 v[16:19], v232 offset:32768
  ds_read_b128 v[20:23], v233 offset:32768
  ds_read_b128 v[216:219], v11 offset:0
  ds_read_b128 v[220:223], v11 offset:1024
  ds_read_b128 v[224:227], v11 offset:2048
  ds_read_b128 v[228:231], v11 offset:3072
  v_min_u32 v14, 2, v0
  v_lshlrev_b32 v14, 2, v14
  buffer_load_dword v15, v14, s[12:15], s87 offen sc1
  s_waitcnt lgkmcnt(4)
  v_lshlrev_b32 v120, 16, v32
  v_and_b32 v121, 0xffff0000, v32
  v_lshlrev_b32_e64 v104, 16, v16
  v_and_b32 v105, 0xffff0000, v16
  v_lshlrev_b32_e64 v122, 16, v33
  v_and_b32 v123, 0xffff0000, v33
  v_lshlrev_b32_e64 v106, 16, v17
  v_and_b32 v107, 0xffff0000, v17
  v_lshlrev_b32_e64 v124, 16, v34
  v_and_b32 v125, 0xffff0000, v34
  v_lshlrev_b32_e64 v108, 16, v18
  v_and_b32 v109, 0xffff0000, v18
  v_lshlrev_b32_e64 v126, 16, v35
  v_and_b32 v127, 0xffff0000, v35
  v_lshlrev_b32_e64 v110, 16, v19
  v_and_b32 v111, 0xffff0000, v19
  v_lshlrev_b32_e64 v128, 16, v36
  v_and_b32 v129, 0xffff0000, v36
  v_lshlrev_b32_e64 v112, 16, v20
  v_and_b32 v113, 0xffff0000, v20
  v_lshlrev_b32_e64 v130, 16, v37
  v_and_b32 v131, 0xffff0000, v37
  v_lshlrev_b32_e64 v114, 16, v21
  v_and_b32 v115, 0xffff0000, v21
  v_lshlrev_b32_e64 v132, 16, v38
  v_and_b32 v133, 0xffff0000, v38
  v_lshlrev_b32_e64 v116, 16, v22
  v_and_b32 v117, 0xffff0000, v22
  v_lshlrev_b32_e64 v134, 16, v39
  v_and_b32 v135, 0xffff0000, v39
  v_lshlrev_b32_e64 v118, 16, v23
  v_and_b32 v119, 0xffff0000, v23
  v_add_f32 v120, v120, v104
  v_add_f32 v121, v121, v105
  v_add_f32 v122, v122, v106
  v_add_f32 v123, v123, v107
  v_add_f32 v124, v124, v108
  v_add_f32 v125, v125, v109
  v_add_f32 v126, v126, v110
  v_add_f32 v127, v127, v111
  v_add_f32 v128, v128, v112
  v_add_f32 v129, v129, v113
  v_add_f32 v130, v130, v114
  v_add_f32 v131, v131, v115
  v_add_f32 v132, v132, v116
  v_add_f32 v133, v133, v117
  v_add_f32 v134, v134, v118
  v_add_f32 v135, v135, v119
  v_cvt_pk_bf16_f32 v32, v120, v121
  v_cvt_pk_bf16_f32 v33, v122, v123
  v_cvt_pk_bf16_f32 v34, v124, v125
  v_cvt_pk_bf16_f32 v35, v126, v127
  v_cvt_pk_bf16_f32 v36, v128, v129
  v_cvt_pk_bf16_f32 v37, v130, v131
  v_cvt_pk_bf16_f32 v38, v132, v133
  v_cvt_pk_bf16_f32 v39, v134, v135
  v_lshlrev_b32_e64 v120, 16, v32
  v_and_b32 v121, 0xffff0000, v32
  v_lshlrev_b32_e64 v104, 16, v24
  v_and_b32 v105, 0xffff0000, v24
  v_lshlrev_b32_e64 v122, 16, v33
  v_and_b32 v123, 0xffff0000, v33
  v_lshlrev_b32_e64 v106, 16, v25
  v_and_b32 v107, 0xffff0000, v25
  v_lshlrev_b32_e64 v124, 16, v34
  v_and_b32 v125, 0xffff0000, v34
  v_lshlrev_b32_e64 v108, 16, v26
  v_and_b32 v109, 0xffff0000, v26
  v_lshlrev_b32_e64 v126, 16, v35
  v_and_b32 v127, 0xffff0000, v35
  v_lshlrev_b32_e64 v110, 16, v27
  v_and_b32 v111, 0xffff0000, v27
  v_lshlrev_b32_e64 v128, 16, v36
  v_and_b32 v129, 0xffff0000, v36
  v_lshlrev_b32_e64 v112, 16, v28
  v_and_b32 v113, 0xffff0000, v28
  v_lshlrev_b32_e64 v130, 16, v37
  v_and_b32 v131, 0xffff0000, v37
  v_lshlrev_b32_e64 v114, 16, v29
  v_and_b32 v115, 0xffff0000, v29
  v_lshlrev_b32_e64 v132, 16, v38
  v_and_b32 v133, 0xffff0000, v38
  v_lshlrev_b32_e64 v116, 16, v30
  v_and_b32 v117, 0xffff0000, v30
  v_lshlrev_b32_e64 v134, 16, v39
  v_and_b32 v135, 0xffff0000, v39
  v_lshlrev_b32_e64 v118, 16, v31
  v_and_b32 v119, 0xffff0000, v31
  v_and_b32_e64 v12, 15, v0
  v_mul_u32_u24 v12, 144, v12
  v_lshrrev_b32_e64 v13, 4, v0
  v_lshl_add_u32 v12, v13, 3, v12
  s_mul_i32 s42, s40, 2304
  v_add_u32 v12, s42, v12
  v_lshrrev_b32 v13, 2, v0
  v_mul_u32_u24 v13, 144, v13
  v_and_b32_e64 v11, 3, v0
  v_lshl_add_u32 v13, v11, 4, v13
  s_mul_i32 s42, s40, 2304
  v_add_u32_e64 v13, s42, v13
  s_mov_b32 s3, 0x20000
Lpbpoll:
  s_waitcnt vmcnt(0)
  v_cmp_ne_u32 vcc, 1, v15
  s_cbranch_vccz Lpbgo
  s_sleep 2
  buffer_load_dword v15, v14, s[12:15], s87 offen sc1
  s_sub_u32 s3, s3, 1
  s_cmp_lg_u32 s3, 0
  s_cbranch_scc1 Lpbpoll
Lpbgo:
  buffer_load_dwordx4 v[168:171], v1, s[24:27], s56 offen offset:0 sc1
  buffer_load_dwordx4 v[172:175], v1, s[24:27], s56 offen offset:1024 sc1
  buffer_load_dwordx4 v[176:179], v1, s[24:27], s56 offen offset:2048 sc1
  buffer_load_dwordx4 v[180:183], v1, s[24:27], s56 offen offset:3072 sc1
  buffer_load_dwordx4 v[184:187], v1, s[24:27], s76 offen offset:0 sc1
  buffer_load_dwordx4 v[188:191], v1, s[24:27], s76 offen offset:1024 sc1
  buffer_load_dwordx4 v[192:195], v1, s[24:27], s76 offen offset:2048 sc1
  buffer_load_dwordx4 v[196:199], v1, s[24:27], s76 offen offset:3072 sc1
  buffer_load_dwordx4 v[200:203], v1, s[24:27], s77 offen offset:0 sc1
  buffer_load_dwordx4 v[204:207], v1, s[24:27], s77 offen offset:1024 sc1
  buffer_load_dwordx4 v[208:211], v1, s[24:27], s77 offen offset:2048 sc1
  buffer_load_dwordx4 v[212:215], v1, s[24:27], s77 offen offset:3072 sc1
  s_waitcnt vmcnt(8) lgkmcnt(0)
  v_pk_add_f32 v[216:217], v[216:217], v[168:169]
  v_pk_add_f32 v[218:219], v[218:219], v[170:171]
  v_pk_add_f32 v[220:221], v[220:221], v[172:173]
  v_pk_add_f32 v[222:223], v[222:223], v[174:175]
  v_pk_add_f32 v[224:225], v[224:225], v[176:177]
  v_pk_add_f32 v[226:227], v[226:227], v[178:179]
  v_pk_add_f32 v[228:229], v[228:229], v[180:181]
  v_pk_add_f32 v[230:231], v[230:231], v[182:183]
  s_waitcnt vmcnt(0)
  v_pk_add_f32 v[184:185], v[184:185], v[200:201]
  v_pk_add_f32 v[186:187], v[186:187], v[202:203]
  v_pk_add_f32 v[188:189], v[188:189], v[204:205]
  v_pk_add_f32 v[190:191], v[190:191], v[206:207]
  v_pk_add_f32 v[192:193], v[192:193], v[208:209]
  v_pk_add_f32 v[194:195], v[194:195], v[210:211]
  v_pk_add_f32 v[196:197], v[196:197], v[212:213]
  v_pk_add_f32 v[198:199], v[198:199], v[214:215]
  v_pk_add_f32 v[216:217], v[216:217], v[184:185]
  v_pk_add_f32 v[218:219], v[218:219], v[186:187]
  v_pk_add_f32 v[220:221], v[220:221], v[188:189]
  v_pk_add_f32 v[222:223], v[222:223], v[190:191]
  v_pk_add_f32 v[224:225], v[224:225], v[192:193]
  v_pk_add_f32 v[226:227], v[226:227], v[194:195]
  v_pk_add_f32 v[228:229], v[228:229], v[196:197]
  v_pk_add_f32 v[230:231], v[230:231], v[198:199]
  v_cvt_pk_bf16_f32 v216, v216, v217
  v_cvt_pk_bf16_f32 v217, v218, v219
  v_cvt_pk_bf16_f32 v218, v220, v221
  v_cvt_pk_bf16_f32 v219, v222, v223
  v_cvt_pk_bf16_f32 v220, v224, v225
  v_cvt_pk_bf16_f32 v221, v226, v227
  v_cvt_pk_bf16_f32 v222, v228, v229
  v_cvt_pk_bf16_f32 v223, v230, v231
  ds_write_b64 v12, v[216:217] offset:16384
  ds_write_b64 v12, v[218:219] offset:16416
  ds_write_b64 v12, v[220:221] offset:16448
  ds_write_b64 v12, v[222:223] offset:16480
  s_waitcnt lgkmcnt(0)
  ds_read_b128 v[16:19], v13 offset:16384
  ds_read_b128 v[20:23], v13 offset:16448
  s_waitcnt lgkmcnt(0)
  v_lshlrev_b32 v40, 16, v16
  v_and_b32 v41, 0xffff0000, v16
  v_lshlrev_b32_e64 v42, 16, v17
  v_and_b32 v43, 0xffff0000, v17
  v_lshlrev_b32_e64 v44, 16, v18
  v_and_b32 v45, 0xffff0000, v18
  v_lshlrev_b32_e64 v46, 16, v19
  v_and_b32 v47, 0xffff0000, v19
  v_lshlrev_b32_e64 v48, 16, v20
  v_and_b32 v49, 0xffff0000, v20
  v_lshlrev_b32_e64 v50, 16, v21
  v_and_b32 v51, 0xffff0000, v21
  v_lshlrev_b32_e64 v52, 16, v22
  v_and_b32 v53, 0xffff0000, v22
  v_lshlrev_b32_e64 v54, 16, v23
  v_and_b32 v55, 0xffff0000, v23
  v_pk_add_f32 v[40:41], v[40:41], v[104:105]
  v_pk_add_f32 v[42:43], v[42:43], v[106:107]
  v_pk_add_f32 v[44:45], v[44:45], v[108:109]
  v_pk_add_f32 v[46:47], v[46:47], v[110:111]
  v_pk_add_f32 v[48:49], v[48:49], v[112:113]
  v_pk_add_f32 v[50:51], v[50:51], v[114:115]
  v_pk_add_f32 v[52:53], v[52:53], v[116:117]
  v_pk_add_f32 v[54:55], v[54:55], v[118:119]
  v_cvt_pk_bf16_f32 v16, v40, v41
  v_cvt_pk_bf16_f32 v17, v42, v43
  v_cvt_pk_bf16_f32 v18, v44, v45
  v_cvt_pk_bf16_f32 v19, v46, v47
  v_cvt_pk_bf16_f32 v20, v48, v49
  v_cvt_pk_bf16_f32 v21, v50, v51
  v_cvt_pk_bf16_f32 v22, v52, v53
  v_cvt_pk_bf16_f32 v23, v54, v55
  v_lshlrev_b32_e64 v40, 16, v16
  v_and_b32 v41, 0xffff0000, v16
  v_lshlrev_b32_e64 v42, 16, v17
  v_and_b32 v43, 0xffff0000, v17
  v_lshlrev_b32_e64 v44, 16, v18
  v_and_b32 v45, 0xffff0000, v18
  v_lshlrev_b32_e64 v46, 16, v19
  v_and_b32 v47, 0xffff0000, v19
  v_lshlrev_b32_e64 v48, 16, v20
  v_and_b32 v49, 0xffff0000, v20
  v_lshlrev_b32_e64 v50, 16, v21
  v_and_b32 v51, 0xffff0000, v21
  v_lshlrev_b32_e64 v52, 16, v22
  v_and_b32 v53, 0xffff0000, v22
  v_lshlrev_b32_e64 v54, 16, v23
  v_and_b32 v55, 0xffff0000, v23
  v_pk_add_f32 v[40:41], v[40:41], v[120:121]
  v_pk_add_f32 v[42:43], v[42:43], v[122:123]
  v_pk_add_f32 v[44:45], v[44:45], v[124:125]
  v_pk_add_f32 v[46:47], v[46:47], v[126:127]
  v_pk_add_f32 v[48:49], v[48:49], v[128:129]
  v_pk_add_f32 v[50:51], v[50:51], v[130:131]
  v_pk_add_f32 v[52:53], v[52:53], v[132:133]
  v_pk_add_f32 v[54:55], v[54:55], v[134:135]
  v_cvt_pk_bf16_f32 v16, v40, v41
  v_cvt_pk_bf16_f32 v17, v42, v43
  v_cvt_pk_bf16_f32 v18, v44, v45
  v_cvt_pk_bf16_f32 v19, v46, v47
  v_cvt_pk_bf16_f32 v20, v48, v49
  v_cvt_pk_bf16_f32 v21, v50, v51
  v_cvt_pk_bf16_f32 v22, v52, v53
  v_cvt_pk_bf16_f32 v23, v54, v55
  buffer_store_dwordx4 v[16:19], v4, s[80:83], s57 offen sc1
  buffer_store_dwordx4 v[20:23], v4, s[80:83], s58 offen sc1
Lend:
  s_endpgm
Lmoered:
  s_mov_b32 s77, 0x20000
  s_mov_b32 s76, 0x430400
Lmoespin:
  v_and_b32 v204, v202, v203
  v_cmp_ne_u32_e64 vcc, 1, v204
  s_cbranch_vccz Lmoego
  s_sleep 4
  buffer_load_dword v202, v200, s[12:15], s76 offen sc1
  buffer_load_dword v203, v201, s[12:15], s76 offen offset:256 sc1
  s_waitcnt vmcnt(0)
  s_sub_u32 s77, s77, 1
  s_cmp_lg_u32 s77, 0
  s_cbranch_scc1 Lmoespin
Lmoego:
  v_lshrrev_b32 v204, 3, v0
  v_lshlrev_b32 v205, 14, v204
  v_and_b32_e64 v206, 7, v0
  v_lshl_add_u32 v205, v206, 4, v205
  v_mov_b32 v206, 0x7fff0000
  v_cmp_gt_u32 vcc, 6, v204
  s_lshl_b32 s76, s60, 1
  s_add_u32 s75, s75, s76
  v_cndmask_b32 v206, v206, v205, vcc
  buffer_load_dwordx4 v[104:107], v205, s[12:15], s75 offen sc1
  s_add_u32 s75, s75, 131072
  buffer_load_dwordx4 v[108:111], v205, s[12:15], s75 offen sc1
  s_add_u32 s75, s75, 131072
  buffer_load_dwordx4 v[112:115], v205, s[12:15], s75 offen sc1
  s_add_u32 s75, s75, 131072
  buffer_load_dwordx4 v[116:119], v205, s[12:15], s75 offen sc1
  s_add_u32 s75, s75, 131072
  buffer_load_dwordx4 v[120:123], v205, s[12:15], s75 offen sc1
  s_add_u32 s75, s75, 131072
  buffer_load_dwordx4 v[124:127], v205, s[12:15], s75 offen sc1
  s_add_u32 s75, s75, 131072
  buffer_load_dwordx4 v[128:131], v205, s[12:15], s75 offen sc1
  s_add_u32 s75, s75, 131072
  buffer_load_dwordx4 v[132:135], v205, s[12:15], s75 offen sc1
  s_add_u32 s75, s75, 131072
  buffer_load_dwordx4 v[136:139], v205, s[12:15], s75 offen sc1
  s_add_u32 s75, s75, 131072
  buffer_load_dwordx4 v[140:143], v205, s[12:15], s75 offen sc1
  s_add_u32 s75, s75, 131072
  buffer_load_dwordx4 v[144:147], v206, s[12:15], s75 offen sc1
  s_add_u32 s75, s75, 131072
  v_mov_b32_e64 v207, s74
  v_and_b32 v207, 0xffff0000, v207
  v_not_b32 v208, v207
  v_ashrrev_i32 v208, 31, v208
  v_and_b32 v208, 0x7fff0000, v208
  v_or_b32 v208, 0x80000000, v208
  v_xor_b32_e64 v207, v207, v208
  v_mul_f32 v207, 0xbfb8aa3b, v207
  v_exp_f32 v207, v207
  s_nop 0
  v_add_f32 v207, 1.0, v207
  v_rcp_f32_e64 v207, v207
  s_nop 0
  v_cvt_pk_bf16_f32 v207, v207, v207
  v_lshlrev_b32 v207, 16, v207
  s_waitcnt vmcnt(0)
  v_pk_add_f32 v[104:105], v[104:105], v[108:109]
  v_pk_add_f32 v[106:107], v[106:107], v[110:111]
  v_pk_add_f32 v[104:105], v[104:105], v[112:113]
  v_pk_add_f32 v[106:107], v[106:107], v[114:115]
  v_pk_add_f32 v[104:105], v[104:105], v[116:117]
  v_pk_add_f32 v[106:107], v[106:107], v[118:119]
  v_pk_add_f32 v[104:105], v[104:105], v[120:121]
  v_pk_add_f32 v[106:107], v[106:107], v[122:123]
  v_pk_add_f32 v[104:105], v[104:105], v[124:125]
  v_pk_add_f32 v[106:107], v[106:107], v[126:127]
  v_pk_add_f32 v[104:105], v[104:105], v[128:129]
  v_pk_add_f32 v[106:107], v[106:107], v[130:131]
  v_pk_add_f32 v[104:105], v[104:105], v[132:133]
  v_pk_add_f32 v[106:107], v[106:107], v[134:135]
  v_pk_add_f32 v[104:105], v[104:105], v[136:137]
  v_pk_add_f32 v[106:107], v[106:107], v[138:139]
  v_pk_add_f32 v[104:105], v[104:105], v[140:141]
  v_pk_add_f32 v[106:107], v[106:107], v[142:143]
  v_pk_add_f32 v[104:105], v[104:105], v[144:145]
  v_pk_add_f32 v[106:107], v[106:107], v[146:147]
  s_nop 1
  v_add_f32_dpp v104, v104, v104 row_ror:8 row_mask:0xf bank_mask:0xf
  v_add_f32_dpp v105, v105, v105 row_ror:8 row_mask:0xf bank_mask:0xf
  v_add_f32_dpp v106, v106, v106 row_ror:8 row_mask:0xf bank_mask:0xf
  v_add_f32_dpp v107, v107, v107 row_ror:8 row_mask:0xf bank_mask:0xf
  v_mov_b32 v108, v104
  v_mov_b32 v109, v105
  v_mov_b32 v110, v106
  v_mov_b32 v111, v107
  s_nop 0
  v_permlane16_swap_b32 v104, v108
  v_permlane16_swap_b32 v105, v109
  v_permlane16_swap_b32 v106, v110
  v_permlane16_swap_b32 v107, v111
  v_add_f32 v104, v104, v108
  v_add_f32 v105, v105, v109
  v_add_f32 v106, v106, v110
  v_add_f32 v107, v107, v111
  v_mov_b32 v108, v104
  v_mov_b32 v109, v105
  v_mov_b32 v110, v106
  v_mov_b32 v111, v107
  s_nop 0
  v_permlane32_swap_b32 v104, v108
  v_permlane32_swap_b32 v105, v109
  v_permlane32_swap_b32 v106, v110
  v_permlane32_swap_b32 v107, v111
  v_add_f32 v104, v104, v108
  v_add_f32 v105, v105, v109
  v_add_f32 v106, v106, v110
  v_add_f32_e64 v107, v107, v111
  v_cvt_pk_bf16_f32 v104, v104, v104
  v_cvt_pk_bf16_f32 v105, v105, v105
  v_cvt_pk_bf16_f32 v106, v106, v106
  v_cvt_pk_bf16_f32 v107, v107, v107
  v_lshlrev_b32 v104, 16, v104
  v_lshlrev_b32 v105, 16, v105
  v_lshlrev_b32 v106, 16, v106
  v_lshlrev_b32 v107, 16, v107
  v_mul_f32 v104, v104, v207
  v_mul_f32 v105, v105, v207
  v_mul_f32 v106, v106, v207
  v_mul_f32 v107, v107, v207
  v_cvt_pk_bf16_f32 v104, v104, v105
  v_cvt_pk_bf16_f32 v105, v106, v107
  v_and_b32 v204, 7, v0
  v_lshlrev_b32 v204, 3, v204
  v_add_u32_e64 v204, s72, v204
  ds_write_b64 v204, v[104:105]
  s_setpc_b64 s[30:31]
Lats16:
  buffer_atomic_add v4, v3, s[4:7], 0 offen offset:0 sc1
  s_branch Lat16
Lats17:
  buffer_atomic_add v4, v3, s[4:7], 0 offen offset:0 sc1
  s_branch Lat17
Lats18:
  buffer_atomic_add v4, v3, s[4:7], 0 offen offset:0 sc1
  s_branch Lat18
Lats19:
  buffer_atomic_add v4, v3, s[4:7], 0 offen offset:0 sc1
  s_branch Lat19
Lats20:
  buffer_atomic_add v4, v3, s[4:7], 0 offen offset:0 sc1
  s_branch Lat20
Lats21:
  buffer_atomic_add v4, v3, s[4:7], 0 offen offset:0 sc1
  s_branch Lat21
Lats22:
  buffer_atomic_add v4, v3, s[4:7], 0 offen offset:0 sc1
  s_branch Lat22
Lats23:
  buffer_atomic_add v4, v3, s[4:7], 0 offen offset:0 sc1
  s_branch Lat23
Lats24:
  buffer_atomic_add v4, v3, s[4:7], 0 offen offset:0 sc1
  s_branch Lat24
Lats25:
  buffer_atomic_add v4, v3, s[4:7], 0 offen offset:0 sc1
  s_branch Lat25
Lats26:
  buffer_atomic_add v4, v3, s[4:7], 0 offen offset:0 sc1
  s_branch Lat26
Lats27:
  buffer_atomic_add v4, v3, s[4:7], 0 offen offset:0 sc1
  s_branch Lat27
Lats28:
  buffer_atomic_add v4, v3, s[4:7], 0 offen offset:0 sc1
  s_branch Lat28
Lats29:
  buffer_atomic_add v4, v3, s[4:7], 0 offen offset:0 sc1
  s_branch Lat29
Lats30:
  buffer_atomic_add v4, v3, s[4:7], 0 offen offset:0 sc1
  s_branch Lat30
Lats31:
  buffer_atomic_add v4, v3, s[4:7], 0 offen offset:0 sc1
  s_branch Lat31
Lwm1:
  v_and_b32 v6, 0xffff, v2
  v_sub_u32 v6, 2047, v6
  v_lshrrev_b32 v7, 5, v6
  v_lshlrev_b32_e64 v7, 15, v7
  v_bfe_u32 v11, v6, 4, 1
  v_lshl_add_u32 v7, v11, 10, v7
  v_and_b32_e64 v6, 15, v6
  v_lshl_add_u32 v6, v6, 4, v7
  v_lshrrev_b32_e64 v7, 5, v0
  v_lshl_add_u32 v6, v7, 8, v6
  s_lshl_b32 s42, s40, 13
  buffer_load_dwordx4 a[192:195], v6, s[12:15], s42 offen offset:0 sc1
  buffer_load_dwordx4 a[196:199], v6, s[12:15], s42 offen offset:512 sc1
  s_branch Lwp1
Lwm2:
  buffer_load_dwordx4 a[200:203], v6, s[12:15], s42 offen offset:2048 sc1
  buffer_load_dwordx4 a[204:207], v6, s[12:15], s42 offen offset:2560 sc1
  s_add_u32 s42, s42, 4096
  buffer_load_dwordx4 a[208:211], v6, s[12:15], s42 offen offset:0 sc1
  s_branch Lwp2
Lwm3:
  buffer_load_dwordx4 a[212:215], v6, s[12:15], s42 offen offset:512 sc1
  buffer_load_dwordx4 a[216:219], v6, s[12:15], s42 offen offset:2048 sc1
  s_branch Lwp3
Lwm4:
  buffer_load_dwordx4 a[220:223], v6, s[12:15], s42 offen offset:2560 sc1
  s_lshl_b32 s42, s46, 14
  s_lshl_b32 s43, s40, 12
  s_add_u32 s42, s42, s43
  s_mul_i32 s35, s40, 12288
  s_add_u32 s35, s35, 65536
  s_add_u32 m0, s35, 0
  s_add_u32 s43, s42, 0x800000
  buffer_load_dwordx4 v1, s[12:15], s43 offen offset:0 sc1 lds
  buffer_load_dwordx4 v1, s[12:15], s43 offen offset:1024 sc1 lds
  s_branch Lwp4
Lwm5:
  buffer_load_dwordx4 v1, s[12:15], s43 offen offset:2048 sc1 lds
  buffer_load_dwordx4 v1, s[12:15], s43 offen offset:3072 sc1 lds
  s_branch Lwp5
Lwm6:
  s_add_u32 m0, s35, 4096
  s_add_u32 s43, s42, 0x960000
  buffer_load_dwordx4 v1, s[12:15], s43 offen offset:0 sc1 lds
  buffer_load_dwordx4 v1, s[12:15], s43 offen offset:1024 sc1 lds
  buffer_load_dwordx4 v1, s[12:15], s43 offen offset:2048 sc1 lds
  s_branch Lwp6
Lwm7:
  buffer_load_dwordx4 v1, s[12:15], s43 offen offset:3072 sc1 lds
  v_lshrrev_b32 v6, 4, v0
  v_lshlrev_b32 v6, 10, v6
  v_and_b32 v7, 15, v0
  v_lshl_add_u32 v6, v7, 4, v6
  s_lshl_b32 s42, s46, 14
  s_lshl_b32 s43, s40, 8
  s_add_u32 s42, s42, s43
  s_add_u32 m0, s35, 8192
  s_add_u32 s43, s42, 0
  buffer_load_dwordx4 v6, s[64:67], s43 offen lds
  s_branch Lwp7
Lwm8:
  s_add_u32 m0, s35, 9216
  s_add_u32 s43, s42, 4096
  buffer_load_dwordx4 v6, s[64:67], s43 offen lds
  s_add_u32 m0, s35, 10240
  s_add_u32 s43, s42, 8192
  buffer_load_dwordx4 v6, s[64:67], s43 offen lds
  s_add_u32 m0, s35, 11264
  s_add_u32 s43, s42, 12288
  buffer_load_dwordx4 v6, s[64:67], s43 offen lds
  s_branch Lwp8
Lsping1:
  s_mov_b32 s3, 0x20000
Lsping1_l:
  s_sleep 2
  global_load_dword v18, v19, s[62:63] sc1
  s_waitcnt vmcnt(0)
  v_cmp_gt_u32 vcc, 256, v18
  s_cbranch_vccz Lokg1
  s_sub_u32 s3, s3, 1
  s_cmp_lg_u32 s3, 0
  s_cbranch_scc1 Lsping1_l
  s_branch Lokg1
Lspinkv:
  s_mov_b32 s3, 0x20000
Lspinkv_l:
  s_sleep 2
  buffer_load_dword v18, v19, s[12:15], s35 offen sc1
  s_waitcnt vmcnt(0)
  v_cmp_gt_u32_e64 vcc, 1, v18
  s_cbranch_vccz Lokkv
  s_sub_u32 s3, s3, 1
  s_cmp_lg_u32 s3, 0
  s_cbranch_scc1 Lspinkv_l
  s_branch Lokkv
Lsping2:
  s_mov_b32 s3, 0x20000
Lsping2_l:
  s_sleep 2
  buffer_load_dwordx4 v[224:227], v1, s[12:15], s35 offen sc1
  s_waitcnt vmcnt(0)
  v_and_b32 v224, v224, v225
  v_and_b32 v226, v226, v227
  v_and_b32 v224, v224, v226
  s_waitcnt vmcnt(0)
  v_cmp_gt_u32 vcc, 1, v224
  s_cbranch_vccz Lokg2
  s_sub_u32 s3, s3, 1
  s_cmp_lg_u32 s3, 0
  s_cbranch_scc1 Lsping2_l
  s_branch Lokg2
Lspinca:
  s_mov_b32 s3, 0x20000
Lspinca_l:
  s_sleep 2
  buffer_load_dword v8, v9, s[12:15], s61 offen sc1
  s_waitcnt vmcnt(0)
  v_cmp_gt_u32 vcc, 1, v8
  s_cbranch_vccz Lokca
  s_sub_u32 s3, s3, 1
  s_cmp_lg_u32 s3, 0
  s_cbranch_scc1 Lspinca_l
  s_branch Lokca
Lspinctx2:
  s_mov_b32 s3, 0x20000
Lspinctx2_l:
  s_sleep 2
  buffer_load_dword v8, v9, s[12:15], s61 offen sc1
  s_waitcnt vmcnt(0)
  v_cmp_gt_u32_e64 vcc, 1, v8
  s_cbranch_vccz Lokctx2
  s_sub_u32 s3, s3, 1
  s_cmp_lg_u32 s3, 0
  s_cbranch_scc1 Lspinctx2_l
  s_branch Lokctx2
Lst1:
  s_call_b64 s[30:31], Lslow11
  s_branch Lst1r
Lst2:
  s_call_b64 s[30:31], Lslow10
  s_branch Lst2r
Lst3:
  s_call_b64 s[30:31], Lslow11
  s_branch Lst3r
Lst4:
  s_call_b64 s[30:31], Lslow10
  s_branch Lst4r
Lst5:
  s_call_b64 s[30:31], Lhook
  s_branch Lst5r
Lst6:
  s_call_b64 s[30:31], Lslow11
  s_branch Lst6r
Lst7:
  s_call_b64 s[30:31], Lslow10
  s_branch Lst7r
Lst8:
  s_call_b64 s[30:31], Lhook
  s_branch Lst8r
Lst9:
  s_call_b64 s[30:31], Lslow11
  s_branch Lst9r
Lst10:
  s_call_b64 s[30:31], Lslow10
  s_branch Lst10r
Lst11:
  s_call_b64 s[30:31], Lhook
  s_branch Lst11r
Lst12:
  s_call_b64 s[30:31], Lslow21
  s_branch Lst12r
Lst13:
  s_call_b64 s[30:31], Lslow20
  s_branch Lst13r
Lst14:
  s_call_b64 s[30:31], Lhook
  s_branch Lst14r
Lst15:
  s_call_b64 s[30:31], Lslow21
  s_branch Lst15r
Lst16:
  s_call_b64 s[30:31], Lslow20
  s_branch Lst16r
Lst17:
  s_call_b64 s[30:31], Lslow21
  s_branch Lst17r
Lst18:
  s_call_b64 s[30:31], Lslow20
  s_branch Lst18r
Lhook:
  s_cmp_lt_u32 s50, s61
  s_cbranch_scc1 Lhk_nop0
  s_waitcnt vmcnt(12)
  buffer_store_dwordx4 v[224:227], v9, s[12:15], s96 offen sc1
  s_add_u32 s96, s96, 131072
  buffer_store_dwordx4 v[232:235], v9, s[12:15], s97 offen sc1
  buffer_store_dwordx4 v[228:231], v9, s[12:15], s96 offen sc1
  global_load_dword v14, v8, s[36:37]
  s_mov_b32 s61, 0xffff
Lhk_nop0:
  s_cmp_lt_u32 s50, s28
  s_cbranch_scc1 Lhk_nop1
  v_mov_b32_e64 v4, 1
  buffer_store_dword v4, v3, s[12:15], s29 offen sc1
  s_mov_b32 s28, 0xffff
Lhk_nop1:
  s_cmp_lt_u32 s50, s32
  s_cbranch_scc1 Lhk_nopa
  v_mov_b32_e64 v4, 1
  buffer_store_dword v4, v3, s[12:15], s44 offen sc1
  s_mov_b32 s32, 0xffff
Lhk_nopa:
  s_min_u32 s53, s28, s32
  s_setpc_b64 s[30:31]
Lslow10:
  s_nop 15
  v_max_f32 v24, v48, v49
  v_max_f32_e64 v25, v56, v57
  v_max3_f32 v24, v24, v50, v51
  v_max3_f32 v25, v25, v58, v59
  v_max3_f32 v24, v24, v52, v53
  v_max3_f32 v25, v25, v60, v61
  v_max3_f32 v24, v24, v54, v55
  v_max3_f32 v25, v25, v62, v63
  v_mov_b32 v26, v24
  v_mov_b32 v27, v25
  s_nop 0
  v_permlane16_swap_b32 v24, v26
  v_permlane16_swap_b32 v25, v27
  v_max_f32 v24, v24, v26
  v_max_f32 v25, v25, v27
  v_mov_b32 v26, v24
  v_mov_b32 v27, v25
  s_nop 0
  v_permlane32_swap_b32 v24, v26
  v_permlane32_swap_b32 v25, v27
  v_max_f32 v24, v24, v26
  v_max_f32 v25, v25, v27
  v_max_f32 v24, 0, v24
  v_sub_f32 v26, 0, v24
  v_exp_f32 v26, v26
  v_add_f32 v22, v22, v24
  v_max_f32 v25, 0, v25
  v_sub_f32 v27, 0, v25
  v_exp_f32 v27, v27
  v_add_f32 v23, v23, v25
  v_sub_f32 v96, v96, v24
  v_sub_f32 v97, v97, v24
  v_sub_f32 v98, v98, v24
  v_sub_f32 v99, v99, v24
  v_sub_f32 v100, v100, v24
  v_sub_f32 v101, v101, v24
  v_sub_f32 v102, v102, v24
  v_sub_f32 v103, v103, v24
  v_sub_f32 v104, v104, v25
  v_sub_f32 v105, v105, v25
  v_sub_f32 v106, v106, v25
  v_sub_f32 v107, v107, v25
  v_sub_f32 v108, v108, v25
  v_sub_f32 v109, v109, v25
  v_sub_f32 v110, v110, v25
  v_sub_f32 v111, v111, v25
  v_sub_f32 v48, v48, v24
  v_sub_f32 v49, v49, v24
  v_sub_f32 v50, v50, v24
  v_sub_f32 v51, v51, v24
  v_sub_f32 v52, v52, v24
  v_sub_f32 v53, v53, v24
  v_sub_f32 v54, v54, v24
  v_sub_f32 v55, v55, v24
  v_sub_f32 v56, v56, v25
  v_sub_f32 v57, v57, v25
  v_sub_f32 v58, v58, v25
  v_sub_f32 v59, v59, v25
  v_sub_f32 v60, v60, v25
  v_sub_f32 v61, v61, v25
  v_sub_f32 v62, v62, v25
  v_sub_f32 v63, v63, v25
  v_sub_f32 v32, v32, v24
  v_sub_f32 v33, v33, v24
  v_sub_f32 v34, v34, v24
  v_sub_f32 v35, v35, v24
  v_sub_f32 v36, v36, v24
  v_sub_f32 v37, v37, v24
  v_sub_f32 v38, v38, v24
  v_sub_f32 v39, v39, v24
  v_sub_f32 v40, v40, v25
  v_sub_f32 v41, v41, v25
  v_sub_f32 v42, v42, v25
  v_sub_f32 v43, v43, v25
  v_sub_f32 v44, v44, v25
  v_sub_f32 v45, v45, v25
  v_sub_f32 v46, v46, v25
  v_sub_f32 v47, v47, v25
  v_mul_f32 v18, v18, v26
  v_mul_f32 v19, v19, v27
  v_accvgpr_read_b32 v28, a0
  v_mul_f32_e64 v28, v28, v26
  v_accvgpr_write_b32 a0, v28
  v_accvgpr_read_b32 v28, a1
  v_mul_f32_e64 v28, v28, v26
  v_accvgpr_write_b32 a1, v28
  v_accvgpr_read_b32 v28, a2
  v_mul_f32_e64 v28, v28, v26
  v_accvgpr_write_b32 a2, v28
  v_accvgpr_read_b32 v28, a3
  v_mul_f32_e64 v28, v28, v26
  v_accvgpr_write_b32 a3, v28
  v_accvgpr_read_b32 v28, a4
  v_mul_f32_e64 v28, v28, v26
  v_accvgpr_write_b32 a4, v28
  v_accvgpr_read_b32 v28, a5
  v_mul_f32_e64 v28, v28, v26
  v_accvgpr_write_b32 a5, v28
  v_accvgpr_read_b32 v28, a6
  v_mul_f32_e64 v28, v28, v26
  v_accvgpr_write_b32 a6, v28
  v_accvgpr_read_b32 v28, a7
  v_mul_f32_e64 v28, v28, v26
  v_accvgpr_write_b32 a7, v28
  v_accvgpr_read_b32 v28, a8
  v_mul_f32_e64 v28, v28, v26
  v_accvgpr_write_b32 a8, v28
  v_accvgpr_read_b32 v28, a9
  v_mul_f32_e64 v28, v28, v26
  v_accvgpr_write_b32 a9, v28
  v_accvgpr_read_b32 v28, a10
  v_mul_f32_e64 v28, v28, v26
  v_accvgpr_write_b32 a10, v28
  v_accvgpr_read_b32 v28, a11
  v_mul_f32_e64 v28, v28, v26
  v_accvgpr_write_b32 a11, v28
  v_accvgpr_read_b32 v28, a12
  v_mul_f32_e64 v28, v28, v26
  v_accvgpr_write_b32 a12, v28
  v_accvgpr_read_b32 v28, a13
  v_mul_f32_e64 v28, v28, v26
  v_accvgpr_write_b32 a13, v28
  v_accvgpr_read_b32 v28, a14
  v_mul_f32_e64 v28, v28, v26
  v_accvgpr_write_b32 a14, v28
  v_accvgpr_read_b32 v28, a15
  v_mul_f32_e64 v28, v28, v26
  v_accvgpr_write_b32 a15, v28
  v_accvgpr_read_b32 v28, a16
  v_mul_f32_e64 v28, v28, v26
  v_accvgpr_write_b32 a16, v28
  v_accvgpr_read_b32 v28, a17
  v_mul_f32_e64 v28, v28, v26
  v_accvgpr_write_b32 a17, v28
  v_accvgpr_read_b32 v28, a18
  v_mul_f32_e64 v28, v28, v26
  v_accvgpr_write_b32 a18, v28
  v_accvgpr_read_b32 v28, a19
  v_mul_f32_e64 v28, v28, v26
  v_accvgpr_write_b32 a19, v28
  v_accvgpr_read_b32 v28, a20
  v_mul_f32_e64 v28, v28, v26
  v_accvgpr_write_b32 a20, v28
  v_accvgpr_read_b32 v28, a21
  v_mul_f32_e64 v28, v28, v26
  v_accvgpr_write_b32 a21, v28
  v_accvgpr_read_b32 v28, a22
  v_mul_f32_e64 v28, v28, v26
  v_accvgpr_write_b32 a22, v28
  v_accvgpr_read_b32 v28, a23
  v_mul_f32_e64 v28, v28, v26
  v_accvgpr_write_b32 a23, v28
  v_accvgpr_read_b32 v28, a24
  v_mul_f32_e64 v28, v28, v26
  v_accvgpr_write_b32 a24, v28
  v_accvgpr_read_b32 v28, a25
  v_mul_f32_e64 v28, v28, v26
  v_accvgpr_write_b32 a25, v28
  v_accvgpr_read_b32 v28, a26
  v_mul_f32_e64 v28, v28, v26
  v_accvgpr_write_b32 a26, v28
  v_accvgpr_read_b32 v28, a27
  v_mul_f32_e64 v28, v28, v26
  v_accvgpr_write_b32 a27, v28
  v_accvgpr_read_b32 v28, a28
  v_mul_f32_e64 v28, v28, v26
  v_accvgpr_write_b32 a28, v28
  v_accvgpr_read_b32 v28, a29
  v_mul_f32_e64 v28, v28, v26
  v_accvgpr_write_b32 a29, v28
  v_accvgpr_read_b32 v28, a30
  v_mul_f32_e64 v28, v28, v26
  v_accvgpr_write_b32 a30, v28
  v_accvgpr_read_b32 v28, a31
  v_mul_f32_e64 v28, v28, v26
  v_accvgpr_write_b32 a31, v28
  v_accvgpr_read_b32 v28, a32
  v_mul_f32_e64 v28, v28, v27
  v_accvgpr_write_b32 a32, v28
  v_accvgpr_read_b32 v28, a33
  v_mul_f32_e64 v28, v28, v27
  v_accvgpr_write_b32 a33, v28
  v_accvgpr_read_b32 v28, a34
  v_mul_f32_e64 v28, v28, v27
  v_accvgpr_write_b32 a34, v28
  v_accvgpr_read_b32 v28, a35
  v_mul_f32_e64 v28, v28, v27
  v_accvgpr_write_b32 a35, v28
  v_accvgpr_read_b32 v28, a36
  v_mul_f32_e64 v28, v28, v27
  v_accvgpr_write_b32 a36, v28
  v_accvgpr_read_b32 v28, a37
  v_mul_f32_e64 v28, v28, v27
  v_accvgpr_write_b32 a37, v28
  v_accvgpr_read_b32 v28, a38
  v_mul_f32_e64 v28, v28, v27
  v_accvgpr_write_b32 a38, v28
  v_accvgpr_read_b32 v28, a39
  v_mul_f32_e64 v28, v28, v27
  v_accvgpr_write_b32 a39, v28
  v_accvgpr_read_b32 v28, a40
  v_mul_f32_e64 v28, v28, v27
  v_accvgpr_write_b32 a40, v28
  v_accvgpr_read_b32 v28, a41
  v_mul_f32_e64 v28, v28, v27
  v_accvgpr_write_b32 a41, v28
  v_accvgpr_read_b32 v28, a42
  v_mul_f32_e64 v28, v28, v27
  v_accvgpr_write_b32 a42, v28
  v_accvgpr_read_b32 v28, a43
  v_mul_f32_e64 v28, v28, v27
  v_accvgpr_write_b32 a43, v28
  v_accvgpr_read_b32 v28, a44
  v_mul_f32_e64 v28, v28, v27
  v_accvgpr_write_b32 a44, v28
  v_accvgpr_read_b32 v28, a45
  v_mul_f32_e64 v28, v28, v27
  v_accvgpr_write_b32 a45, v28
  v_accvgpr_read_b32 v28, a46
  v_mul_f32_e64 v28, v28, v27
  v_accvgpr_write_b32 a46, v28
  v_accvgpr_read_b32 v28, a47
  v_mul_f32_e64 v28, v28, v27
  v_accvgpr_write_b32 a47, v28
  v_accvgpr_read_b32 v28, a48
  v_mul_f32_e64 v28, v28, v27
  v_accvgpr_write_b32 a48, v28
  v_accvgpr_read_b32 v28, a49
  v_mul_f32_e64 v28, v28, v27
  v_accvgpr_write_b32 a49, v28
  v_accvgpr_read_b32 v28, a50
  v_mul_f32_e64 v28, v28, v27
  v_accvgpr_write_b32 a50, v28
  v_accvgpr_read_b32 v28, a51
  v_mul_f32_e64 v28, v28, v27
  v_accvgpr_write_b32 a51, v28
  v_accvgpr_read_b32 v28, a52
  v_mul_f32_e64 v28, v28, v27
  v_accvgpr_write_b32 a52, v28
  v_accvgpr_read_b32 v28, a53
  v_mul_f32_e64 v28, v28, v27
  v_accvgpr_write_b32 a53, v28
  v_accvgpr_read_b32 v28, a54
  v_mul_f32_e64 v28, v28, v27
  v_accvgpr_write_b32 a54, v28
  v_accvgpr_read_b32 v28, a55
  v_mul_f32_e64 v28, v28, v27
  v_accvgpr_write_b32 a55, v28
  v_accvgpr_read_b32 v28, a56
  v_mul_f32_e64 v28, v28, v27
  v_accvgpr_write_b32 a56, v28
  v_accvgpr_read_b32 v28, a57
  v_mul_f32_e64 v28, v28, v27
  v_accvgpr_write_b32 a57, v28
  v_accvgpr_read_b32 v28, a58
  v_mul_f32_e64 v28, v28, v27
  v_accvgpr_write_b32 a58, v28
  v_accvgpr_read_b32 v28, a59
  v_mul_f32_e64 v28, v28, v27
  v_accvgpr_write_b32 a59, v28
  v_accvgpr_read_b32 v28, a60
  v_mul_f32_e64 v28, v28, v27
  v_accvgpr_write_b32 a60, v28
  v_accvgpr_read_b32 v28, a61
  v_mul_f32_e64 v28, v28, v27
  v_accvgpr_write_b32 a61, v28
  v_accvgpr_read_b32 v28, a62
  v_mul_f32_e64 v28, v28, v27
  v_accvgpr_write_b32 a62, v28
  v_accvgpr_read_b32 v28, a63
  v_mul_f32_e64 v28, v28, v27
  v_accvgpr_write_b32 a63, v28
  v_mov_b32 v248, 0
  v_mov_b32 v249, 0
  v_exp_f32 v28, v48
  v_exp_f32_e64 v29, v49
  s_nop 0
  v_cvt_pk_bf16_f32 v136, v28, v29
  v_exp_f32 v28, v50
  v_exp_f32_e64 v29, v51
  s_nop 0
  v_cvt_pk_bf16_f32 v137, v28, v29
  v_exp_f32 v28, v52
  v_exp_f32_e64 v29, v53
  s_nop 0
  v_cvt_pk_bf16_f32 v138, v28, v29
  v_exp_f32 v28, v54
  v_exp_f32_e64 v29, v55
  s_nop 0
  v_cvt_pk_bf16_f32 v139, v28, v29
  v_exp_f32 v28, v56
  v_exp_f32_e64 v29, v57
  s_nop 0
  v_cvt_pk_bf16_f32 v140, v28, v29
  v_exp_f32 v28, v58
  v_exp_f32_e64 v29, v59
  s_nop 0
  v_cvt_pk_bf16_f32 v141, v28, v29
  v_exp_f32 v28, v60
  v_exp_f32_e64 v29, v61
  s_nop 0
  v_cvt_pk_bf16_f32 v142, v28, v29
  v_exp_f32 v28, v62
  v_exp_f32_e64 v29, v63
  s_nop 0
  v_cvt_pk_bf16_f32 v143, v28, v29
  s_nop 1
  v_mfma_f32_16x16x32_bf16 v[240:243], v[252:255], v[136:139], 0
  v_mfma_f32_16x16x32_bf16 v[244:247], v[252:255], v[140:143], 0
  s_nop 9
  v_mov_b32 v248, v240
  v_mov_b32 v249, v244
  v_max_f32 v24, v80, v81
  v_max_f32 v25, v88, v89
  v_max3_f32 v24, v24, v82, v83
  v_max3_f32 v25, v25, v90, v91
  v_max3_f32 v24, v24, v84, v85
  v_max3_f32 v25, v25, v92, v93
  v_max3_f32 v24, v24, v86, v87
  v_max3_f32 v25, v25, v94, v95
  v_mov_b32 v26, v24
  v_mov_b32 v27, v25
  s_nop 0
  v_permlane16_swap_b32 v24, v26
  v_permlane16_swap_b32 v25, v27
  v_max_f32 v24, v24, v26
  v_max_f32 v25, v25, v27
  v_mov_b32 v26, v24
  v_mov_b32 v27, v25
  s_nop 0
  v_permlane32_swap_b32 v24, v26
  v_permlane32_swap_b32 v25, v27
  v_max_f32 v24, v24, v26
  v_max_f32 v25, v25, v27
  v_max_f32 v24, 0, v24
  v_sub_f32 v26, 0, v24
  v_exp_f32 v26, v26
  v_add_f32 v30, v30, v24
  v_max_f32 v25, 0, v25
  v_sub_f32 v27, 0, v25
  v_exp_f32 v27, v27
  v_add_f32 v31, v31, v25
  v_sub_f32 v112, v112, v24
  v_sub_f32 v113, v113, v24
  v_sub_f32 v114, v114, v24
  v_sub_f32 v115, v115, v24
  v_sub_f32 v116, v116, v24
  v_sub_f32 v117, v117, v24
  v_sub_f32 v118, v118, v24
  v_sub_f32 v119, v119, v24
  v_sub_f32 v120, v120, v25
  v_sub_f32 v121, v121, v25
  v_sub_f32 v122, v122, v25
  v_sub_f32 v123, v123, v25
  v_sub_f32 v124, v124, v25
  v_sub_f32 v125, v125, v25
  v_sub_f32 v126, v126, v25
  v_sub_f32 v127, v127, v25
  v_sub_f32 v80, v80, v24
  v_sub_f32 v81, v81, v24
  v_sub_f32 v82, v82, v24
  v_sub_f32 v83, v83, v24
  v_sub_f32 v84, v84, v24
  v_sub_f32 v85, v85, v24
  v_sub_f32 v86, v86, v24
  v_sub_f32 v87, v87, v24
  v_sub_f32 v88, v88, v25
  v_sub_f32 v89, v89, v25
  v_sub_f32 v90, v90, v25
  v_sub_f32 v91, v91, v25
  v_sub_f32 v92, v92, v25
  v_sub_f32 v93, v93, v25
  v_sub_f32 v94, v94, v25
  v_sub_f32 v95, v95, v25
  v_sub_f32 v64, v64, v24
  v_sub_f32 v65, v65, v24
  v_sub_f32 v66, v66, v24
  v_sub_f32 v67, v67, v24
  v_sub_f32 v68, v68, v24
  v_sub_f32 v69, v69, v24
  v_sub_f32 v70, v70, v24
  v_sub_f32 v71, v71, v24
  v_sub_f32 v72, v72, v25
  v_sub_f32 v73, v73, v25
  v_sub_f32 v74, v74, v25
  v_sub_f32 v75, v75, v25
  v_sub_f32 v76, v76, v25
  v_sub_f32 v77, v77, v25
  v_sub_f32 v78, v78, v25
  v_sub_f32 v79, v79, v25
  v_mul_f32 v16, v16, v26
  v_mul_f32 v17, v17, v27
  v_accvgpr_read_b32 v28, a64
  v_mul_f32_e64 v28, v28, v26
  v_accvgpr_write_b32 a64, v28
  v_accvgpr_read_b32 v28, a65
  v_mul_f32_e64 v28, v28, v26
  v_accvgpr_write_b32 a65, v28
  v_accvgpr_read_b32 v28, a66
  v_mul_f32_e64 v28, v28, v26
  v_accvgpr_write_b32 a66, v28
  v_accvgpr_read_b32 v28, a67
  v_mul_f32_e64 v28, v28, v26
  v_accvgpr_write_b32 a67, v28
  v_accvgpr_read_b32 v28, a68
  v_mul_f32_e64 v28, v28, v26
  v_accvgpr_write_b32 a68, v28
  v_accvgpr_read_b32 v28, a69
  v_mul_f32_e64 v28, v28, v26
  v_accvgpr_write_b32 a69, v28
  v_accvgpr_read_b32 v28, a70
  v_mul_f32_e64 v28, v28, v26
  v_accvgpr_write_b32 a70, v28
  v_accvgpr_read_b32 v28, a71
  v_mul_f32_e64 v28, v28, v26
  v_accvgpr_write_b32 a71, v28
  v_accvgpr_read_b32 v28, a72
  v_mul_f32_e64 v28, v28, v26
  v_accvgpr_write_b32 a72, v28
  v_accvgpr_read_b32 v28, a73
  v_mul_f32_e64 v28, v28, v26
  v_accvgpr_write_b32 a73, v28
  v_accvgpr_read_b32 v28, a74
  v_mul_f32_e64 v28, v28, v26
  v_accvgpr_write_b32 a74, v28
  v_accvgpr_read_b32 v28, a75
  v_mul_f32_e64 v28, v28, v26
  v_accvgpr_write_b32 a75, v28
  v_accvgpr_read_b32 v28, a76
  v_mul_f32_e64 v28, v28, v26
  v_accvgpr_write_b32 a76, v28
  v_accvgpr_read_b32 v28, a77
  v_mul_f32_e64 v28, v28, v26
  v_accvgpr_write_b32 a77, v28
  v_accvgpr_read_b32 v28, a78
  v_mul_f32_e64 v28, v28, v26
  v_accvgpr_write_b32 a78, v28
  v_accvgpr_read_b32 v28, a79
  v_mul_f32_e64 v28, v28, v26
  v_accvgpr_write_b32 a79, v28
  v_accvgpr_read_b32 v28, a80
  v_mul_f32_e64 v28, v28, v26
  v_accvgpr_write_b32 a80, v28
  v_accvgpr_read_b32 v28, a81
  v_mul_f32_e64 v28, v28, v26
  v_accvgpr_write_b32 a81, v28
  v_accvgpr_read_b32 v28, a82
  v_mul_f32_e64 v28, v28, v26
  v_accvgpr_write_b32 a82, v28
  v_accvgpr_read_b32 v28, a83
  v_mul_f32_e64 v28, v28, v26
  v_accvgpr_write_b32 a83, v28
  v_accvgpr_read_b32 v28, a84
  v_mul_f32_e64 v28, v28, v26
  v_accvgpr_write_b32 a84, v28
  v_accvgpr_read_b32 v28, a85
  v_mul_f32_e64 v28, v28, v26
  v_accvgpr_write_b32 a85, v28
  v_accvgpr_read_b32 v28, a86
  v_mul_f32_e64 v28, v28, v26
  v_accvgpr_write_b32 a86, v28
  v_accvgpr_read_b32 v28, a87
  v_mul_f32_e64 v28, v28, v26
  v_accvgpr_write_b32 a87, v28
  v_accvgpr_read_b32 v28, a88
  v_mul_f32_e64 v28, v28, v26
  v_accvgpr_write_b32 a88, v28
  v_accvgpr_read_b32 v28, a89
  v_mul_f32_e64 v28, v28, v26
  v_accvgpr_write_b32 a89, v28
  v_accvgpr_read_b32 v28, a90
  v_mul_f32_e64 v28, v28, v26
  v_accvgpr_write_b32 a90, v28
  v_accvgpr_read_b32 v28, a91
  v_mul_f32_e64 v28, v28, v26
  v_accvgpr_write_b32 a91, v28
  v_accvgpr_read_b32 v28, a92
  v_mul_f32_e64 v28, v28, v26
  v_accvgpr_write_b32 a92, v28
  v_accvgpr_read_b32 v28, a93
  v_mul_f32_e64 v28, v28, v26
  v_accvgpr_write_b32 a93, v28
  v_accvgpr_read_b32 v28, a94
  v_mul_f32_e64 v28, v28, v26
  v_accvgpr_write_b32 a94, v28
  v_accvgpr_read_b32 v28, a95
  v_mul_f32_e64 v28, v28, v26
  v_accvgpr_write_b32 a95, v28
  v_accvgpr_read_b32 v28, a96
  v_mul_f32_e64 v28, v28, v27
  v_accvgpr_write_b32 a96, v28
  v_accvgpr_read_b32 v28, a97
  v_mul_f32_e64 v28, v28, v27
  v_accvgpr_write_b32 a97, v28
  v_accvgpr_read_b32 v28, a98
  v_mul_f32_e64 v28, v28, v27
  v_accvgpr_write_b32 a98, v28
  v_accvgpr_read_b32 v28, a99
  v_mul_f32_e64 v28, v28, v27
  v_accvgpr_write_b32 a99, v28
  v_accvgpr_read_b32 v28, a100
  v_mul_f32_e64 v28, v28, v27
  v_accvgpr_write_b32 a100, v28
  v_accvgpr_read_b32 v28, a101
  v_mul_f32_e64 v28, v28, v27
  v_accvgpr_write_b32 a101, v28
  v_accvgpr_read_b32 v28, a102
  v_mul_f32_e64 v28, v28, v27
  v_accvgpr_write_b32 a102, v28
  v_accvgpr_read_b32 v28, a103
  v_mul_f32_e64 v28, v28, v27
  v_accvgpr_write_b32 a103, v28
  v_accvgpr_read_b32 v28, a104
  v_mul_f32_e64 v28, v28, v27
  v_accvgpr_write_b32 a104, v28
  v_accvgpr_read_b32 v28, a105
  v_mul_f32_e64 v28, v28, v27
  v_accvgpr_write_b32 a105, v28
  v_accvgpr_read_b32 v28, a106
  v_mul_f32_e64 v28, v28, v27
  v_accvgpr_write_b32 a106, v28
  v_accvgpr_read_b32 v28, a107
  v_mul_f32_e64 v28, v28, v27
  v_accvgpr_write_b32 a107, v28
  v_accvgpr_read_b32 v28, a108
  v_mul_f32_e64 v28, v28, v27
  v_accvgpr_write_b32 a108, v28
  v_accvgpr_read_b32 v28, a109
  v_mul_f32_e64 v28, v28, v27
  v_accvgpr_write_b32 a109, v28
  v_accvgpr_read_b32 v28, a110
  v_mul_f32_e64 v28, v28, v27
  v_accvgpr_write_b32 a110, v28
  v_accvgpr_read_b32 v28, a111
  v_mul_f32_e64 v28, v28, v27
  v_accvgpr_write_b32 a111, v28
  v_accvgpr_read_b32 v28, a112
  v_mul_f32_e64 v28, v28, v27
  v_accvgpr_write_b32 a112, v28
  v_accvgpr_read_b32 v28, a113
  v_mul_f32_e64 v28, v28, v27
  v_accvgpr_write_b32 a113, v28
  v_accvgpr_read_b32 v28, a114
  v_mul_f32_e64 v28, v28, v27
  v_accvgpr_write_b32 a114, v28
  v_accvgpr_read_b32 v28, a115
  v_mul_f32_e64 v28, v28, v27
  v_accvgpr_write_b32 a115, v28
  v_accvgpr_read_b32 v28, a116
  v_mul_f32_e64 v28, v28, v27
  v_accvgpr_write_b32 a116, v28
  v_accvgpr_read_b32 v28, a117
  v_mul_f32_e64 v28, v28, v27
  v_accvgpr_write_b32 a117, v28
  v_accvgpr_read_b32 v28, a118
  v_mul_f32_e64 v28, v28, v27
  v_accvgpr_write_b32 a118, v28
  v_accvgpr_read_b32 v28, a119
  v_mul_f32_e64 v28, v28, v27
  v_accvgpr_write_b32 a119, v28
  v_accvgpr_read_b32 v28, a120
  v_mul_f32_e64 v28, v28, v27
  v_accvgpr_write_b32 a120, v28
  v_accvgpr_read_b32 v28, a121
  v_mul_f32_e64 v28, v28, v27
  v_accvgpr_write_b32 a121, v28
  v_accvgpr_read_b32 v28, a122
  v_mul_f32_e64 v28, v28, v27
  v_accvgpr_write_b32 a122, v28
  v_accvgpr_read_b32 v28, a123
  v_mul_f32_e64 v28, v28, v27
  v_accvgpr_write_b32 a123, v28
  v_accvgpr_read_b32 v28, a124
  v_mul_f32_e64 v28, v28, v27
  v_accvgpr_write_b32 a124, v28
  v_accvgpr_read_b32 v28, a125
  v_mul_f32_e64 v28, v28, v27
  v_accvgpr_write_b32 a125, v28
  v_accvgpr_read_b32 v28, a126
  v_mul_f32_e64 v28, v28, v27
  v_accvgpr_write_b32 a126, v28
  v_accvgpr_read_b32 v28, a127
  v_mul_f32_e64 v28, v28, v27
  v_accvgpr_write_b32 a127, v28
  v_mov_b32 v240, 0
  v_mov_b32 v244, 0
  v_exp_f32 v28, v80
  v_exp_f32_e64 v29, v81
  s_nop 0
  v_cvt_pk_bf16_f32 v152, v28, v29
  v_exp_f32 v28, v82
  v_exp_f32_e64 v29, v83
  s_nop 0
  v_cvt_pk_bf16_f32 v153, v28, v29
  v_exp_f32 v28, v84
  v_exp_f32_e64 v29, v85
  s_nop 0
  v_cvt_pk_bf16_f32 v154, v28, v29
  v_exp_f32 v28, v86
  v_exp_f32_e64 v29, v87
  s_nop 0
  v_cvt_pk_bf16_f32 v155, v28, v29
  v_exp_f32 v28, v88
  v_exp_f32_e64 v29, v89
  s_nop 0
  v_cvt_pk_bf16_f32 v156, v28, v29
  v_exp_f32 v28, v90
  v_exp_f32_e64 v29, v91
  s_nop 0
  v_cvt_pk_bf16_f32 v157, v28, v29
  v_exp_f32 v28, v92
  v_exp_f32_e64 v29, v93
  s_nop 0
  v_cvt_pk_bf16_f32 v158, v28, v29
  v_exp_f32 v28, v94
  v_exp_f32_e64 v29, v95
  s_nop 0
  v_cvt_pk_bf16_f32 v159, v28, v29
  s_nop 1
  v_mfma_f32_16x16x32_bf16 v[240:243], v[252:255], v[152:155], 0
  v_mfma_f32_16x16x32_bf16 v[244:247], v[252:255], v[156:159], 0
  s_nop 9
  s_nop 1
  s_setpc_b64 s[30:31]
Lslow11:
  s_nop 15
  v_max_f32 v24, v32, v33
  v_max_f32_e64 v25, v40, v41
  v_max3_f32 v24, v24, v34, v35
  v_max3_f32 v25, v25, v42, v43
  v_max3_f32 v24, v24, v36, v37
  v_max3_f32 v25, v25, v44, v45
  v_max3_f32 v24, v24, v38, v39
  v_max3_f32 v25, v25, v46, v47
  v_mov_b32 v26, v24
  v_mov_b32 v27, v25
  s_nop 0
  v_permlane16_swap_b32 v24, v26
  v_permlane16_swap_b32 v25, v27
  v_max_f32 v24, v24, v26
  v_max_f32 v25, v25, v27
  v_mov_b32 v26, v24
  v_mov_b32 v27, v25
  s_nop 0
  v_permlane32_swap_b32 v24, v26
  v_permlane32_swap_b32 v25, v27
  v_max_f32 v24, v24, v26
  v_max_f32 v25, v25, v27
  v_max_f32 v24, 0, v24
  v_sub_f32 v26, 0, v24
  v_exp_f32 v26, v26
  v_add_f32 v22, v22, v24
  v_max_f32 v25, 0, v25
  v_sub_f32 v27, 0, v25
  v_exp_f32 v27, v27
  v_add_f32 v23, v23, v25
  v_sub_f32 v96, v96, v24
  v_sub_f32 v97, v97, v24
  v_sub_f32 v98, v98, v24
  v_sub_f32 v99, v99, v24
  v_sub_f32 v100, v100, v24
  v_sub_f32 v101, v101, v24
  v_sub_f32 v102, v102, v24
  v_sub_f32 v103, v103, v24
  v_sub_f32 v104, v104, v25
  v_sub_f32 v105, v105, v25
  v_sub_f32 v106, v106, v25
  v_sub_f32 v107, v107, v25
  v_sub_f32 v108, v108, v25
  v_sub_f32 v109, v109, v25
  v_sub_f32 v110, v110, v25
  v_sub_f32 v111, v111, v25
  v_sub_f32 v32, v32, v24
  v_sub_f32 v33, v33, v24
  v_sub_f32 v34, v34, v24
  v_sub_f32 v35, v35, v24
  v_sub_f32 v36, v36, v24
  v_sub_f32 v37, v37, v24
  v_sub_f32 v38, v38, v24
  v_sub_f32 v39, v39, v24
  v_sub_f32 v40, v40, v25
  v_sub_f32 v41, v41, v25
  v_sub_f32 v42, v42, v25
  v_sub_f32 v43, v43, v25
  v_sub_f32 v44, v44, v25
  v_sub_f32 v45, v45, v25
  v_sub_f32 v46, v46, v25
  v_sub_f32 v47, v47, v25
  v_sub_f32 v48, v48, v24
  v_sub_f32 v49, v49, v24
  v_sub_f32 v50, v50, v24
  v_sub_f32 v51, v51, v24
  v_sub_f32 v52, v52, v24
  v_sub_f32 v53, v53, v24
  v_sub_f32 v54, v54, v24
  v_sub_f32 v55, v55, v24
  v_sub_f32 v56, v56, v25
  v_sub_f32 v57, v57, v25
  v_sub_f32 v58, v58, v25
  v_sub_f32 v59, v59, v25
  v_sub_f32 v60, v60, v25
  v_sub_f32 v61, v61, v25
  v_sub_f32 v62, v62, v25
  v_sub_f32 v63, v63, v25
  v_mul_f32 v18, v18, v26
  v_mul_f32 v19, v19, v27
  v_accvgpr_read_b32 v28, a0
  v_mul_f32_e64 v28, v28, v26
  v_accvgpr_write_b32 a0, v28
  v_accvgpr_read_b32 v28, a1
  v_mul_f32_e64 v28, v28, v26
  v_accvgpr_write_b32 a1, v28
  v_accvgpr_read_b32 v28, a2
  v_mul_f32_e64 v28, v28, v26
  v_accvgpr_write_b32 a2, v28
  v_accvgpr_read_b32 v28, a3
  v_mul_f32_e64 v28, v28, v26
  v_accvgpr_write_b32 a3, v28
  v_accvgpr_read_b32 v28, a4
  v_mul_f32_e64 v28, v28, v26
  v_accvgpr_write_b32 a4, v28
  v_accvgpr_read_b32 v28, a5
  v_mul_f32_e64 v28, v28, v26
  v_accvgpr_write_b32 a5, v28
  v_accvgpr_read_b32 v28, a6
  v_mul_f32_e64 v28, v28, v26
  v_accvgpr_write_b32 a6, v28
  v_accvgpr_read_b32 v28, a7
  v_mul_f32_e64 v28, v28, v26
  v_accvgpr_write_b32 a7, v28
  v_accvgpr_read_b32 v28, a8
  v_mul_f32_e64 v28, v28, v26
  v_accvgpr_write_b32 a8, v28
  v_accvgpr_read_b32 v28, a9
  v_mul_f32_e64 v28, v28, v26
  v_accvgpr_write_b32 a9, v28
  v_accvgpr_read_b32 v28, a10
  v_mul_f32_e64 v28, v28, v26
  v_accvgpr_write_b32 a10, v28
  v_accvgpr_read_b32 v28, a11
  v_mul_f32_e64 v28, v28, v26
  v_accvgpr_write_b32 a11, v28
  v_accvgpr_read_b32 v28, a12
  v_mul_f32_e64 v28, v28, v26
  v_accvgpr_write_b32 a12, v28
  v_accvgpr_read_b32 v28, a13
  v_mul_f32_e64 v28, v28, v26
  v_accvgpr_write_b32 a13, v28
  v_accvgpr_read_b32 v28, a14
  v_mul_f32_e64 v28, v28, v26
  v_accvgpr_write_b32 a14, v28
  v_accvgpr_read_b32 v28, a15
  v_mul_f32_e64 v28, v28, v26
  v_accvgpr_write_b32 a15, v28
  v_accvgpr_read_b32 v28, a16
  v_mul_f32_e64 v28, v28, v26
  v_accvgpr_write_b32 a16, v28
  v_accvgpr_read_b32 v28, a17
  v_mul_f32_e64 v28, v28, v26
  v_accvgpr_write_b32 a17, v28
  v_accvgpr_read_b32 v28, a18
  v_mul_f32_e64 v28, v28, v26
  v_accvgpr_write_b32 a18, v28
  v_accvgpr_read_b32 v28, a19
  v_mul_f32_e64 v28, v28, v26
  v_accvgpr_write_b32 a19, v28
  v_accvgpr_read_b32 v28, a20
  v_mul_f32_e64 v28, v28, v26
  v_accvgpr_write_b32 a20, v28
  v_accvgpr_read_b32 v28, a21
  v_mul_f32_e64 v28, v28, v26
  v_accvgpr_write_b32 a21, v28
  v_accvgpr_read_b32 v28, a22
  v_mul_f32_e64 v28, v28, v26
  v_accvgpr_write_b32 a22, v28
  v_accvgpr_read_b32 v28, a23
  v_mul_f32_e64 v28, v28, v26
  v_accvgpr_write_b32 a23, v28
  v_accvgpr_read_b32 v28, a24
  v_mul_f32_e64 v28, v28, v26
  v_accvgpr_write_b32 a24, v28
  v_accvgpr_read_b32 v28, a25
  v_mul_f32_e64 v28, v28, v26
  v_accvgpr_write_b32 a25, v28
  v_accvgpr_read_b32 v28, a26
  v_mul_f32_e64 v28, v28, v26
  v_accvgpr_write_b32 a26, v28
  v_accvgpr_read_b32 v28, a27
  v_mul_f32_e64 v28, v28, v26
  v_accvgpr_write_b32 a27, v28
  v_accvgpr_read_b32 v28, a28
  v_mul_f32_e64 v28, v28, v26
  v_accvgpr_write_b32 a28, v28
  v_accvgpr_read_b32 v28, a29
  v_mul_f32_e64 v28, v28, v26
  v_accvgpr_write_b32 a29, v28
  v_accvgpr_read_b32 v28, a30
  v_mul_f32_e64 v28, v28, v26
  v_accvgpr_write_b32 a30, v28
  v_accvgpr_read_b32 v28, a31
  v_mul_f32_e64 v28, v28, v26
  v_accvgpr_write_b32 a31, v28
  v_accvgpr_read_b32 v28, a32
  v_mul_f32_e64 v28, v28, v27
  v_accvgpr_write_b32 a32, v28
  v_accvgpr_read_b32 v28, a33
  v_mul_f32_e64 v28, v28, v27
  v_accvgpr_write_b32 a33, v28
  v_accvgpr_read_b32 v28, a34
  v_mul_f32_e64 v28, v28, v27
  v_accvgpr_write_b32 a34, v28
  v_accvgpr_read_b32 v28, a35
  v_mul_f32_e64 v28, v28, v27
  v_accvgpr_write_b32 a35, v28
  v_accvgpr_read_b32 v28, a36
  v_mul_f32_e64 v28, v28, v27
  v_accvgpr_write_b32 a36, v28
  v_accvgpr_read_b32 v28, a37
  v_mul_f32_e64 v28, v28, v27
  v_accvgpr_write_b32 a37, v28
  v_accvgpr_read_b32 v28, a38
  v_mul_f32_e64 v28, v28, v27
  v_accvgpr_write_b32 a38, v28
  v_accvgpr_read_b32 v28, a39
  v_mul_f32_e64 v28, v28, v27
  v_accvgpr_write_b32 a39, v28
  v_accvgpr_read_b32 v28, a40
  v_mul_f32_e64 v28, v28, v27
  v_accvgpr_write_b32 a40, v28
  v_accvgpr_read_b32 v28, a41
  v_mul_f32_e64 v28, v28, v27
  v_accvgpr_write_b32 a41, v28
  v_accvgpr_read_b32 v28, a42
  v_mul_f32_e64 v28, v28, v27
  v_accvgpr_write_b32 a42, v28
  v_accvgpr_read_b32 v28, a43
  v_mul_f32_e64 v28, v28, v27
  v_accvgpr_write_b32 a43, v28
  v_accvgpr_read_b32 v28, a44
  v_mul_f32_e64 v28, v28, v27
  v_accvgpr_write_b32 a44, v28
  v_accvgpr_read_b32 v28, a45
  v_mul_f32_e64 v28, v28, v27
  v_accvgpr_write_b32 a45, v28
  v_accvgpr_read_b32 v28, a46
  v_mul_f32_e64 v28, v28, v27
  v_accvgpr_write_b32 a46, v28
  v_accvgpr_read_b32 v28, a47
  v_mul_f32_e64 v28, v28, v27
  v_accvgpr_write_b32 a47, v28
  v_accvgpr_read_b32 v28, a48
  v_mul_f32_e64 v28, v28, v27
  v_accvgpr_write_b32 a48, v28
  v_accvgpr_read_b32 v28, a49
  v_mul_f32_e64 v28, v28, v27
  v_accvgpr_write_b32 a49, v28
  v_accvgpr_read_b32 v28, a50
  v_mul_f32_e64 v28, v28, v27
  v_accvgpr_write_b32 a50, v28
  v_accvgpr_read_b32 v28, a51
  v_mul_f32_e64 v28, v28, v27
  v_accvgpr_write_b32 a51, v28
  v_accvgpr_read_b32 v28, a52
  v_mul_f32_e64 v28, v28, v27
  v_accvgpr_write_b32 a52, v28
  v_accvgpr_read_b32 v28, a53
  v_mul_f32_e64 v28, v28, v27
  v_accvgpr_write_b32 a53, v28
  v_accvgpr_read_b32 v28, a54
  v_mul_f32_e64 v28, v28, v27
  v_accvgpr_write_b32 a54, v28
  v_accvgpr_read_b32 v28, a55
  v_mul_f32_e64 v28, v28, v27
  v_accvgpr_write_b32 a55, v28
  v_accvgpr_read_b32 v28, a56
  v_mul_f32_e64 v28, v28, v27
  v_accvgpr_write_b32 a56, v28
  v_accvgpr_read_b32 v28, a57
  v_mul_f32_e64 v28, v28, v27
  v_accvgpr_write_b32 a57, v28
  v_accvgpr_read_b32 v28, a58
  v_mul_f32_e64 v28, v28, v27
  v_accvgpr_write_b32 a58, v28
  v_accvgpr_read_b32 v28, a59
  v_mul_f32_e64 v28, v28, v27
  v_accvgpr_write_b32 a59, v28
  v_accvgpr_read_b32 v28, a60
  v_mul_f32_e64 v28, v28, v27
  v_accvgpr_write_b32 a60, v28
  v_accvgpr_read_b32 v28, a61
  v_mul_f32_e64 v28, v28, v27
  v_accvgpr_write_b32 a61, v28
  v_accvgpr_read_b32 v28, a62
  v_mul_f32_e64 v28, v28, v27
  v_accvgpr_write_b32 a62, v28
  v_accvgpr_read_b32 v28, a63
  v_mul_f32_e64 v28, v28, v27
  v_accvgpr_write_b32 a63, v28
  v_mov_b32 v248, 0
  v_mov_b32 v249, 0
  v_exp_f32 v28, v32
  v_exp_f32_e64 v29, v33
  s_nop 0
  v_cvt_pk_bf16_f32 v128, v28, v29
  v_exp_f32 v28, v34
  v_exp_f32_e64 v29, v35
  s_nop 0
  v_cvt_pk_bf16_f32 v129, v28, v29
  v_exp_f32 v28, v36
  v_exp_f32_e64 v29, v37
  s_nop 0
  v_cvt_pk_bf16_f32 v130, v28, v29
  v_exp_f32 v28, v38
  v_exp_f32_e64 v29, v39
  s_nop 0
  v_cvt_pk_bf16_f32 v131, v28, v29
  v_exp_f32 v28, v40
  v_exp_f32_e64 v29, v41
  s_nop 0
  v_cvt_pk_bf16_f32 v132, v28, v29
  v_exp_f32 v28, v42
  v_exp_f32_e64 v29, v43
  s_nop 0
  v_cvt_pk_bf16_f32 v133, v28, v29
  v_exp_f32 v28, v44
  v_exp_f32_e64 v29, v45
  s_nop 0
  v_cvt_pk_bf16_f32 v134, v28, v29
  v_exp_f32 v28, v46
  v_exp_f32_e64 v29, v47
  s_nop 0
  v_cvt_pk_bf16_f32 v135, v28, v29
  s_nop 1
  v_mfma_f32_16x16x32_bf16 v[240:243], v[252:255], v[128:131], 0
  v_mfma_f32_16x16x32_bf16 v[244:247], v[252:255], v[132:135], 0
  s_nop 9
  v_mov_b32 v248, v240
  v_mov_b32 v249, v244
  v_max_f32 v24, v64, v65
  v_max_f32 v25, v72, v73
  v_max3_f32 v24, v24, v66, v67
  v_max3_f32 v25, v25, v74, v75
  v_max3_f32 v24, v24, v68, v69
  v_max3_f32 v25, v25, v76, v77
  v_max3_f32 v24, v24, v70, v71
  v_max3_f32 v25, v25, v78, v79
  v_mov_b32 v26, v24
  v_mov_b32 v27, v25
  s_nop 0
  v_permlane16_swap_b32 v24, v26
  v_permlane16_swap_b32 v25, v27
  v_max_f32 v24, v24, v26
  v_max_f32 v25, v25, v27
  v_mov_b32 v26, v24
  v_mov_b32 v27, v25
  s_nop 0
  v_permlane32_swap_b32 v24, v26
  v_permlane32_swap_b32 v25, v27
  v_max_f32 v24, v24, v26
  v_max_f32 v25, v25, v27
  v_max_f32 v24, 0, v24
  v_sub_f32 v26, 0, v24
  v_exp_f32 v26, v26
  v_add_f32 v30, v30, v24
  v_max_f32 v25, 0, v25
  v_sub_f32 v27, 0, v25
  v_exp_f32 v27, v27
  v_add_f32 v31, v31, v25
  v_sub_f32 v112, v112, v24
  v_sub_f32 v113, v113, v24
  v_sub_f32 v114, v114, v24
  v_sub_f32 v115, v115, v24
  v_sub_f32 v116, v116, v24
  v_sub_f32 v117, v117, v24
  v_sub_f32 v118, v118, v24
  v_sub_f32 v119, v119, v24
  v_sub_f32 v120, v120, v25
  v_sub_f32 v121, v121, v25
  v_sub_f32 v122, v122, v25
  v_sub_f32 v123, v123, v25
  v_sub_f32 v124, v124, v25
  v_sub_f32 v125, v125, v25
  v_sub_f32 v126, v126, v25
  v_sub_f32 v127, v127, v25
  v_sub_f32 v64, v64, v24
  v_sub_f32 v65, v65, v24
  v_sub_f32 v66, v66, v24
  v_sub_f32 v67, v67, v24
  v_sub_f32 v68, v68, v24
  v_sub_f32 v69, v69, v24
  v_sub_f32 v70, v70, v24
  v_sub_f32 v71, v71, v24
  v_sub_f32 v72, v72, v25
  v_sub_f32 v73, v73, v25
  v_sub_f32 v74, v74, v25
  v_sub_f32 v75, v75, v25
  v_sub_f32 v76, v76, v25
  v_sub_f32 v77, v77, v25
  v_sub_f32 v78, v78, v25
  v_sub_f32 v79, v79, v25
  v_sub_f32 v80, v80, v24
  v_sub_f32 v81, v81, v24
  v_sub_f32 v82, v82, v24
  v_sub_f32 v83, v83, v24
  v_sub_f32 v84, v84, v24
  v_sub_f32 v85, v85, v24
  v_sub_f32 v86, v86, v24
  v_sub_f32 v87, v87, v24
  v_sub_f32 v88, v88, v25
  v_sub_f32 v89, v89, v25
  v_sub_f32 v90, v90, v25
  v_sub_f32 v91, v91, v25
  v_sub_f32 v92, v92, v25
  v_sub_f32 v93, v93, v25
  v_sub_f32 v94, v94, v25
  v_sub_f32 v95, v95, v25
  v_mul_f32 v16, v16, v26
  v_mul_f32 v17, v17, v27
  v_accvgpr_read_b32 v28, a64
  v_mul_f32_e64 v28, v28, v26
  v_accvgpr_write_b32 a64, v28
  v_accvgpr_read_b32 v28, a65
  v_mul_f32_e64 v28, v28, v26
  v_accvgpr_write_b32 a65, v28
  v_accvgpr_read_b32 v28, a66
  v_mul_f32_e64 v28, v28, v26
  v_accvgpr_write_b32 a66, v28
  v_accvgpr_read_b32 v28, a67
  v_mul_f32_e64 v28, v28, v26
  v_accvgpr_write_b32 a67, v28
  v_accvgpr_read_b32 v28, a68
  v_mul_f32_e64 v28, v28, v26
  v_accvgpr_write_b32 a68, v28
  v_accvgpr_read_b32 v28, a69
  v_mul_f32_e64 v28, v28, v26
  v_accvgpr_write_b32 a69, v28
  v_accvgpr_read_b32 v28, a70
  v_mul_f32_e64 v28, v28, v26
  v_accvgpr_write_b32 a70, v28
  v_accvgpr_read_b32 v28, a71
  v_mul_f32_e64 v28, v28, v26
  v_accvgpr_write_b32 a71, v28
  v_accvgpr_read_b32 v28, a72
  v_mul_f32_e64 v28, v28, v26
  v_accvgpr_write_b32 a72, v28
  v_accvgpr_read_b32 v28, a73
  v_mul_f32_e64 v28, v28, v26
  v_accvgpr_write_b32 a73, v28
  v_accvgpr_read_b32 v28, a74
  v_mul_f32_e64 v28, v28, v26
  v_accvgpr_write_b32 a74, v28
  v_accvgpr_read_b32 v28, a75
  v_mul_f32_e64 v28, v28, v26
  v_accvgpr_write_b32 a75, v28
  v_accvgpr_read_b32 v28, a76
  v_mul_f32_e64 v28, v28, v26
  v_accvgpr_write_b32 a76, v28
  v_accvgpr_read_b32 v28, a77
  v_mul_f32_e64 v28, v28, v26
  v_accvgpr_write_b32 a77, v28
  v_accvgpr_read_b32 v28, a78
  v_mul_f32_e64 v28, v28, v26
  v_accvgpr_write_b32 a78, v28
  v_accvgpr_read_b32 v28, a79
  v_mul_f32_e64 v28, v28, v26
  v_accvgpr_write_b32 a79, v28
  v_accvgpr_read_b32 v28, a80
  v_mul_f32_e64 v28, v28, v26
  v_accvgpr_write_b32 a80, v28
  v_accvgpr_read_b32 v28, a81
  v_mul_f32_e64 v28, v28, v26
  v_accvgpr_write_b32 a81, v28
  v_accvgpr_read_b32 v28, a82
  v_mul_f32_e64 v28, v28, v26
  v_accvgpr_write_b32 a82, v28
  v_accvgpr_read_b32 v28, a83
  v_mul_f32_e64 v28, v28, v26
  v_accvgpr_write_b32 a83, v28
  v_accvgpr_read_b32 v28, a84
  v_mul_f32_e64 v28, v28, v26
  v_accvgpr_write_b32 a84, v28
  v_accvgpr_read_b32 v28, a85
  v_mul_f32_e64 v28, v28, v26
  v_accvgpr_write_b32 a85, v28
  v_accvgpr_read_b32 v28, a86
  v_mul_f32_e64 v28, v28, v26
  v_accvgpr_write_b32 a86, v28
  v_accvgpr_read_b32 v28, a87
  v_mul_f32_e64 v28, v28, v26
  v_accvgpr_write_b32 a87, v28
  v_accvgpr_read_b32 v28, a88
  v_mul_f32_e64 v28, v28, v26
  v_accvgpr_write_b32 a88, v28
  v_accvgpr_read_b32 v28, a89
  v_mul_f32_e64 v28, v28, v26
  v_accvgpr_write_b32 a89, v28
  v_accvgpr_read_b32 v28, a90
  v_mul_f32_e64 v28, v28, v26
  v_accvgpr_write_b32 a90, v28
  v_accvgpr_read_b32 v28, a91
  v_mul_f32_e64 v28, v28, v26
  v_accvgpr_write_b32 a91, v28
  v_accvgpr_read_b32 v28, a92
  v_mul_f32_e64 v28, v28, v26
  v_accvgpr_write_b32 a92, v28
  v_accvgpr_read_b32 v28, a93
  v_mul_f32_e64 v28, v28, v26
  v_accvgpr_write_b32 a93, v28
  v_accvgpr_read_b32 v28, a94
  v_mul_f32_e64 v28, v28, v26
  v_accvgpr_write_b32 a94, v28
  v_accvgpr_read_b32 v28, a95
  v_mul_f32_e64 v28, v28, v26
  v_accvgpr_write_b32 a95, v28
  v_accvgpr_read_b32 v28, a96
  v_mul_f32_e64 v28, v28, v27
  v_accvgpr_write_b32 a96, v28
  v_accvgpr_read_b32 v28, a97
  v_mul_f32_e64 v28, v28, v27
  v_accvgpr_write_b32 a97, v28
  v_accvgpr_read_b32 v28, a98
  v_mul_f32_e64 v28, v28, v27
  v_accvgpr_write_b32 a98, v28
  v_accvgpr_read_b32 v28, a99
  v_mul_f32_e64 v28, v28, v27
  v_accvgpr_write_b32 a99, v28
  v_accvgpr_read_b32 v28, a100
  v_mul_f32_e64 v28, v28, v27
  v_accvgpr_write_b32 a100, v28
  v_accvgpr_read_b32 v28, a101
  v_mul_f32_e64 v28, v28, v27
  v_accvgpr_write_b32 a101, v28
  v_accvgpr_read_b32 v28, a102
  v_mul_f32_e64 v28, v28, v27
  v_accvgpr_write_b32 a102, v28
  v_accvgpr_read_b32 v28, a103
  v_mul_f32_e64 v28, v28, v27
  v_accvgpr_write_b32 a103, v28
  v_accvgpr_read_b32 v28, a104
  v_mul_f32_e64 v28, v28, v27
  v_accvgpr_write_b32 a104, v28
  v_accvgpr_read_b32 v28, a105
  v_mul_f32_e64 v28, v28, v27
  v_accvgpr_write_b32 a105, v28
  v_accvgpr_read_b32 v28, a106
  v_mul_f32_e64 v28, v28, v27
  v_accvgpr_write_b32 a106, v28
  v_accvgpr_read_b32 v28, a107
  v_mul_f32_e64 v28, v28, v27
  v_accvgpr_write_b32 a107, v28
  v_accvgpr_read_b32 v28, a108
  v_mul_f32_e64 v28, v28, v27
  v_accvgpr_write_b32 a108, v28
  v_accvgpr_read_b32 v28, a109
  v_mul_f32_e64 v28, v28, v27
  v_accvgpr_write_b32 a109, v28
  v_accvgpr_read_b32 v28, a110
  v_mul_f32_e64 v28, v28, v27
  v_accvgpr_write_b32 a110, v28
  v_accvgpr_read_b32 v28, a111
  v_mul_f32_e64 v28, v28, v27
  v_accvgpr_write_b32 a111, v28
  v_accvgpr_read_b32 v28, a112
  v_mul_f32_e64 v28, v28, v27
  v_accvgpr_write_b32 a112, v28
  v_accvgpr_read_b32 v28, a113
  v_mul_f32_e64 v28, v28, v27
  v_accvgpr_write_b32 a113, v28
  v_accvgpr_read_b32 v28, a114
  v_mul_f32_e64 v28, v28, v27
  v_accvgpr_write_b32 a114, v28
  v_accvgpr_read_b32 v28, a115
  v_mul_f32_e64 v28, v28, v27
  v_accvgpr_write_b32 a115, v28
  v_accvgpr_read_b32 v28, a116
  v_mul_f32_e64 v28, v28, v27
  v_accvgpr_write_b32 a116, v28
  v_accvgpr_read_b32 v28, a117
  v_mul_f32_e64 v28, v28, v27
  v_accvgpr_write_b32 a117, v28
  v_accvgpr_read_b32 v28, a118
  v_mul_f32_e64 v28, v28, v27
  v_accvgpr_write_b32 a118, v28
  v_accvgpr_read_b32 v28, a119
  v_mul_f32_e64 v28, v28, v27
  v_accvgpr_write_b32 a119, v28
  v_accvgpr_read_b32 v28, a120
  v_mul_f32_e64 v28, v28, v27
  v_accvgpr_write_b32 a120, v28
  v_accvgpr_read_b32 v28, a121
  v_mul_f32_e64 v28, v28, v27
  v_accvgpr_write_b32 a121, v28
  v_accvgpr_read_b32 v28, a122
  v_mul_f32_e64 v28, v28, v27
  v_accvgpr_write_b32 a122, v28
  v_accvgpr_read_b32 v28, a123
  v_mul_f32_e64 v28, v28, v27
  v_accvgpr_write_b32 a123, v28
  v_accvgpr_read_b32 v28, a124
  v_mul_f32_e64 v28, v28, v27
  v_accvgpr_write_b32 a124, v28
  v_accvgpr_read_b32 v28, a125
  v_mul_f32_e64 v28, v28, v27
  v_accvgpr_write_b32 a125, v28
  v_accvgpr_read_b32 v28, a126
  v_mul_f32_e64 v28, v28, v27
  v_accvgpr_write_b32 a126, v28
  v_accvgpr_read_b32 v28, a127
  v_mul_f32_e64 v28, v28, v27
  v_accvgpr_write_b32 a127, v28
  v_mov_b32 v240, 0
  v_mov_b32 v244, 0
  v_exp_f32 v28, v64
  v_exp_f32_e64 v29, v65
  s_nop 0
  v_cvt_pk_bf16_f32 v144, v28, v29
  v_exp_f32 v28, v66
  v_exp_f32_e64 v29, v67
  s_nop 0
  v_cvt_pk_bf16_f32 v145, v28, v29
  v_exp_f32 v28, v68
  v_exp_f32_e64 v29, v69
  s_nop 0
  v_cvt_pk_bf16_f32 v146, v28, v29
  v_exp_f32 v28, v70
  v_exp_f32_e64 v29, v71
  s_nop 0
  v_cvt_pk_bf16_f32 v147, v28, v29
  v_exp_f32 v28, v72
  v_exp_f32_e64 v29, v73
  s_nop 0
  v_cvt_pk_bf16_f32 v148, v28, v29
  v_exp_f32 v28, v74
  v_exp_f32_e64 v29, v75
  s_nop 0
  v_cvt_pk_bf16_f32 v149, v28, v29
  v_exp_f32 v28, v76
  v_exp_f32_e64 v29, v77
  s_nop 0
  v_cvt_pk_bf16_f32 v150, v28, v29
  v_exp_f32 v28, v78
  v_exp_f32_e64 v29, v79
  s_nop 0
  v_cvt_pk_bf16_f32 v151, v28, v29
  s_nop 1
  v_mfma_f32_16x16x32_bf16 v[240:243], v[252:255], v[144:147], 0
  v_mfma_f32_16x16x32_bf16 v[244:247], v[252:255], v[148:151], 0
  s_nop 9
  s_nop 1
  s_setpc_b64 s[30:31]
Lslow20:
  s_nop 15
  v_max_f32 v24, v48, v49
  v_max_f32_e64 v25, v56, v57
  v_max3_f32 v24, v24, v50, v51
  v_max3_f32 v25, v25, v58, v59
  v_max3_f32 v24, v24, v52, v53
  v_max3_f32 v25, v25, v60, v61
  v_max3_f32 v24, v24, v54, v55
  v_max3_f32 v25, v25, v62, v63
  v_mov_b32 v26, v24
  v_mov_b32 v27, v25
  s_nop 0
  v_permlane16_swap_b32 v24, v26
  v_permlane16_swap_b32 v25, v27
  v_max_f32 v24, v24, v26
  v_max_f32 v25, v25, v27
  v_mov_b32 v26, v24
  v_mov_b32 v27, v25
  s_nop 0
  v_permlane32_swap_b32 v24, v26
  v_permlane32_swap_b32 v25, v27
  v_max_f32 v24, v24, v26
  v_max_f32 v25, v25, v27
  v_max_f32 v24, 0, v24
  v_sub_f32 v26, 0, v24
  v_exp_f32 v26, v26
  v_add_f32 v22, v22, v24
  v_max_f32 v25, 0, v25
  v_sub_f32 v27, 0, v25
  v_exp_f32 v27, v27
  v_add_f32 v23, v23, v25
  v_sub_f32 v96, v96, v24
  v_sub_f32 v97, v97, v24
  v_sub_f32 v98, v98, v24
  v_sub_f32 v99, v99, v24
  v_sub_f32 v100, v100, v24
  v_sub_f32 v101, v101, v24
  v_sub_f32 v102, v102, v24
  v_sub_f32 v103, v103, v24
  v_sub_f32 v104, v104, v25
  v_sub_f32 v105, v105, v25
  v_sub_f32 v106, v106, v25
  v_sub_f32 v107, v107, v25
  v_sub_f32 v108, v108, v25
  v_sub_f32 v109, v109, v25
  v_sub_f32 v110, v110, v25
  v_sub_f32 v111, v111, v25
  v_sub_f32 v48, v48, v24
  v_sub_f32 v49, v49, v24
  v_sub_f32 v50, v50, v24
  v_sub_f32 v51, v51, v24
  v_sub_f32 v52, v52, v24
  v_sub_f32 v53, v53, v24
  v_sub_f32 v54, v54, v24
  v_sub_f32 v55, v55, v24
  v_sub_f32 v56, v56, v25
  v_sub_f32 v57, v57, v25
  v_sub_f32 v58, v58, v25
  v_sub_f32 v59, v59, v25
  v_sub_f32 v60, v60, v25
  v_sub_f32 v61, v61, v25
  v_sub_f32 v62, v62, v25
  v_sub_f32 v63, v63, v25
  v_sub_f32 v32, v32, v24
  v_sub_f32 v33, v33, v24
  v_sub_f32 v34, v34, v24
  v_sub_f32 v35, v35, v24
  v_sub_f32 v36, v36, v24
  v_sub_f32 v37, v37, v24
  v_sub_f32 v38, v38, v24
  v_sub_f32 v39, v39, v24
  v_sub_f32 v40, v40, v25
  v_sub_f32 v41, v41, v25
  v_sub_f32 v42, v42, v25
  v_sub_f32 v43, v43, v25
  v_sub_f32 v44, v44, v25
  v_sub_f32 v45, v45, v25
  v_sub_f32 v46, v46, v25
  v_sub_f32 v47, v47, v25
  v_mul_f32 v20, v20, v26
  v_mul_f32 v21, v21, v27
  v_accvgpr_read_b32 v28, a128
  v_mul_f32_e64 v28, v28, v26
  v_accvgpr_write_b32 a128, v28
  v_accvgpr_read_b32 v28, a129
  v_mul_f32_e64 v28, v28, v26
  v_accvgpr_write_b32 a129, v28
  v_accvgpr_read_b32 v28, a130
  v_mul_f32_e64 v28, v28, v26
  v_accvgpr_write_b32 a130, v28
  v_accvgpr_read_b32 v28, a131
  v_mul_f32_e64 v28, v28, v26
  v_accvgpr_write_b32 a131, v28
  v_accvgpr_read_b32 v28, a132
  v_mul_f32_e64 v28, v28, v26
  v_accvgpr_write_b32 a132, v28
  v_accvgpr_read_b32 v28, a133
  v_mul_f32_e64 v28, v28, v26
  v_accvgpr_write_b32 a133, v28
  v_accvgpr_read_b32 v28, a134
  v_mul_f32_e64 v28, v28, v26
  v_accvgpr_write_b32 a134, v28
  v_accvgpr_read_b32 v28, a135
  v_mul_f32_e64 v28, v28, v26
  v_accvgpr_write_b32 a135, v28
  v_accvgpr_read_b32 v28, a136
  v_mul_f32_e64 v28, v28, v26
  v_accvgpr_write_b32 a136, v28
  v_accvgpr_read_b32 v28, a137
  v_mul_f32_e64 v28, v28, v26
  v_accvgpr_write_b32 a137, v28
  v_accvgpr_read_b32 v28, a138
  v_mul_f32_e64 v28, v28, v26
  v_accvgpr_write_b32 a138, v28
  v_accvgpr_read_b32 v28, a139
  v_mul_f32_e64 v28, v28, v26
  v_accvgpr_write_b32 a139, v28
  v_accvgpr_read_b32 v28, a140
  v_mul_f32_e64 v28, v28, v26
  v_accvgpr_write_b32 a140, v28
  v_accvgpr_read_b32 v28, a141
  v_mul_f32_e64 v28, v28, v26
  v_accvgpr_write_b32 a141, v28
  v_accvgpr_read_b32 v28, a142
  v_mul_f32_e64 v28, v28, v26
  v_accvgpr_write_b32 a142, v28
  v_accvgpr_read_b32 v28, a143
  v_mul_f32_e64 v28, v28, v26
  v_accvgpr_write_b32 a143, v28
  v_accvgpr_read_b32 v28, a144
  v_mul_f32_e64 v28, v28, v26
  v_accvgpr_write_b32 a144, v28
  v_accvgpr_read_b32 v28, a145
  v_mul_f32_e64 v28, v28, v26
  v_accvgpr_write_b32 a145, v28
  v_accvgpr_read_b32 v28, a146
  v_mul_f32_e64 v28, v28, v26
  v_accvgpr_write_b32 a146, v28
  v_accvgpr_read_b32 v28, a147
  v_mul_f32_e64 v28, v28, v26
  v_accvgpr_write_b32 a147, v28
  v_accvgpr_read_b32 v28, a148
  v_mul_f32_e64 v28, v28, v26
  v_accvgpr_write_b32 a148, v28
  v_accvgpr_read_b32 v28, a149
  v_mul_f32_e64 v28, v28, v26
  v_accvgpr_write_b32 a149, v28
  v_accvgpr_read_b32 v28, a150
  v_mul_f32_e64 v28, v28, v26
  v_accvgpr_write_b32 a150, v28
  v_accvgpr_read_b32 v28, a151
  v_mul_f32_e64 v28, v28, v26
  v_accvgpr_write_b32 a151, v28
  v_accvgpr_read_b32 v28, a152
  v_mul_f32_e64 v28, v28, v26
  v_accvgpr_write_b32 a152, v28
  v_accvgpr_read_b32 v28, a153
  v_mul_f32_e64 v28, v28, v26
  v_accvgpr_write_b32 a153, v28
  v_accvgpr_read_b32 v28, a154
  v_mul_f32_e64 v28, v28, v26
  v_accvgpr_write_b32 a154, v28
  v_accvgpr_read_b32 v28, a155
  v_mul_f32_e64 v28, v28, v26
  v_accvgpr_write_b32 a155, v28
  v_accvgpr_read_b32 v28, a156
  v_mul_f32_e64 v28, v28, v26
  v_accvgpr_write_b32 a156, v28
  v_accvgpr_read_b32 v28, a157
  v_mul_f32_e64 v28, v28, v26
  v_accvgpr_write_b32 a157, v28
  v_accvgpr_read_b32 v28, a158
  v_mul_f32_e64 v28, v28, v26
  v_accvgpr_write_b32 a158, v28
  v_accvgpr_read_b32 v28, a159
  v_mul_f32_e64 v28, v28, v26
  v_accvgpr_write_b32 a159, v28
  v_accvgpr_read_b32 v28, a160
  v_mul_f32_e64 v28, v28, v27
  v_accvgpr_write_b32 a160, v28
  v_accvgpr_read_b32 v28, a161
  v_mul_f32_e64 v28, v28, v27
  v_accvgpr_write_b32 a161, v28
  v_accvgpr_read_b32 v28, a162
  v_mul_f32_e64 v28, v28, v27
  v_accvgpr_write_b32 a162, v28
  v_accvgpr_read_b32 v28, a163
  v_mul_f32_e64 v28, v28, v27
  v_accvgpr_write_b32 a163, v28
  v_accvgpr_read_b32 v28, a164
  v_mul_f32_e64 v28, v28, v27
  v_accvgpr_write_b32 a164, v28
  v_accvgpr_read_b32 v28, a165
  v_mul_f32_e64 v28, v28, v27
  v_accvgpr_write_b32 a165, v28
  v_accvgpr_read_b32 v28, a166
  v_mul_f32_e64 v28, v28, v27
  v_accvgpr_write_b32 a166, v28
  v_accvgpr_read_b32 v28, a167
  v_mul_f32_e64 v28, v28, v27
  v_accvgpr_write_b32 a167, v28
  v_accvgpr_read_b32 v28, a168
  v_mul_f32_e64 v28, v28, v27
  v_accvgpr_write_b32 a168, v28
  v_accvgpr_read_b32 v28, a169
  v_mul_f32_e64 v28, v28, v27
  v_accvgpr_write_b32 a169, v28
  v_accvgpr_read_b32 v28, a170
  v_mul_f32_e64 v28, v28, v27
  v_accvgpr_write_b32 a170, v28
  v_accvgpr_read_b32 v28, a171
  v_mul_f32_e64 v28, v28, v27
  v_accvgpr_write_b32 a171, v28
  v_accvgpr_read_b32 v28, a172
  v_mul_f32_e64 v28, v28, v27
  v_accvgpr_write_b32 a172, v28
  v_accvgpr_read_b32 v28, a173
  v_mul_f32_e64 v28, v28, v27
  v_accvgpr_write_b32 a173, v28
  v_accvgpr_read_b32 v28, a174
  v_mul_f32_e64 v28, v28, v27
  v_accvgpr_write_b32 a174, v28
  v_accvgpr_read_b32 v28, a175
  v_mul_f32_e64 v28, v28, v27
  v_accvgpr_write_b32 a175, v28
  v_accvgpr_read_b32 v28, a176
  v_mul_f32_e64 v28, v28, v27
  v_accvgpr_write_b32 a176, v28
  v_accvgpr_read_b32 v28, a177
  v_mul_f32_e64 v28, v28, v27
  v_accvgpr_write_b32 a177, v28
  v_accvgpr_read_b32 v28, a178
  v_mul_f32_e64 v28, v28, v27
  v_accvgpr_write_b32 a178, v28
  v_accvgpr_read_b32 v28, a179
  v_mul_f32_e64 v28, v28, v27
  v_accvgpr_write_b32 a179, v28
  v_accvgpr_read_b32 v28, a180
  v_mul_f32_e64 v28, v28, v27
  v_accvgpr_write_b32 a180, v28
  v_accvgpr_read_b32 v28, a181
  v_mul_f32_e64 v28, v28, v27
  v_accvgpr_write_b32 a181, v28
  v_accvgpr_read_b32 v28, a182
  v_mul_f32_e64 v28, v28, v27
  v_accvgpr_write_b32 a182, v28
  v_accvgpr_read_b32 v28, a183
  v_mul_f32_e64 v28, v28, v27
  v_accvgpr_write_b32 a183, v28
  v_accvgpr_read_b32 v28, a184
  v_mul_f32_e64 v28, v28, v27
  v_accvgpr_write_b32 a184, v28
  v_accvgpr_read_b32 v28, a185
  v_mul_f32_e64 v28, v28, v27
  v_accvgpr_write_b32 a185, v28
  v_accvgpr_read_b32 v28, a186
  v_mul_f32_e64 v28, v28, v27
  v_accvgpr_write_b32 a186, v28
  v_accvgpr_read_b32 v28, a187
  v_mul_f32_e64 v28, v28, v27
  v_accvgpr_write_b32 a187, v28
  v_accvgpr_read_b32 v28, a188
  v_mul_f32_e64 v28, v28, v27
  v_accvgpr_write_b32 a188, v28
  v_accvgpr_read_b32 v28, a189
  v_mul_f32_e64 v28, v28, v27
  v_accvgpr_write_b32 a189, v28
  v_accvgpr_read_b32 v28, a190
  v_mul_f32_e64 v28, v28, v27
  v_accvgpr_write_b32 a190, v28
  v_accvgpr_read_b32 v28, a191
  v_mul_f32_e64 v28, v28, v27
  v_accvgpr_write_b32 a191, v28
  v_mov_b32 v248, 0
  v_mov_b32 v249, 0
  v_exp_f32 v28, v48
  v_exp_f32_e64 v29, v49
  s_nop 0
  v_cvt_pk_bf16_f32 v136, v28, v29
  v_exp_f32 v28, v50
  v_exp_f32_e64 v29, v51
  s_nop 0
  v_cvt_pk_bf16_f32 v137, v28, v29
  v_exp_f32 v28, v52
  v_exp_f32_e64 v29, v53
  s_nop 0
  v_cvt_pk_bf16_f32 v138, v28, v29
  v_exp_f32 v28, v54
  v_exp_f32_e64 v29, v55
  s_nop 0
  v_cvt_pk_bf16_f32 v139, v28, v29
  v_exp_f32 v28, v56
  v_exp_f32_e64 v29, v57
  s_nop 0
  v_cvt_pk_bf16_f32 v140, v28, v29
  v_exp_f32 v28, v58
  v_exp_f32_e64 v29, v59
  s_nop 0
  v_cvt_pk_bf16_f32 v141, v28, v29
  v_exp_f32 v28, v60
  v_exp_f32_e64 v29, v61
  s_nop 0
  v_cvt_pk_bf16_f32 v142, v28, v29
  v_exp_f32 v28, v62
  v_exp_f32_e64 v29, v63
  s_nop 0
  v_cvt_pk_bf16_f32 v143, v28, v29
  s_nop 1
  v_mfma_f32_16x16x32_bf16 v[240:243], v[252:255], v[136:139], 0
  v_mfma_f32_16x16x32_bf16 v[244:247], v[252:255], v[140:143], 0
  s_nop 9
  v_mov_b32 v248, v240
  v_mov_b32 v249, v244
  v_max_f32 v24, v80, v81
  v_max_f32 v25, v88, v89
  v_max3_f32 v24, v24, v82, v83
  v_max3_f32 v25, v25, v90, v91
  v_max3_f32 v24, v24, v84, v85
  v_max3_f32 v25, v25, v92, v93
  v_max3_f32 v24, v24, v86, v87
  v_max3_f32 v25, v25, v94, v95
  v_mov_b32 v26, v24
  v_mov_b32 v27, v25
  s_nop 0
  v_permlane16_swap_b32 v24, v26
  v_permlane16_swap_b32 v25, v27
  v_max_f32 v24, v24, v26
  v_max_f32 v25, v25, v27
  v_mov_b32 v26, v24
  v_mov_b32 v27, v25
  s_nop 0
  v_permlane32_swap_b32 v24, v26
  v_permlane32_swap_b32 v25, v27
  v_max_f32 v24, v24, v26
  v_max_f32 v25, v25, v27
  v_max_f32 v24, 0, v24
  v_sub_f32 v26, 0, v24
  v_exp_f32 v26, v26
  v_add_f32 v30, v30, v24
  v_max_f32 v25, 0, v25
  v_sub_f32 v27, 0, v25
  v_exp_f32 v27, v27
  v_add_f32 v31, v31, v25
  v_sub_f32 v112, v112, v24
  v_sub_f32 v113, v113, v24
  v_sub_f32 v114, v114, v24
  v_sub_f32 v115, v115, v24
  v_sub_f32 v116, v116, v24
  v_sub_f32 v117, v117, v24
  v_sub_f32 v118, v118, v24
  v_sub_f32 v119, v119, v24
  v_sub_f32 v120, v120, v25
  v_sub_f32 v121, v121, v25
  v_sub_f32 v122, v122, v25
  v_sub_f32 v123, v123, v25
  v_sub_f32 v124, v124, v25
  v_sub_f32 v125, v125, v25
  v_sub_f32 v126, v126, v25
  v_sub_f32 v127, v127, v25
  v_sub_f32 v80, v80, v24
  v_sub_f32 v81, v81, v24
  v_sub_f32 v82, v82, v24
  v_sub_f32 v83, v83, v24
  v_sub_f32 v84, v84, v24
  v_sub_f32 v85, v85, v24
  v_sub_f32 v86, v86, v24
  v_sub_f32 v87, v87, v24
  v_sub_f32 v88, v88, v25
  v_sub_f32 v89, v89, v25
  v_sub_f32 v90, v90, v25
  v_sub_f32 v91, v91, v25
  v_sub_f32 v92, v92, v25
  v_sub_f32 v93, v93, v25
  v_sub_f32 v94, v94, v25
  v_sub_f32 v95, v95, v25
  v_sub_f32 v64, v64, v24
  v_sub_f32 v65, v65, v24
  v_sub_f32 v66, v66, v24
  v_sub_f32 v67, v67, v24
  v_sub_f32 v68, v68, v24
  v_sub_f32 v69, v69, v24
  v_sub_f32 v70, v70, v24
  v_sub_f32 v71, v71, v24
  v_sub_f32 v72, v72, v25
  v_sub_f32 v73, v73, v25
  v_sub_f32 v74, v74, v25
  v_sub_f32 v75, v75, v25
  v_sub_f32 v76, v76, v25
  v_sub_f32 v77, v77, v25
  v_sub_f32 v78, v78, v25
  v_sub_f32 v79, v79, v25
  v_mul_f32 v16, v16, v26
  v_mul_f32 v17, v17, v27
  v_accvgpr_read_b32 v28, a64
  v_mul_f32_e64 v28, v28, v26
  v_accvgpr_write_b32 a64, v28
  v_accvgpr_read_b32 v28, a65
  v_mul_f32_e64 v28, v28, v26
  v_accvgpr_write_b32 a65, v28
  v_accvgpr_read_b32 v28, a66
  v_mul_f32_e64 v28, v28, v26
  v_accvgpr_write_b32 a66, v28
  v_accvgpr_read_b32 v28, a67
  v_mul_f32_e64 v28, v28, v26
  v_accvgpr_write_b32 a67, v28
  v_accvgpr_read_b32 v28, a68
  v_mul_f32_e64 v28, v28, v26
  v_accvgpr_write_b32 a68, v28
  v_accvgpr_read_b32 v28, a69
  v_mul_f32_e64 v28, v28, v26
  v_accvgpr_write_b32 a69, v28
  v_accvgpr_read_b32 v28, a70
  v_mul_f32_e64 v28, v28, v26
  v_accvgpr_write_b32 a70, v28
  v_accvgpr_read_b32 v28, a71
  v_mul_f32_e64 v28, v28, v26
  v_accvgpr_write_b32 a71, v28
  v_accvgpr_read_b32 v28, a72
  v_mul_f32_e64 v28, v28, v26
  v_accvgpr_write_b32 a72, v28
  v_accvgpr_read_b32 v28, a73
  v_mul_f32_e64 v28, v28, v26
  v_accvgpr_write_b32 a73, v28
  v_accvgpr_read_b32 v28, a74
  v_mul_f32_e64 v28, v28, v26
  v_accvgpr_write_b32 a74, v28
  v_accvgpr_read_b32 v28, a75
  v_mul_f32_e64 v28, v28, v26
  v_accvgpr_write_b32 a75, v28
  v_accvgpr_read_b32 v28, a76
  v_mul_f32_e64 v28, v28, v26
  v_accvgpr_write_b32 a76, v28
  v_accvgpr_read_b32 v28, a77
  v_mul_f32_e64 v28, v28, v26
  v_accvgpr_write_b32 a77, v28
  v_accvgpr_read_b32 v28, a78
  v_mul_f32_e64 v28, v28, v26
  v_accvgpr_write_b32 a78, v28
  v_accvgpr_read_b32 v28, a79
  v_mul_f32_e64 v28, v28, v26
  v_accvgpr_write_b32 a79, v28
  v_accvgpr_read_b32 v28, a80
  v_mul_f32_e64 v28, v28, v26
  v_accvgpr_write_b32 a80, v28
  v_accvgpr_read_b32 v28, a81
  v_mul_f32_e64 v28, v28, v26
  v_accvgpr_write_b32 a81, v28
  v_accvgpr_read_b32 v28, a82
  v_mul_f32_e64 v28, v28, v26
  v_accvgpr_write_b32 a82, v28
  v_accvgpr_read_b32 v28, a83
  v_mul_f32_e64 v28, v28, v26
  v_accvgpr_write_b32 a83, v28
  v_accvgpr_read_b32 v28, a84
  v_mul_f32_e64 v28, v28, v26
  v_accvgpr_write_b32 a84, v28
  v_accvgpr_read_b32 v28, a85
  v_mul_f32_e64 v28, v28, v26
  v_accvgpr_write_b32 a85, v28
  v_accvgpr_read_b32 v28, a86
  v_mul_f32_e64 v28, v28, v26
  v_accvgpr_write_b32 a86, v28
  v_accvgpr_read_b32 v28, a87
  v_mul_f32_e64 v28, v28, v26
  v_accvgpr_write_b32 a87, v28
  v_accvgpr_read_b32 v28, a88
  v_mul_f32_e64 v28, v28, v26
  v_accvgpr_write_b32 a88, v28
  v_accvgpr_read_b32 v28, a89
  v_mul_f32_e64 v28, v28, v26
  v_accvgpr_write_b32 a89, v28
  v_accvgpr_read_b32 v28, a90
  v_mul_f32_e64 v28, v28, v26
  v_accvgpr_write_b32 a90, v28
  v_accvgpr_read_b32 v28, a91
  v_mul_f32_e64 v28, v28, v26
  v_accvgpr_write_b32 a91, v28
  v_accvgpr_read_b32 v28, a92
  v_mul_f32_e64 v28, v28, v26
  v_accvgpr_write_b32 a92, v28
  v_accvgpr_read_b32 v28, a93
  v_mul_f32_e64 v28, v28, v26
  v_accvgpr_write_b32 a93, v28
  v_accvgpr_read_b32 v28, a94
  v_mul_f32_e64 v28, v28, v26
  v_accvgpr_write_b32 a94, v28
  v_accvgpr_read_b32 v28, a95
  v_mul_f32_e64 v28, v28, v26
  v_accvgpr_write_b32 a95, v28
  v_accvgpr_read_b32 v28, a96
  v_mul_f32_e64 v28, v28, v27
  v_accvgpr_write_b32 a96, v28
  v_accvgpr_read_b32 v28, a97
  v_mul_f32_e64 v28, v28, v27
  v_accvgpr_write_b32 a97, v28
  v_accvgpr_read_b32 v28, a98
  v_mul_f32_e64 v28, v28, v27
  v_accvgpr_write_b32 a98, v28
  v_accvgpr_read_b32 v28, a99
  v_mul_f32_e64 v28, v28, v27
  v_accvgpr_write_b32 a99, v28
  v_accvgpr_read_b32 v28, a100
  v_mul_f32_e64 v28, v28, v27
  v_accvgpr_write_b32 a100, v28
  v_accvgpr_read_b32 v28, a101
  v_mul_f32_e64 v28, v28, v27
  v_accvgpr_write_b32 a101, v28
  v_accvgpr_read_b32 v28, a102
  v_mul_f32_e64 v28, v28, v27
  v_accvgpr_write_b32 a102, v28
  v_accvgpr_read_b32 v28, a103
  v_mul_f32_e64 v28, v28, v27
  v_accvgpr_write_b32 a103, v28
  v_accvgpr_read_b32 v28, a104
  v_mul_f32_e64 v28, v28, v27
  v_accvgpr_write_b32 a104, v28
  v_accvgpr_read_b32 v28, a105
  v_mul_f32_e64 v28, v28, v27
  v_accvgpr_write_b32 a105, v28
  v_accvgpr_read_b32 v28, a106
  v_mul_f32_e64 v28, v28, v27
  v_accvgpr_write_b32 a106, v28
  v_accvgpr_read_b32 v28, a107
  v_mul_f32_e64 v28, v28, v27
  v_accvgpr_write_b32 a107, v28
  v_accvgpr_read_b32 v28, a108
  v_mul_f32_e64 v28, v28, v27
  v_accvgpr_write_b32 a108, v28
  v_accvgpr_read_b32 v28, a109
  v_mul_f32_e64 v28, v28, v27
  v_accvgpr_write_b32 a109, v28
  v_accvgpr_read_b32 v28, a110
  v_mul_f32_e64 v28, v28, v27
  v_accvgpr_write_b32 a110, v28
  v_accvgpr_read_b32 v28, a111
  v_mul_f32_e64 v28, v28, v27
  v_accvgpr_write_b32 a111, v28
  v_accvgpr_read_b32 v28, a112
  v_mul_f32_e64 v28, v28, v27
  v_accvgpr_write_b32 a112, v28
  v_accvgpr_read_b32 v28, a113
  v_mul_f32_e64 v28, v28, v27
  v_accvgpr_write_b32 a113, v28
  v_accvgpr_read_b32 v28, a114
  v_mul_f32_e64 v28, v28, v27
  v_accvgpr_write_b32 a114, v28
  v_accvgpr_read_b32 v28, a115
  v_mul_f32_e64 v28, v28, v27
  v_accvgpr_write_b32 a115, v28
  v_accvgpr_read_b32 v28, a116
  v_mul_f32_e64 v28, v28, v27
  v_accvgpr_write_b32 a116, v28
  v_accvgpr_read_b32 v28, a117
  v_mul_f32_e64 v28, v28, v27
  v_accvgpr_write_b32 a117, v28
  v_accvgpr_read_b32 v28, a118
  v_mul_f32_e64 v28, v28, v27
  v_accvgpr_write_b32 a118, v28
  v_accvgpr_read_b32 v28, a119
  v_mul_f32_e64 v28, v28, v27
  v_accvgpr_write_b32 a119, v28
  v_accvgpr_read_b32 v28, a120
  v_mul_f32_e64 v28, v28, v27
  v_accvgpr_write_b32 a120, v28
  v_accvgpr_read_b32 v28, a121
  v_mul_f32_e64 v28, v28, v27
  v_accvgpr_write_b32 a121, v28
  v_accvgpr_read_b32 v28, a122
  v_mul_f32_e64 v28, v28, v27
  v_accvgpr_write_b32 a122, v28
  v_accvgpr_read_b32 v28, a123
  v_mul_f32_e64 v28, v28, v27
  v_accvgpr_write_b32 a123, v28
  v_accvgpr_read_b32 v28, a124
  v_mul_f32_e64 v28, v28, v27
  v_accvgpr_write_b32 a124, v28
  v_accvgpr_read_b32 v28, a125
  v_mul_f32_e64 v28, v28, v27
  v_accvgpr_write_b32 a125, v28
  v_accvgpr_read_b32 v28, a126
  v_mul_f32_e64 v28, v28, v27
  v_accvgpr_write_b32 a126, v28
  v_accvgpr_read_b32 v28, a127
  v_mul_f32_e64 v28, v28, v27
  v_accvgpr_write_b32 a127, v28
  v_mov_b32 v240, 0
  v_mov_b32 v244, 0
  v_exp_f32 v28, v80
  v_exp_f32_e64 v29, v81
  s_nop 0
  v_cvt_pk_bf16_f32 v152, v28, v29
  v_exp_f32 v28, v82
  v_exp_f32_e64 v29, v83
  s_nop 0
  v_cvt_pk_bf16_f32 v153, v28, v29
  v_exp_f32 v28, v84
  v_exp_f32_e64 v29, v85
  s_nop 0
  v_cvt_pk_bf16_f32 v154, v28, v29
  v_exp_f32 v28, v86
  v_exp_f32_e64 v29, v87
  s_nop 0
  v_cvt_pk_bf16_f32 v155, v28, v29
  v_exp_f32 v28, v88
  v_exp_f32_e64 v29, v89
  s_nop 0
  v_cvt_pk_bf16_f32 v156, v28, v29
  v_exp_f32 v28, v90
  v_exp_f32_e64 v29, v91
  s_nop 0
  v_cvt_pk_bf16_f32 v157, v28, v29
  v_exp_f32 v28, v92
  v_exp_f32_e64 v29, v93
  s_nop 0
  v_cvt_pk_bf16_f32 v158, v28, v29
  v_exp_f32 v28, v94
  v_exp_f32_e64 v29, v95
  s_nop 0
  v_cvt_pk_bf16_f32 v159, v28, v29
  s_nop 1
  v_mfma_f32_16x16x32_bf16 v[240:243], v[252:255], v[152:155], 0
  v_mfma_f32_16x16x32_bf16 v[244:247], v[252:255], v[156:159], 0
  s_nop 9
  s_nop 1
  s_setpc_b64 s[30:31]
Lslow21:
  s_nop 15
  v_max_f32 v24, v32, v33
  v_max_f32_e64 v25, v40, v41
  v_max3_f32 v24, v24, v34, v35
  v_max3_f32 v25, v25, v42, v43
  v_max3_f32 v24, v24, v36, v37
  v_max3_f32 v25, v25, v44, v45
  v_max3_f32 v24, v24, v38, v39
  v_max3_f32 v25, v25, v46, v47
  v_mov_b32 v26, v24
  v_mov_b32 v27, v25
  s_nop 0
  v_permlane16_swap_b32 v24, v26
  v_permlane16_swap_b32 v25, v27
  v_max_f32 v24, v24, v26
  v_max_f32 v25, v25, v27
  v_mov_b32 v26, v24
  v_mov_b32 v27, v25
  s_nop 0
  v_permlane32_swap_b32 v24, v26
  v_permlane32_swap_b32 v25, v27
  v_max_f32 v24, v24, v26
  v_max_f32 v25, v25, v27
  v_max_f32 v24, 0, v24
  v_sub_f32 v26, 0, v24
  v_exp_f32 v26, v26
  v_add_f32 v22, v22, v24
  v_max_f32 v25, 0, v25
  v_sub_f32 v27, 0, v25
  v_exp_f32 v27, v27
  v_add_f32 v23, v23, v25
  v_sub_f32 v96, v96, v24
  v_sub_f32 v97, v97, v24
  v_sub_f32 v98, v98, v24
  v_sub_f32 v99, v99, v24
  v_sub_f32 v100, v100, v24
  v_sub_f32 v101, v101, v24
  v_sub_f32 v102, v102, v24
  v_sub_f32 v103, v103, v24
  v_sub_f32 v104, v104, v25
  v_sub_f32 v105, v105, v25
  v_sub_f32 v106, v106, v25
  v_sub_f32 v107, v107, v25
  v_sub_f32 v108, v108, v25
  v_sub_f32 v109, v109, v25
  v_sub_f32 v110, v110, v25
  v_sub_f32 v111, v111, v25
  v_sub_f32 v32, v32, v24
  v_sub_f32 v33, v33, v24
  v_sub_f32 v34, v34, v24
  v_sub_f32 v35, v35, v24
  v_sub_f32 v36, v36, v24
  v_sub_f32 v37, v37, v24
  v_sub_f32 v38, v38, v24
  v_sub_f32 v39, v39, v24
  v_sub_f32 v40, v40, v25
  v_sub_f32 v41, v41, v25
  v_sub_f32 v42, v42, v25
  v_sub_f32 v43, v43, v25
  v_sub_f32 v44, v44, v25
  v_sub_f32 v45, v45, v25
  v_sub_f32 v46, v46, v25
  v_sub_f32 v47, v47, v25
  v_sub_f32 v48, v48, v24
  v_sub_f32 v49, v49, v24
  v_sub_f32 v50, v50, v24
  v_sub_f32 v51, v51, v24
  v_sub_f32 v52, v52, v24
  v_sub_f32 v53, v53, v24
  v_sub_f32 v54, v54, v24
  v_sub_f32 v55, v55, v24
  v_sub_f32 v56, v56, v25
  v_sub_f32 v57, v57, v25
  v_sub_f32 v58, v58, v25
  v_sub_f32 v59, v59, v25
  v_sub_f32 v60, v60, v25
  v_sub_f32 v61, v61, v25
  v_sub_f32 v62, v62, v25
  v_sub_f32 v63, v63, v25
  v_mul_f32 v20, v20, v26
  v_mul_f32 v21, v21, v27
  v_accvgpr_read_b32 v28, a128
  v_mul_f32_e64 v28, v28, v26
  v_accvgpr_write_b32 a128, v28
  v_accvgpr_read_b32 v28, a129
  v_mul_f32_e64 v28, v28, v26
  v_accvgpr_write_b32 a129, v28
  v_accvgpr_read_b32 v28, a130
  v_mul_f32_e64 v28, v28, v26
  v_accvgpr_write_b32 a130, v28
  v_accvgpr_read_b32 v28, a131
  v_mul_f32_e64 v28, v28, v26
  v_accvgpr_write_b32 a131, v28
  v_accvgpr_read_b32 v28, a132
  v_mul_f32_e64 v28, v28, v26
  v_accvgpr_write_b32 a132, v28
  v_accvgpr_read_b32 v28, a133
  v_mul_f32_e64 v28, v28, v26
  v_accvgpr_write_b32 a133, v28
  v_accvgpr_read_b32 v28, a134
  v_mul_f32_e64 v28, v28, v26
  v_accvgpr_write_b32 a134, v28
  v_accvgpr_read_b32 v28, a135
  v_mul_f32_e64 v28, v28, v26
  v_accvgpr_write_b32 a135, v28
  v_accvgpr_read_b32 v28, a136
  v_mul_f32_e64 v28, v28, v26
  v_accvgpr_write_b32 a136, v28
  v_accvgpr_read_b32 v28, a137
  v_mul_f32_e64 v28, v28, v26
  v_accvgpr_write_b32 a137, v28
  v_accvgpr_read_b32 v28, a138
  v_mul_f32_e64 v28, v28, v26
  v_accvgpr_write_b32 a138, v28
  v_accvgpr_read_b32 v28, a139
  v_mul_f32_e64 v28, v28, v26
  v_accvgpr_write_b32 a139, v28
  v_accvgpr_read_b32 v28, a140
  v_mul_f32_e64 v28, v28, v26
  v_accvgpr_write_b32 a140, v28
  v_accvgpr_read_b32 v28, a141
  v_mul_f32_e64 v28, v28, v26
  v_accvgpr_write_b32 a141, v28
  v_accvgpr_read_b32 v28, a142
  v_mul_f32_e64 v28, v28, v26
  v_accvgpr_write_b32 a142, v28
  v_accvgpr_read_b32 v28, a143
  v_mul_f32_e64 v28, v28, v26
  v_accvgpr_write_b32 a143, v28
  v_accvgpr_read_b32 v28, a144
  v_mul_f32_e64 v28, v28, v26
  v_accvgpr_write_b32 a144, v28
  v_accvgpr_read_b32 v28, a145
  v_mul_f32_e64 v28, v28, v26
  v_accvgpr_write_b32 a145, v28
  v_accvgpr_read_b32 v28, a146
  v_mul_f32_e64 v28, v28, v26
  v_accvgpr_write_b32 a146, v28
  v_accvgpr_read_b32 v28, a147
  v_mul_f32_e64 v28, v28, v26
  v_accvgpr_write_b32 a147, v28
  v_accvgpr_read_b32 v28, a148
  v_mul_f32_e64 v28, v28, v26
  v_accvgpr_write_b32 a148, v28
  v_accvgpr_read_b32 v28, a149
  v_mul_f32_e64 v28, v28, v26
  v_accvgpr_write_b32 a149, v28
  v_accvgpr_read_b32 v28, a150
  v_mul_f32_e64 v28, v28, v26
  v_accvgpr_write_b32 a150, v28
  v_accvgpr_read_b32 v28, a151
  v_mul_f32_e64 v28, v28, v26
  v_accvgpr_write_b32 a151, v28
  v_accvgpr_read_b32 v28, a152
  v_mul_f32_e64 v28, v28, v26
  v_accvgpr_write_b32 a152, v28
  v_accvgpr_read_b32 v28, a153
  v_mul_f32_e64 v28, v28, v26
  v_accvgpr_write_b32 a153, v28
  v_accvgpr_read_b32 v28, a154
  v_mul_f32_e64 v28, v28, v26
  v_accvgpr_write_b32 a154, v28
  v_accvgpr_read_b32 v28, a155
  v_mul_f32_e64 v28, v28, v26
  v_accvgpr_write_b32 a155, v28
  v_accvgpr_read_b32 v28, a156
  v_mul_f32_e64 v28, v28, v26
  v_accvgpr_write_b32 a156, v28
  v_accvgpr_read_b32 v28, a157
  v_mul_f32_e64 v28, v28, v26
  v_accvgpr_write_b32 a157, v28
  v_accvgpr_read_b32 v28, a158
  v_mul_f32_e64 v28, v28, v26
  v_accvgpr_write_b32 a158, v28
  v_accvgpr_read_b32 v28, a159
  v_mul_f32_e64 v28, v28, v26
  v_accvgpr_write_b32 a159, v28
  v_accvgpr_read_b32 v28, a160
  v_mul_f32_e64 v28, v28, v27
  v_accvgpr_write_b32 a160, v28
  v_accvgpr_read_b32 v28, a161
  v_mul_f32_e64 v28, v28, v27
  v_accvgpr_write_b32 a161, v28
  v_accvgpr_read_b32 v28, a162
  v_mul_f32_e64 v28, v28, v27
  v_accvgpr_write_b32 a162, v28
  v_accvgpr_read_b32 v28, a163
  v_mul_f32_e64 v28, v28, v27
  v_accvgpr_write_b32 a163, v28
  v_accvgpr_read_b32 v28, a164
  v_mul_f32_e64 v28, v28, v27
  v_accvgpr_write_b32 a164, v28
  v_accvgpr_read_b32 v28, a165
  v_mul_f32_e64 v28, v28, v27
  v_accvgpr_write_b32 a165, v28
  v_accvgpr_read_b32 v28, a166
  v_mul_f32_e64 v28, v28, v27
  v_accvgpr_write_b32 a166, v28
  v_accvgpr_read_b32 v28, a167
  v_mul_f32_e64 v28, v28, v27
  v_accvgpr_write_b32 a167, v28
  v_accvgpr_read_b32 v28, a168
  v_mul_f32_e64 v28, v28, v27
  v_accvgpr_write_b32 a168, v28
  v_accvgpr_read_b32 v28, a169
  v_mul_f32_e64 v28, v28, v27
  v_accvgpr_write_b32 a169, v28
  v_accvgpr_read_b32 v28, a170
  v_mul_f32_e64 v28, v28, v27
  v_accvgpr_write_b32 a170, v28
  v_accvgpr_read_b32 v28, a171
  v_mul_f32_e64 v28, v28, v27
  v_accvgpr_write_b32 a171, v28
  v_accvgpr_read_b32 v28, a172
  v_mul_f32_e64 v28, v28, v27
  v_accvgpr_write_b32 a172, v28
  v_accvgpr_read_b32 v28, a173
  v_mul_f32_e64 v28, v28, v27
  v_accvgpr_write_b32 a173, v28
  v_accvgpr_read_b32 v28, a174
  v_mul_f32_e64 v28, v28, v27
  v_accvgpr_write_b32 a174, v28
  v_accvgpr_read_b32 v28, a175
  v_mul_f32_e64 v28, v28, v27
  v_accvgpr_write_b32 a175, v28
  v_accvgpr_read_b32 v28, a176
  v_mul_f32_e64 v28, v28, v27
  v_accvgpr_write_b32 a176, v28
  v_accvgpr_read_b32 v28, a177
  v_mul_f32_e64 v28, v28, v27
  v_accvgpr_write_b32 a177, v28
  v_accvgpr_read_b32 v28, a178
  v_mul_f32_e64 v28, v28, v27
  v_accvgpr_write_b32 a178, v28
  v_accvgpr_read_b32 v28, a179
  v_mul_f32_e64 v28, v28, v27
  v_accvgpr_write_b32 a179, v28
  v_accvgpr_read_b32 v28, a180
  v_mul_f32_e64 v28, v28, v27
  v_accvgpr_write_b32 a180, v28
  v_accvgpr_read_b32 v28, a181
  v_mul_f32_e64 v28, v28, v27
  v_accvgpr_write_b32 a181, v28
  v_accvgpr_read_b32 v28, a182
  v_mul_f32_e64 v28, v28, v27
  v_accvgpr_write_b32 a182, v28
  v_accvgpr_read_b32 v28, a183
  v_mul_f32_e64 v28, v28, v27
  v_accvgpr_write_b32 a183, v28
  v_accvgpr_read_b32 v28, a184
  v_mul_f32_e64 v28, v28, v27
  v_accvgpr_write_b32 a184, v28
  v_accvgpr_read_b32 v28, a185
  v_mul_f32_e64 v28, v28, v27
  v_accvgpr_write_b32 a185, v28
  v_accvgpr_read_b32 v28, a186
  v_mul_f32_e64 v28, v28, v27
  v_accvgpr_write_b32 a186, v28
  v_accvgpr_read_b32 v28, a187
  v_mul_f32_e64 v28, v28, v27
  v_accvgpr_write_b32 a187, v28
  v_accvgpr_read_b32 v28, a188
  v_mul_f32_e64 v28, v28, v27
  v_accvgpr_write_b32 a188, v28
  v_accvgpr_read_b32 v28, a189
  v_mul_f32_e64 v28, v28, v27
  v_accvgpr_write_b32 a189, v28
  v_accvgpr_read_b32 v28, a190
  v_mul_f32_e64 v28, v28, v27
  v_accvgpr_write_b32 a190, v28
  v_accvgpr_read_b32 v28, a191
  v_mul_f32_e64 v28, v28, v27
  v_accvgpr_write_b32 a191, v28
  v_mov_b32 v248, 0
  v_mov_b32 v249, 0
  v_exp_f32 v28, v32
  v_exp_f32_e64 v29, v33
  s_nop 0
  v_cvt_pk_bf16_f32 v128, v28, v29
  v_exp_f32 v28, v34
  v_exp_f32_e64 v29, v35
  s_nop 0
  v_cvt_pk_bf16_f32 v129, v28, v29
  v_exp_f32 v28, v36
  v_exp_f32_e64 v29, v37
  s_nop 0
  v_cvt_pk_bf16_f32 v130, v28, v29
  v_exp_f32 v28, v38
  v_exp_f32_e64 v29, v39
  s_nop 0
  v_cvt_pk_bf16_f32 v131, v28, v29
  v_exp_f32 v28, v40
  v_exp_f32_e64 v29, v41
  s_nop 0
  v_cvt_pk_bf16_f32 v132, v28, v29
  v_exp_f32 v28, v42
  v_exp_f32_e64 v29, v43
  s_nop 0
  v_cvt_pk_bf16_f32 v133, v28, v29
  v_exp_f32 v28, v44
  v_exp_f32_e64 v29, v45
  s_nop 0
  v_cvt_pk_bf16_f32 v134, v28, v29
  v_exp_f32 v28, v46
  v_exp_f32_e64 v29, v47
  s_nop 0
  v_cvt_pk_bf16_f32 v135, v28, v29
  s_nop 1
  v_mfma_f32_16x16x32_bf16 v[240:243], v[252:255], v[128:131], 0
  v_mfma_f32_16x16x32_bf16 v[244:247], v[252:255], v[132:135], 0
  s_nop 9
  v_mov_b32 v248, v240
  v_mov_b32 v249, v244
  v_max_f32 v24, v64, v65
  v_max_f32 v25, v72, v73
  v_max3_f32 v24, v24, v66, v67
  v_max3_f32 v25, v25, v74, v75
  v_max3_f32 v24, v24, v68, v69
  v_max3_f32 v25, v25, v76, v77
  v_max3_f32 v24, v24, v70, v71
  v_max3_f32 v25, v25, v78, v79
  v_mov_b32 v26, v24
  v_mov_b32 v27, v25
  s_nop 0
  v_permlane16_swap_b32 v24, v26
  v_permlane16_swap_b32 v25, v27
  v_max_f32 v24, v24, v26
  v_max_f32 v25, v25, v27
  v_mov_b32 v26, v24
  v_mov_b32 v27, v25
  s_nop 0
  v_permlane32_swap_b32 v24, v26
  v_permlane32_swap_b32 v25, v27
  v_max_f32 v24, v24, v26
  v_max_f32 v25, v25, v27
  v_max_f32 v24, 0, v24
  v_sub_f32 v26, 0, v24
  v_exp_f32 v26, v26
  v_add_f32 v30, v30, v24
  v_max_f32 v25, 0, v25
  v_sub_f32 v27, 0, v25
  v_exp_f32 v27, v27
  v_add_f32 v31, v31, v25
  v_sub_f32 v112, v112, v24
  v_sub_f32 v113, v113, v24
  v_sub_f32 v114, v114, v24
  v_sub_f32 v115, v115, v24
  v_sub_f32 v116, v116, v24
  v_sub_f32 v117, v117, v24
  v_sub_f32 v118, v118, v24
  v_sub_f32 v119, v119, v24
  v_sub_f32 v120, v120, v25
  v_sub_f32 v121, v121, v25
  v_sub_f32 v122, v122, v25
  v_sub_f32 v123, v123, v25
  v_sub_f32 v124, v124, v25
  v_sub_f32 v125, v125, v25
  v_sub_f32 v126, v126, v25
  v_sub_f32 v127, v127, v25
  v_sub_f32 v64, v64, v24
  v_sub_f32 v65, v65, v24
  v_sub_f32 v66, v66, v24
  v_sub_f32 v67, v67, v24
  v_sub_f32 v68, v68, v24
  v_sub_f32 v69, v69, v24
  v_sub_f32 v70, v70, v24
  v_sub_f32 v71, v71, v24
  v_sub_f32 v72, v72, v25
  v_sub_f32 v73, v73, v25
  v_sub_f32 v74, v74, v25
  v_sub_f32 v75, v75, v25
  v_sub_f32 v76, v76, v25
  v_sub_f32 v77, v77, v25
  v_sub_f32 v78, v78, v25
  v_sub_f32 v79, v79, v25
  v_sub_f32 v80, v80, v24
  v_sub_f32 v81, v81, v24
  v_sub_f32 v82, v82, v24
  v_sub_f32 v83, v83, v24
  v_sub_f32 v84, v84, v24
  v_sub_f32 v85, v85, v24
  v_sub_f32 v86, v86, v24
  v_sub_f32 v87, v87, v24
  v_sub_f32 v88, v88, v25
  v_sub_f32 v89, v89, v25
  v_sub_f32 v90, v90, v25
  v_sub_f32 v91, v91, v25
  v_sub_f32 v92, v92, v25
  v_sub_f32 v93, v93, v25
  v_sub_f32 v94, v94, v25
  v_sub_f32 v95, v95, v25
  v_mul_f32 v16, v16, v26
  v_mul_f32 v17, v17, v27
  v_accvgpr_read_b32 v28, a64
  v_mul_f32_e64 v28, v28, v26
  v_accvgpr_write_b32 a64, v28
  v_accvgpr_read_b32 v28, a65
  v_mul_f32_e64 v28, v28, v26
  v_accvgpr_write_b32 a65, v28
  v_accvgpr_read_b32 v28, a66
  v_mul_f32_e64 v28, v28, v26
  v_accvgpr_write_b32 a66, v28
  v_accvgpr_read_b32 v28, a67
  v_mul_f32_e64 v28, v28, v26
  v_accvgpr_write_b32 a67, v28
  v_accvgpr_read_b32 v28, a68
  v_mul_f32_e64 v28, v28, v26
  v_accvgpr_write_b32 a68, v28
  v_accvgpr_read_b32 v28, a69
  v_mul_f32_e64 v28, v28, v26
  v_accvgpr_write_b32 a69, v28
  v_accvgpr_read_b32 v28, a70
  v_mul_f32_e64 v28, v28, v26
  v_accvgpr_write_b32 a70, v28
  v_accvgpr_read_b32 v28, a71
  v_mul_f32_e64 v28, v28, v26
  v_accvgpr_write_b32 a71, v28
  v_accvgpr_read_b32 v28, a72
  v_mul_f32_e64 v28, v28, v26
  v_accvgpr_write_b32 a72, v28
  v_accvgpr_read_b32 v28, a73
  v_mul_f32_e64 v28, v28, v26
  v_accvgpr_write_b32 a73, v28
  v_accvgpr_read_b32 v28, a74
  v_mul_f32_e64 v28, v28, v26
  v_accvgpr_write_b32 a74, v28
  v_accvgpr_read_b32 v28, a75
  v_mul_f32_e64 v28, v28, v26
  v_accvgpr_write_b32 a75, v28
  v_accvgpr_read_b32 v28, a76
  v_mul_f32_e64 v28, v28, v26
  v_accvgpr_write_b32 a76, v28
  v_accvgpr_read_b32 v28, a77
  v_mul_f32_e64 v28, v28, v26
  v_accvgpr_write_b32 a77, v28
  v_accvgpr_read_b32 v28, a78
  v_mul_f32_e64 v28, v28, v26
  v_accvgpr_write_b32 a78, v28
  v_accvgpr_read_b32 v28, a79
  v_mul_f32_e64 v28, v28, v26
  v_accvgpr_write_b32 a79, v28
  v_accvgpr_read_b32 v28, a80
  v_mul_f32_e64 v28, v28, v26
  v_accvgpr_write_b32 a80, v28
  v_accvgpr_read_b32 v28, a81
  v_mul_f32_e64 v28, v28, v26
  v_accvgpr_write_b32 a81, v28
  v_accvgpr_read_b32 v28, a82
  v_mul_f32_e64 v28, v28, v26
  v_accvgpr_write_b32 a82, v28
  v_accvgpr_read_b32 v28, a83
  v_mul_f32_e64 v28, v28, v26
  v_accvgpr_write_b32 a83, v28
  v_accvgpr_read_b32 v28, a84
  v_mul_f32_e64 v28, v28, v26
  v_accvgpr_write_b32 a84, v28
  v_accvgpr_read_b32 v28, a85
  v_mul_f32_e64 v28, v28, v26
  v_accvgpr_write_b32 a85, v28
  v_accvgpr_read_b32 v28, a86
  v_mul_f32_e64 v28, v28, v26
  v_accvgpr_write_b32 a86, v28
  v_accvgpr_read_b32 v28, a87
  v_mul_f32_e64 v28, v28, v26
  v_accvgpr_write_b32 a87, v28
  v_accvgpr_read_b32 v28, a88
  v_mul_f32_e64 v28, v28, v26
  v_accvgpr_write_b32 a88, v28
  v_accvgpr_read_b32 v28, a89
  v_mul_f32_e64 v28, v28, v26
  v_accvgpr_write_b32 a89, v28
  v_accvgpr_read_b32 v28, a90
  v_mul_f32_e64 v28, v28, v26
  v_accvgpr_write_b32 a90, v28
  v_accvgpr_read_b32 v28, a91
  v_mul_f32_e64 v28, v28, v26
  v_accvgpr_write_b32 a91, v28
  v_accvgpr_read_b32 v28, a92
  v_mul_f32_e64 v28, v28, v26
  v_accvgpr_write_b32 a92, v28
  v_accvgpr_read_b32 v28, a93
  v_mul_f32_e64 v28, v28, v26
  v_accvgpr_write_b32 a93, v28
  v_accvgpr_read_b32 v28, a94
  v_mul_f32_e64 v28, v28, v26
  v_accvgpr_write_b32 a94, v28
  v_accvgpr_read_b32 v28, a95
  v_mul_f32_e64 v28, v28, v26
  v_accvgpr_write_b32 a95, v28
  v_accvgpr_read_b32 v28, a96
  v_mul_f32_e64 v28, v28, v27
  v_accvgpr_write_b32 a96, v28
  v_accvgpr_read_b32 v28, a97
  v_mul_f32_e64 v28, v28, v27
  v_accvgpr_write_b32 a97, v28
  v_accvgpr_read_b32 v28, a98
  v_mul_f32_e64 v28, v28, v27
  v_accvgpr_write_b32 a98, v28
  v_accvgpr_read_b32 v28, a99
  v_mul_f32_e64 v28, v28, v27
  v_accvgpr_write_b32 a99, v28
  v_accvgpr_read_b32 v28, a100
  v_mul_f32_e64 v28, v28, v27
  v_accvgpr_write_b32 a100, v28
  v_accvgpr_read_b32 v28, a101
  v_mul_f32_e64 v28, v28, v27
  v_accvgpr_write_b32 a101, v28
  v_accvgpr_read_b32 v28, a102
  v_mul_f32_e64 v28, v28, v27
  v_accvgpr_write_b32 a102, v28
  v_accvgpr_read_b32 v28, a103
  v_mul_f32_e64 v28, v28, v27
  v_accvgpr_write_b32 a103, v28
  v_accvgpr_read_b32 v28, a104
  v_mul_f32_e64 v28, v28, v27
  v_accvgpr_write_b32 a104, v28
  v_accvgpr_read_b32 v28, a105
  v_mul_f32_e64 v28, v28, v27
  v_accvgpr_write_b32 a105, v28
  v_accvgpr_read_b32 v28, a106
  v_mul_f32_e64 v28, v28, v27
  v_accvgpr_write_b32 a106, v28
  v_accvgpr_read_b32 v28, a107
  v_mul_f32_e64 v28, v28, v27
  v_accvgpr_write_b32 a107, v28
  v_accvgpr_read_b32 v28, a108
  v_mul_f32_e64 v28, v28, v27
  v_accvgpr_write_b32 a108, v28
  v_accvgpr_read_b32 v28, a109
  v_mul_f32_e64 v28, v28, v27
  v_accvgpr_write_b32 a109, v28
  v_accvgpr_read_b32 v28, a110
  v_mul_f32_e64 v28, v28, v27
  v_accvgpr_write_b32 a110, v28
  v_accvgpr_read_b32 v28, a111
  v_mul_f32_e64 v28, v28, v27
  v_accvgpr_write_b32 a111, v28
  v_accvgpr_read_b32 v28, a112
  v_mul_f32_e64 v28, v28, v27
  v_accvgpr_write_b32 a112, v28
  v_accvgpr_read_b32 v28, a113
  v_mul_f32_e64 v28, v28, v27
  v_accvgpr_write_b32 a113, v28
  v_accvgpr_read_b32 v28, a114
  v_mul_f32_e64 v28, v28, v27
  v_accvgpr_write_b32 a114, v28
  v_accvgpr_read_b32 v28, a115
  v_mul_f32_e64 v28, v28, v27
  v_accvgpr_write_b32 a115, v28
  v_accvgpr_read_b32 v28, a116
  v_mul_f32_e64 v28, v28, v27
  v_accvgpr_write_b32 a116, v28
  v_accvgpr_read_b32 v28, a117
  v_mul_f32_e64 v28, v28, v27
  v_accvgpr_write_b32 a117, v28
  v_accvgpr_read_b32 v28, a118
  v_mul_f32_e64 v28, v28, v27
  v_accvgpr_write_b32 a118, v28
  v_accvgpr_read_b32 v28, a119
  v_mul_f32_e64 v28, v28, v27
  v_accvgpr_write_b32 a119, v28
  v_accvgpr_read_b32 v28, a120
  v_mul_f32_e64 v28, v28, v27
  v_accvgpr_write_b32 a120, v28
  v_accvgpr_read_b32 v28, a121
  v_mul_f32_e64 v28, v28, v27
  v_accvgpr_write_b32 a121, v28
  v_accvgpr_read_b32 v28, a122
  v_mul_f32_e64 v28, v28, v27
  v_accvgpr_write_b32 a122, v28
  v_accvgpr_read_b32 v28, a123
  v_mul_f32_e64 v28, v28, v27
  v_accvgpr_write_b32 a123, v28
  v_accvgpr_read_b32 v28, a124
  v_mul_f32_e64 v28, v28, v27
  v_accvgpr_write_b32 a124, v28
  v_accvgpr_read_b32 v28, a125
  v_mul_f32_e64 v28, v28, v27
  v_accvgpr_write_b32 a125, v28
  v_accvgpr_read_b32 v28, a126
  v_mul_f32_e64 v28, v28, v27
  v_accvgpr_write_b32 a126, v28
  v_accvgpr_read_b32 v28, a127
  v_mul_f32_e64 v28, v28, v27
  v_accvgpr_write_b32 a127, v28
  v_mov_b32 v240, 0
  v_mov_b32 v244, 0
  v_exp_f32 v28, v64
  v_exp_f32_e64 v29, v65
  s_nop 0
  v_cvt_pk_bf16_f32 v144, v28, v29
  v_exp_f32 v28, v66
  v_exp_f32_e64 v29, v67
  s_nop 0
  v_cvt_pk_bf16_f32 v145, v28, v29
  v_exp_f32 v28, v68
  v_exp_f32_e64 v29, v69
  s_nop 0
  v_cvt_pk_bf16_f32 v146, v28, v29
  v_exp_f32 v28, v70
  v_exp_f32_e64 v29, v71
  s_nop 0
  v_cvt_pk_bf16_f32 v147, v28, v29
  v_exp_f32 v28, v72
  v_exp_f32_e64 v29, v73
  s_nop 0
  v_cvt_pk_bf16_f32 v148, v28, v29
  v_exp_f32 v28, v74
  v_exp_f32_e64 v29, v75
  s_nop 0
  v_cvt_pk_bf16_f32 v149, v28, v29
  v_exp_f32 v28, v76
  v_exp_f32_e64 v29, v77
  s_nop 0
  v_cvt_pk_bf16_f32 v150, v28, v29
  v_exp_f32 v28, v78
  v_exp_f32_e64 v29, v79
  s_nop 0
  v_cvt_pk_bf16_f32 v151, v28, v29
  s_nop 1
  v_mfma_f32_16x16x32_bf16 v[240:243], v[252:255], v[144:147], 0
  v_mfma_f32_16x16x32_bf16 v[244:247], v[252:255], v[148:151], 0
  s_nop 9
  s_nop 1
  s_setpc_b64 s[30:31]

.section .rodata,"a"
.p2align 6
.amdhsa_kernel parallel_sum__compressed_kv_cla__moe_arch_mod__prompt_kernel
  .amdhsa_next_free_vgpr 512
  .amdhsa_next_free_sgpr 102
  .amdhsa_accum_offset 256
  .amdhsa_group_segment_fixed_size 0
  .amdhsa_kernarg_size 112
  .amdhsa_user_sgpr_count 2
  .amdhsa_user_sgpr_kernarg_segment_ptr 1
  .amdhsa_system_sgpr_workgroup_id_x 1
.end_amdhsa_kernel
```
